```python
import torch

def _softmax(x, axis=-1):
    return torch.softmax(x, dim=axis)

def _gelu(x):
    return torch.nn.functional.gelu(x, approximate='tanh')

def _silu(x):
    return torch.nn.functional.silu(x)

def _sigmoid(x):
    return torch.sigmoid(x)

def _layernorm(x, axis=-1, eps=1e-05):
    m = x.mean(dim=axis, keepdim=True)
    v = x.var(dim=axis, keepdim=True, unbiased=False)
    return (x - m) / torch.sqrt(v + eps)

def _scatter_add(tgt, idx, src, axis=0):
    return tgt.clone().index_add_(axis, idx, src)

def _segment_sum(src, seg, n):
    out = torch.zeros((n,) + src.shape[1:], dtype=src.dtype)
    return out.index_add_(0, seg, src)

def _pad(x, pw):
    flat = tuple((v for pair in reversed(pw) for v in pair))
    return torch.nn.functional.pad(x, flat)
kernel_name = 'adaLN_cond__mha_block_cached__glu_gated_reglu__prompt'

def setup_inputs():

    _w = lambda a: (lambda t: t.to(torch.bfloat16) if t.is_floating_point() else t)(torch.as_tensor(a))

    def _A_setup():
        B, Sq, D = (1, 2048, 576)
        H, Sk, Dh = (32, 2048, 128)
        return {'x': _w((lambda *s: torch.randn(*s, dtype=torch.bfloat16) * 0.05)(B, Sq, D)), 'k_cache': _w((lambda *s: torch.randn(*s, dtype=torch.bfloat16) * 1.6)(B, H, Sk, Dh)), 'v_cache': _w((lambda *s: torch.randn(*s, dtype=torch.bfloat16) * 0.8)(B, H, Sk, Dh)), 'wq': _w((lambda *s: torch.randn(*s, dtype=torch.bfloat16) * 1.6)(D, H * Dh) * D ** (-0.5)), 'wo': _w((lambda *s: torch.randn(*s, dtype=torch.bfloat16) * 0.8)(H * Dh, D) * (H * Dh) ** (-0.5))}
    _A_in = _A_setup()

    def _B_setup():
        B, S, D, F = (1, 2048, 576, 4608)
        return {'x': _w((lambda *s: torch.randn(*s, dtype=torch.bfloat16) * 0.05)(B, S, D)), 'W_gate': _w((lambda *s: torch.randn(*s, dtype=torch.bfloat16) * 0.4)(D, F) * (2.0 / D) ** 0.5), 'W_up': _w((lambda *s: torch.randn(*s, dtype=torch.bfloat16) * 0.4)(D, F) * (2.0 / D) ** 0.5), 'W_down': _w((lambda *s: torch.randn(*s, dtype=torch.bfloat16) * 0.4)(F, D) * (1.0 / F) ** 0.5)}
    _B_in = _B_setup()
    return {'A_x': _A_in['x'], 'A_k_cache': _A_in['k_cache'], 'A_v_cache': _A_in['v_cache'], 'A_wq': _A_in['wq'], 'A_wo': _A_in['wo'], 'B_x': _B_in['x'], 'B_W_gate': _B_in['W_gate'], 'B_W_up': _B_in['W_up'], 'B_W_down': _B_in['W_down'], 'c': _w((lambda *s: torch.randn(*s, dtype=torch.bfloat16) * 0.1)(1, 576) * 8.0), 'w_mod': _w((lambda *s: torch.randn(*s, dtype=torch.bfloat16) * 0.1)(576, 6 * 576) * 576 ** (-0.5) * 8.0)}

def reference(A_x, A_k_cache, A_v_cache, A_wq, A_wo, B_x, B_W_gate, B_W_up, B_W_down, c, w_mod):

    def _A_ref(x, k_cache, v_cache, wq, wo):
        B, Sq, D = x.shape
        H, Dh = (32, 128)
        q = (lambda x, *d: x.permute(*d))((x @ wq).reshape(B, Sq, H, Dh), 0, 2, 1, 3)
        scores = torch.einsum('bhqd,bhkd->bhqk', q, k_cache) * Dh ** (-0.5)
        p = _softmax(scores, axis=-1)
        o = torch.einsum('bhqk,bhkd->bhqd', p, v_cache)
        return (lambda x, *d: x.permute(*d))(o, 0, 2, 1, 3).reshape(B, Sq, H * Dh) @ wo

    def _B_ref(x, W_gate, W_up, W_down):
        gate = torch.einsum('bsd,df->bsf', x, W_gate)
        up = torch.einsum('bsd,df->bsf', x, W_up)
        gate = gate * (lambda x, dt: x.to(dt))(gate > 0, gate.dtype)
        h = gate * up
        return torch.einsum('bsf,fd->bsd', h, W_down)
    x = A_x
    mod = (_silu(c) @ w_mod).reshape(c.shape[0], 6, 1, -1)
    sa, ca, ga, sb, cb, gb = (mod[:, 0].clone(), mod[:, 1].clone(), mod[:, 2].clone(), mod[:, 3].clone(), mod[:, 4].clone(), mod[:, 5].clone())
    h = _layernorm(x, axis=-1) * (1 + ca) + sa
    x = x + ga * _A_ref(h, A_k_cache, A_v_cache, A_wq, A_wo)
    h = _layernorm(x, axis=-1) * (1 + cb) + sb
    x = x + gb * _B_ref(h, B_W_gate, B_W_up, B_W_down)
    return x
```

```asm
; @launch kernel=mod_kernel grid=(108,1,1) block=(256,1,1) lds=16384
; @launch kernel=ln1_kernel grid=(256,1,1) block=(256,1,1) lds=0
; @launch kernel=attn_kernel grid=(256,1,1) block=(256,1,1) lds=163840
; @launch kernel=oproj_kernel grid=(256,1,1) block=(256,1,1) lds=147456
; @launch kernel=glu_kernel grid=(256,1,1) block=(256,1,1) lds=147712
; @launch kernel=down_kernel grid=(256,1,1) block=(256,1,1) lds=147456
.amdgcn_target "amdgcn-amd-amdhsa--gfx950"
.text
.globl mod_kernel
.p2align 8
.type mod_kernel,@function
mod_kernel:

    s_cmp_ge_u32 s2, 108
    s_cbranch_scc1 mod_kernel_pf
    s_load_dwordx2 s[42:43], s[0:1], 96
    s_load_dwordx2 s[4:5], s[0:1], 72
    s_load_dwordx2 s[6:7], s[0:1], 80
    s_load_dwordx2 s[8:9], s[0:1], 104
    v_and_b32 v1, 3, v0
    v_lshrrev_b32 v2, 2, v0
    v_lshlrev_b32 v3, 1, v2
    s_mov_b32 s24, 6912
    v_mul_lo_u32 v4, v2, s24
    v_lshlrev_b32 v5, 4, v1
    v_add_u32 v4, v4, v5
    s_lshl_b32 s25, s2, 6
    v_add_u32 v4, s25, v4
    s_waitcnt lgkmcnt(0)
    s_mov_b32 s12, s4
    s_mov_b32 s13, s5
    s_mov_b32 s14, 0x480
    s_mov_b32 s15, 0x00020000
    s_mov_b32 s16, s6
    s_mov_b32 s17, s7
    s_mov_b32 s18, 0x3cc000
    s_mov_b32 s19, 0x00020000
    s_mov_b32 s20, s8
    s_mov_b32 s21, s9
    s_mov_b32 s22, 0x3600
    s_mov_b32 s23, 0x00020000
    s_mov_b32 s26, 0
    s_mov_b32 s27, 442368
    s_mov_b32 s28, 884736
    s_mov_b32 s29, 1327104
    s_mov_b32 s30, 1769472
    s_mov_b32 s31, 2211840
    s_mov_b32 s32, 2654208
    s_mov_b32 s33, 3096576
    s_mov_b32 s34, 3538944
    buffer_load_dwordx4 v[24:27], v4, s[16:19], s26 offen
    buffer_load_dwordx4 v[28:31], v4, s[16:19], s27 offen
    buffer_load_dwordx4 v[32:35], v4, s[16:19], s28 offen
    buffer_load_dwordx4 v[36:39], v4, s[16:19], s29 offen
    buffer_load_dwordx4 v[40:43], v4, s[16:19], s30 offen
    buffer_load_dwordx4 v[44:47], v4, s[16:19], s31 offen
    buffer_load_dwordx4 v[48:51], v4, s[16:19], s32 offen
    buffer_load_dwordx4 v[52:55], v4, s[16:19], s33 offen
    buffer_load_dwordx4 v[56:59], v4, s[16:19], s34 offen
    buffer_load_ushort v10, v3, s[12:15], 0 offen offset:0
    buffer_load_ushort v11, v3, s[12:15], 0 offen offset:128
    buffer_load_ushort v12, v3, s[12:15], 0 offen offset:256
    buffer_load_ushort v13, v3, s[12:15], 0 offen offset:384
    buffer_load_ushort v14, v3, s[12:15], 0 offen offset:512
    buffer_load_ushort v15, v3, s[12:15], 0 offen offset:640
    buffer_load_ushort v16, v3, s[12:15], 0 offen offset:768
    buffer_load_ushort v17, v3, s[12:15], 0 offen offset:896
    buffer_load_ushort v18, v3, s[12:15], 0 offen offset:1024
    v_mov_b32 v64, 0
    v_mov_b32 v65, 0
    v_mov_b32 v66, 0
    v_mov_b32 v67, 0
    v_mov_b32 v68, 0
    v_mov_b32 v69, 0
    v_mov_b32 v70, 0
    v_mov_b32 v71, 0
    s_waitcnt vmcnt(0)
    s_mov_b32 s36, 0xbfb8aa3b
    v_lshlrev_b32 v10, 16, v10
    v_mul_f32 v20, s36, v10
    v_exp_f32 v20, v20
    s_nop 0
    v_add_f32 v20, 1.0, v20
    v_rcp_f32 v20, v20
    s_nop 0
    v_mul_f32 v10, v10, v20
    v_cvt_pk_bf16_f32 v10, v10, v10
    v_lshlrev_b32 v10, 16, v10
    v_lshlrev_b32 v11, 16, v11
    v_mul_f32 v20, s36, v11
    v_exp_f32 v20, v20
    s_nop 0
    v_add_f32 v20, 1.0, v20
    v_rcp_f32 v20, v20
    s_nop 0
    v_mul_f32 v11, v11, v20
    v_cvt_pk_bf16_f32 v11, v11, v11
    v_lshlrev_b32 v11, 16, v11
    v_lshlrev_b32 v12, 16, v12
    v_mul_f32 v20, s36, v12
    v_exp_f32 v20, v20
    s_nop 0
    v_add_f32 v20, 1.0, v20
    v_rcp_f32 v20, v20
    s_nop 0
    v_mul_f32 v12, v12, v20
    v_cvt_pk_bf16_f32 v12, v12, v12
    v_lshlrev_b32 v12, 16, v12
    v_lshlrev_b32 v13, 16, v13
    v_mul_f32 v20, s36, v13
    v_exp_f32 v20, v20
    s_nop 0
    v_add_f32 v20, 1.0, v20
    v_rcp_f32 v20, v20
    s_nop 0
    v_mul_f32 v13, v13, v20
    v_cvt_pk_bf16_f32 v13, v13, v13
    v_lshlrev_b32 v13, 16, v13
    v_lshlrev_b32 v14, 16, v14
    v_mul_f32 v20, s36, v14
    v_exp_f32 v20, v20
    s_nop 0
    v_add_f32 v20, 1.0, v20
    v_rcp_f32 v20, v20
    s_nop 0
    v_mul_f32 v14, v14, v20
    v_cvt_pk_bf16_f32 v14, v14, v14
    v_lshlrev_b32 v14, 16, v14
    v_lshlrev_b32 v15, 16, v15
    v_mul_f32 v20, s36, v15
    v_exp_f32 v20, v20
    s_nop 0
    v_add_f32 v20, 1.0, v20
    v_rcp_f32 v20, v20
    s_nop 0
    v_mul_f32 v15, v15, v20
    v_cvt_pk_bf16_f32 v15, v15, v15
    v_lshlrev_b32 v15, 16, v15
    v_lshlrev_b32 v16, 16, v16
    v_mul_f32 v20, s36, v16
    v_exp_f32 v20, v20
    s_nop 0
    v_add_f32 v20, 1.0, v20
    v_rcp_f32 v20, v20
    s_nop 0
    v_mul_f32 v16, v16, v20
    v_cvt_pk_bf16_f32 v16, v16, v16
    v_lshlrev_b32 v16, 16, v16
    v_lshlrev_b32 v17, 16, v17
    v_mul_f32 v20, s36, v17
    v_exp_f32 v20, v20
    s_nop 0
    v_add_f32 v20, 1.0, v20
    v_rcp_f32 v20, v20
    s_nop 0
    v_mul_f32 v17, v17, v20
    v_cvt_pk_bf16_f32 v17, v17, v17
    v_lshlrev_b32 v17, 16, v17
    v_lshlrev_b32 v18, 16, v18
    v_mul_f32 v20, s36, v18
    v_exp_f32 v20, v20
    s_nop 0
    v_add_f32 v20, 1.0, v20
    v_rcp_f32 v20, v20
    s_nop 0
    v_mul_f32 v18, v18, v20
    v_cvt_pk_bf16_f32 v18, v18, v18
    v_lshlrev_b32 v18, 16, v18
    v_lshlrev_b32 v21, 16, v24
    v_and_b32 v22, 0xffff0000, v24
    v_fmac_f32 v64, v10, v21
    v_fmac_f32 v65, v10, v22
    v_lshlrev_b32 v21, 16, v25
    v_and_b32 v22, 0xffff0000, v25
    v_fmac_f32 v66, v10, v21
    v_fmac_f32 v67, v10, v22
    v_lshlrev_b32 v21, 16, v26
    v_and_b32 v22, 0xffff0000, v26
    v_fmac_f32 v68, v10, v21
    v_fmac_f32 v69, v10, v22
    v_lshlrev_b32 v21, 16, v27
    v_and_b32 v22, 0xffff0000, v27
    v_fmac_f32 v70, v10, v21
    v_fmac_f32 v71, v10, v22
    v_lshlrev_b32 v21, 16, v28
    v_and_b32 v22, 0xffff0000, v28
    v_fmac_f32 v64, v11, v21
    v_fmac_f32 v65, v11, v22
    v_lshlrev_b32 v21, 16, v29
    v_and_b32 v22, 0xffff0000, v29
    v_fmac_f32 v66, v11, v21
    v_fmac_f32 v67, v11, v22
    v_lshlrev_b32 v21, 16, v30
    v_and_b32 v22, 0xffff0000, v30
    v_fmac_f32 v68, v11, v21
    v_fmac_f32 v69, v11, v22
    v_lshlrev_b32 v21, 16, v31
    v_and_b32 v22, 0xffff0000, v31
    v_fmac_f32 v70, v11, v21
    v_fmac_f32 v71, v11, v22
    v_lshlrev_b32 v21, 16, v32
    v_and_b32 v22, 0xffff0000, v32
    v_fmac_f32 v64, v12, v21
    v_fmac_f32 v65, v12, v22
    v_lshlrev_b32 v21, 16, v33
    v_and_b32 v22, 0xffff0000, v33
    v_fmac_f32 v66, v12, v21
    v_fmac_f32 v67, v12, v22
    v_lshlrev_b32 v21, 16, v34
    v_and_b32 v22, 0xffff0000, v34
    v_fmac_f32 v68, v12, v21
    v_fmac_f32 v69, v12, v22
    v_lshlrev_b32 v21, 16, v35
    v_and_b32 v22, 0xffff0000, v35
    v_fmac_f32 v70, v12, v21
    v_fmac_f32 v71, v12, v22
    v_lshlrev_b32 v21, 16, v36
    v_and_b32 v22, 0xffff0000, v36
    v_fmac_f32 v64, v13, v21
    v_fmac_f32 v65, v13, v22
    v_lshlrev_b32 v21, 16, v37
    v_and_b32 v22, 0xffff0000, v37
    v_fmac_f32 v66, v13, v21
    v_fmac_f32 v67, v13, v22
    v_lshlrev_b32 v21, 16, v38
    v_and_b32 v22, 0xffff0000, v38
    v_fmac_f32 v68, v13, v21
    v_fmac_f32 v69, v13, v22
    v_lshlrev_b32 v21, 16, v39
    v_and_b32 v22, 0xffff0000, v39
    v_fmac_f32 v70, v13, v21
    v_fmac_f32 v71, v13, v22
    v_lshlrev_b32 v21, 16, v40
    v_and_b32 v22, 0xffff0000, v40
    v_fmac_f32 v64, v14, v21
    v_fmac_f32 v65, v14, v22
    v_lshlrev_b32 v21, 16, v41
    v_and_b32 v22, 0xffff0000, v41
    v_fmac_f32 v66, v14, v21
    v_fmac_f32 v67, v14, v22
    v_lshlrev_b32 v21, 16, v42
    v_and_b32 v22, 0xffff0000, v42
    v_fmac_f32 v68, v14, v21
    v_fmac_f32 v69, v14, v22
    v_lshlrev_b32 v21, 16, v43
    v_and_b32 v22, 0xffff0000, v43
    v_fmac_f32 v70, v14, v21
    v_fmac_f32 v71, v14, v22
    v_lshlrev_b32 v21, 16, v44
    v_and_b32 v22, 0xffff0000, v44
    v_fmac_f32 v64, v15, v21
    v_fmac_f32 v65, v15, v22
    v_lshlrev_b32 v21, 16, v45
    v_and_b32 v22, 0xffff0000, v45
    v_fmac_f32 v66, v15, v21
    v_fmac_f32 v67, v15, v22
    v_lshlrev_b32 v21, 16, v46
    v_and_b32 v22, 0xffff0000, v46
    v_fmac_f32 v68, v15, v21
    v_fmac_f32 v69, v15, v22
    v_lshlrev_b32 v21, 16, v47
    v_and_b32 v22, 0xffff0000, v47
    v_fmac_f32 v70, v15, v21
    v_fmac_f32 v71, v15, v22
    v_lshlrev_b32 v21, 16, v48
    v_and_b32 v22, 0xffff0000, v48
    v_fmac_f32 v64, v16, v21
    v_fmac_f32 v65, v16, v22
    v_lshlrev_b32 v21, 16, v49
    v_and_b32 v22, 0xffff0000, v49
    v_fmac_f32 v66, v16, v21
    v_fmac_f32 v67, v16, v22
    v_lshlrev_b32 v21, 16, v50
    v_and_b32 v22, 0xffff0000, v50
    v_fmac_f32 v68, v16, v21
    v_fmac_f32 v69, v16, v22
    v_lshlrev_b32 v21, 16, v51
    v_and_b32 v22, 0xffff0000, v51
    v_fmac_f32 v70, v16, v21
    v_fmac_f32 v71, v16, v22
    v_lshlrev_b32 v21, 16, v52
    v_and_b32 v22, 0xffff0000, v52
    v_fmac_f32 v64, v17, v21
    v_fmac_f32 v65, v17, v22
    v_lshlrev_b32 v21, 16, v53
    v_and_b32 v22, 0xffff0000, v53
    v_fmac_f32 v66, v17, v21
    v_fmac_f32 v67, v17, v22
    v_lshlrev_b32 v21, 16, v54
    v_and_b32 v22, 0xffff0000, v54
    v_fmac_f32 v68, v17, v21
    v_fmac_f32 v69, v17, v22
    v_lshlrev_b32 v21, 16, v55
    v_and_b32 v22, 0xffff0000, v55
    v_fmac_f32 v70, v17, v21
    v_fmac_f32 v71, v17, v22
    v_lshlrev_b32 v21, 16, v56
    v_and_b32 v22, 0xffff0000, v56
    v_fmac_f32 v64, v18, v21
    v_fmac_f32 v65, v18, v22
    v_lshlrev_b32 v21, 16, v57
    v_and_b32 v22, 0xffff0000, v57
    v_fmac_f32 v66, v18, v21
    v_fmac_f32 v67, v18, v22
    v_lshlrev_b32 v21, 16, v58
    v_and_b32 v22, 0xffff0000, v58
    v_fmac_f32 v68, v18, v21
    v_fmac_f32 v69, v18, v22
    v_lshlrev_b32 v21, 16, v59
    v_and_b32 v22, 0xffff0000, v59
    v_fmac_f32 v70, v18, v21
    v_fmac_f32 v71, v18, v22
    v_lshlrev_b32 v5, 7, v2
    v_lshlrev_b32 v6, 5, v1
    v_add_u32 v5, v5, v6
    ds_write_b128 v5, v[64:67]
    ds_write_b128 v5, v[68:71] offset:16
    s_waitcnt lgkmcnt(0)
    s_barrier
    v_and_b32 v6, 31, v0
    v_lshrrev_b32 v7, 5, v0
    v_lshlrev_b32 v8, 10, v7
    v_lshlrev_b32 v9, 2, v6
    v_add_u32 v8, v8, v9
    ds_read_b32 v24, v8 offset:0
    ds_read_b32 v25, v8 offset:128
    ds_read_b32 v26, v8 offset:256
    ds_read_b32 v27, v8 offset:384
    ds_read_b32 v28, v8 offset:512
    ds_read_b32 v29, v8 offset:640
    ds_read_b32 v30, v8 offset:768
    ds_read_b32 v31, v8 offset:896
    s_waitcnt lgkmcnt(6)
    v_add_f32 v24, v24, v25
    s_waitcnt lgkmcnt(5)
    v_add_f32 v24, v24, v26
    s_waitcnt lgkmcnt(4)
    v_add_f32 v24, v24, v27
    s_waitcnt lgkmcnt(3)
    v_add_f32 v24, v24, v28
    s_waitcnt lgkmcnt(2)
    v_add_f32 v24, v24, v29
    s_waitcnt lgkmcnt(1)
    v_add_f32 v24, v24, v30
    s_waitcnt lgkmcnt(0)
    v_add_f32 v24, v24, v31
    v_lshlrev_b32 v8, 7, v7
    v_add_u32 v8, v8, v9
    ds_write_b32 v8, v24 offset:8192
    s_waitcnt lgkmcnt(0)
    s_barrier
    ds_read_b32 v24, v9 offset:8192
    ds_read_b32 v25, v9 offset:8320
    ds_read_b32 v26, v9 offset:8448
    ds_read_b32 v27, v9 offset:8576
    ds_read_b32 v28, v9 offset:8704
    ds_read_b32 v29, v9 offset:8832
    ds_read_b32 v30, v9 offset:8960
    ds_read_b32 v31, v9 offset:9088
    s_waitcnt lgkmcnt(6)
    v_add_f32 v24, v24, v25
    s_waitcnt lgkmcnt(5)
    v_add_f32 v24, v24, v26
    s_waitcnt lgkmcnt(4)
    v_add_f32 v24, v24, v27
    s_waitcnt lgkmcnt(3)
    v_add_f32 v24, v24, v28
    s_waitcnt lgkmcnt(2)
    v_add_f32 v24, v24, v29
    s_waitcnt lgkmcnt(1)
    v_add_f32 v24, v24, v30
    s_waitcnt lgkmcnt(0)
    v_add_f32 v24, v24, v31
    v_cvt_pk_bf16_f32 v24, v24, v24
    v_lshlrev_b32 v24, 16, v24
    s_mul_i32 s37, s2, 3641
    s_lshr_b32 s37, s37, 16
    s_cmp_eq_u32 s37, 1
    s_cselect_b32 s38, 1, 0
    s_cmp_eq_u32 s37, 4
    s_cselect_b32 s38, 1, s38
    s_cmp_eq_u32 s38, 0
    s_cbranch_scc1 mod_kernel_noadd
    v_add_f32 v24, 1.0, v24
    v_cvt_pk_bf16_f32 v24, v24, v24
    v_lshlrev_b32 v24, 16, v24
mod_kernel_noadd:
    s_lshl_b32 s25, s2, 7
    v_add_u32 v9, s25, v9
    v_cmp_gt_u32 vcc, 32, v0
    s_and_saveexec_b64 s[40:41], vcc
    s_cbranch_execz mod_kernel_end
    buffer_store_dword v24, v9, s[20:23], 0 offen
mod_kernel_end:
    s_endpgm
mod_kernel_pf:
    s_sub_u32 s2, s2, 108
    s_cmp_ge_u32 s2, 144
    s_cbranch_scc1 mod_kernel_end
    s_load_dwordx2 s[4:5], s[0:1], 0
    v_lshlrev_b32 v1, 4, v0
    s_lshl_b32 s28, s2, 14
    s_waitcnt lgkmcnt(0)
    s_mov_b32 s12, s4
    s_mov_b32 s13, s5
    s_mov_b32 s14, 0x240000
    s_mov_b32 s15, 0x00020000
    buffer_load_dwordx4 v[4:7], v1, s[12:15], s28 offen
    s_add_u32 s28, s28, 4096
    buffer_load_dwordx4 v[4:7], v1, s[12:15], s28 offen
    s_add_u32 s28, s28, 4096
    buffer_load_dwordx4 v[4:7], v1, s[12:15], s28 offen
    s_add_u32 s28, s28, 4096
    buffer_load_dwordx4 v[4:7], v1, s[12:15], s28 offen
    s_add_u32 s28, s28, 4096
    s_endpgm
.globl ln1_kernel
.p2align 8
.type ln1_kernel,@function
ln1_kernel:

    s_and_b32 s64, s2, 7
    s_cmp_ge_u32 s2, 256
    s_cbranch_scc1 ln1_kernel_end
    s_load_dwordx2 s[4:5], s[0:1], 0
    s_load_dwordx2 s[6:7], s[0:1], 88
    s_load_dwordx2 s[8:9], s[0:1], 104
    v_and_b32 v1, 31, v0
    v_lshrrev_b32 v2, 5, v0
    s_lshl_b32 s3, s2, 3
    v_add_u32 v2, s3, v2
    s_movk_i32 s10, 1152
    v_mul_lo_u32 v3, v2, s10
    v_lshlrev_b32 v4, 2, v1
    v_add_u32 v3, v3, v4
    v_lshlrev_b32 v5, 1, v3
    v_lshlrev_b32 v6, 3, v1
    s_waitcnt lgkmcnt(0)
    s_mov_b32 s12, s8
    s_mov_b32 s13, s9
    s_mov_b32 s14, 0x3600
    s_mov_b32 s15, 0x00020000
    s_mov_b32 s16, s4
    s_mov_b32 s17, s5
    s_mov_b32 s18, 0x240000
    s_mov_b32 s19, 0x00020000
    buffer_load_dword v8, v3, s[16:19], 0 offen offset:0
    buffer_load_dword v9, v3, s[16:19], 0 offen offset:128
    buffer_load_dword v10, v3, s[16:19], 0 offen offset:256
    buffer_load_dword v11, v3, s[16:19], 0 offen offset:384
    buffer_load_dword v12, v3, s[16:19], 0 offen offset:512
    buffer_load_dword v13, v3, s[16:19], 0 offen offset:640
    buffer_load_dword v14, v3, s[16:19], 0 offen offset:768
    buffer_load_dword v15, v3, s[16:19], 0 offen offset:896
    buffer_load_dword v16, v3, s[16:19], 0 offen offset:1024
    s_mov_b32 s32, 2304
    buffer_load_dwordx2 v[116:117], v6, s[12:15], s32 offen offset:0
    buffer_load_dwordx2 v[118:119], v6, s[12:15], s32 offen offset:256
    buffer_load_dwordx2 v[120:121], v6, s[12:15], s32 offen offset:512
    buffer_load_dwordx2 v[122:123], v6, s[12:15], s32 offen offset:768
    buffer_load_dwordx2 v[124:125], v6, s[12:15], s32 offen offset:1024
    buffer_load_dwordx2 v[126:127], v6, s[12:15], s32 offen offset:1280
    buffer_load_dwordx2 v[128:129], v6, s[12:15], s32 offen offset:1536
    buffer_load_dwordx2 v[130:131], v6, s[12:15], s32 offen offset:1792
    buffer_load_dwordx2 v[132:133], v6, s[12:15], s32 offen offset:2048
    s_mov_b32 s32, 0
    buffer_load_dwordx2 v[136:137], v6, s[12:15], s32 offen offset:0
    buffer_load_dwordx2 v[138:139], v6, s[12:15], s32 offen offset:256
    buffer_load_dwordx2 v[140:141], v6, s[12:15], s32 offen offset:512
    buffer_load_dwordx2 v[142:143], v6, s[12:15], s32 offen offset:768
    buffer_load_dwordx2 v[144:145], v6, s[12:15], s32 offen offset:1024
    buffer_load_dwordx2 v[146:147], v6, s[12:15], s32 offen offset:1280
    buffer_load_dwordx2 v[148:149], v6, s[12:15], s32 offen offset:1536
    buffer_load_dwordx2 v[150:151], v6, s[12:15], s32 offen offset:1792
    buffer_load_dwordx2 v[152:153], v6, s[12:15], s32 offen offset:2048
    s_mov_b32 s40, s64
    s_lshr_b32 s41, s2, 3
    v_lshrrev_b32 v184, 6, v0
    v_and_b32 v185, 63, v0
    v_readfirstlane_b32 s42, v184
    s_lshl_b32 s41, s41, 2
    s_add_u32 s41, s41, s42
    s_load_dwordx2 s[44:45], s[0:1], 24
    s_load_dwordx4 s[48:51], s[0:1], 8
    v_lshlrev_b32 v186, 4, v185
    s_waitcnt lgkmcnt(0)
    s_mov_b32 s52, s44
    s_mov_b32 s53, s45
    s_mov_b32 s54, 0x480000
    s_mov_b32 s55, 0x00020000
    s_mov_b32 s56, s48
    s_mov_b32 s57, s49
    s_mov_b32 s58, 0x1000000
    s_mov_b32 s59, 0x00020000
    s_mov_b32 s60, s50
    s_mov_b32 s61, s51
    s_mov_b32 s62, 0x1000000
    s_mov_b32 s63, 0x00020000
    s_lshl_b32 s43, s40, 10
    s_add_u32 s46, s41, 0
    s_lshl_b32 s46, s46, 13
    s_add_u32 s46, s46, s43
    buffer_load_dwordx4 v[188:191], v186, s[52:55], s46 offen
    s_add_u32 s46, s41, 128
    s_lshl_b32 s46, s46, 13
    s_add_u32 s46, s46, s43
    buffer_load_dwordx4 v[188:191], v186, s[52:55], s46 offen
    s_add_u32 s46, s41, 256
    s_lshl_b32 s46, s46, 13
    s_add_u32 s46, s46, s43
    buffer_load_dwordx4 v[188:191], v186, s[52:55], s46 offen
    s_add_u32 s46, s41, 384
    s_lshl_b32 s46, s46, 13
    s_add_u32 s46, s46, s43
    buffer_load_dwordx4 v[188:191], v186, s[52:55], s46 offen
    s_add_u32 s46, s41, 512
    s_lshl_b32 s46, s46, 13
    s_add_u32 s46, s46, s43
    buffer_load_dwordx4 v[188:191], v186, s[52:55], s46 offen
    s_lshr_b32 s46, s41, 5
    s_lshl_b32 s47, s40, 2
    s_add_u32 s46, s46, s47
    s_lshl_b32 s46, s46, 19
    s_and_b32 s47, s41, 31
    s_lshl_b32 s47, s47, 10
    s_add_u32 s46, s46, s47
    buffer_load_dwordx4 v[188:191], v186, s[56:59], s46 offen
    buffer_load_dwordx4 v[188:191], v186, s[60:63], s46 offen
    s_waitcnt vmcnt(7)
    v_lshlrev_b32 v160, 16, v8
    v_and_b32 v161, 0xffff0000, v8
    v_lshlrev_b32 v162, 16, v9
    v_and_b32 v163, 0xffff0000, v9
    v_lshlrev_b32 v164, 16, v10
    v_and_b32 v165, 0xffff0000, v10
    v_lshlrev_b32 v166, 16, v11
    v_and_b32 v167, 0xffff0000, v11
    v_lshlrev_b32 v168, 16, v12
    v_and_b32 v169, 0xffff0000, v12
    v_lshlrev_b32 v170, 16, v13
    v_and_b32 v171, 0xffff0000, v13
    v_lshlrev_b32 v172, 16, v14
    v_and_b32 v173, 0xffff0000, v14
    v_lshlrev_b32 v174, 16, v15
    v_and_b32 v175, 0xffff0000, v15
    v_lshlrev_b32 v176, 16, v16
    v_and_b32 v177, 0xffff0000, v16
    v_add_f32 v180, v160, v161
    v_add_f32 v180, v180, v162
    v_add_f32 v180, v180, v163
    v_add_f32 v180, v180, v164
    v_add_f32 v180, v180, v165
    v_add_f32 v180, v180, v166
    v_add_f32 v180, v180, v167
    v_add_f32 v180, v180, v168
    v_add_f32 v180, v180, v169
    v_add_f32 v180, v180, v170
    v_add_f32 v180, v180, v171
    v_add_f32 v180, v180, v172
    v_add_f32 v180, v180, v173
    v_add_f32 v180, v180, v174
    v_add_f32 v180, v180, v175
    v_add_f32 v180, v180, v176
    v_add_f32 v180, v180, v177
    s_nop 1
    v_add_f32_dpp v180, v180, v180 quad_perm:[1,0,3,2] row_mask:0xf bank_mask:0xf
    s_nop 1
    v_add_f32_dpp v180, v180, v180 quad_perm:[2,3,0,1] row_mask:0xf bank_mask:0xf
    s_nop 1
    v_add_f32_dpp v180, v180, v180 row_half_mirror row_mask:0xf bank_mask:0xf
    s_nop 1
    v_add_f32_dpp v180, v180, v180 row_mirror row_mask:0xf bank_mask:0xf
    ds_swizzle_b32 v181, v180 offset:0x401F
    s_waitcnt lgkmcnt(0)
    v_add_f32 v180, v180, v181
    s_mov_b32 s33, 0x3ae38e39
    v_mul_f32 v180, s33, v180
    v_mov_b32 v182, 0
    v_sub_f32 v183, v160, v180
    v_fmac_f32 v182, v183, v183
    v_sub_f32 v183, v161, v180
    v_fmac_f32 v182, v183, v183
    v_sub_f32 v183, v162, v180
    v_fmac_f32 v182, v183, v183
    v_sub_f32 v183, v163, v180
    v_fmac_f32 v182, v183, v183
    v_sub_f32 v183, v164, v180
    v_fmac_f32 v182, v183, v183
    v_sub_f32 v183, v165, v180
    v_fmac_f32 v182, v183, v183
    v_sub_f32 v183, v166, v180
    v_fmac_f32 v182, v183, v183
    v_sub_f32 v183, v167, v180
    v_fmac_f32 v182, v183, v183
    v_sub_f32 v183, v168, v180
    v_fmac_f32 v182, v183, v183
    v_sub_f32 v183, v169, v180
    v_fmac_f32 v182, v183, v183
    v_sub_f32 v183, v170, v180
    v_fmac_f32 v182, v183, v183
    v_sub_f32 v183, v171, v180
    v_fmac_f32 v182, v183, v183
    v_sub_f32 v183, v172, v180
    v_fmac_f32 v182, v183, v183
    v_sub_f32 v183, v173, v180
    v_fmac_f32 v182, v183, v183
    v_sub_f32 v183, v174, v180
    v_fmac_f32 v182, v183, v183
    v_sub_f32 v183, v175, v180
    v_fmac_f32 v182, v183, v183
    v_sub_f32 v183, v176, v180
    v_fmac_f32 v182, v183, v183
    v_sub_f32 v183, v177, v180
    v_fmac_f32 v182, v183, v183
    s_nop 1
    v_add_f32_dpp v182, v182, v182 quad_perm:[1,0,3,2] row_mask:0xf bank_mask:0xf
    s_nop 1
    v_add_f32_dpp v182, v182, v182 quad_perm:[2,3,0,1] row_mask:0xf bank_mask:0xf
    s_nop 1
    v_add_f32_dpp v182, v182, v182 row_half_mirror row_mask:0xf bank_mask:0xf
    s_nop 1
    v_add_f32_dpp v182, v182, v182 row_mirror row_mask:0xf bank_mask:0xf
    ds_swizzle_b32 v181, v182 offset:0x401F
    s_waitcnt lgkmcnt(0)
    v_add_f32 v182, v182, v181
    v_mul_f32 v182, s33, v182
    v_cvt_pk_bf16_f32 v182, v182, v182
    v_lshlrev_b32 v182, 16, v182
    v_add_f32 v182, 0x3727c5ac, v182
    v_cvt_pk_bf16_f32 v182, v182, v182
    v_lshlrev_b32 v182, 16, v182
    v_sqrt_f32 v182, v182
    s_nop 0
    v_cvt_pk_bf16_f32 v182, v182, v182
    v_lshlrev_b32 v182, 16, v182
    v_rcp_f32 v182, v182
    v_cvt_pk_bf16_f32 v180, v180, v180
    v_lshlrev_b32 v180, 16, v180
    v_sub_f32 v160, v160, v180
    v_sub_f32 v161, v161, v180
    v_cvt_pk_bf16_f32 v7, v160, v161
    v_lshlrev_b32 v160, 16, v7
    v_and_b32 v161, 0xffff0000, v7
    v_mul_f32 v160, v160, v182
    v_mul_f32 v161, v161, v182
    v_cvt_pk_bf16_f32 v7, v160, v161
    v_lshlrev_b32 v160, 16, v7
    v_and_b32 v161, 0xffff0000, v7
    v_sub_f32 v162, v162, v180
    v_sub_f32 v163, v163, v180
    v_cvt_pk_bf16_f32 v7, v162, v163
    v_lshlrev_b32 v162, 16, v7
    v_and_b32 v163, 0xffff0000, v7
    v_mul_f32 v162, v162, v182
    v_mul_f32 v163, v163, v182
    v_cvt_pk_bf16_f32 v7, v162, v163
    v_lshlrev_b32 v162, 16, v7
    v_and_b32 v163, 0xffff0000, v7
    v_sub_f32 v164, v164, v180
    v_sub_f32 v165, v165, v180
    v_cvt_pk_bf16_f32 v7, v164, v165
    v_lshlrev_b32 v164, 16, v7
    v_and_b32 v165, 0xffff0000, v7
    v_mul_f32 v164, v164, v182
    v_mul_f32 v165, v165, v182
    v_cvt_pk_bf16_f32 v7, v164, v165
    v_lshlrev_b32 v164, 16, v7
    v_and_b32 v165, 0xffff0000, v7
    v_sub_f32 v166, v166, v180
    v_sub_f32 v167, v167, v180
    v_cvt_pk_bf16_f32 v7, v166, v167
    v_lshlrev_b32 v166, 16, v7
    v_and_b32 v167, 0xffff0000, v7
    v_mul_f32 v166, v166, v182
    v_mul_f32 v167, v167, v182
    v_cvt_pk_bf16_f32 v7, v166, v167
    v_lshlrev_b32 v166, 16, v7
    v_and_b32 v167, 0xffff0000, v7
    v_sub_f32 v168, v168, v180
    v_sub_f32 v169, v169, v180
    v_cvt_pk_bf16_f32 v7, v168, v169
    v_lshlrev_b32 v168, 16, v7
    v_and_b32 v169, 0xffff0000, v7
    v_mul_f32 v168, v168, v182
    v_mul_f32 v169, v169, v182
    v_cvt_pk_bf16_f32 v7, v168, v169
    v_lshlrev_b32 v168, 16, v7
    v_and_b32 v169, 0xffff0000, v7
    v_sub_f32 v170, v170, v180
    v_sub_f32 v171, v171, v180
    v_cvt_pk_bf16_f32 v7, v170, v171
    v_lshlrev_b32 v170, 16, v7
    v_and_b32 v171, 0xffff0000, v7
    v_mul_f32 v170, v170, v182
    v_mul_f32 v171, v171, v182
    v_cvt_pk_bf16_f32 v7, v170, v171
    v_lshlrev_b32 v170, 16, v7
    v_and_b32 v171, 0xffff0000, v7
    v_sub_f32 v172, v172, v180
    v_sub_f32 v173, v173, v180
    v_cvt_pk_bf16_f32 v7, v172, v173
    v_lshlrev_b32 v172, 16, v7
    v_and_b32 v173, 0xffff0000, v7
    v_mul_f32 v172, v172, v182
    v_mul_f32 v173, v173, v182
    v_cvt_pk_bf16_f32 v7, v172, v173
    v_lshlrev_b32 v172, 16, v7
    v_and_b32 v173, 0xffff0000, v7
    v_sub_f32 v174, v174, v180
    v_sub_f32 v175, v175, v180
    v_cvt_pk_bf16_f32 v7, v174, v175
    v_lshlrev_b32 v174, 16, v7
    v_and_b32 v175, 0xffff0000, v7
    v_mul_f32 v174, v174, v182
    v_mul_f32 v175, v175, v182
    v_cvt_pk_bf16_f32 v7, v174, v175
    v_lshlrev_b32 v174, 16, v7
    v_and_b32 v175, 0xffff0000, v7
    v_sub_f32 v176, v176, v180
    v_sub_f32 v177, v177, v180
    v_cvt_pk_bf16_f32 v7, v176, v177
    v_lshlrev_b32 v176, 16, v7
    v_and_b32 v177, 0xffff0000, v7
    v_mul_f32 v176, v176, v182
    v_mul_f32 v177, v177, v182
    v_cvt_pk_bf16_f32 v7, v176, v177
    v_lshlrev_b32 v176, 16, v7
    v_and_b32 v177, 0xffff0000, v7
    v_mul_f32 v160, v160, v116
    v_mul_f32 v161, v161, v117
    v_cvt_pk_bf16_f32 v7, v160, v161
    v_lshlrev_b32 v160, 16, v7
    v_and_b32 v161, 0xffff0000, v7
    v_add_f32 v160, v160, v136
    v_add_f32 v161, v161, v137
    v_cvt_pk_bf16_f32 v20, v160, v161
    v_mul_f32 v162, v162, v118
    v_mul_f32 v163, v163, v119
    v_cvt_pk_bf16_f32 v7, v162, v163
    v_lshlrev_b32 v162, 16, v7
    v_and_b32 v163, 0xffff0000, v7
    v_add_f32 v162, v162, v138
    v_add_f32 v163, v163, v139
    v_cvt_pk_bf16_f32 v21, v162, v163
    v_mul_f32 v164, v164, v120
    v_mul_f32 v165, v165, v121
    v_cvt_pk_bf16_f32 v7, v164, v165
    v_lshlrev_b32 v164, 16, v7
    v_and_b32 v165, 0xffff0000, v7
    v_add_f32 v164, v164, v140
    v_add_f32 v165, v165, v141
    v_cvt_pk_bf16_f32 v22, v164, v165
    v_mul_f32 v166, v166, v122
    v_mul_f32 v167, v167, v123
    v_cvt_pk_bf16_f32 v7, v166, v167
    v_lshlrev_b32 v166, 16, v7
    v_and_b32 v167, 0xffff0000, v7
    v_add_f32 v166, v166, v142
    v_add_f32 v167, v167, v143
    v_cvt_pk_bf16_f32 v23, v166, v167
    v_mul_f32 v168, v168, v124
    v_mul_f32 v169, v169, v125
    v_cvt_pk_bf16_f32 v7, v168, v169
    v_lshlrev_b32 v168, 16, v7
    v_and_b32 v169, 0xffff0000, v7
    v_add_f32 v168, v168, v144
    v_add_f32 v169, v169, v145
    v_cvt_pk_bf16_f32 v24, v168, v169
    v_mul_f32 v170, v170, v126
    v_mul_f32 v171, v171, v127
    v_cvt_pk_bf16_f32 v7, v170, v171
    v_lshlrev_b32 v170, 16, v7
    v_and_b32 v171, 0xffff0000, v7
    v_add_f32 v170, v170, v146
    v_add_f32 v171, v171, v147
    v_cvt_pk_bf16_f32 v25, v170, v171
    v_mul_f32 v172, v172, v128
    v_mul_f32 v173, v173, v129
    v_cvt_pk_bf16_f32 v7, v172, v173
    v_lshlrev_b32 v172, 16, v7
    v_and_b32 v173, 0xffff0000, v7
    v_add_f32 v172, v172, v148
    v_add_f32 v173, v173, v149
    v_cvt_pk_bf16_f32 v26, v172, v173
    v_mul_f32 v174, v174, v130
    v_mul_f32 v175, v175, v131
    v_cvt_pk_bf16_f32 v7, v174, v175
    v_lshlrev_b32 v174, 16, v7
    v_and_b32 v175, 0xffff0000, v7
    v_add_f32 v174, v174, v150
    v_add_f32 v175, v175, v151
    v_cvt_pk_bf16_f32 v27, v174, v175
    v_mul_f32 v176, v176, v132
    v_mul_f32 v177, v177, v133
    v_cvt_pk_bf16_f32 v7, v176, v177
    v_lshlrev_b32 v176, 16, v7
    v_and_b32 v177, 0xffff0000, v7
    v_add_f32 v176, v176, v152
    v_add_f32 v177, v177, v153
    v_cvt_pk_bf16_f32 v28, v176, v177
    s_add_u32 s36, s8, 0x10000
    s_addc_u32 s37, s9, 0
    s_mov_b32 s38, 0x240000
    s_mov_b32 s39, 0x00020000
    buffer_store_dword v20, v3, s[36:39], 0 offen offset:0
    buffer_store_dword v21, v3, s[36:39], 0 offen offset:128
    buffer_store_dword v22, v3, s[36:39], 0 offen offset:256
    buffer_store_dword v23, v3, s[36:39], 0 offen offset:384
    buffer_store_dword v24, v3, s[36:39], 0 offen offset:512
    buffer_store_dword v25, v3, s[36:39], 0 offen offset:640
    buffer_store_dword v26, v3, s[36:39], 0 offen offset:768
    buffer_store_dword v27, v3, s[36:39], 0 offen offset:896
    buffer_store_dword v28, v3, s[36:39], 0 offen offset:1024
ln1_kernel_end:
    s_endpgm
.globl attn_kernel
.p2align 8
.type attn_kernel,@function
attn_kernel:

    s_cmp_ge_u32 s2, 256
    s_cbranch_scc1 attn_kernel_end
    s_load_dwordx2 s[4:5], s[0:1], 8
    s_load_dwordx2 s[6:7], s[0:1], 16
    s_load_dwordx2 s[8:9], s[0:1], 24
    s_load_dwordx2 s[10:11], s[0:1], 104
    s_load_dwordx4 s[64:67], s[0:1], 48
    s_load_dwordx2 s[68:69], s[0:1], 64
    s_load_dwordx2 s[70:71], s[0:1], 32
    v_lshrrev_b32 v212, 6, v0
    v_and_b32 v213, 63, v0
    v_readfirstlane_b32 s36, v212
    s_and_b32 s37, s2, 7
    s_lshl_b32 s37, s37, 2
    s_lshr_b32 s38, s2, 3
    s_and_b32 s38, s38, 3
    s_add_u32 s37, s37, s38
    s_lshr_b32 s38, s2, 5
    v_lshrrev_b32 v214, 3, v213
    s_movk_i32 s39, 1152
    v_mul_lo_u32 v214, v214, s39
    s_mul_i32 s40, s36, 73728
    v_add_u32 v214, s40, v214
    v_and_b32 v215, 7, v213
    v_lshrrev_b32 v216, 4, v213
    v_xor_b32 v217, v215, v216
    v_lshl_add_u32 v1, v217, 4, v214
    v_xor_b32 v217, 4, v217
    v_lshl_add_u32 v2, v217, 4, v214
    v_and_b32 v215, 15, v213
    v_lshlrev_b32 v217, 2, v216
    v_xor_b32 v217, v215, v217
    v_lshlrev_b32 v218, 4, v217
    v_lshl_add_u32 v218, v216, 13, v218
    s_lshl_b32 s40, s36, 17
    s_lshl_b32 s41, s37, 8
    s_add_u32 s40, s40, s41
    v_add_u32 v3, s40, v218
    v_lshlrev_b32 v218, 8, v216
    s_lshl_b32 s44, s36, 12
    v_add_u32 v218, s44, v218
    v_lshl_add_u32 v246, v217, 4, v218
    v_add_u32 v217, 0, v216
    v_xor_b32 v217, v217, v215
    v_lshl_add_u32 v242, v217, 4, v218
    v_add_u32 v217, 4, v216
    v_xor_b32 v217, v217, v215
    v_lshl_add_u32 v243, v217, 4, v218
    v_add_u32 v217, 8, v216
    v_xor_b32 v217, v217, v215
    v_lshl_add_u32 v244, v217, 4, v218
    v_add_u32 v217, 12, v216
    v_xor_b32 v217, v217, v215
    v_lshl_add_u32 v245, v217, 4, v218
    s_mov_b32 s52, 0
    s_mov_b32 s53, 8192
    s_mov_b32 s54, 16384
    s_mov_b32 s55, 24576
    s_mov_b32 s56, 36864
    s_mov_b32 s57, 45056
    s_mov_b32 s58, 53248
    s_mov_b32 s59, 61440
    s_mov_b32 s32, 0
    s_mov_b32 s33, 31744
    s_mov_b32 s34, 63488
    s_mov_b32 s35, 95232
    s_waitcnt lgkmcnt(0)
    s_lshl_b32 s40, s37, 19
    s_add_u32 s12, s4, s40
    s_addc_u32 s13, s5, 0
    s_mov_b32 s14, 0x80000
    s_mov_b32 s15, 0x00020000
    s_add_u32 s16, s6, s40
    s_addc_u32 s17, s7, 0
    s_mov_b32 s18, 0x80000
    s_mov_b32 s19, 0x00020000
    s_mul_i32 s40, s38, 294912
    s_add_u32 s40, s40, 0x10000
    s_add_u32 s20, s10, s40
    s_addc_u32 s21, s11, 0
    s_mov_b32 s22, 0x48000
    s_mov_b32 s23, 0x00020000
    s_mov_b32 s28, s8
    s_mov_b32 s29, s9
    s_mov_b32 s30, 0x480000
    s_mov_b32 s31, 0x00020000
    s_add_u32 s24, s10, 0x1300000
    s_addc_u32 s25, s11, 0
    s_mov_b32 s26, 0x1000000
    s_mov_b32 s27, 0x00020000
    s_mov_b32 s46, 0
    s_mov_b32 s47, 0
    s_mov_b32 s72, s64
    s_mov_b32 s73, s65
    s_mov_b32 s74, 0x510000
    s_mov_b32 s75, 0x00020000
    s_mov_b32 s76, s66
    s_mov_b32 s77, s67
    s_mov_b32 s78, 0x510000
    s_mov_b32 s79, 0x00020000
    s_mov_b32 s80, s68
    s_mov_b32 s81, s69
    s_mov_b32 s82, 0x510000
    s_mov_b32 s83, 0x00020000
    s_mov_b32 s84, s70
    s_mov_b32 s85, s71
    s_mov_b32 s86, 0x480000
    s_mov_b32 s87, 0x00020000
    s_lshl_b32 s49, s2, 2
    s_add_u32 s49, s49, s36
    s_mul_i32 s49, s49, 5184
    v_lshlrev_b32 v229, 4, v213
    s_add_u32 s45, s44, 65536
    s_lshl_b32 s42, s36, 13
    s_add_u32 s43, s44, 32768
    s_mov_b32 s88, s10
    s_mov_b32 s89, s11
    s_mov_b32 s90, 0x3600
    s_mov_b32 s91, 0x00020000
    s_lshl_b32 s40, s36, 11
    s_add_u32 m0, s40, 147456
    s_add_u32 m0, s42, 0
    s_nop 0
    buffer_load_dwordx4 v1, s[20:23], s52 offen offset:0 lds
    buffer_load_dwordx4 v2, s[20:23], s53 offen offset:1024 lds
    buffer_load_dwordx4 v1, s[20:23], s54 offen offset:2048 lds
    buffer_load_dwordx4 v2, s[20:23], s55 offen offset:3072 lds
    s_add_u32 m0, s42, 4096
    s_nop 0
    buffer_load_dwordx4 v1, s[20:23], s56 offen offset:0 lds
    buffer_load_dwordx4 v2, s[20:23], s57 offen offset:1024 lds
    buffer_load_dwordx4 v1, s[20:23], s58 offen offset:2048 lds
    buffer_load_dwordx4 v2, s[20:23], s59 offen offset:3072 lds
    s_add_u32 m0, s43, 0
    s_nop 0
    buffer_load_dwordx4 v3, s[28:31], s32 offen offset:0 lds
    buffer_load_dwordx4 v3, s[28:31], s33 offen offset:1024 lds
    buffer_load_dwordx4 v3, s[28:31], s34 offen offset:2048 lds
    buffer_load_dwordx4 v3, s[28:31], s35 offen offset:3072 lds
    s_add_u32 s20, s20, 128
    s_addc_u32 s21, s21, 0
    s_sub_u32 s22, s22, 128
    s_add_u32 s28, s28, 524288
    s_addc_u32 s29, s29, 0
    s_sub_u32 s30, s30, 524288
    s_add_u32 m0, s42, 49152
    s_nop 0
    buffer_load_dwordx4 v1, s[20:23], s52 offen offset:0 lds
    buffer_load_dwordx4 v2, s[20:23], s53 offen offset:1024 lds
    buffer_load_dwordx4 v1, s[20:23], s54 offen offset:2048 lds
    buffer_load_dwordx4 v2, s[20:23], s55 offen offset:3072 lds
    s_add_u32 m0, s42, 53248
    s_nop 0
    buffer_load_dwordx4 v1, s[20:23], s56 offen offset:0 lds
    buffer_load_dwordx4 v2, s[20:23], s57 offen offset:1024 lds
    buffer_load_dwordx4 v1, s[20:23], s58 offen offset:2048 lds
    buffer_load_dwordx4 v2, s[20:23], s59 offen offset:3072 lds
    s_add_u32 m0, s43, 49152
    s_nop 0
    buffer_load_dwordx4 v3, s[28:31], s32 offen offset:0 lds
    buffer_load_dwordx4 v3, s[28:31], s33 offen offset:1024 lds
    buffer_load_dwordx4 v3, s[28:31], s34 offen offset:2048 lds
    buffer_load_dwordx4 v3, s[28:31], s35 offen offset:3072 lds
    s_add_u32 s20, s20, 128
    s_addc_u32 s21, s21, 0
    s_sub_u32 s22, s22, 128
    s_add_u32 s28, s28, 524288
    s_addc_u32 s29, s29, 0
    s_sub_u32 s30, s30, 524288
    v_and_b32 v214, 31, v213
    v_lshrrev_b32 v216, 5, v213
    v_lshrrev_b32 v217, 1, v214
    v_and_b32 v217, 7, v217
    v_lshlrev_b32 v218, 7, v214
    v_add_u32 v218, s42, v218
    v_add_u32 v219, 0, v216
    v_xor_b32 v219, v219, v217
    v_lshl_add_u32 v219, v219, 4, v218
    v_add_u32 v4, 0, v219
    v_add_u32 v8, 49152, v219
    v_add_u32 v12, 98304, v219
    v_add_u32 v219, 2, v216
    v_xor_b32 v219, v219, v217
    v_lshl_add_u32 v219, v219, 4, v218
    v_add_u32 v5, 0, v219
    v_add_u32 v9, 49152, v219
    v_add_u32 v13, 98304, v219
    v_add_u32 v219, 4, v216
    v_xor_b32 v219, v219, v217
    v_lshl_add_u32 v219, v219, 4, v218
    v_add_u32 v6, 0, v219
    v_add_u32 v10, 49152, v219
    v_add_u32 v14, 98304, v219
    v_add_u32 v219, 6, v216
    v_xor_b32 v219, v219, v217
    v_lshl_add_u32 v219, v219, 4, v218
    v_add_u32 v7, 0, v219
    v_add_u32 v11, 49152, v219
    v_add_u32 v15, 98304, v219
    v_lshlrev_b32 v156, 5, v216
    v_add_u32 v156, 147456, v156
    v_lshlrev_b32 v217, 8, v214
    v_add_u32 v218, 0, v216
    v_xor_b32 v218, v218, v215
    v_lshl_add_u32 v218, v218, 4, v217
    v_add_u32 v230, 0, v218
    v_add_u32 v218, 2, v216
    v_xor_b32 v218, v218, v215
    v_lshl_add_u32 v218, v218, 4, v217
    v_add_u32 v231, 0, v218
    v_add_u32 v218, 4, v216
    v_xor_b32 v218, v218, v215
    v_lshl_add_u32 v218, v218, 4, v217
    v_add_u32 v232, 0, v218
    v_add_u32 v218, 6, v216
    v_xor_b32 v218, v218, v215
    v_lshl_add_u32 v218, v218, 4, v217
    v_add_u32 v233, 0, v218
    v_add_u32 v218, 8, v216
    v_xor_b32 v218, v218, v215
    v_lshl_add_u32 v218, v218, 4, v217
    v_add_u32 v234, 0, v218
    v_add_u32 v218, 10, v216
    v_xor_b32 v218, v218, v215
    v_lshl_add_u32 v218, v218, 4, v217
    v_add_u32 v235, 0, v218
    v_add_u32 v218, 12, v216
    v_xor_b32 v218, v218, v215
    v_lshl_add_u32 v218, v218, 4, v217
    v_add_u32 v236, 0, v218
    v_add_u32 v218, 14, v216
    v_xor_b32 v218, v218, v215
    v_lshl_add_u32 v218, v218, 4, v217
    v_add_u32 v237, 0, v218
    s_lshl_b32 s40, s36, 13
    s_add_u32 s40, s40, 131072
    v_add_u32 v253, s40, v217
    v_lshrrev_b32 v222, 4, v213
    v_lshlrev_b32 v223, 8, v222
    v_add_u32 v254, s40, v223
    s_lshl_b32 s40, s38, 8
    s_lshl_b32 s41, s36, 6
    s_add_u32 s40, s40, s41
    v_add_u32 v223, s40, v222
    v_lshlrev_b32 v223, 13, v223
    v_lshl_add_u32 v223, v215, 4, v223
    s_lshl_b32 s40, s37, 8
    v_add_u32 v255, s40, v223
    v_lshrrev_b32 v217, 2, v215
    v_lshrrev_b32 v219, 4, v213
    v_and_b32 v219, 1, v219
    v_lshlrev_b32 v219, 5, v219
    v_and_b32 v218, 3, v213
    v_lshl_add_u32 v219, v218, 3, v219
    v_lshl_add_u32 v218, v216, 2, v217
    v_lshl_add_u32 v222, v218, 8, v219
    v_add_u32 v222, 65536, v222
    v_lshl_add_u32 v218, v216, 3, v217
    v_lshl_add_u32 v223, v218, 8, v219
    v_xor_b32 v218, 0, v217
    v_lshl_add_u32 v238, v218, 6, v222
    v_lshl_add_u32 v218, v218, 6, v223
    v_add_u32 v144, 32768, v218
    v_add_u32 v148, 81920, v218
    v_add_u32 v152, 131072, v218
    v_xor_b32 v218, 1, v217
    v_lshl_add_u32 v239, v218, 6, v222
    v_lshl_add_u32 v218, v218, 6, v223
    v_add_u32 v145, 32768, v218
    v_add_u32 v149, 81920, v218
    v_add_u32 v153, 131072, v218
    v_xor_b32 v218, 2, v217
    v_lshl_add_u32 v240, v218, 6, v222
    v_lshl_add_u32 v218, v218, 6, v223
    v_add_u32 v146, 32768, v218
    v_add_u32 v150, 81920, v218
    v_add_u32 v154, 131072, v218
    v_xor_b32 v218, 3, v217
    v_lshl_add_u32 v241, v218, 6, v222
    v_lshl_add_u32 v218, v218, 6, v223
    v_add_u32 v147, 32768, v218
    v_add_u32 v151, 81920, v218
    v_add_u32 v155, 131072, v218
    v_accvgpr_write_b32 a0, 0
    v_accvgpr_write_b32 a1, 0
    v_accvgpr_write_b32 a2, 0
    v_accvgpr_write_b32 a3, 0
    v_accvgpr_write_b32 a4, 0
    v_accvgpr_write_b32 a5, 0
    v_accvgpr_write_b32 a6, 0
    v_accvgpr_write_b32 a7, 0
    v_accvgpr_write_b32 a8, 0
    v_accvgpr_write_b32 a9, 0
    v_accvgpr_write_b32 a10, 0
    v_accvgpr_write_b32 a11, 0
    v_accvgpr_write_b32 a12, 0
    v_accvgpr_write_b32 a13, 0
    v_accvgpr_write_b32 a14, 0
    v_accvgpr_write_b32 a15, 0
    v_accvgpr_write_b32 a16, 0
    v_accvgpr_write_b32 a17, 0
    v_accvgpr_write_b32 a18, 0
    v_accvgpr_write_b32 a19, 0
    v_accvgpr_write_b32 a20, 0
    v_accvgpr_write_b32 a21, 0
    v_accvgpr_write_b32 a22, 0
    v_accvgpr_write_b32 a23, 0
    v_accvgpr_write_b32 a24, 0
    v_accvgpr_write_b32 a25, 0
    v_accvgpr_write_b32 a26, 0
    v_accvgpr_write_b32 a27, 0
    v_accvgpr_write_b32 a28, 0
    v_accvgpr_write_b32 a29, 0
    v_accvgpr_write_b32 a30, 0
    v_accvgpr_write_b32 a31, 0
    v_accvgpr_write_b32 a32, 0
    v_accvgpr_write_b32 a33, 0
    v_accvgpr_write_b32 a34, 0
    v_accvgpr_write_b32 a35, 0
    v_accvgpr_write_b32 a36, 0
    v_accvgpr_write_b32 a37, 0
    v_accvgpr_write_b32 a38, 0
    v_accvgpr_write_b32 a39, 0
    v_accvgpr_write_b32 a40, 0
    v_accvgpr_write_b32 a41, 0
    v_accvgpr_write_b32 a42, 0
    v_accvgpr_write_b32 a43, 0
    v_accvgpr_write_b32 a44, 0
    v_accvgpr_write_b32 a45, 0
    v_accvgpr_write_b32 a46, 0
    v_accvgpr_write_b32 a47, 0
    v_accvgpr_write_b32 a48, 0
    v_accvgpr_write_b32 a49, 0
    v_accvgpr_write_b32 a50, 0
    v_accvgpr_write_b32 a51, 0
    v_accvgpr_write_b32 a52, 0
    v_accvgpr_write_b32 a53, 0
    v_accvgpr_write_b32 a54, 0
    v_accvgpr_write_b32 a55, 0
    v_accvgpr_write_b32 a56, 0
    v_accvgpr_write_b32 a57, 0
    v_accvgpr_write_b32 a58, 0
    v_accvgpr_write_b32 a59, 0
    v_accvgpr_write_b32 a60, 0
    v_accvgpr_write_b32 a61, 0
    v_accvgpr_write_b32 a62, 0
    v_accvgpr_write_b32 a63, 0
    v_accvgpr_write_b32 a64, 0
    v_accvgpr_write_b32 a65, 0
    v_accvgpr_write_b32 a66, 0
    v_accvgpr_write_b32 a67, 0
    v_accvgpr_write_b32 a68, 0
    v_accvgpr_write_b32 a69, 0
    v_accvgpr_write_b32 a70, 0
    v_accvgpr_write_b32 a71, 0
    v_accvgpr_write_b32 a72, 0
    v_accvgpr_write_b32 a73, 0
    v_accvgpr_write_b32 a74, 0
    v_accvgpr_write_b32 a75, 0
    v_accvgpr_write_b32 a76, 0
    v_accvgpr_write_b32 a77, 0
    v_accvgpr_write_b32 a78, 0
    v_accvgpr_write_b32 a79, 0
    v_accvgpr_write_b32 a80, 0
    v_accvgpr_write_b32 a81, 0
    v_accvgpr_write_b32 a82, 0
    v_accvgpr_write_b32 a83, 0
    v_accvgpr_write_b32 a84, 0
    v_accvgpr_write_b32 a85, 0
    v_accvgpr_write_b32 a86, 0
    v_accvgpr_write_b32 a87, 0
    v_accvgpr_write_b32 a88, 0
    v_accvgpr_write_b32 a89, 0
    v_accvgpr_write_b32 a90, 0
    v_accvgpr_write_b32 a91, 0
    v_accvgpr_write_b32 a92, 0
    v_accvgpr_write_b32 a93, 0
    v_accvgpr_write_b32 a94, 0
    v_accvgpr_write_b32 a95, 0
    v_accvgpr_write_b32 a96, 0
    v_accvgpr_write_b32 a97, 0
    v_accvgpr_write_b32 a98, 0
    v_accvgpr_write_b32 a99, 0
    v_accvgpr_write_b32 a100, 0
    v_accvgpr_write_b32 a101, 0
    v_accvgpr_write_b32 a102, 0
    v_accvgpr_write_b32 a103, 0
    v_accvgpr_write_b32 a104, 0
    v_accvgpr_write_b32 a105, 0
    v_accvgpr_write_b32 a106, 0
    v_accvgpr_write_b32 a107, 0
    v_accvgpr_write_b32 a108, 0
    v_accvgpr_write_b32 a109, 0
    v_accvgpr_write_b32 a110, 0
    v_accvgpr_write_b32 a111, 0
    v_accvgpr_write_b32 a112, 0
    v_accvgpr_write_b32 a113, 0
    v_accvgpr_write_b32 a114, 0
    v_accvgpr_write_b32 a115, 0
    v_accvgpr_write_b32 a116, 0
    v_accvgpr_write_b32 a117, 0
    v_accvgpr_write_b32 a118, 0
    v_accvgpr_write_b32 a119, 0
    v_accvgpr_write_b32 a120, 0
    v_accvgpr_write_b32 a121, 0
    v_accvgpr_write_b32 a122, 0
    v_accvgpr_write_b32 a123, 0
    v_accvgpr_write_b32 a124, 0
    v_accvgpr_write_b32 a125, 0
    v_accvgpr_write_b32 a126, 0
    v_accvgpr_write_b32 a127, 0
    v_accvgpr_write_b32 a224, 0
    v_accvgpr_write_b32 a225, 0
    v_accvgpr_write_b32 a226, 0
    v_accvgpr_write_b32 a227, 0
    v_accvgpr_write_b32 a228, 0
    v_accvgpr_write_b32 a229, 0
    v_accvgpr_write_b32 a230, 0
    v_accvgpr_write_b32 a231, 0
    v_accvgpr_write_b32 a232, 0
    v_accvgpr_write_b32 a233, 0
    v_accvgpr_write_b32 a234, 0
    v_accvgpr_write_b32 a235, 0
    v_accvgpr_write_b32 a236, 0
    v_accvgpr_write_b32 a237, 0
    v_accvgpr_write_b32 a238, 0
    v_accvgpr_write_b32 a239, 0
    v_accvgpr_write_b32 a240, 0
    v_accvgpr_write_b32 a241, 0
    v_accvgpr_write_b32 a242, 0
    v_accvgpr_write_b32 a243, 0
    v_accvgpr_write_b32 a244, 0
    v_accvgpr_write_b32 a245, 0
    v_accvgpr_write_b32 a246, 0
    v_accvgpr_write_b32 a247, 0
    v_accvgpr_write_b32 a248, 0
    v_accvgpr_write_b32 a249, 0
    v_accvgpr_write_b32 a250, 0
    v_accvgpr_write_b32 a251, 0
    v_accvgpr_write_b32 a252, 0
    v_accvgpr_write_b32 a253, 0
    v_accvgpr_write_b32 a254, 0
    v_accvgpr_write_b32 a255, 0
    s_waitcnt vmcnt(12)
    s_barrier
    ds_read_b128 v[160:163], v4 offset:0
    ds_read_b128 v[164:167], v4 offset:4096
    ds_read_b64_tr_b16 a[136:137], v144 offset:0
    ds_read_b64_tr_b16 a[138:139], v144 offset:1024
    ds_read_b64_tr_b16 a[140:141], v145 offset:0
    ds_read_b64_tr_b16 a[142:143], v145 offset:1024
    ds_read_b64_tr_b16 a[144:145], v146 offset:0
    ds_read_b64_tr_b16 a[146:147], v146 offset:1024
    ds_read_b64_tr_b16 a[148:149], v147 offset:0
    ds_read_b64_tr_b16 a[150:151], v147 offset:1024
    s_waitcnt lgkmcnt(6)
    v_mfma_f32_32x32x16_bf16 v[16:31], a[136:139], v[160:163], 0
    ds_read_b128 v[168:171], v5 offset:0
    ds_read_b128 v[172:175], v5 offset:4096
    ds_read_b64_tr_b16 a[160:161], v144 offset:4096
    v_mfma_f32_32x32x16_bf16 v[32:47], a[136:139], v[164:167], 0
    ds_read_b64_tr_b16 a[162:163], v144 offset:5120
    ds_read_b64_tr_b16 a[164:165], v145 offset:4096
    s_waitcnt lgkmcnt(9)
    v_mfma_f32_32x32x16_bf16 v[48:63], a[140:143], v[160:163], 0
    s_add_u32 m0, s42, 98304
    s_nop 0
    buffer_load_dwordx4 v1, s[20:23], s52 offen offset:0 lds
    v_mfma_f32_32x32x16_bf16 v[64:79], a[140:143], v[164:167], 0
    ds_read_b64_tr_b16 a[166:167], v145 offset:5120
    buffer_load_dwordx4 v2, s[20:23], s53 offen offset:1024 lds
    s_waitcnt lgkmcnt(8)
    v_mfma_f32_32x32x16_bf16 v[80:95], a[144:147], v[160:163], 0
    ds_read_b64_tr_b16 a[168:169], v146 offset:4096
    buffer_load_dwordx4 v1, s[20:23], s54 offen offset:2048 lds
    v_mfma_f32_32x32x16_bf16 v[96:111], a[144:147], v[164:167], 0
    ds_read_b64_tr_b16 a[170:171], v146 offset:5120
    buffer_load_dwordx4 v2, s[20:23], s55 offen offset:3072 lds
    s_waitcnt lgkmcnt(8)
    v_mfma_f32_32x32x16_bf16 v[112:127], a[148:151], v[160:163], 0
    ds_read_b64_tr_b16 a[172:173], v147 offset:4096
    s_add_u32 m0, s42, 102400
    v_mfma_f32_32x32x16_bf16 v[128:143], a[148:151], v[164:167], 0
    ds_read_b64_tr_b16 a[174:175], v147 offset:5120
    buffer_load_dwordx4 v1, s[20:23], s56 offen offset:0 lds
    s_waitcnt lgkmcnt(6)
    v_mfma_f32_32x32x16_bf16 v[16:31], a[160:163], v[168:171], v[16:31]
    ds_read_b128 v[160:163], v6 offset:0
    ds_read_b128 v[164:167], v6 offset:4096
    ds_read_b64_tr_b16 a[136:137], v144 offset:8192
    v_mfma_f32_32x32x16_bf16 v[32:47], a[160:163], v[172:175], v[32:47]
    ds_read_b64_tr_b16 a[138:139], v144 offset:9216
    ds_read_b64_tr_b16 a[140:141], v145 offset:8192
    s_waitcnt lgkmcnt(9)
    v_mfma_f32_32x32x16_bf16 v[48:63], a[164:167], v[168:171], v[48:63]
    buffer_load_dwordx4 v2, s[20:23], s57 offen offset:1024 lds
    buffer_load_dwordx4 v1, s[20:23], s58 offen offset:2048 lds
    v_mfma_f32_32x32x16_bf16 v[64:79], a[164:167], v[172:175], v[64:79]
    ds_read_b64_tr_b16 a[142:143], v145 offset:9216
    buffer_load_dwordx4 v2, s[20:23], s59 offen offset:3072 lds
    s_waitcnt lgkmcnt(8)
    v_mfma_f32_32x32x16_bf16 v[80:95], a[168:171], v[168:171], v[80:95]
    ds_read_b64_tr_b16 a[144:145], v146 offset:8192
    s_add_u32 m0, s43, 98304
    v_mfma_f32_32x32x16_bf16 v[96:111], a[168:171], v[172:175], v[96:111]
    ds_read_b64_tr_b16 a[146:147], v146 offset:9216
    buffer_load_dwordx4 v3, s[28:31], s32 offen offset:0 lds
    s_waitcnt lgkmcnt(8)
    v_mfma_f32_32x32x16_bf16 v[112:127], a[172:175], v[168:171], v[112:127]
    ds_read_b64_tr_b16 a[148:149], v147 offset:8192
    buffer_load_dwordx4 v3, s[28:31], s33 offen offset:1024 lds
    v_mfma_f32_32x32x16_bf16 v[128:143], a[172:175], v[172:175], v[128:143]
    ds_read_b64_tr_b16 a[150:151], v147 offset:9216
    buffer_load_dwordx4 v3, s[28:31], s34 offen offset:2048 lds
    s_waitcnt lgkmcnt(6)
    v_mfma_f32_32x32x16_bf16 v[16:31], a[136:139], v[160:163], v[16:31]
    ds_read_b128 v[168:171], v7 offset:0
    ds_read_b128 v[172:175], v7 offset:4096
    ds_read_b64_tr_b16 a[160:161], v144 offset:12288
    v_mfma_f32_32x32x16_bf16 v[32:47], a[136:139], v[164:167], v[32:47]
    ds_read_b64_tr_b16 a[162:163], v144 offset:13312
    ds_read_b64_tr_b16 a[164:165], v145 offset:12288
    s_waitcnt lgkmcnt(9)
    v_mfma_f32_32x32x16_bf16 v[48:63], a[140:143], v[160:163], v[48:63]
    buffer_load_dwordx4 v3, s[28:31], s35 offen offset:3072 lds
    s_add_u32 s20, s20, 128
    v_mfma_f32_32x32x16_bf16 v[64:79], a[140:143], v[164:167], v[64:79]
    ds_read_b64_tr_b16 a[166:167], v145 offset:13312
    s_addc_u32 s21, s21, 0
    s_waitcnt lgkmcnt(8)
    v_mfma_f32_32x32x16_bf16 v[80:95], a[144:147], v[160:163], v[80:95]
    ds_read_b64_tr_b16 a[168:169], v146 offset:12288
    s_sub_u32 s22, s22, 128
    v_mfma_f32_32x32x16_bf16 v[96:111], a[144:147], v[164:167], v[96:111]
    ds_read_b64_tr_b16 a[170:171], v146 offset:13312
    s_add_u32 s28, s28, 524288
    s_waitcnt lgkmcnt(8)
    v_mfma_f32_32x32x16_bf16 v[112:127], a[148:151], v[160:163], v[112:127]
    ds_read_b64_tr_b16 a[172:173], v147 offset:12288
    s_addc_u32 s29, s29, 0
    v_mfma_f32_32x32x16_bf16 v[128:143], a[148:151], v[164:167], v[128:143]
    ds_read_b64_tr_b16 a[174:175], v147 offset:13312
    s_sub_u32 s30, s30, 524288
    s_waitcnt lgkmcnt(0)
    v_mfma_f32_32x32x16_bf16 v[16:31], a[160:163], v[168:171], v[16:31]
    v_mfma_f32_32x32x16_bf16 v[32:47], a[160:163], v[172:175], v[32:47]
    s_waitcnt vmcnt(12)
    s_barrier
    v_mfma_f32_32x32x16_bf16 v[48:63], a[164:167], v[168:171], v[48:63]
    ds_read_b128 v[160:163], v8 offset:0
    ds_read_b128 v[164:167], v8 offset:4096
    ds_read_b64_tr_b16 a[136:137], v148 offset:0
    v_mfma_f32_32x32x16_bf16 v[64:79], a[164:167], v[172:175], v[64:79]
    ds_read_b64_tr_b16 a[138:139], v148 offset:1024
    ds_read_b64_tr_b16 a[140:141], v149 offset:0
    s_add_u32 m0, s42, 0
    v_mfma_f32_32x32x16_bf16 v[80:95], a[168:171], v[168:171], v[80:95]
    ds_read_b64_tr_b16 a[142:143], v149 offset:1024
    buffer_load_dwordx4 v1, s[20:23], s52 offen offset:0 lds
    v_mfma_f32_32x32x16_bf16 v[96:111], a[168:171], v[172:175], v[96:111]
    ds_read_b64_tr_b16 a[144:145], v150 offset:0
    buffer_load_dwordx4 v2, s[20:23], s53 offen offset:1024 lds
    ds_read_b64_tr_b16 a[146:147], v150 offset:1024
    v_mfma_f32_32x32x16_bf16 v[112:127], a[172:175], v[168:171], v[112:127]
    buffer_load_dwordx4 v1, s[20:23], s54 offen offset:2048 lds
    ds_read_b64_tr_b16 a[148:149], v151 offset:0
    buffer_load_dwordx4 v2, s[20:23], s55 offen offset:3072 lds
    v_mfma_f32_32x32x16_bf16 v[128:143], a[172:175], v[172:175], v[128:143]
    ds_read_b64_tr_b16 a[150:151], v151 offset:1024
    s_add_u32 m0, s42, 4096
    s_waitcnt lgkmcnt(6)
    v_mfma_f32_32x32x16_bf16 v[16:31], a[136:139], v[160:163], v[16:31]
    ds_read_b128 v[168:171], v9 offset:0
    ds_read_b128 v[172:175], v9 offset:4096
    v_mfma_f32_32x32x16_bf16 v[32:47], a[136:139], v[164:167], v[32:47]
    ds_read_b64_tr_b16 a[160:161], v148 offset:4096
    ds_read_b64_tr_b16 a[162:163], v148 offset:5120
    s_waitcnt lgkmcnt(8)
    v_mfma_f32_32x32x16_bf16 v[48:63], a[140:143], v[160:163], v[48:63]
    ds_read_b64_tr_b16 a[164:165], v149 offset:4096
    buffer_load_dwordx4 v1, s[20:23], s56 offen offset:0 lds
    v_mfma_f32_32x32x16_bf16 v[64:79], a[140:143], v[164:167], v[64:79]
    ds_read_b64_tr_b16 a[166:167], v149 offset:5120
    buffer_load_dwordx4 v2, s[20:23], s57 offen offset:1024 lds
    s_waitcnt lgkmcnt(8)
    v_mfma_f32_32x32x16_bf16 v[80:95], a[144:147], v[160:163], v[80:95]
    ds_read_b64_tr_b16 a[168:169], v150 offset:4096
    buffer_load_dwordx4 v1, s[20:23], s58 offen offset:2048 lds
    v_mfma_f32_32x32x16_bf16 v[96:111], a[144:147], v[164:167], v[96:111]
    ds_read_b64_tr_b16 a[170:171], v150 offset:5120
    buffer_load_dwordx4 v2, s[20:23], s59 offen offset:3072 lds
    s_waitcnt lgkmcnt(8)
    v_mfma_f32_32x32x16_bf16 v[112:127], a[148:151], v[160:163], v[112:127]
    ds_read_b64_tr_b16 a[172:173], v151 offset:4096
    s_add_u32 m0, s43, 0
    v_mfma_f32_32x32x16_bf16 v[128:143], a[148:151], v[164:167], v[128:143]
    ds_read_b64_tr_b16 a[174:175], v151 offset:5120
    s_waitcnt lgkmcnt(6)
    v_mfma_f32_32x32x16_bf16 v[16:31], a[160:163], v[168:171], v[16:31]
    ds_read_b128 v[160:163], v10 offset:0
    ds_read_b128 v[164:167], v10 offset:4096
    v_mfma_f32_32x32x16_bf16 v[32:47], a[160:163], v[172:175], v[32:47]
    ds_read_b64_tr_b16 a[136:137], v148 offset:8192
    ds_read_b64_tr_b16 a[138:139], v148 offset:9216
    s_waitcnt lgkmcnt(8)
    v_mfma_f32_32x32x16_bf16 v[48:63], a[164:167], v[168:171], v[48:63]
    ds_read_b64_tr_b16 a[140:141], v149 offset:8192
    buffer_load_dwordx4 v3, s[28:31], s32 offen offset:0 lds
    v_mfma_f32_32x32x16_bf16 v[64:79], a[164:167], v[172:175], v[64:79]
    ds_read_b64_tr_b16 a[142:143], v149 offset:9216
    buffer_load_dwordx4 v3, s[28:31], s33 offen offset:1024 lds
    s_waitcnt lgkmcnt(8)
    v_mfma_f32_32x32x16_bf16 v[80:95], a[168:171], v[168:171], v[80:95]
    ds_read_b64_tr_b16 a[144:145], v150 offset:8192
    buffer_load_dwordx4 v3, s[28:31], s34 offen offset:2048 lds
    v_mfma_f32_32x32x16_bf16 v[96:111], a[168:171], v[172:175], v[96:111]
    ds_read_b64_tr_b16 a[146:147], v150 offset:9216
    buffer_load_dwordx4 v3, s[28:31], s35 offen offset:3072 lds
    s_waitcnt lgkmcnt(8)
    v_mfma_f32_32x32x16_bf16 v[112:127], a[172:175], v[168:171], v[112:127]
    ds_read_b64_tr_b16 a[148:149], v151 offset:8192
    s_add_u32 s20, s20, 128
    v_mfma_f32_32x32x16_bf16 v[128:143], a[172:175], v[172:175], v[128:143]
    ds_read_b64_tr_b16 a[150:151], v151 offset:9216
    s_waitcnt lgkmcnt(6)
    v_mfma_f32_32x32x16_bf16 v[16:31], a[136:139], v[160:163], v[16:31]
    ds_read_b128 v[168:171], v11 offset:0
    ds_read_b128 v[172:175], v11 offset:4096
    v_mfma_f32_32x32x16_bf16 v[32:47], a[136:139], v[164:167], v[32:47]
    ds_read_b64_tr_b16 a[160:161], v148 offset:12288
    ds_read_b64_tr_b16 a[162:163], v148 offset:13312
    s_waitcnt lgkmcnt(8)
    v_mfma_f32_32x32x16_bf16 v[48:63], a[140:143], v[160:163], v[48:63]
    ds_read_b64_tr_b16 a[164:165], v149 offset:12288
    s_addc_u32 s21, s21, 0
    v_mfma_f32_32x32x16_bf16 v[64:79], a[140:143], v[164:167], v[64:79]
    ds_read_b64_tr_b16 a[166:167], v149 offset:13312
    s_sub_u32 s22, s22, 128
    s_waitcnt lgkmcnt(8)
    v_mfma_f32_32x32x16_bf16 v[80:95], a[144:147], v[160:163], v[80:95]
    ds_read_b64_tr_b16 a[168:169], v150 offset:12288
    s_add_u32 s28, s28, 524288
    v_mfma_f32_32x32x16_bf16 v[96:111], a[144:147], v[164:167], v[96:111]
    ds_read_b64_tr_b16 a[170:171], v150 offset:13312
    s_addc_u32 s29, s29, 0
    s_waitcnt lgkmcnt(8)
    v_mfma_f32_32x32x16_bf16 v[112:127], a[148:151], v[160:163], v[112:127]
    ds_read_b64_tr_b16 a[172:173], v151 offset:12288
    s_sub_u32 s30, s30, 524288
    v_mfma_f32_32x32x16_bf16 v[128:143], a[148:151], v[164:167], v[128:143]
    ds_read_b64_tr_b16 a[174:175], v151 offset:13312
    s_waitcnt lgkmcnt(0)
    v_mfma_f32_32x32x16_bf16 v[16:31], a[160:163], v[168:171], v[16:31]
    v_mfma_f32_32x32x16_bf16 v[32:47], a[160:163], v[172:175], v[32:47]
    s_waitcnt vmcnt(12)
    s_barrier
    v_mfma_f32_32x32x16_bf16 v[48:63], a[164:167], v[168:171], v[48:63]
    ds_read_b128 v[160:163], v12 offset:0
    ds_read_b128 v[164:167], v12 offset:4096
    ds_read_b64_tr_b16 a[136:137], v152 offset:0
    v_mfma_f32_32x32x16_bf16 v[64:79], a[164:167], v[172:175], v[64:79]
    ds_read_b64_tr_b16 a[138:139], v152 offset:1024
    ds_read_b64_tr_b16 a[140:141], v153 offset:0
    s_add_u32 m0, s42, 49152
    v_mfma_f32_32x32x16_bf16 v[80:95], a[168:171], v[168:171], v[80:95]
    ds_read_b64_tr_b16 a[142:143], v153 offset:1024
    buffer_load_dwordx4 v1, s[20:23], s52 offen offset:0 lds
    v_mfma_f32_32x32x16_bf16 v[96:111], a[168:171], v[172:175], v[96:111]
    ds_read_b64_tr_b16 a[144:145], v154 offset:0
    buffer_load_dwordx4 v2, s[20:23], s53 offen offset:1024 lds
    ds_read_b64_tr_b16 a[146:147], v154 offset:1024
    v_mfma_f32_32x32x16_bf16 v[112:127], a[172:175], v[168:171], v[112:127]
    buffer_load_dwordx4 v1, s[20:23], s54 offen offset:2048 lds
    ds_read_b64_tr_b16 a[148:149], v155 offset:0
    buffer_load_dwordx4 v2, s[20:23], s55 offen offset:3072 lds
    v_mfma_f32_32x32x16_bf16 v[128:143], a[172:175], v[172:175], v[128:143]
    ds_read_b64_tr_b16 a[150:151], v155 offset:1024
    s_add_u32 m0, s42, 53248
    s_waitcnt lgkmcnt(6)
    v_mfma_f32_32x32x16_bf16 v[16:31], a[136:139], v[160:163], v[16:31]
    ds_read_b128 v[168:171], v13 offset:0
    ds_read_b128 v[172:175], v13 offset:4096
    v_mfma_f32_32x32x16_bf16 v[32:47], a[136:139], v[164:167], v[32:47]
    ds_read_b64_tr_b16 a[160:161], v152 offset:4096
    ds_read_b64_tr_b16 a[162:163], v152 offset:5120
    s_waitcnt lgkmcnt(8)
    v_mfma_f32_32x32x16_bf16 v[48:63], a[140:143], v[160:163], v[48:63]
    ds_read_b64_tr_b16 a[164:165], v153 offset:4096
    buffer_load_dwordx4 v1, s[20:23], s56 offen offset:0 lds
    v_mfma_f32_32x32x16_bf16 v[64:79], a[140:143], v[164:167], v[64:79]
    ds_read_b64_tr_b16 a[166:167], v153 offset:5120
    buffer_load_dwordx4 v2, s[20:23], s57 offen offset:1024 lds
    s_waitcnt lgkmcnt(8)
    v_mfma_f32_32x32x16_bf16 v[80:95], a[144:147], v[160:163], v[80:95]
    ds_read_b64_tr_b16 a[168:169], v154 offset:4096
    buffer_load_dwordx4 v1, s[20:23], s58 offen offset:2048 lds
    v_mfma_f32_32x32x16_bf16 v[96:111], a[144:147], v[164:167], v[96:111]
    ds_read_b64_tr_b16 a[170:171], v154 offset:5120
    buffer_load_dwordx4 v2, s[20:23], s59 offen offset:3072 lds
    s_waitcnt lgkmcnt(8)
    v_mfma_f32_32x32x16_bf16 v[112:127], a[148:151], v[160:163], v[112:127]
    ds_read_b64_tr_b16 a[172:173], v155 offset:4096
    s_add_u32 m0, s43, 49152
    v_mfma_f32_32x32x16_bf16 v[128:143], a[148:151], v[164:167], v[128:143]
    ds_read_b64_tr_b16 a[174:175], v155 offset:5120
    s_waitcnt lgkmcnt(6)
    v_mfma_f32_32x32x16_bf16 v[16:31], a[160:163], v[168:171], v[16:31]
    ds_read_b128 v[160:163], v14 offset:0
    ds_read_b128 v[164:167], v14 offset:4096
    v_mfma_f32_32x32x16_bf16 v[32:47], a[160:163], v[172:175], v[32:47]
    ds_read_b64_tr_b16 a[136:137], v152 offset:8192
    ds_read_b64_tr_b16 a[138:139], v152 offset:9216
    s_waitcnt lgkmcnt(8)
    v_mfma_f32_32x32x16_bf16 v[48:63], a[164:167], v[168:171], v[48:63]
    ds_read_b64_tr_b16 a[140:141], v153 offset:8192
    buffer_load_dwordx4 v3, s[28:31], s32 offen offset:0 lds
    v_mfma_f32_32x32x16_bf16 v[64:79], a[164:167], v[172:175], v[64:79]
    ds_read_b64_tr_b16 a[142:143], v153 offset:9216
    buffer_load_dwordx4 v3, s[28:31], s33 offen offset:1024 lds
    s_waitcnt lgkmcnt(8)
    v_mfma_f32_32x32x16_bf16 v[80:95], a[168:171], v[168:171], v[80:95]
    ds_read_b64_tr_b16 a[144:145], v154 offset:8192
    buffer_load_dwordx4 v3, s[28:31], s34 offen offset:2048 lds
    v_mfma_f32_32x32x16_bf16 v[96:111], a[168:171], v[172:175], v[96:111]
    ds_read_b64_tr_b16 a[146:147], v154 offset:9216
    buffer_load_dwordx4 v3, s[28:31], s35 offen offset:3072 lds
    s_waitcnt lgkmcnt(8)
    v_mfma_f32_32x32x16_bf16 v[112:127], a[172:175], v[168:171], v[112:127]
    ds_read_b64_tr_b16 a[148:149], v155 offset:8192
    s_add_u32 s20, s20, 128
    v_mfma_f32_32x32x16_bf16 v[128:143], a[172:175], v[172:175], v[128:143]
    ds_read_b64_tr_b16 a[150:151], v155 offset:9216
    s_waitcnt lgkmcnt(6)
    v_mfma_f32_32x32x16_bf16 v[16:31], a[136:139], v[160:163], v[16:31]
    ds_read_b128 v[168:171], v15 offset:0
    ds_read_b128 v[172:175], v15 offset:4096
    v_mfma_f32_32x32x16_bf16 v[32:47], a[136:139], v[164:167], v[32:47]
    ds_read_b64_tr_b16 a[160:161], v152 offset:12288
    ds_read_b64_tr_b16 a[162:163], v152 offset:13312
    s_waitcnt lgkmcnt(8)
    v_mfma_f32_32x32x16_bf16 v[48:63], a[140:143], v[160:163], v[48:63]
    ds_read_b64_tr_b16 a[164:165], v153 offset:12288
    s_addc_u32 s21, s21, 0
    v_mfma_f32_32x32x16_bf16 v[64:79], a[140:143], v[164:167], v[64:79]
    ds_read_b64_tr_b16 a[166:167], v153 offset:13312
    s_sub_u32 s22, s22, 128
    s_waitcnt lgkmcnt(8)
    v_mfma_f32_32x32x16_bf16 v[80:95], a[144:147], v[160:163], v[80:95]
    ds_read_b64_tr_b16 a[168:169], v154 offset:12288
    s_add_u32 s28, s28, 524288
    v_mfma_f32_32x32x16_bf16 v[96:111], a[144:147], v[164:167], v[96:111]
    ds_read_b64_tr_b16 a[170:171], v154 offset:13312
    s_addc_u32 s29, s29, 0
    s_waitcnt lgkmcnt(8)
    v_mfma_f32_32x32x16_bf16 v[112:127], a[148:151], v[160:163], v[112:127]
    ds_read_b64_tr_b16 a[172:173], v155 offset:12288
    s_sub_u32 s30, s30, 524288
    v_mfma_f32_32x32x16_bf16 v[128:143], a[148:151], v[164:167], v[128:143]
    ds_read_b64_tr_b16 a[174:175], v155 offset:13312
    s_waitcnt lgkmcnt(0)
    v_mfma_f32_32x32x16_bf16 v[16:31], a[160:163], v[168:171], v[16:31]
    v_mfma_f32_32x32x16_bf16 v[32:47], a[160:163], v[172:175], v[32:47]
    s_waitcnt vmcnt(12)
    s_barrier
    v_mfma_f32_32x32x16_bf16 v[48:63], a[164:167], v[168:171], v[48:63]
    ds_read_b128 v[160:163], v4 offset:0
    ds_read_b128 v[164:167], v4 offset:4096
    ds_read_b64_tr_b16 a[136:137], v144 offset:0
    v_mfma_f32_32x32x16_bf16 v[64:79], a[164:167], v[172:175], v[64:79]
    ds_read_b64_tr_b16 a[138:139], v144 offset:1024
    ds_read_b64_tr_b16 a[140:141], v145 offset:0
    s_add_u32 m0, s42, 98304
    v_mfma_f32_32x32x16_bf16 v[80:95], a[168:171], v[168:171], v[80:95]
    ds_read_b64_tr_b16 a[142:143], v145 offset:1024
    buffer_load_dwordx4 v1, s[20:23], s52 offen offset:0 lds
    v_mfma_f32_32x32x16_bf16 v[96:111], a[168:171], v[172:175], v[96:111]
    ds_read_b64_tr_b16 a[144:145], v146 offset:0
    buffer_load_dwordx4 v2, s[20:23], s53 offen offset:1024 lds
    ds_read_b64_tr_b16 a[146:147], v146 offset:1024
    v_mfma_f32_32x32x16_bf16 v[112:127], a[172:175], v[168:171], v[112:127]
    buffer_load_dwordx4 v1, s[20:23], s54 offen offset:2048 lds
    ds_read_b64_tr_b16 a[148:149], v147 offset:0
    buffer_load_dwordx4 v2, s[20:23], s55 offen offset:3072 lds
    v_mfma_f32_32x32x16_bf16 v[128:143], a[172:175], v[172:175], v[128:143]
    ds_read_b64_tr_b16 a[150:151], v147 offset:1024
    s_add_u32 m0, s42, 102400
    s_waitcnt lgkmcnt(6)
    v_mfma_f32_32x32x16_bf16 v[16:31], a[136:139], v[160:163], v[16:31]
    ds_read_b128 v[168:171], v5 offset:0
    ds_read_b128 v[172:175], v5 offset:4096
    v_mfma_f32_32x32x16_bf16 v[32:47], a[136:139], v[164:167], v[32:47]
    ds_read_b64_tr_b16 a[160:161], v144 offset:4096
    ds_read_b64_tr_b16 a[162:163], v144 offset:5120
    s_waitcnt lgkmcnt(8)
    v_mfma_f32_32x32x16_bf16 v[48:63], a[140:143], v[160:163], v[48:63]
    ds_read_b64_tr_b16 a[164:165], v145 offset:4096
    buffer_load_dwordx4 v1, s[20:23], s56 offen offset:0 lds
    v_mfma_f32_32x32x16_bf16 v[64:79], a[140:143], v[164:167], v[64:79]
    ds_read_b64_tr_b16 a[166:167], v145 offset:5120
    buffer_load_dwordx4 v2, s[20:23], s57 offen offset:1024 lds
    s_waitcnt lgkmcnt(8)
    v_mfma_f32_32x32x16_bf16 v[80:95], a[144:147], v[160:163], v[80:95]
    ds_read_b64_tr_b16 a[168:169], v146 offset:4096
    buffer_load_dwordx4 v1, s[20:23], s58 offen offset:2048 lds
    v_mfma_f32_32x32x16_bf16 v[96:111], a[144:147], v[164:167], v[96:111]
    ds_read_b64_tr_b16 a[170:171], v146 offset:5120
    buffer_load_dwordx4 v2, s[20:23], s59 offen offset:3072 lds
    s_waitcnt lgkmcnt(8)
    v_mfma_f32_32x32x16_bf16 v[112:127], a[148:151], v[160:163], v[112:127]
    ds_read_b64_tr_b16 a[172:173], v147 offset:4096
    s_add_u32 m0, s43, 98304
    v_mfma_f32_32x32x16_bf16 v[128:143], a[148:151], v[164:167], v[128:143]
    ds_read_b64_tr_b16 a[174:175], v147 offset:5120
    s_waitcnt lgkmcnt(6)
    v_mfma_f32_32x32x16_bf16 v[16:31], a[160:163], v[168:171], v[16:31]
    ds_read_b128 v[160:163], v6 offset:0
    ds_read_b128 v[164:167], v6 offset:4096
    v_mfma_f32_32x32x16_bf16 v[32:47], a[160:163], v[172:175], v[32:47]
    ds_read_b64_tr_b16 a[136:137], v144 offset:8192
    ds_read_b64_tr_b16 a[138:139], v144 offset:9216
    s_waitcnt lgkmcnt(8)
    v_mfma_f32_32x32x16_bf16 v[48:63], a[164:167], v[168:171], v[48:63]
    ds_read_b64_tr_b16 a[140:141], v145 offset:8192
    buffer_load_dwordx4 v3, s[28:31], s32 offen offset:0 lds
    v_mfma_f32_32x32x16_bf16 v[64:79], a[164:167], v[172:175], v[64:79]
    ds_read_b64_tr_b16 a[142:143], v145 offset:9216
    buffer_load_dwordx4 v3, s[28:31], s33 offen offset:1024 lds
    s_waitcnt lgkmcnt(8)
    v_mfma_f32_32x32x16_bf16 v[80:95], a[168:171], v[168:171], v[80:95]
    ds_read_b64_tr_b16 a[144:145], v146 offset:8192
    buffer_load_dwordx4 v3, s[28:31], s34 offen offset:2048 lds
    v_mfma_f32_32x32x16_bf16 v[96:111], a[168:171], v[172:175], v[96:111]
    ds_read_b64_tr_b16 a[146:147], v146 offset:9216
    buffer_load_dwordx4 v3, s[28:31], s35 offen offset:3072 lds
    s_waitcnt lgkmcnt(8)
    v_mfma_f32_32x32x16_bf16 v[112:127], a[172:175], v[168:171], v[112:127]
    ds_read_b64_tr_b16 a[148:149], v147 offset:8192
    s_add_u32 s20, s20, 128
    v_mfma_f32_32x32x16_bf16 v[128:143], a[172:175], v[172:175], v[128:143]
    ds_read_b64_tr_b16 a[150:151], v147 offset:9216
    s_waitcnt lgkmcnt(6)
    v_mfma_f32_32x32x16_bf16 v[16:31], a[136:139], v[160:163], v[16:31]
    ds_read_b128 v[168:171], v7 offset:0
    ds_read_b128 v[172:175], v7 offset:4096
    v_mfma_f32_32x32x16_bf16 v[32:47], a[136:139], v[164:167], v[32:47]
    ds_read_b64_tr_b16 a[160:161], v144 offset:12288
    ds_read_b64_tr_b16 a[162:163], v144 offset:13312
    s_waitcnt lgkmcnt(8)
    v_mfma_f32_32x32x16_bf16 v[48:63], a[140:143], v[160:163], v[48:63]
    ds_read_b64_tr_b16 a[164:165], v145 offset:12288
    s_addc_u32 s21, s21, 0
    v_mfma_f32_32x32x16_bf16 v[64:79], a[140:143], v[164:167], v[64:79]
    ds_read_b64_tr_b16 a[166:167], v145 offset:13312
    s_sub_u32 s22, s22, 128
    s_waitcnt lgkmcnt(8)
    v_mfma_f32_32x32x16_bf16 v[80:95], a[144:147], v[160:163], v[80:95]
    ds_read_b64_tr_b16 a[168:169], v146 offset:12288
    s_add_u32 s28, s28, 524288
    v_mfma_f32_32x32x16_bf16 v[96:111], a[144:147], v[164:167], v[96:111]
    ds_read_b64_tr_b16 a[170:171], v146 offset:13312
    s_addc_u32 s29, s29, 0
    s_waitcnt lgkmcnt(8)
    v_mfma_f32_32x32x16_bf16 v[112:127], a[148:151], v[160:163], v[112:127]
    ds_read_b64_tr_b16 a[172:173], v147 offset:12288
    s_sub_u32 s30, s30, 524288
    v_mfma_f32_32x32x16_bf16 v[128:143], a[148:151], v[164:167], v[128:143]
    ds_read_b64_tr_b16 a[174:175], v147 offset:13312
    s_waitcnt lgkmcnt(0)
    v_mfma_f32_32x32x16_bf16 v[16:31], a[160:163], v[168:171], v[16:31]
    v_mfma_f32_32x32x16_bf16 v[32:47], a[160:163], v[172:175], v[32:47]
    s_waitcnt vmcnt(12)
    s_barrier
    v_mfma_f32_32x32x16_bf16 v[48:63], a[164:167], v[168:171], v[48:63]
    ds_read_b128 v[160:163], v8 offset:0
    ds_read_b128 v[164:167], v8 offset:4096
    ds_read_b64_tr_b16 a[136:137], v148 offset:0
    v_mfma_f32_32x32x16_bf16 v[64:79], a[164:167], v[172:175], v[64:79]
    ds_read_b64_tr_b16 a[138:139], v148 offset:1024
    ds_read_b64_tr_b16 a[140:141], v149 offset:0
    s_add_u32 m0, s42, 0
    v_mfma_f32_32x32x16_bf16 v[80:95], a[168:171], v[168:171], v[80:95]
    ds_read_b64_tr_b16 a[142:143], v149 offset:1024
    buffer_load_dwordx4 v1, s[20:23], s52 offen offset:0 lds
    v_mfma_f32_32x32x16_bf16 v[96:111], a[168:171], v[172:175], v[96:111]
    ds_read_b64_tr_b16 a[144:145], v150 offset:0
    buffer_load_dwordx4 v2, s[20:23], s53 offen offset:1024 lds
    ds_read_b64_tr_b16 a[146:147], v150 offset:1024
    v_mfma_f32_32x32x16_bf16 v[112:127], a[172:175], v[168:171], v[112:127]
    buffer_load_dwordx4 v1, s[20:23], s54 offen offset:2048 lds
    ds_read_b64_tr_b16 a[148:149], v151 offset:0
    buffer_load_dwordx4 v2, s[20:23], s55 offen offset:3072 lds
    v_mfma_f32_32x32x16_bf16 v[128:143], a[172:175], v[172:175], v[128:143]
    ds_read_b64_tr_b16 a[150:151], v151 offset:1024
    s_add_u32 m0, s42, 4096
    s_waitcnt lgkmcnt(6)
    v_mfma_f32_32x32x16_bf16 v[16:31], a[136:139], v[160:163], v[16:31]
    ds_read_b128 v[168:171], v9 offset:0
    ds_read_b128 v[172:175], v9 offset:4096
    v_mfma_f32_32x32x16_bf16 v[32:47], a[136:139], v[164:167], v[32:47]
    ds_read_b64_tr_b16 a[160:161], v148 offset:4096
    ds_read_b64_tr_b16 a[162:163], v148 offset:5120
    s_waitcnt lgkmcnt(8)
    v_mfma_f32_32x32x16_bf16 v[48:63], a[140:143], v[160:163], v[48:63]
    ds_read_b64_tr_b16 a[164:165], v149 offset:4096
    buffer_load_dwordx4 v1, s[20:23], s56 offen offset:0 lds
    v_mfma_f32_32x32x16_bf16 v[64:79], a[140:143], v[164:167], v[64:79]
    ds_read_b64_tr_b16 a[166:167], v149 offset:5120
    buffer_load_dwordx4 v2, s[20:23], s57 offen offset:1024 lds
    s_waitcnt lgkmcnt(8)
    v_mfma_f32_32x32x16_bf16 v[80:95], a[144:147], v[160:163], v[80:95]
    ds_read_b64_tr_b16 a[168:169], v150 offset:4096
    buffer_load_dwordx4 v1, s[20:23], s58 offen offset:2048 lds
    v_mfma_f32_32x32x16_bf16 v[96:111], a[144:147], v[164:167], v[96:111]
    ds_read_b64_tr_b16 a[170:171], v150 offset:5120
    buffer_load_dwordx4 v2, s[20:23], s59 offen offset:3072 lds
    s_waitcnt lgkmcnt(8)
    v_mfma_f32_32x32x16_bf16 v[112:127], a[148:151], v[160:163], v[112:127]
    ds_read_b64_tr_b16 a[172:173], v151 offset:4096
    s_add_u32 m0, s43, 0
    v_mfma_f32_32x32x16_bf16 v[128:143], a[148:151], v[164:167], v[128:143]
    ds_read_b64_tr_b16 a[174:175], v151 offset:5120
    s_waitcnt lgkmcnt(6)
    v_mfma_f32_32x32x16_bf16 v[16:31], a[160:163], v[168:171], v[16:31]
    ds_read_b128 v[160:163], v10 offset:0
    ds_read_b128 v[164:167], v10 offset:4096
    v_mfma_f32_32x32x16_bf16 v[32:47], a[160:163], v[172:175], v[32:47]
    ds_read_b64_tr_b16 a[136:137], v148 offset:8192
    ds_read_b64_tr_b16 a[138:139], v148 offset:9216
    s_waitcnt lgkmcnt(8)
    v_mfma_f32_32x32x16_bf16 v[48:63], a[164:167], v[168:171], v[48:63]
    ds_read_b64_tr_b16 a[140:141], v149 offset:8192
    buffer_load_dwordx4 v3, s[28:31], s32 offen offset:0 lds
    v_mfma_f32_32x32x16_bf16 v[64:79], a[164:167], v[172:175], v[64:79]
    ds_read_b64_tr_b16 a[142:143], v149 offset:9216
    buffer_load_dwordx4 v3, s[28:31], s33 offen offset:1024 lds
    s_waitcnt lgkmcnt(8)
    v_mfma_f32_32x32x16_bf16 v[80:95], a[168:171], v[168:171], v[80:95]
    ds_read_b64_tr_b16 a[144:145], v150 offset:8192
    buffer_load_dwordx4 v3, s[28:31], s34 offen offset:2048 lds
    v_mfma_f32_32x32x16_bf16 v[96:111], a[168:171], v[172:175], v[96:111]
    ds_read_b64_tr_b16 a[146:147], v150 offset:9216
    buffer_load_dwordx4 v3, s[28:31], s35 offen offset:3072 lds
    s_waitcnt lgkmcnt(8)
    v_mfma_f32_32x32x16_bf16 v[112:127], a[172:175], v[168:171], v[112:127]
    ds_read_b64_tr_b16 a[148:149], v151 offset:8192
    s_add_u32 s20, s20, 128
    v_mfma_f32_32x32x16_bf16 v[128:143], a[172:175], v[172:175], v[128:143]
    ds_read_b64_tr_b16 a[150:151], v151 offset:9216
    s_waitcnt lgkmcnt(6)
    v_mfma_f32_32x32x16_bf16 v[16:31], a[136:139], v[160:163], v[16:31]
    ds_read_b128 v[168:171], v11 offset:0
    ds_read_b128 v[172:175], v11 offset:4096
    v_mfma_f32_32x32x16_bf16 v[32:47], a[136:139], v[164:167], v[32:47]
    ds_read_b64_tr_b16 a[160:161], v148 offset:12288
    ds_read_b64_tr_b16 a[162:163], v148 offset:13312
    s_waitcnt lgkmcnt(8)
    v_mfma_f32_32x32x16_bf16 v[48:63], a[140:143], v[160:163], v[48:63]
    ds_read_b64_tr_b16 a[164:165], v149 offset:12288
    s_addc_u32 s21, s21, 0
    v_mfma_f32_32x32x16_bf16 v[64:79], a[140:143], v[164:167], v[64:79]
    ds_read_b64_tr_b16 a[166:167], v149 offset:13312
    s_sub_u32 s22, s22, 128
    s_waitcnt lgkmcnt(8)
    v_mfma_f32_32x32x16_bf16 v[80:95], a[144:147], v[160:163], v[80:95]
    ds_read_b64_tr_b16 a[168:169], v150 offset:12288
    s_add_u32 s28, s28, 524288
    v_mfma_f32_32x32x16_bf16 v[96:111], a[144:147], v[164:167], v[96:111]
    ds_read_b64_tr_b16 a[170:171], v150 offset:13312
    s_addc_u32 s29, s29, 0
    s_waitcnt lgkmcnt(8)
    v_mfma_f32_32x32x16_bf16 v[112:127], a[148:151], v[160:163], v[112:127]
    ds_read_b64_tr_b16 a[172:173], v151 offset:12288
    s_sub_u32 s30, s30, 524288
    v_mfma_f32_32x32x16_bf16 v[128:143], a[148:151], v[164:167], v[128:143]
    ds_read_b64_tr_b16 a[174:175], v151 offset:13312
    s_waitcnt lgkmcnt(0)
    v_mfma_f32_32x32x16_bf16 v[16:31], a[160:163], v[168:171], v[16:31]
    v_mfma_f32_32x32x16_bf16 v[32:47], a[160:163], v[172:175], v[32:47]
    s_waitcnt vmcnt(12)
    s_barrier
    v_mfma_f32_32x32x16_bf16 v[48:63], a[164:167], v[168:171], v[48:63]
    ds_read_b128 v[160:163], v12 offset:0
    ds_read_b128 v[164:167], v12 offset:4096
    ds_read_b64_tr_b16 a[136:137], v152 offset:0
    v_mfma_f32_32x32x16_bf16 v[64:79], a[164:167], v[172:175], v[64:79]
    ds_read_b64_tr_b16 a[138:139], v152 offset:1024
    ds_read_b64_tr_b16 a[140:141], v153 offset:0
    s_add_u32 m0, s42, 49152
    v_mfma_f32_32x32x16_bf16 v[80:95], a[168:171], v[168:171], v[80:95]
    ds_read_b64_tr_b16 a[142:143], v153 offset:1024
    buffer_load_dwordx4 v1, s[20:23], s52 offen offset:0 lds
    v_mfma_f32_32x32x16_bf16 v[96:111], a[168:171], v[172:175], v[96:111]
    ds_read_b64_tr_b16 a[144:145], v154 offset:0
    buffer_load_dwordx4 v2, s[20:23], s53 offen offset:1024 lds
    ds_read_b64_tr_b16 a[146:147], v154 offset:1024
    v_mfma_f32_32x32x16_bf16 v[112:127], a[172:175], v[168:171], v[112:127]
    buffer_load_dwordx4 v1, s[20:23], s54 offen offset:2048 lds
    ds_read_b64_tr_b16 a[148:149], v155 offset:0
    buffer_load_dwordx4 v2, s[20:23], s55 offen offset:3072 lds
    v_mfma_f32_32x32x16_bf16 v[128:143], a[172:175], v[172:175], v[128:143]
    ds_read_b64_tr_b16 a[150:151], v155 offset:1024
    s_add_u32 m0, s42, 53248
    s_waitcnt lgkmcnt(6)
    v_mfma_f32_32x32x16_bf16 v[16:31], a[136:139], v[160:163], v[16:31]
    ds_read_b128 v[168:171], v13 offset:0
    ds_read_b128 v[172:175], v13 offset:4096
    v_mfma_f32_32x32x16_bf16 v[32:47], a[136:139], v[164:167], v[32:47]
    ds_read_b64_tr_b16 a[160:161], v152 offset:4096
    ds_read_b64_tr_b16 a[162:163], v152 offset:5120
    s_waitcnt lgkmcnt(8)
    v_mfma_f32_32x32x16_bf16 v[48:63], a[140:143], v[160:163], v[48:63]
    ds_read_b64_tr_b16 a[164:165], v153 offset:4096
    buffer_load_dwordx4 v1, s[20:23], s56 offen offset:0 lds
    v_mfma_f32_32x32x16_bf16 v[64:79], a[140:143], v[164:167], v[64:79]
    ds_read_b64_tr_b16 a[166:167], v153 offset:5120
    buffer_load_dwordx4 v2, s[20:23], s57 offen offset:1024 lds
    s_waitcnt lgkmcnt(8)
    v_mfma_f32_32x32x16_bf16 v[80:95], a[144:147], v[160:163], v[80:95]
    ds_read_b64_tr_b16 a[168:169], v154 offset:4096
    buffer_load_dwordx4 v1, s[20:23], s58 offen offset:2048 lds
    v_mfma_f32_32x32x16_bf16 v[96:111], a[144:147], v[164:167], v[96:111]
    ds_read_b64_tr_b16 a[170:171], v154 offset:5120
    buffer_load_dwordx4 v2, s[20:23], s59 offen offset:3072 lds
    s_waitcnt lgkmcnt(8)
    v_mfma_f32_32x32x16_bf16 v[112:127], a[148:151], v[160:163], v[112:127]
    ds_read_b64_tr_b16 a[172:173], v155 offset:4096
    s_add_u32 m0, s43, 49152
    v_mfma_f32_32x32x16_bf16 v[128:143], a[148:151], v[164:167], v[128:143]
    ds_read_b64_tr_b16 a[174:175], v155 offset:5120
    s_waitcnt lgkmcnt(6)
    v_mfma_f32_32x32x16_bf16 v[16:31], a[160:163], v[168:171], v[16:31]
    ds_read_b128 v[160:163], v14 offset:0
    ds_read_b128 v[164:167], v14 offset:4096
    v_mfma_f32_32x32x16_bf16 v[32:47], a[160:163], v[172:175], v[32:47]
    ds_read_b64_tr_b16 a[136:137], v152 offset:8192
    ds_read_b64_tr_b16 a[138:139], v152 offset:9216
    s_waitcnt lgkmcnt(8)
    v_mfma_f32_32x32x16_bf16 v[48:63], a[164:167], v[168:171], v[48:63]
    ds_read_b64_tr_b16 a[140:141], v153 offset:8192
    buffer_load_dwordx4 v3, s[28:31], s32 offen offset:0 lds
    v_mfma_f32_32x32x16_bf16 v[64:79], a[164:167], v[172:175], v[64:79]
    ds_read_b64_tr_b16 a[142:143], v153 offset:9216
    buffer_load_dwordx4 v3, s[28:31], s33 offen offset:1024 lds
    s_waitcnt lgkmcnt(8)
    v_mfma_f32_32x32x16_bf16 v[80:95], a[168:171], v[168:171], v[80:95]
    ds_read_b64_tr_b16 a[144:145], v154 offset:8192
    buffer_load_dwordx4 v3, s[28:31], s34 offen offset:2048 lds
    v_mfma_f32_32x32x16_bf16 v[96:111], a[168:171], v[172:175], v[96:111]
    ds_read_b64_tr_b16 a[146:147], v154 offset:9216
    buffer_load_dwordx4 v3, s[28:31], s35 offen offset:3072 lds
    s_waitcnt lgkmcnt(8)
    v_mfma_f32_32x32x16_bf16 v[112:127], a[172:175], v[168:171], v[112:127]
    ds_read_b64_tr_b16 a[148:149], v155 offset:8192
    s_add_u32 s20, s20, 128
    v_mfma_f32_32x32x16_bf16 v[128:143], a[172:175], v[172:175], v[128:143]
    ds_read_b64_tr_b16 a[150:151], v155 offset:9216
    s_waitcnt lgkmcnt(6)
    v_mfma_f32_32x32x16_bf16 v[16:31], a[136:139], v[160:163], v[16:31]
    ds_read_b128 v[168:171], v15 offset:0
    ds_read_b128 v[172:175], v15 offset:4096
    v_mfma_f32_32x32x16_bf16 v[32:47], a[136:139], v[164:167], v[32:47]
    ds_read_b64_tr_b16 a[160:161], v152 offset:12288
    ds_read_b64_tr_b16 a[162:163], v152 offset:13312
    s_waitcnt lgkmcnt(8)
    v_mfma_f32_32x32x16_bf16 v[48:63], a[140:143], v[160:163], v[48:63]
    ds_read_b64_tr_b16 a[164:165], v153 offset:12288
    s_addc_u32 s21, s21, 0
    v_mfma_f32_32x32x16_bf16 v[64:79], a[140:143], v[164:167], v[64:79]
    ds_read_b64_tr_b16 a[166:167], v153 offset:13312
    s_sub_u32 s22, s22, 128
    s_waitcnt lgkmcnt(8)
    v_mfma_f32_32x32x16_bf16 v[80:95], a[144:147], v[160:163], v[80:95]
    ds_read_b64_tr_b16 a[168:169], v154 offset:12288
    s_add_u32 s28, s28, 524288
    v_mfma_f32_32x32x16_bf16 v[96:111], a[144:147], v[164:167], v[96:111]
    ds_read_b64_tr_b16 a[170:171], v154 offset:13312
    s_addc_u32 s29, s29, 0
    s_waitcnt lgkmcnt(8)
    v_mfma_f32_32x32x16_bf16 v[112:127], a[148:151], v[160:163], v[112:127]
    ds_read_b64_tr_b16 a[172:173], v155 offset:12288
    s_sub_u32 s30, s30, 524288
    v_mfma_f32_32x32x16_bf16 v[128:143], a[148:151], v[164:167], v[128:143]
    ds_read_b64_tr_b16 a[174:175], v155 offset:13312
    s_waitcnt lgkmcnt(0)
    v_mfma_f32_32x32x16_bf16 v[16:31], a[160:163], v[168:171], v[16:31]
    v_mfma_f32_32x32x16_bf16 v[32:47], a[160:163], v[172:175], v[32:47]
    s_waitcnt vmcnt(12)
    s_barrier
    v_mfma_f32_32x32x16_bf16 v[48:63], a[164:167], v[168:171], v[48:63]
    ds_read_b128 v[160:163], v4 offset:0
    ds_read_b128 v[164:167], v4 offset:4096
    ds_read_b64_tr_b16 a[136:137], v144 offset:0
    v_mfma_f32_32x32x16_bf16 v[64:79], a[164:167], v[172:175], v[64:79]
    ds_read_b64_tr_b16 a[138:139], v144 offset:1024
    ds_read_b64_tr_b16 a[140:141], v145 offset:0
    s_add_u32 m0, s42, 98304
    v_mfma_f32_32x32x16_bf16 v[80:95], a[168:171], v[168:171], v[80:95]
    ds_read_b64_tr_b16 a[142:143], v145 offset:1024
    buffer_load_dwordx4 v1, s[20:23], s52 offen offset:0 lds
    v_mfma_f32_32x32x16_bf16 v[96:111], a[168:171], v[172:175], v[96:111]
    ds_read_b64_tr_b16 a[144:145], v146 offset:0
    buffer_load_dwordx4 v2, s[20:23], s53 offen offset:1024 lds
    ds_read_b64_tr_b16 a[146:147], v146 offset:1024
    v_mfma_f32_32x32x16_bf16 v[112:127], a[172:175], v[168:171], v[112:127]
    buffer_load_dwordx4 v1, s[20:23], s54 offen offset:2048 lds
    ds_read_b64_tr_b16 a[148:149], v147 offset:0
    buffer_load_dwordx4 v2, s[20:23], s55 offen offset:3072 lds
    v_mfma_f32_32x32x16_bf16 v[128:143], a[172:175], v[172:175], v[128:143]
    ds_read_b64_tr_b16 a[150:151], v147 offset:1024
    s_add_u32 m0, s42, 102400
    s_waitcnt lgkmcnt(6)
    v_mfma_f32_32x32x16_bf16 v[16:31], a[136:139], v[160:163], v[16:31]
    ds_read_b128 v[168:171], v5 offset:0
    ds_read_b128 v[172:175], v5 offset:4096
    v_mfma_f32_32x32x16_bf16 v[32:47], a[136:139], v[164:167], v[32:47]
    ds_read_b64_tr_b16 a[160:161], v144 offset:4096
    ds_read_b64_tr_b16 a[162:163], v144 offset:5120
    s_waitcnt lgkmcnt(8)
    v_mfma_f32_32x32x16_bf16 v[48:63], a[140:143], v[160:163], v[48:63]
    ds_read_b64_tr_b16 a[164:165], v145 offset:4096
    buffer_load_dwordx4 v1, s[20:23], s56 offen offset:0 lds
    v_mfma_f32_32x32x16_bf16 v[64:79], a[140:143], v[164:167], v[64:79]
    ds_read_b64_tr_b16 a[166:167], v145 offset:5120
    buffer_load_dwordx4 v2, s[20:23], s57 offen offset:1024 lds
    s_waitcnt lgkmcnt(8)
    v_mfma_f32_32x32x16_bf16 v[80:95], a[144:147], v[160:163], v[80:95]
    ds_read_b64_tr_b16 a[168:169], v146 offset:4096
    buffer_load_dwordx4 v1, s[20:23], s58 offen offset:2048 lds
    v_mfma_f32_32x32x16_bf16 v[96:111], a[144:147], v[164:167], v[96:111]
    ds_read_b64_tr_b16 a[170:171], v146 offset:5120
    buffer_load_dwordx4 v2, s[20:23], s59 offen offset:3072 lds
    s_waitcnt lgkmcnt(8)
    v_mfma_f32_32x32x16_bf16 v[112:127], a[148:151], v[160:163], v[112:127]
    ds_read_b64_tr_b16 a[172:173], v147 offset:4096
    s_add_u32 m0, s43, 98304
    v_mfma_f32_32x32x16_bf16 v[128:143], a[148:151], v[164:167], v[128:143]
    ds_read_b64_tr_b16 a[174:175], v147 offset:5120
    s_waitcnt lgkmcnt(6)
    v_mfma_f32_32x32x16_bf16 v[16:31], a[160:163], v[168:171], v[16:31]
    ds_read_b128 v[160:163], v6 offset:0
    ds_read_b128 v[164:167], v6 offset:4096
    v_mfma_f32_32x32x16_bf16 v[32:47], a[160:163], v[172:175], v[32:47]
    ds_read_b64_tr_b16 a[136:137], v144 offset:8192
    ds_read_b64_tr_b16 a[138:139], v144 offset:9216
    s_waitcnt lgkmcnt(8)
    v_mfma_f32_32x32x16_bf16 v[48:63], a[164:167], v[168:171], v[48:63]
    ds_read_b64_tr_b16 a[140:141], v145 offset:8192
    buffer_load_dwordx4 v3, s[28:31], s32 offen offset:0 lds
    v_mfma_f32_32x32x16_bf16 v[64:79], a[164:167], v[172:175], v[64:79]
    ds_read_b64_tr_b16 a[142:143], v145 offset:9216
    buffer_load_dwordx4 v3, s[28:31], s33 offen offset:1024 lds
    s_waitcnt lgkmcnt(8)
    v_mfma_f32_32x32x16_bf16 v[80:95], a[168:171], v[168:171], v[80:95]
    ds_read_b64_tr_b16 a[144:145], v146 offset:8192
    buffer_load_dwordx4 v3, s[28:31], s34 offen offset:2048 lds
    v_mfma_f32_32x32x16_bf16 v[96:111], a[168:171], v[172:175], v[96:111]
    ds_read_b64_tr_b16 a[146:147], v146 offset:9216
    buffer_load_dwordx4 v3, s[28:31], s35 offen offset:3072 lds
    s_waitcnt lgkmcnt(8)
    v_mfma_f32_32x32x16_bf16 v[112:127], a[172:175], v[168:171], v[112:127]
    ds_read_b64_tr_b16 a[148:149], v147 offset:8192
    s_add_u32 s20, s20, 128
    v_mfma_f32_32x32x16_bf16 v[128:143], a[172:175], v[172:175], v[128:143]
    ds_read_b64_tr_b16 a[150:151], v147 offset:9216
    s_waitcnt lgkmcnt(6)
    v_mfma_f32_32x32x16_bf16 v[16:31], a[136:139], v[160:163], v[16:31]
    ds_read_b128 v[168:171], v7 offset:0
    ds_read_b128 v[172:175], v7 offset:4096
    v_mfma_f32_32x32x16_bf16 v[32:47], a[136:139], v[164:167], v[32:47]
    ds_read_b64_tr_b16 a[160:161], v144 offset:12288
    ds_read_b64_tr_b16 a[162:163], v144 offset:13312
    s_waitcnt lgkmcnt(8)
    v_mfma_f32_32x32x16_bf16 v[48:63], a[140:143], v[160:163], v[48:63]
    ds_read_b64_tr_b16 a[164:165], v145 offset:12288
    s_addc_u32 s21, s21, 0
    v_mfma_f32_32x32x16_bf16 v[64:79], a[140:143], v[164:167], v[64:79]
    ds_read_b64_tr_b16 a[166:167], v145 offset:13312
    s_sub_u32 s22, s22, 128
    s_waitcnt lgkmcnt(8)
    v_mfma_f32_32x32x16_bf16 v[80:95], a[144:147], v[160:163], v[80:95]
    ds_read_b64_tr_b16 a[168:169], v146 offset:12288
    s_add_u32 s28, s28, 524288
    v_mfma_f32_32x32x16_bf16 v[96:111], a[144:147], v[164:167], v[96:111]
    ds_read_b64_tr_b16 a[170:171], v146 offset:13312
    s_addc_u32 s29, s29, 0
    s_waitcnt lgkmcnt(8)
    v_mfma_f32_32x32x16_bf16 v[112:127], a[148:151], v[160:163], v[112:127]
    ds_read_b64_tr_b16 a[172:173], v147 offset:12288
    s_sub_u32 s30, s30, 524288
    v_mfma_f32_32x32x16_bf16 v[128:143], a[148:151], v[164:167], v[128:143]
    ds_read_b64_tr_b16 a[174:175], v147 offset:13312
    s_waitcnt lgkmcnt(0)
    v_mfma_f32_32x32x16_bf16 v[16:31], a[160:163], v[168:171], v[16:31]
    v_mfma_f32_32x32x16_bf16 v[32:47], a[160:163], v[172:175], v[32:47]
    s_waitcnt vmcnt(12)
    s_barrier
    v_mfma_f32_32x32x16_bf16 v[48:63], a[164:167], v[168:171], v[48:63]
    ds_read_b128 v[160:163], v8 offset:0
    ds_read_b128 v[164:167], v8 offset:4096
    ds_read_b64_tr_b16 a[136:137], v148 offset:0
    v_mfma_f32_32x32x16_bf16 v[64:79], a[164:167], v[172:175], v[64:79]
    ds_read_b64_tr_b16 a[138:139], v148 offset:1024
    ds_read_b64_tr_b16 a[140:141], v149 offset:0
    v_mfma_f32_32x32x16_bf16 v[80:95], a[168:171], v[168:171], v[80:95]
    s_add_u32 m0, s44, 0
    ds_read_b64_tr_b16 a[142:143], v149 offset:1024
    buffer_load_dwordx4 v242, s[12:15], s46 offen offset:0 lds
    v_mfma_f32_32x32x16_bf16 v[96:111], a[168:171], v[172:175], v[96:111]
    ds_read_b64_tr_b16 a[144:145], v150 offset:0
    buffer_load_dwordx4 v243, s[12:15], s46 offen offset:1024 lds
    v_mfma_f32_32x32x16_bf16 v[112:127], a[172:175], v[168:171], v[112:127]
    ds_read_b64_tr_b16 a[146:147], v150 offset:1024
    buffer_load_dwordx4 v244, s[12:15], s46 offen offset:2048 lds
    ds_read_b64_tr_b16 a[148:149], v151 offset:0
    v_mfma_f32_32x32x16_bf16 v[128:143], a[172:175], v[172:175], v[128:143]
    buffer_load_dwordx4 v245, s[12:15], s46 offen offset:3072 lds
    ds_read_b64_tr_b16 a[150:151], v151 offset:1024
    s_waitcnt lgkmcnt(6)
    v_mfma_f32_32x32x16_bf16 v[16:31], a[136:139], v[160:163], v[16:31]
    ds_read_b128 v[168:171], v9 offset:0
    ds_read_b128 v[172:175], v9 offset:4096
    v_mfma_f32_32x32x16_bf16 v[32:47], a[136:139], v[164:167], v[32:47]
    ds_read_b64_tr_b16 a[160:161], v148 offset:4096
    ds_read_b64_tr_b16 a[162:163], v148 offset:5120
    s_waitcnt lgkmcnt(8)
    v_mfma_f32_32x32x16_bf16 v[48:63], a[140:143], v[160:163], v[48:63]
    ds_read_b64_tr_b16 a[164:165], v149 offset:4096
    s_add_u32 s46, s46, 16384
    v_mfma_f32_32x32x16_bf16 v[64:79], a[140:143], v[164:167], v[64:79]
    ds_read_b64_tr_b16 a[166:167], v149 offset:5120
    s_add_u32 m0, s44, 16384
    s_waitcnt lgkmcnt(8)
    v_mfma_f32_32x32x16_bf16 v[80:95], a[144:147], v[160:163], v[80:95]
    ds_read_b64_tr_b16 a[168:169], v150 offset:4096
    buffer_load_dwordx4 v242, s[12:15], s46 offen offset:0 lds
    v_mfma_f32_32x32x16_bf16 v[96:111], a[144:147], v[164:167], v[96:111]
    ds_read_b64_tr_b16 a[170:171], v150 offset:5120
    buffer_load_dwordx4 v243, s[12:15], s46 offen offset:1024 lds
    s_waitcnt lgkmcnt(8)
    v_mfma_f32_32x32x16_bf16 v[112:127], a[148:151], v[160:163], v[112:127]
    ds_read_b64_tr_b16 a[172:173], v151 offset:4096
    buffer_load_dwordx4 v244, s[12:15], s46 offen offset:2048 lds
    v_mfma_f32_32x32x16_bf16 v[128:143], a[148:151], v[164:167], v[128:143]
    ds_read_b64_tr_b16 a[174:175], v151 offset:5120
    s_waitcnt lgkmcnt(6)
    v_mfma_f32_32x32x16_bf16 v[16:31], a[160:163], v[168:171], v[16:31]
    ds_read_b128 v[160:163], v10 offset:0
    ds_read_b128 v[164:167], v10 offset:4096
    v_mfma_f32_32x32x16_bf16 v[32:47], a[160:163], v[172:175], v[32:47]
    ds_read_b64_tr_b16 a[136:137], v148 offset:8192
    ds_read_b64_tr_b16 a[138:139], v148 offset:9216
    s_waitcnt lgkmcnt(8)
    v_mfma_f32_32x32x16_bf16 v[48:63], a[164:167], v[168:171], v[48:63]
    ds_read_b64_tr_b16 a[140:141], v149 offset:8192
    buffer_load_dwordx4 v245, s[12:15], s46 offen offset:3072 lds
    v_mfma_f32_32x32x16_bf16 v[64:79], a[164:167], v[172:175], v[64:79]
    ds_read_b64_tr_b16 a[142:143], v149 offset:9216
    s_waitcnt lgkmcnt(8)
    v_mfma_f32_32x32x16_bf16 v[80:95], a[168:171], v[168:171], v[80:95]
    s_add_u32 s46, s46, 16384
    ds_read_b64_tr_b16 a[144:145], v150 offset:8192
    v_mfma_f32_32x32x16_bf16 v[96:111], a[168:171], v[172:175], v[96:111]
    ds_read_b64_tr_b16 a[146:147], v150 offset:9216
    s_add_u32 m0, s44, 32768
    s_waitcnt lgkmcnt(8)
    v_mfma_f32_32x32x16_bf16 v[112:127], a[172:175], v[168:171], v[112:127]
    ds_read_b64_tr_b16 a[148:149], v151 offset:8192
    buffer_load_dwordx4 v242, s[12:15], s46 offen offset:0 lds
    v_mfma_f32_32x32x16_bf16 v[128:143], a[172:175], v[172:175], v[128:143]
    ds_read_b64_tr_b16 a[150:151], v151 offset:9216
    s_waitcnt lgkmcnt(6)
    v_mfma_f32_32x32x16_bf16 v[16:31], a[136:139], v[160:163], v[16:31]
    ds_read_b128 v[168:171], v11 offset:0
    ds_read_b128 v[172:175], v11 offset:4096
    v_mfma_f32_32x32x16_bf16 v[32:47], a[136:139], v[164:167], v[32:47]
    ds_read_b64_tr_b16 a[160:161], v148 offset:12288
    ds_read_b64_tr_b16 a[162:163], v148 offset:13312
    s_waitcnt lgkmcnt(8)
    v_mfma_f32_32x32x16_bf16 v[48:63], a[140:143], v[160:163], v[48:63]
    ds_read_b64_tr_b16 a[164:165], v149 offset:12288
    buffer_load_dwordx4 v243, s[12:15], s46 offen offset:1024 lds
    v_mfma_f32_32x32x16_bf16 v[64:79], a[140:143], v[164:167], v[64:79]
    ds_read_b64_tr_b16 a[166:167], v149 offset:13312
    s_waitcnt lgkmcnt(8)
    v_mfma_f32_32x32x16_bf16 v[80:95], a[144:147], v[160:163], v[80:95]
    buffer_load_dwordx4 v244, s[12:15], s46 offen offset:2048 lds
    ds_read_b64_tr_b16 a[168:169], v150 offset:12288
    v_mfma_f32_32x32x16_bf16 v[96:111], a[144:147], v[164:167], v[96:111]
    ds_read_b64_tr_b16 a[170:171], v150 offset:13312
    buffer_load_dwordx4 v245, s[12:15], s46 offen offset:3072 lds
    s_waitcnt lgkmcnt(8)
    v_mfma_f32_32x32x16_bf16 v[112:127], a[148:151], v[160:163], v[112:127]
    ds_read_b64_tr_b16 a[172:173], v151 offset:12288
    s_add_u32 s46, s46, 16384
    v_mfma_f32_32x32x16_bf16 v[128:143], a[148:151], v[164:167], v[128:143]
    ds_read_b64_tr_b16 a[174:175], v151 offset:13312
    s_waitcnt lgkmcnt(0)
    v_mfma_f32_32x32x16_bf16 v[16:31], a[160:163], v[168:171], v[16:31]
    v_mfma_f32_32x32x16_bf16 v[32:47], a[160:163], v[172:175], v[32:47]
    s_waitcnt vmcnt(12)
    s_barrier
    v_mfma_f32_32x32x16_bf16 v[48:63], a[164:167], v[168:171], v[48:63]
    ds_read_b128 v[160:163], v12 offset:0
    ds_read_b128 v[164:167], v12 offset:4096
    ds_read_b64_tr_b16 a[136:137], v152 offset:0
    ds_read_b64_tr_b16 a[138:139], v152 offset:1024
    v_mfma_f32_32x32x16_bf16 v[64:79], a[164:167], v[172:175], v[64:79]
    ds_read_b64_tr_b16 a[140:141], v153 offset:0
    s_add_u32 m0, s45, 0
    s_nop 0
    buffer_load_dwordx4 v246, s[16:19], s47 offen offset:0 lds
    ds_read_b64_tr_b16 a[142:143], v153 offset:1024
    v_mfma_f32_32x32x16_bf16 v[80:95], a[168:171], v[168:171], v[80:95]
    buffer_load_dwordx4 v246, s[16:19], s47 offen offset:1024 lds
    buffer_load_dwordx4 v246, s[16:19], s47 offen offset:2048 lds
    ds_read_b64_tr_b16 a[144:145], v154 offset:0
    v_mfma_f32_32x32x16_bf16 v[96:111], a[168:171], v[172:175], v[96:111]
    buffer_load_dwordx4 v246, s[16:19], s47 offen offset:3072 lds
    s_add_u32 s47, s47, 16384
    ds_read_b64_tr_b16 a[146:147], v154 offset:1024
    s_add_u32 m0, s45, 16384
    v_mfma_f32_32x32x16_bf16 v[112:127], a[172:175], v[168:171], v[112:127]
    buffer_load_dwordx4 v246, s[16:19], s47 offen offset:0 lds
    ds_read_b64_tr_b16 a[148:149], v155 offset:0
    buffer_load_dwordx4 v246, s[16:19], s47 offen offset:1024 lds
    buffer_load_dwordx4 v246, s[16:19], s47 offen offset:2048 lds
    v_mfma_f32_32x32x16_bf16 v[128:143], a[172:175], v[172:175], v[128:143]
    ds_read_b64_tr_b16 a[150:151], v155 offset:1024
    buffer_load_dwordx4 v246, s[16:19], s47 offen offset:3072 lds
    s_add_u32 s47, s47, 16384
    s_waitcnt lgkmcnt(6)
    v_mfma_f32_32x32x16_bf16 v[16:31], a[136:139], v[160:163], v[16:31]
    ds_read_b128 v[168:171], v13 offset:0
    ds_read_b128 v[172:175], v13 offset:4096
    v_mfma_f32_32x32x16_bf16 v[32:47], a[136:139], v[164:167], v[32:47]
    ds_read_b64_tr_b16 a[160:161], v152 offset:4096
    s_waitcnt lgkmcnt(7)
    v_mfma_f32_32x32x16_bf16 v[48:63], a[140:143], v[160:163], v[48:63]
    ds_read_b64_tr_b16 a[162:163], v152 offset:5120
    v_mfma_f32_32x32x16_bf16 v[64:79], a[140:143], v[164:167], v[64:79]
    ds_read_b64_tr_b16 a[164:165], v153 offset:4096
    s_waitcnt lgkmcnt(7)
    v_mfma_f32_32x32x16_bf16 v[80:95], a[144:147], v[160:163], v[80:95]
    ds_read_b64_tr_b16 a[166:167], v153 offset:5120
    ds_read_b64_tr_b16 a[168:169], v154 offset:4096
    v_mfma_f32_32x32x16_bf16 v[96:111], a[144:147], v[164:167], v[96:111]
    ds_read_b64_tr_b16 a[170:171], v154 offset:5120
    s_waitcnt lgkmcnt(8)
    v_mfma_f32_32x32x16_bf16 v[112:127], a[148:151], v[160:163], v[112:127]
    ds_read_b64_tr_b16 a[172:173], v155 offset:4096
    v_mfma_f32_32x32x16_bf16 v[128:143], a[148:151], v[164:167], v[128:143]
    ds_read_b64_tr_b16 a[174:175], v155 offset:5120
    s_waitcnt lgkmcnt(6)
    v_mfma_f32_32x32x16_bf16 v[16:31], a[160:163], v[168:171], v[16:31]
    ds_read_b128 v[160:163], v14 offset:0
    ds_read_b128 v[164:167], v14 offset:4096
    v_mfma_f32_32x32x16_bf16 v[32:47], a[160:163], v[172:175], v[32:47]
    ds_read_b64_tr_b16 a[136:137], v152 offset:8192
    s_waitcnt lgkmcnt(7)
    v_mfma_f32_32x32x16_bf16 v[48:63], a[164:167], v[168:171], v[48:63]
    ds_read_b64_tr_b16 a[138:139], v152 offset:9216
    v_mfma_f32_32x32x16_bf16 v[64:79], a[164:167], v[172:175], v[64:79]
    ds_read_b64_tr_b16 a[140:141], v153 offset:8192
    s_waitcnt lgkmcnt(7)
    v_mfma_f32_32x32x16_bf16 v[80:95], a[168:171], v[168:171], v[80:95]
    ds_read_b64_tr_b16 a[142:143], v153 offset:9216
    ds_read_b64_tr_b16 a[144:145], v154 offset:8192
    v_mfma_f32_32x32x16_bf16 v[96:111], a[168:171], v[172:175], v[96:111]
    ds_read_b64_tr_b16 a[146:147], v154 offset:9216
    s_waitcnt lgkmcnt(8)
    v_mfma_f32_32x32x16_bf16 v[112:127], a[172:175], v[168:171], v[112:127]
    ds_read_b64_tr_b16 a[148:149], v155 offset:8192
    v_mfma_f32_32x32x16_bf16 v[128:143], a[172:175], v[172:175], v[128:143]
    ds_read_b64_tr_b16 a[150:151], v155 offset:9216
    s_waitcnt lgkmcnt(6)
    v_mfma_f32_32x32x16_bf16 v[16:31], a[136:139], v[160:163], v[16:31]
    ds_read_b128 v[168:171], v15 offset:0
    ds_read_b128 v[172:175], v15 offset:4096
    v_mfma_f32_32x32x16_bf16 v[32:47], a[136:139], v[164:167], v[32:47]
    ds_read_b64_tr_b16 a[160:161], v152 offset:12288
    s_waitcnt lgkmcnt(7)
    v_mfma_f32_32x32x16_bf16 v[48:63], a[140:143], v[160:163], v[48:63]
    ds_read_b64_tr_b16 a[162:163], v152 offset:13312
    v_mfma_f32_32x32x16_bf16 v[64:79], a[140:143], v[164:167], v[64:79]
    ds_read_b64_tr_b16 a[164:165], v153 offset:12288
    s_waitcnt lgkmcnt(7)
    v_mfma_f32_32x32x16_bf16 v[80:95], a[144:147], v[160:163], v[80:95]
    ds_read_b64_tr_b16 a[166:167], v153 offset:13312
    ds_read_b64_tr_b16 a[168:169], v154 offset:12288
    v_mfma_f32_32x32x16_bf16 v[96:111], a[144:147], v[164:167], v[96:111]
    ds_read_b64_tr_b16 a[170:171], v154 offset:13312
    s_waitcnt lgkmcnt(8)
    v_mfma_f32_32x32x16_bf16 v[112:127], a[148:151], v[160:163], v[112:127]
    ds_read_b64_tr_b16 a[172:173], v155 offset:12288
    v_mfma_f32_32x32x16_bf16 v[128:143], a[148:151], v[164:167], v[128:143]
    ds_read_b64_tr_b16 a[174:175], v155 offset:13312
    s_waitcnt lgkmcnt(0)
    v_mfma_f32_32x32x16_bf16 v[16:31], a[160:163], v[168:171], v[16:31]
    v_mfma_f32_32x32x16_bf16 v[32:47], a[160:163], v[172:175], v[32:47]
    s_waitcnt vmcnt(4)
    s_barrier
    v_mfma_f32_32x32x16_bf16 v[48:63], a[164:167], v[168:171], v[48:63]
    v_mfma_f32_32x32x16_bf16 v[64:79], a[164:167], v[172:175], v[64:79]
    v_mfma_f32_32x32x16_bf16 v[80:95], a[168:171], v[168:171], v[80:95]
    v_mfma_f32_32x32x16_bf16 v[96:111], a[168:171], v[172:175], v[96:111]
    v_mfma_f32_32x32x16_bf16 v[112:127], a[172:175], v[168:171], v[112:127]
    v_mfma_f32_32x32x16_bf16 v[128:143], a[172:175], v[172:175], v[128:143]
    s_mov_b32 s40, 0x3e0293ee
    s_nop 1
    v_mul_f32 v16, s40, v16
    v_mul_f32 v17, s40, v17
    v_cvt_pk_bf16_f32 v160, v16, v17
    v_mul_f32 v18, s40, v18
    v_mul_f32 v19, s40, v19
    v_cvt_pk_bf16_f32 v161, v18, v19
    v_mul_f32 v20, s40, v20
    v_mul_f32 v21, s40, v21
    v_cvt_pk_bf16_f32 v162, v20, v21
    v_mul_f32 v22, s40, v22
    v_mul_f32 v23, s40, v23
    v_cvt_pk_bf16_f32 v163, v22, v23
    v_permlane32_swap_b32 v160, v162
    s_nop 0
    v_permlane32_swap_b32 v161, v163
    v_mul_f32 v24, s40, v24
    v_mul_f32 v25, s40, v25
    v_cvt_pk_bf16_f32 v164, v24, v25
    v_mul_f32 v26, s40, v26
    v_mul_f32 v27, s40, v27
    v_cvt_pk_bf16_f32 v165, v26, v27
    v_mul_f32 v28, s40, v28
    v_mul_f32 v29, s40, v29
    v_cvt_pk_bf16_f32 v166, v28, v29
    v_mul_f32 v30, s40, v30
    v_mul_f32 v31, s40, v31
    v_cvt_pk_bf16_f32 v167, v30, v31
    v_permlane32_swap_b32 v164, v166
    s_nop 0
    v_permlane32_swap_b32 v165, v167
    v_mul_f32 v48, s40, v48
    v_mul_f32 v49, s40, v49
    v_cvt_pk_bf16_f32 v168, v48, v49
    v_mul_f32 v50, s40, v50
    v_mul_f32 v51, s40, v51
    v_cvt_pk_bf16_f32 v169, v50, v51
    v_mul_f32 v52, s40, v52
    v_mul_f32 v53, s40, v53
    v_cvt_pk_bf16_f32 v170, v52, v53
    v_mul_f32 v54, s40, v54
    v_mul_f32 v55, s40, v55
    v_cvt_pk_bf16_f32 v171, v54, v55
    v_permlane32_swap_b32 v168, v170
    s_nop 0
    v_permlane32_swap_b32 v169, v171
    v_mul_f32 v56, s40, v56
    v_mul_f32 v57, s40, v57
    v_cvt_pk_bf16_f32 v172, v56, v57
    v_mul_f32 v58, s40, v58
    v_mul_f32 v59, s40, v59
    v_cvt_pk_bf16_f32 v173, v58, v59
    v_mul_f32 v60, s40, v60
    v_mul_f32 v61, s40, v61
    v_cvt_pk_bf16_f32 v174, v60, v61
    v_mul_f32 v62, s40, v62
    v_mul_f32 v63, s40, v63
    v_cvt_pk_bf16_f32 v175, v62, v63
    v_permlane32_swap_b32 v172, v174
    s_nop 0
    v_permlane32_swap_b32 v173, v175
    v_mul_f32 v80, s40, v80
    v_mul_f32 v81, s40, v81
    v_cvt_pk_bf16_f32 v176, v80, v81
    v_mul_f32 v82, s40, v82
    v_mul_f32 v83, s40, v83
    v_cvt_pk_bf16_f32 v177, v82, v83
    v_mul_f32 v84, s40, v84
    v_mul_f32 v85, s40, v85
    v_cvt_pk_bf16_f32 v178, v84, v85
    v_mul_f32 v86, s40, v86
    v_mul_f32 v87, s40, v87
    v_cvt_pk_bf16_f32 v179, v86, v87
    v_permlane32_swap_b32 v176, v178
    s_nop 0
    v_permlane32_swap_b32 v177, v179
    v_mul_f32 v88, s40, v88
    v_mul_f32 v89, s40, v89
    v_cvt_pk_bf16_f32 v180, v88, v89
    v_mul_f32 v90, s40, v90
    v_mul_f32 v91, s40, v91
    v_cvt_pk_bf16_f32 v181, v90, v91
    v_mul_f32 v92, s40, v92
    v_mul_f32 v93, s40, v93
    v_cvt_pk_bf16_f32 v182, v92, v93
    v_mul_f32 v94, s40, v94
    v_mul_f32 v95, s40, v95
    v_cvt_pk_bf16_f32 v183, v94, v95
    v_permlane32_swap_b32 v180, v182
    s_nop 0
    v_permlane32_swap_b32 v181, v183
    v_mul_f32 v112, s40, v112
    v_mul_f32 v113, s40, v113
    v_cvt_pk_bf16_f32 v184, v112, v113
    v_mul_f32 v114, s40, v114
    v_mul_f32 v115, s40, v115
    v_cvt_pk_bf16_f32 v185, v114, v115
    v_mul_f32 v116, s40, v116
    v_mul_f32 v117, s40, v117
    v_cvt_pk_bf16_f32 v186, v116, v117
    v_mul_f32 v118, s40, v118
    v_mul_f32 v119, s40, v119
    v_cvt_pk_bf16_f32 v187, v118, v119
    v_permlane32_swap_b32 v184, v186
    s_nop 0
    v_permlane32_swap_b32 v185, v187
    v_mul_f32 v120, s40, v120
    v_mul_f32 v121, s40, v121
    v_cvt_pk_bf16_f32 v188, v120, v121
    v_mul_f32 v122, s40, v122
    v_mul_f32 v123, s40, v123
    v_cvt_pk_bf16_f32 v189, v122, v123
    v_mul_f32 v124, s40, v124
    v_mul_f32 v125, s40, v125
    v_cvt_pk_bf16_f32 v190, v124, v125
    v_mul_f32 v126, s40, v126
    v_mul_f32 v127, s40, v127
    v_cvt_pk_bf16_f32 v191, v126, v127
    v_permlane32_swap_b32 v188, v190
    s_nop 0
    v_permlane32_swap_b32 v189, v191
    v_mul_f32 v32, s40, v32
    v_mul_f32 v33, s40, v33
    v_cvt_pk_bf16_f32 v192, v32, v33
    v_mul_f32 v34, s40, v34
    v_mul_f32 v35, s40, v35
    v_cvt_pk_bf16_f32 v193, v34, v35
    v_mul_f32 v36, s40, v36
    v_mul_f32 v37, s40, v37
    v_cvt_pk_bf16_f32 v194, v36, v37
    v_mul_f32 v38, s40, v38
    v_mul_f32 v39, s40, v39
    v_cvt_pk_bf16_f32 v195, v38, v39
    v_permlane32_swap_b32 v192, v194
    s_nop 0
    v_permlane32_swap_b32 v193, v195
    v_mul_f32 v40, s40, v40
    v_mul_f32 v41, s40, v41
    v_cvt_pk_bf16_f32 v196, v40, v41
    v_mul_f32 v42, s40, v42
    v_mul_f32 v43, s40, v43
    v_cvt_pk_bf16_f32 v197, v42, v43
    v_mul_f32 v44, s40, v44
    v_mul_f32 v45, s40, v45
    v_cvt_pk_bf16_f32 v198, v44, v45
    v_mul_f32 v46, s40, v46
    v_mul_f32 v47, s40, v47
    v_cvt_pk_bf16_f32 v199, v46, v47
    v_permlane32_swap_b32 v196, v198
    s_nop 0
    v_permlane32_swap_b32 v197, v199
    v_mul_f32 v64, s40, v64
    v_mul_f32 v65, s40, v65
    v_cvt_pk_bf16_f32 v200, v64, v65
    v_mul_f32 v66, s40, v66
    v_mul_f32 v67, s40, v67
    v_cvt_pk_bf16_f32 v201, v66, v67
    v_mul_f32 v68, s40, v68
    v_mul_f32 v69, s40, v69
    v_cvt_pk_bf16_f32 v202, v68, v69
    v_mul_f32 v70, s40, v70
    v_mul_f32 v71, s40, v71
    v_cvt_pk_bf16_f32 v203, v70, v71
    v_permlane32_swap_b32 v200, v202
    s_nop 0
    v_permlane32_swap_b32 v201, v203
    v_mul_f32 v72, s40, v72
    v_mul_f32 v73, s40, v73
    v_cvt_pk_bf16_f32 v204, v72, v73
    v_mul_f32 v74, s40, v74
    v_mul_f32 v75, s40, v75
    v_cvt_pk_bf16_f32 v205, v74, v75
    v_mul_f32 v76, s40, v76
    v_mul_f32 v77, s40, v77
    v_cvt_pk_bf16_f32 v206, v76, v77
    v_mul_f32 v78, s40, v78
    v_mul_f32 v79, s40, v79
    v_cvt_pk_bf16_f32 v207, v78, v79
    v_permlane32_swap_b32 v204, v206
    s_nop 0
    v_permlane32_swap_b32 v205, v207
    v_mul_f32 v96, s40, v96
    v_mul_f32 v97, s40, v97
    v_cvt_pk_bf16_f32 v208, v96, v97
    v_mul_f32 v98, s40, v98
    v_mul_f32 v99, s40, v99
    v_cvt_pk_bf16_f32 v209, v98, v99
    v_mul_f32 v100, s40, v100
    v_mul_f32 v101, s40, v101
    v_cvt_pk_bf16_f32 v210, v100, v101
    v_mul_f32 v102, s40, v102
    v_mul_f32 v103, s40, v103
    v_cvt_pk_bf16_f32 v211, v102, v103
    v_permlane32_swap_b32 v208, v210
    s_nop 0
    v_permlane32_swap_b32 v209, v211
    v_mul_f32 v104, s40, v104
    v_mul_f32 v105, s40, v105
    v_cvt_pk_bf16_f32 v212, v104, v105
    v_mul_f32 v106, s40, v106
    v_mul_f32 v107, s40, v107
    v_cvt_pk_bf16_f32 v213, v106, v107
    v_mul_f32 v108, s40, v108
    v_mul_f32 v109, s40, v109
    v_cvt_pk_bf16_f32 v214, v108, v109
    v_mul_f32 v110, s40, v110
    v_mul_f32 v111, s40, v111
    v_cvt_pk_bf16_f32 v215, v110, v111
    v_permlane32_swap_b32 v212, v214
    s_nop 0
    v_permlane32_swap_b32 v213, v215
    v_mul_f32 v128, s40, v128
    v_mul_f32 v129, s40, v129
    v_cvt_pk_bf16_f32 v216, v128, v129
    v_mul_f32 v130, s40, v130
    v_mul_f32 v131, s40, v131
    v_cvt_pk_bf16_f32 v217, v130, v131
    v_mul_f32 v132, s40, v132
    v_mul_f32 v133, s40, v133
    v_cvt_pk_bf16_f32 v218, v132, v133
    v_mul_f32 v134, s40, v134
    v_mul_f32 v135, s40, v135
    v_cvt_pk_bf16_f32 v219, v134, v135
    v_permlane32_swap_b32 v216, v218
    s_nop 0
    v_permlane32_swap_b32 v217, v219
    v_mul_f32 v136, s40, v136
    v_mul_f32 v137, s40, v137
    v_cvt_pk_bf16_f32 v220, v136, v137
    v_mul_f32 v138, s40, v138
    v_mul_f32 v139, s40, v139
    v_cvt_pk_bf16_f32 v221, v138, v139
    v_mul_f32 v140, s40, v140
    v_mul_f32 v141, s40, v141
    v_cvt_pk_bf16_f32 v222, v140, v141
    v_mul_f32 v142, s40, v142
    v_mul_f32 v143, s40, v143
    v_cvt_pk_bf16_f32 v223, v142, v143
    v_permlane32_swap_b32 v220, v222
    s_nop 0
    v_permlane32_swap_b32 v221, v223
    ds_read_b128 a[192:195], v230 offset:0
    ds_read_b128 a[196:199], v231 offset:0
    ds_read_b128 a[200:203], v232 offset:0
    ds_read_b128 a[204:207], v233 offset:0
    ds_read_b128 a[208:211], v234 offset:0
    ds_read_b128 a[212:215], v235 offset:0
    ds_read_b128 a[216:219], v236 offset:0
    ds_read_b128 a[220:223], v237 offset:0
    v_mov_b32 v48, 0
    v_mov_b32 v49, 0
    v_mov_b32 v50, 0
    v_mov_b32 v51, 0
    v_mov_b32 v52, 0
    v_mov_b32 v53, 0
    v_mov_b32 v54, 0
    v_mov_b32 v55, 0
    v_mov_b32 v56, 0
    v_mov_b32 v57, 0
    v_mov_b32 v58, 0
    v_mov_b32 v59, 0
    v_mov_b32 v60, 0
    v_mov_b32 v61, 0
    v_mov_b32 v62, 0
    v_mov_b32 v63, 0
    v_mov_b32 v64, 0
    v_mov_b32 v65, 0
    v_mov_b32 v66, 0
    v_mov_b32 v67, 0
    v_mov_b32 v68, 0
    v_mov_b32 v69, 0
    v_mov_b32 v70, 0
    v_mov_b32 v71, 0
    v_mov_b32 v72, 0
    v_mov_b32 v73, 0
    v_mov_b32 v74, 0
    v_mov_b32 v75, 0
    v_mov_b32 v76, 0
    v_mov_b32 v77, 0
    v_mov_b32 v78, 0
    v_mov_b32 v79, 0
    v_mov_b32 v80, 0
    v_mov_b32 v81, 0
    v_mov_b32 v82, 0
    v_mov_b32 v83, 0
    v_mov_b32 v84, 0
    v_mov_b32 v85, 0
    v_mov_b32 v86, 0
    v_mov_b32 v87, 0
    v_mov_b32 v88, 0
    v_mov_b32 v89, 0
    v_mov_b32 v90, 0
    v_mov_b32 v91, 0
    v_mov_b32 v92, 0
    v_mov_b32 v93, 0
    v_mov_b32 v94, 0
    v_mov_b32 v95, 0
    v_mov_b32 v247, 0
    v_mov_b32 v251, 0
    s_mov_b32 s50, 0x4f800000
    v_mov_b32 v248, 0
    v_mov_b32 v252, 0
    s_mov_b32 s51, 0x4f800000
    s_waitcnt lgkmcnt(0)
    v_mfma_f32_32x32x16_bf16 v[16:31], a[192:195], v[160:163], v[48:63]
    v_mfma_f32_32x32x16_bf16 v[16:31], a[196:199], v[164:167], v[16:31]
    s_add_u32 m0, s45, 32768
    s_nop 0
    buffer_load_dwordx4 v246, s[16:19], s47 offen offset:0 lds
    v_mfma_f32_32x32x16_bf16 v[16:31], a[200:203], v[168:171], v[16:31]
    v_mfma_f32_32x32x16_bf16 v[16:31], a[204:207], v[172:175], v[16:31]
    v_mfma_f32_32x32x16_bf16 v[16:31], a[208:211], v[176:179], v[16:31]
    v_mfma_f32_32x32x16_bf16 v[16:31], a[212:215], v[180:183], v[16:31]
    buffer_load_dwordx4 v246, s[16:19], s47 offen offset:1024 lds
    v_mfma_f32_32x32x16_bf16 v[16:31], a[216:219], v[184:187], v[16:31]
    v_mfma_f32_32x32x16_bf16 v[16:31], a[220:223], v[188:191], v[16:31]
    v_mfma_f32_32x32x16_bf16 a[64:79], a[224:227], v[88:91], a[64:79]
    ds_read_b64_tr_b16 a[224:225], v238 offset:0
    ds_read_b64_tr_b16 a[226:227], v238 offset:2048
    v_mfma_f32_32x32x16_bf16 a[80:95], a[228:231], v[88:91], a[80:95]
    ds_read_b64_tr_b16 a[228:229], v239 offset:0
    ds_read_b64_tr_b16 a[230:231], v239 offset:2048
    buffer_load_dwordx4 v246, s[16:19], s47 offen offset:2048 lds
    v_mfma_f32_32x32x16_bf16 a[96:111], a[232:235], v[88:91], a[96:111]
    ds_read_b64_tr_b16 a[232:233], v240 offset:0
    ds_read_b64_tr_b16 a[234:235], v240 offset:2048
    s_nop 1
    v_max_f32 v112, v16, v17
    v_max3_f32 v112, v112, v18, v19
    v_max3_f32 v112, v112, v20, v21
    v_max3_f32 v112, v112, v22, v23
    v_mfma_f32_32x32x16_bf16 a[112:127], a[236:239], v[88:91], a[112:127]
    ds_read_b64_tr_b16 a[236:237], v241 offset:0
    ds_read_b64_tr_b16 a[238:239], v241 offset:2048
    v_max3_f32 v112, v112, v24, v25
    v_max3_f32 v112, v112, v26, v27
    v_max3_f32 v112, v112, v28, v29
    v_max3_f32 v112, v112, v30, v31
    v_mfma_f32_32x32x16_bf16 a[64:79], a[240:243], v[92:95], a[64:79]
    ds_read_b64_tr_b16 a[240:241], v238 offset:4096
    ds_read_b64_tr_b16 a[242:243], v238 offset:6144
    v_mov_b32 v113, v112
    s_nop 1
    v_permlane32_swap_b32 v112, v113
    v_max_f32 v112, v112, v113
    v_mfma_f32_32x32x16_bf16 a[80:95], a[244:247], v[92:95], a[80:95]
    ds_read_b64_tr_b16 a[244:245], v239 offset:4096
    ds_read_b64_tr_b16 a[246:247], v239 offset:6144
    v_sub_f32 v16, v16, v112
    v_sub_f32 v17, v17, v112
    v_sub_f32 v18, v18, v112
    v_sub_f32 v19, v19, v112
    buffer_load_dwordx4 v246, s[16:19], s47 offen offset:3072 lds
    s_add_u32 s47, s47, 16384
    v_mfma_f32_32x32x16_bf16 a[96:111], a[248:251], v[92:95], a[96:111]
    ds_read_b64_tr_b16 a[248:249], v240 offset:4096
    ds_read_b64_tr_b16 a[250:251], v240 offset:6144
    v_sub_f32 v20, v20, v112
    v_sub_f32 v21, v21, v112
    v_sub_f32 v22, v22, v112
    v_sub_f32 v23, v23, v112
    v_mfma_f32_32x32x16_bf16 a[112:127], a[252:255], v[92:95], a[112:127]
    ds_read_b64_tr_b16 a[252:253], v241 offset:4096
    ds_read_b64_tr_b16 a[254:255], v241 offset:6144
    v_sub_f32 v24, v24, v112
    v_sub_f32 v25, v25, v112
    v_sub_f32 v26, v26, v112
    v_sub_f32 v27, v27, v112
    v_mfma_f32_32x32x16_bf16 v[32:47], a[192:195], v[192:195], v[64:79]
    ds_read_b128 a[192:195], v230 offset:8192
    v_sub_f32 v28, v28, v112
    v_sub_f32 v29, v29, v112
    v_sub_f32 v30, v30, v112
    v_sub_f32 v31, v31, v112
    v_sub_f32 v48, 0, v112
    v_mfma_f32_32x32x16_bf16 v[32:47], a[196:199], v[196:199], v[32:47]
    ds_read_b128 a[196:199], v231 offset:8192
    v_sub_f32 v49, 0, v112
    v_sub_f32 v50, 0, v112
    v_sub_f32 v51, 0, v112
    v_sub_f32 v52, 0, v112
    v_sub_f32 v53, 0, v112
    s_add_u32 m0, s44, 49152
    s_nop 0
    buffer_load_dwordx4 v242, s[12:15], s46 offen offset:0 lds
    v_mfma_f32_32x32x16_bf16 v[32:47], a[200:203], v[200:203], v[32:47]
    ds_read_b128 a[200:203], v232 offset:8192
    v_sub_f32 v54, 0, v112
    v_sub_f32 v55, 0, v112
    v_sub_f32 v56, 0, v112
    v_sub_f32 v57, 0, v112
    v_sub_f32 v58, 0, v112
    v_mfma_f32_32x32x16_bf16 v[32:47], a[204:207], v[204:207], v[32:47]
    ds_read_b128 a[204:207], v233 offset:8192
    v_sub_f32 v59, 0, v112
    v_sub_f32 v60, 0, v112
    v_sub_f32 v61, 0, v112
    v_sub_f32 v62, 0, v112
    v_sub_f32 v63, 0, v112
    v_mfma_f32_32x32x16_bf16 v[32:47], a[208:211], v[208:211], v[32:47]
    ds_read_b128 a[208:211], v234 offset:8192
    v_exp_f32 v96, v16
    v_exp_f32 v97, v17
    v_mfma_f32_32x32x16_bf16 v[32:47], a[212:215], v[212:215], v[32:47]
    ds_read_b128 a[212:215], v235 offset:8192
    v_exp_f32 v98, v18
    v_add_f32 v249, v96, v97
    v_exp_f32 v99, v19
    buffer_load_dwordx4 v243, s[12:15], s46 offen offset:1024 lds
    v_mfma_f32_32x32x16_bf16 v[32:47], a[216:219], v[216:219], v[32:47]
    ds_read_b128 a[216:219], v236 offset:8192
    v_cvt_pk_bf16_f32 v80, v96, v97
    v_add_f32 v249, v249, v98
    v_exp_f32 v100, v20
    v_add_f32 v249, v249, v99
    v_mfma_f32_32x32x16_bf16 v[32:47], a[220:223], v[220:223], v[32:47]
    ds_read_b128 a[220:223], v237 offset:8192
    v_exp_f32 v101, v21
    v_cvt_pk_bf16_f32 v81, v98, v99
    v_add_f32 v249, v249, v100
    v_exp_f32 v102, v22
    v_add_f32 v249, v249, v101
    v_exp_f32 v103, v23
    v_cvt_pk_bf16_f32 v82, v100, v101
    v_add_f32 v249, v249, v102
    v_exp_f32 v104, v24
    v_add_f32 v249, v249, v103
    v_exp_f32 v105, v25
    v_cvt_pk_bf16_f32 v83, v102, v103
    v_add_f32 v249, v249, v104
    v_exp_f32 v106, v26
    v_add_f32 v249, v249, v105
    v_exp_f32 v107, v27
    v_cvt_pk_bf16_f32 v84, v104, v105
    v_add_f32 v249, v249, v106
    v_exp_f32 v108, v28
    v_add_f32 v249, v249, v107
    v_exp_f32 v109, v29
    v_cvt_pk_bf16_f32 v85, v106, v107
    v_add_f32 v249, v249, v108
    v_exp_f32 v110, v30
    v_add_f32 v249, v249, v109
    v_exp_f32 v111, v31
    v_cvt_pk_bf16_f32 v86, v108, v109
    v_add_f32 v249, v249, v110
    v_cvt_pk_bf16_f32 v87, v110, v111
    v_add_f32 v249, v249, v111
    v_cmp_nge_f32 vcc, s50, v249
    s_cbranch_vccnz attn_kernel_stub1
attn_kernel_back1:
    v_add_f32 v247, v247, v249
    s_waitcnt lgkmcnt(0)
    v_mfma_f32_32x32x16_bf16 a[0:15], a[224:227], v[80:83], a[0:15]
    v_mfma_f32_32x32x16_bf16 a[16:31], a[228:231], v[80:83], a[16:31]
    buffer_load_dwordx4 v244, s[12:15], s46 offen offset:2048 lds
    v_mfma_f32_32x32x16_bf16 a[32:47], a[232:235], v[80:83], a[32:47]
    v_max_f32 v112, v32, v33
    v_max3_f32 v112, v112, v34, v35
    v_max3_f32 v112, v112, v36, v37
    v_max3_f32 v112, v112, v38, v39
    v_max3_f32 v112, v112, v40, v41
    v_max3_f32 v112, v112, v42, v43
    v_mfma_f32_32x32x16_bf16 a[48:63], a[236:239], v[80:83], a[48:63]
    v_max3_f32 v112, v112, v44, v45
    v_max3_f32 v112, v112, v46, v47
    v_mov_b32 v113, v112
    s_nop 1
    v_permlane32_swap_b32 v112, v113
    v_max_f32 v112, v112, v113
    v_mfma_f32_32x32x16_bf16 a[0:15], a[240:243], v[84:87], a[0:15]
    v_sub_f32 v32, v32, v112
    v_sub_f32 v33, v33, v112
    v_sub_f32 v34, v34, v112
    v_sub_f32 v35, v35, v112
    v_sub_f32 v36, v36, v112
    v_sub_f32 v37, v37, v112
    v_mfma_f32_32x32x16_bf16 a[16:31], a[244:247], v[84:87], a[16:31]
    v_sub_f32 v38, v38, v112
    v_sub_f32 v39, v39, v112
    v_sub_f32 v40, v40, v112
    v_sub_f32 v41, v41, v112
    v_sub_f32 v42, v42, v112
    v_sub_f32 v43, v43, v112
    buffer_load_dwordx4 v245, s[12:15], s46 offen offset:3072 lds
    s_add_u32 s46, s46, 16384
    v_mfma_f32_32x32x16_bf16 a[32:47], a[248:251], v[84:87], a[32:47]
    v_sub_f32 v44, v44, v112
    v_sub_f32 v45, v45, v112
    v_sub_f32 v46, v46, v112
    v_sub_f32 v47, v47, v112
    v_sub_f32 v64, 0, v112
    v_sub_f32 v65, 0, v112
    v_mfma_f32_32x32x16_bf16 a[48:63], a[252:255], v[84:87], a[48:63]
    v_sub_f32 v66, 0, v112
    v_sub_f32 v67, 0, v112
    v_sub_f32 v68, 0, v112
    v_sub_f32 v69, 0, v112
    v_sub_f32 v70, 0, v112
    v_sub_f32 v71, 0, v112
    v_mfma_f32_32x32x16_bf16 v[16:31], a[192:195], v[160:163], v[48:63]
    v_sub_f32 v72, 0, v112
    v_sub_f32 v73, 0, v112
    v_sub_f32 v74, 0, v112
    v_sub_f32 v75, 0, v112
    v_sub_f32 v76, 0, v112
    v_sub_f32 v77, 0, v112
    v_mfma_f32_32x32x16_bf16 v[16:31], a[196:199], v[164:167], v[16:31]
    v_sub_f32 v78, 0, v112
    v_sub_f32 v79, 0, v112
    v_exp_f32 v96, v32
    v_exp_f32 v97, v33
    v_mfma_f32_32x32x16_bf16 v[16:31], a[200:203], v[168:171], v[16:31]
    v_exp_f32 v98, v34
    v_add_f32 v250, v96, v97
    v_exp_f32 v99, v35
    v_cvt_pk_bf16_f32 v88, v96, v97
    v_mfma_f32_32x32x16_bf16 v[16:31], a[204:207], v[172:175], v[16:31]
    v_add_f32 v250, v250, v98
    v_exp_f32 v100, v36
    v_add_f32 v250, v250, v99
    v_exp_f32 v101, v37
    v_mfma_f32_32x32x16_bf16 v[16:31], a[208:211], v[176:179], v[16:31]
    v_cvt_pk_bf16_f32 v89, v98, v99
    v_add_f32 v250, v250, v100
    v_exp_f32 v102, v38
    v_add_f32 v250, v250, v101
    v_mfma_f32_32x32x16_bf16 v[16:31], a[212:215], v[180:183], v[16:31]
    v_exp_f32 v103, v39
    v_cvt_pk_bf16_f32 v90, v100, v101
    v_add_f32 v250, v250, v102
    v_exp_f32 v104, v40
    v_mfma_f32_32x32x16_bf16 v[16:31], a[216:219], v[184:187], v[16:31]
    v_add_f32 v250, v250, v103
    v_exp_f32 v105, v41
    v_cvt_pk_bf16_f32 v91, v102, v103
    v_add_f32 v250, v250, v104
    v_mfma_f32_32x32x16_bf16 v[16:31], a[220:223], v[188:191], v[16:31]
    v_exp_f32 v106, v42
    v_add_f32 v250, v250, v105
    v_exp_f32 v107, v43
    v_cvt_pk_bf16_f32 v92, v104, v105
    v_add_f32 v250, v250, v106
    v_exp_f32 v108, v44
    v_add_f32 v250, v250, v107
    v_exp_f32 v109, v45
    v_cvt_pk_bf16_f32 v93, v106, v107
    v_add_f32 v250, v250, v108
    v_exp_f32 v110, v46
    v_add_f32 v250, v250, v109
    v_exp_f32 v111, v47
    v_cvt_pk_bf16_f32 v94, v108, v109
    v_add_f32 v250, v250, v110
    v_cvt_pk_bf16_f32 v95, v110, v111
    v_add_f32 v250, v250, v111
    v_cmp_nge_f32 vcc, s51, v250
    s_cbranch_vccnz attn_kernel_stub2
attn_kernel_back2:
    v_add_f32 v248, v248, v250
    v_mfma_f32_32x32x16_bf16 a[64:79], a[224:227], v[88:91], a[64:79]
    ds_read_b64_tr_b16 a[224:225], v238 offset:8192
    ds_read_b64_tr_b16 a[226:227], v238 offset:10240
    v_mfma_f32_32x32x16_bf16 a[80:95], a[228:231], v[88:91], a[80:95]
    ds_read_b64_tr_b16 a[228:229], v239 offset:8192
    ds_read_b64_tr_b16 a[230:231], v239 offset:10240
    v_mfma_f32_32x32x16_bf16 a[96:111], a[232:235], v[88:91], a[96:111]
    ds_read_b64_tr_b16 a[232:233], v240 offset:8192
    ds_read_b64_tr_b16 a[234:235], v240 offset:10240
    v_exp_f32 v96, v16
    v_exp_f32 v97, v17
    v_mfma_f32_32x32x16_bf16 a[112:127], a[236:239], v[88:91], a[112:127]
    ds_read_b64_tr_b16 a[236:237], v241 offset:8192
    ds_read_b64_tr_b16 a[238:239], v241 offset:10240
    v_exp_f32 v98, v18
    v_add_f32 v249, v96, v97
    v_mfma_f32_32x32x16_bf16 a[64:79], a[240:243], v[92:95], a[64:79]
    ds_read_b64_tr_b16 a[240:241], v238 offset:12288
    ds_read_b64_tr_b16 a[242:243], v238 offset:14336
    v_exp_f32 v99, v19
    v_cvt_pk_bf16_f32 v80, v96, v97
    v_add_f32 v249, v249, v98
    v_mfma_f32_32x32x16_bf16 a[80:95], a[244:247], v[92:95], a[80:95]
    ds_read_b64_tr_b16 a[244:245], v239 offset:12288
    ds_read_b64_tr_b16 a[246:247], v239 offset:14336
    v_exp_f32 v100, v20
    v_add_f32 v249, v249, v99
    v_mfma_f32_32x32x16_bf16 a[96:111], a[248:251], v[92:95], a[96:111]
    ds_read_b64_tr_b16 a[248:249], v240 offset:12288
    ds_read_b64_tr_b16 a[250:251], v240 offset:14336
    v_exp_f32 v101, v21
    v_cvt_pk_bf16_f32 v81, v98, v99
    v_add_f32 v249, v249, v100
    v_mfma_f32_32x32x16_bf16 a[112:127], a[252:255], v[92:95], a[112:127]
    ds_read_b64_tr_b16 a[252:253], v241 offset:12288
    ds_read_b64_tr_b16 a[254:255], v241 offset:14336
    v_exp_f32 v102, v22
    v_add_f32 v249, v249, v101
    s_waitcnt vmcnt(8)
    s_barrier
    v_mfma_f32_32x32x16_bf16 v[32:47], a[192:195], v[192:195], v[64:79]
    ds_read_b128 a[192:195], v230 offset:16384
    v_exp_f32 v103, v23
    v_cvt_pk_bf16_f32 v82, v100, v101
    v_add_f32 v249, v249, v102
    v_mfma_f32_32x32x16_bf16 v[32:47], a[196:199], v[196:199], v[32:47]
    ds_read_b128 a[196:199], v231 offset:16384
    v_exp_f32 v104, v24
    v_add_f32 v249, v249, v103
    v_exp_f32 v105, v25
    v_mfma_f32_32x32x16_bf16 v[32:47], a[200:203], v[200:203], v[32:47]
    ds_read_b128 a[200:203], v232 offset:16384
    v_cvt_pk_bf16_f32 v83, v102, v103
    v_add_f32 v249, v249, v104
    v_exp_f32 v106, v26
    v_add_f32 v249, v249, v105
    v_mfma_f32_32x32x16_bf16 v[32:47], a[204:207], v[204:207], v[32:47]
    ds_read_b128 a[204:207], v233 offset:16384
    v_exp_f32 v107, v27
    v_cvt_pk_bf16_f32 v84, v104, v105
    v_add_f32 v249, v249, v106
    v_mfma_f32_32x32x16_bf16 v[32:47], a[208:211], v[208:211], v[32:47]
    ds_read_b128 a[208:211], v234 offset:16384
    v_exp_f32 v108, v28
    v_add_f32 v249, v249, v107
    v_exp_f32 v109, v29
    v_mfma_f32_32x32x16_bf16 v[32:47], a[212:215], v[212:215], v[32:47]
    ds_read_b128 a[212:215], v235 offset:16384
    v_cvt_pk_bf16_f32 v85, v106, v107
    v_add_f32 v249, v249, v108
    v_exp_f32 v110, v30
    v_add_f32 v249, v249, v109
    s_add_u32 m0, s45, 49152
    s_nop 0
    buffer_load_dwordx4 v246, s[16:19], s47 offen offset:0 lds
    v_mfma_f32_32x32x16_bf16 v[32:47], a[216:219], v[216:219], v[32:47]
    ds_read_b128 a[216:219], v236 offset:16384
    v_exp_f32 v111, v31
    v_cvt_pk_bf16_f32 v86, v108, v109
    v_add_f32 v249, v249, v110
    v_cvt_pk_bf16_f32 v87, v110, v111
    v_mfma_f32_32x32x16_bf16 v[32:47], a[220:223], v[220:223], v[32:47]
    ds_read_b128 a[220:223], v237 offset:16384
    v_add_f32 v249, v249, v111
    v_cmp_nge_f32 vcc, s50, v249
    s_cbranch_vccnz attn_kernel_stub3
attn_kernel_back3:
    v_add_f32 v247, v247, v249
    s_waitcnt lgkmcnt(4)
    v_mfma_f32_32x32x16_bf16 a[0:15], a[224:227], v[80:83], a[0:15]
    v_mfma_f32_32x32x16_bf16 a[16:31], a[228:231], v[80:83], a[16:31]
    buffer_load_dwordx4 v246, s[16:19], s47 offen offset:1024 lds
    v_mfma_f32_32x32x16_bf16 a[32:47], a[232:235], v[80:83], a[32:47]
    s_nop 1
    v_exp_f32 v96, v32
    v_exp_f32 v97, v33
    v_exp_f32 v98, v34
    v_mfma_f32_32x32x16_bf16 a[48:63], a[236:239], v[80:83], a[48:63]
    v_add_f32 v250, v96, v97
    v_exp_f32 v99, v35
    v_cvt_pk_bf16_f32 v88, v96, v97
    v_add_f32 v250, v250, v98
    v_mfma_f32_32x32x16_bf16 a[0:15], a[240:243], v[84:87], a[0:15]
    v_exp_f32 v100, v36
    v_add_f32 v250, v250, v99
    v_exp_f32 v101, v37
    v_cvt_pk_bf16_f32 v89, v98, v99
    v_mfma_f32_32x32x16_bf16 a[16:31], a[244:247], v[84:87], a[16:31]
    v_add_f32 v250, v250, v100
    v_exp_f32 v102, v38
    v_add_f32 v250, v250, v101
    v_exp_f32 v103, v39
    buffer_load_dwordx4 v246, s[16:19], s47 offen offset:2048 lds
    v_mfma_f32_32x32x16_bf16 a[32:47], a[248:251], v[84:87], a[32:47]
    v_cvt_pk_bf16_f32 v90, v100, v101
    v_add_f32 v250, v250, v102
    v_exp_f32 v104, v40
    v_add_f32 v250, v250, v103
    v_mfma_f32_32x32x16_bf16 a[48:63], a[252:255], v[84:87], a[48:63]
    v_exp_f32 v105, v41
    v_cvt_pk_bf16_f32 v91, v102, v103
    v_add_f32 v250, v250, v104
    v_exp_f32 v106, v42
    v_mfma_f32_32x32x16_bf16 v[16:31], a[192:195], v[160:163], v[48:63]
    v_add_f32 v250, v250, v105
    v_exp_f32 v107, v43
    v_cvt_pk_bf16_f32 v92, v104, v105
    v_add_f32 v250, v250, v106
    v_mfma_f32_32x32x16_bf16 v[16:31], a[196:199], v[164:167], v[16:31]
    v_exp_f32 v108, v44
    v_add_f32 v250, v250, v107
    v_exp_f32 v109, v45
    v_cvt_pk_bf16_f32 v93, v106, v107
    buffer_load_dwordx4 v246, s[16:19], s47 offen offset:3072 lds
    s_add_u32 s47, s47, 16384
    v_mfma_f32_32x32x16_bf16 v[16:31], a[200:203], v[168:171], v[16:31]
    v_add_f32 v250, v250, v108
    v_exp_f32 v110, v46
    v_add_f32 v250, v250, v109
    v_exp_f32 v111, v47
    v_mfma_f32_32x32x16_bf16 v[16:31], a[204:207], v[172:175], v[16:31]
    v_cvt_pk_bf16_f32 v94, v108, v109
    v_add_f32 v250, v250, v110
    v_cvt_pk_bf16_f32 v95, v110, v111
    v_add_f32 v250, v250, v111
    v_cmp_nge_f32 vcc, s51, v250
    s_waitcnt lgkmcnt(0)
    v_mfma_f32_32x32x16_bf16 v[16:31], a[208:211], v[176:179], v[16:31]
    s_cbranch_vccnz attn_kernel_stub4
attn_kernel_back4:
    v_add_f32 v248, v248, v250
    v_mfma_f32_32x32x16_bf16 v[16:31], a[212:215], v[180:183], v[16:31]
    s_add_u32 m0, s44, 0
    s_nop 0
    buffer_load_dwordx4 v242, s[12:15], s46 offen offset:0 lds
    v_mfma_f32_32x32x16_bf16 v[16:31], a[216:219], v[184:187], v[16:31]
    v_mfma_f32_32x32x16_bf16 v[16:31], a[220:223], v[188:191], v[16:31]
    v_mfma_f32_32x32x16_bf16 a[64:79], a[224:227], v[88:91], a[64:79]
    ds_read_b64_tr_b16 a[224:225], v238 offset:16384
    ds_read_b64_tr_b16 a[226:227], v238 offset:18432
    v_mfma_f32_32x32x16_bf16 a[80:95], a[228:231], v[88:91], a[80:95]
    ds_read_b64_tr_b16 a[228:229], v239 offset:16384
    ds_read_b64_tr_b16 a[230:231], v239 offset:18432
    buffer_load_dwordx4 v243, s[12:15], s46 offen offset:1024 lds
    v_mfma_f32_32x32x16_bf16 a[96:111], a[232:235], v[88:91], a[96:111]
    ds_read_b64_tr_b16 a[232:233], v240 offset:16384
    ds_read_b64_tr_b16 a[234:235], v240 offset:18432
    s_nop 1
    v_exp_f32 v96, v16
    v_exp_f32 v97, v17
    v_mfma_f32_32x32x16_bf16 a[112:127], a[236:239], v[88:91], a[112:127]
    ds_read_b64_tr_b16 a[236:237], v241 offset:16384
    ds_read_b64_tr_b16 a[238:239], v241 offset:18432
    v_exp_f32 v98, v18
    v_add_f32 v249, v96, v97
    v_mfma_f32_32x32x16_bf16 a[64:79], a[240:243], v[92:95], a[64:79]
    ds_read_b64_tr_b16 a[240:241], v238 offset:20480
    ds_read_b64_tr_b16 a[242:243], v238 offset:22528
    v_exp_f32 v99, v19
    v_cvt_pk_bf16_f32 v80, v96, v97
    v_add_f32 v249, v249, v98
    v_mfma_f32_32x32x16_bf16 a[80:95], a[244:247], v[92:95], a[80:95]
    ds_read_b64_tr_b16 a[244:245], v239 offset:20480
    ds_read_b64_tr_b16 a[246:247], v239 offset:22528
    v_exp_f32 v100, v20
    v_add_f32 v249, v249, v99
    buffer_load_dwordx4 v244, s[12:15], s46 offen offset:2048 lds
    v_mfma_f32_32x32x16_bf16 a[96:111], a[248:251], v[92:95], a[96:111]
    ds_read_b64_tr_b16 a[248:249], v240 offset:20480
    ds_read_b64_tr_b16 a[250:251], v240 offset:22528
    v_exp_f32 v101, v21
    v_cvt_pk_bf16_f32 v81, v98, v99
    v_add_f32 v249, v249, v100
    v_mfma_f32_32x32x16_bf16 a[112:127], a[252:255], v[92:95], a[112:127]
    ds_read_b64_tr_b16 a[252:253], v241 offset:20480
    ds_read_b64_tr_b16 a[254:255], v241 offset:22528
    v_exp_f32 v102, v22
    v_add_f32 v249, v249, v101
    v_mfma_f32_32x32x16_bf16 v[32:47], a[192:195], v[192:195], v[64:79]
    ds_read_b128 a[192:195], v230 offset:24576
    v_exp_f32 v103, v23
    v_cvt_pk_bf16_f32 v82, v100, v101
    v_add_f32 v249, v249, v102
    v_mfma_f32_32x32x16_bf16 v[32:47], a[196:199], v[196:199], v[32:47]
    ds_read_b128 a[196:199], v231 offset:24576
    v_exp_f32 v104, v24
    v_add_f32 v249, v249, v103
    v_exp_f32 v105, v25
    buffer_load_dwordx4 v245, s[12:15], s46 offen offset:3072 lds
    s_add_u32 s46, s46, 16384
    v_mfma_f32_32x32x16_bf16 v[32:47], a[200:203], v[200:203], v[32:47]
    ds_read_b128 a[200:203], v232 offset:24576
    v_cvt_pk_bf16_f32 v83, v102, v103
    v_add_f32 v249, v249, v104
    v_exp_f32 v106, v26
    v_add_f32 v249, v249, v105
    v_mfma_f32_32x32x16_bf16 v[32:47], a[204:207], v[204:207], v[32:47]
    ds_read_b128 a[204:207], v233 offset:24576
    v_exp_f32 v107, v27
    v_cvt_pk_bf16_f32 v84, v104, v105
    v_add_f32 v249, v249, v106
    v_mfma_f32_32x32x16_bf16 v[32:47], a[208:211], v[208:211], v[32:47]
    ds_read_b128 a[208:211], v234 offset:24576
    v_exp_f32 v108, v28
    v_add_f32 v249, v249, v107
    v_exp_f32 v109, v29
    v_mfma_f32_32x32x16_bf16 v[32:47], a[212:215], v[212:215], v[32:47]
    ds_read_b128 a[212:215], v235 offset:24576
    v_cvt_pk_bf16_f32 v85, v106, v107
    v_add_f32 v249, v249, v108
    v_exp_f32 v110, v30
    v_add_f32 v249, v249, v109
    buffer_load_dwordx4 v[120:123], v229, s[72:75], s49 offen
    v_mfma_f32_32x32x16_bf16 v[32:47], a[216:219], v[216:219], v[32:47]
    ds_read_b128 a[216:219], v236 offset:24576
    v_exp_f32 v111, v31
    v_cvt_pk_bf16_f32 v86, v108, v109
    v_add_f32 v249, v249, v110
    v_cvt_pk_bf16_f32 v87, v110, v111
    v_mfma_f32_32x32x16_bf16 v[32:47], a[220:223], v[220:223], v[32:47]
    ds_read_b128 a[220:223], v237 offset:24576
    v_add_f32 v249, v249, v111
    v_cmp_nge_f32 vcc, s50, v249
    s_cbranch_vccnz attn_kernel_stub5
attn_kernel_back5:
    v_add_f32 v247, v247, v249
    s_waitcnt lgkmcnt(4)
    v_mfma_f32_32x32x16_bf16 a[0:15], a[224:227], v[80:83], a[0:15]
    v_mfma_f32_32x32x16_bf16 a[16:31], a[228:231], v[80:83], a[16:31]
    v_mfma_f32_32x32x16_bf16 a[32:47], a[232:235], v[80:83], a[32:47]
    s_nop 2
    v_exp_f32 v96, v32
    v_exp_f32 v97, v33
    v_exp_f32 v98, v34
    v_mfma_f32_32x32x16_bf16 a[48:63], a[236:239], v[80:83], a[48:63]
    v_add_f32 v250, v96, v97
    v_exp_f32 v99, v35
    v_cvt_pk_bf16_f32 v88, v96, v97
    v_add_f32 v250, v250, v98
    v_mfma_f32_32x32x16_bf16 a[0:15], a[240:243], v[84:87], a[0:15]
    v_exp_f32 v100, v36
    v_add_f32 v250, v250, v99
    v_exp_f32 v101, v37
    v_cvt_pk_bf16_f32 v89, v98, v99
    v_mfma_f32_32x32x16_bf16 a[16:31], a[244:247], v[84:87], a[16:31]
    v_add_f32 v250, v250, v100
    v_exp_f32 v102, v38
    v_add_f32 v250, v250, v101
    v_exp_f32 v103, v39
    v_mfma_f32_32x32x16_bf16 a[32:47], a[248:251], v[84:87], a[32:47]
    v_cvt_pk_bf16_f32 v90, v100, v101
    v_add_f32 v250, v250, v102
    v_exp_f32 v104, v40
    v_add_f32 v250, v250, v103
    v_mfma_f32_32x32x16_bf16 a[48:63], a[252:255], v[84:87], a[48:63]
    v_exp_f32 v105, v41
    v_cvt_pk_bf16_f32 v91, v102, v103
    v_add_f32 v250, v250, v104
    v_exp_f32 v106, v42
    v_mfma_f32_32x32x16_bf16 v[16:31], a[192:195], v[160:163], v[48:63]
    v_add_f32 v250, v250, v105
    v_exp_f32 v107, v43
    v_cvt_pk_bf16_f32 v92, v104, v105
    v_add_f32 v250, v250, v106
    v_mfma_f32_32x32x16_bf16 v[16:31], a[196:199], v[164:167], v[16:31]
    v_exp_f32 v108, v44
    v_add_f32 v250, v250, v107
    v_exp_f32 v109, v45
    v_cvt_pk_bf16_f32 v93, v106, v107
    v_mfma_f32_32x32x16_bf16 v[16:31], a[200:203], v[168:171], v[16:31]
    v_add_f32 v250, v250, v108
    v_exp_f32 v110, v46
    v_add_f32 v250, v250, v109
    v_exp_f32 v111, v47
    v_mfma_f32_32x32x16_bf16 v[16:31], a[204:207], v[172:175], v[16:31]
    v_cvt_pk_bf16_f32 v94, v108, v109
    v_add_f32 v250, v250, v110
    v_cvt_pk_bf16_f32 v95, v110, v111
    v_add_f32 v250, v250, v111
    v_cmp_nge_f32 vcc, s51, v250
    s_waitcnt lgkmcnt(0)
    v_mfma_f32_32x32x16_bf16 v[16:31], a[208:211], v[176:179], v[16:31]
    s_cbranch_vccnz attn_kernel_stub6
attn_kernel_back6:
    v_add_f32 v248, v248, v250
    v_mfma_f32_32x32x16_bf16 v[16:31], a[212:215], v[180:183], v[16:31]
    v_mfma_f32_32x32x16_bf16 v[16:31], a[216:219], v[184:187], v[16:31]
    v_mfma_f32_32x32x16_bf16 v[16:31], a[220:223], v[188:191], v[16:31]
    v_mfma_f32_32x32x16_bf16 a[64:79], a[224:227], v[88:91], a[64:79]
    ds_read_b64_tr_b16 a[224:225], v238 offset:24576
    ds_read_b64_tr_b16 a[226:227], v238 offset:26624
    v_mfma_f32_32x32x16_bf16 a[80:95], a[228:231], v[88:91], a[80:95]
    ds_read_b64_tr_b16 a[228:229], v239 offset:24576
    ds_read_b64_tr_b16 a[230:231], v239 offset:26624
    v_mfma_f32_32x32x16_bf16 a[96:111], a[232:235], v[88:91], a[96:111]
    ds_read_b64_tr_b16 a[232:233], v240 offset:24576
    ds_read_b64_tr_b16 a[234:235], v240 offset:26624
    s_nop 2
    v_exp_f32 v96, v16
    v_exp_f32 v97, v17
    v_mfma_f32_32x32x16_bf16 a[112:127], a[236:239], v[88:91], a[112:127]
    ds_read_b64_tr_b16 a[236:237], v241 offset:24576
    ds_read_b64_tr_b16 a[238:239], v241 offset:26624
    v_exp_f32 v98, v18
    v_add_f32 v249, v96, v97
    v_mfma_f32_32x32x16_bf16 a[64:79], a[240:243], v[92:95], a[64:79]
    ds_read_b64_tr_b16 a[240:241], v238 offset:28672
    ds_read_b64_tr_b16 a[242:243], v238 offset:30720
    v_exp_f32 v99, v19
    v_cvt_pk_bf16_f32 v80, v96, v97
    v_add_f32 v249, v249, v98
    v_mfma_f32_32x32x16_bf16 a[80:95], a[244:247], v[92:95], a[80:95]
    ds_read_b64_tr_b16 a[244:245], v239 offset:28672
    ds_read_b64_tr_b16 a[246:247], v239 offset:30720
    v_exp_f32 v100, v20
    v_add_f32 v249, v249, v99
    v_mfma_f32_32x32x16_bf16 a[96:111], a[248:251], v[92:95], a[96:111]
    ds_read_b64_tr_b16 a[248:249], v240 offset:28672
    ds_read_b64_tr_b16 a[250:251], v240 offset:30720
    v_exp_f32 v101, v21
    v_cvt_pk_bf16_f32 v81, v98, v99
    v_add_f32 v249, v249, v100
    v_mfma_f32_32x32x16_bf16 a[112:127], a[252:255], v[92:95], a[112:127]
    ds_read_b64_tr_b16 a[252:253], v241 offset:28672
    ds_read_b64_tr_b16 a[254:255], v241 offset:30720
    v_exp_f32 v102, v22
    v_add_f32 v249, v249, v101
    s_waitcnt vmcnt(13)
    s_barrier
    v_mfma_f32_32x32x16_bf16 v[32:47], a[192:195], v[192:195], v[64:79]
    ds_read_b128 a[192:195], v230 offset:32768
    v_exp_f32 v103, v23
    v_cvt_pk_bf16_f32 v82, v100, v101
    v_add_f32 v249, v249, v102
    v_mfma_f32_32x32x16_bf16 v[32:47], a[196:199], v[196:199], v[32:47]
    ds_read_b128 a[196:199], v231 offset:32768
    v_exp_f32 v104, v24
    v_add_f32 v249, v249, v103
    v_exp_f32 v105, v25
    v_mfma_f32_32x32x16_bf16 v[32:47], a[200:203], v[200:203], v[32:47]
    ds_read_b128 a[200:203], v232 offset:32768
    v_cvt_pk_bf16_f32 v83, v102, v103
    v_add_f32 v249, v249, v104
    v_exp_f32 v106, v26
    v_add_f32 v249, v249, v105
    v_mfma_f32_32x32x16_bf16 v[32:47], a[204:207], v[204:207], v[32:47]
    ds_read_b128 a[204:207], v233 offset:32768
    v_exp_f32 v107, v27
    v_cvt_pk_bf16_f32 v84, v104, v105
    v_add_f32 v249, v249, v106
    v_mfma_f32_32x32x16_bf16 v[32:47], a[208:211], v[208:211], v[32:47]
    ds_read_b128 a[208:211], v234 offset:32768
    v_exp_f32 v108, v28
    v_add_f32 v249, v249, v107
    v_exp_f32 v109, v29
    v_mfma_f32_32x32x16_bf16 v[32:47], a[212:215], v[212:215], v[32:47]
    ds_read_b128 a[212:215], v235 offset:32768
    v_cvt_pk_bf16_f32 v85, v106, v107
    v_add_f32 v249, v249, v108
    v_exp_f32 v110, v30
    v_add_f32 v249, v249, v109
    s_add_u32 m0, s45, 0
    s_nop 0
    buffer_load_dwordx4 v246, s[16:19], s47 offen offset:0 lds
    v_mfma_f32_32x32x16_bf16 v[32:47], a[216:219], v[216:219], v[32:47]
    ds_read_b128 a[216:219], v236 offset:32768
    v_exp_f32 v111, v31
    v_cvt_pk_bf16_f32 v86, v108, v109
    v_add_f32 v249, v249, v110
    v_cvt_pk_bf16_f32 v87, v110, v111
    v_mfma_f32_32x32x16_bf16 v[32:47], a[220:223], v[220:223], v[32:47]
    ds_read_b128 a[220:223], v237 offset:32768
    v_add_f32 v249, v249, v111
    v_cmp_nge_f32 vcc, s50, v249
    s_cbranch_vccnz attn_kernel_stub7
attn_kernel_back7:
    v_add_f32 v247, v247, v249
    s_waitcnt lgkmcnt(4)
    v_mfma_f32_32x32x16_bf16 a[0:15], a[224:227], v[80:83], a[0:15]
    v_mfma_f32_32x32x16_bf16 a[16:31], a[228:231], v[80:83], a[16:31]
    buffer_load_dwordx4 v246, s[16:19], s47 offen offset:1024 lds
    v_mfma_f32_32x32x16_bf16 a[32:47], a[232:235], v[80:83], a[32:47]
    s_nop 1
    v_exp_f32 v96, v32
    v_exp_f32 v97, v33
    v_exp_f32 v98, v34
    v_mfma_f32_32x32x16_bf16 a[48:63], a[236:239], v[80:83], a[48:63]
    v_add_f32 v250, v96, v97
    v_exp_f32 v99, v35
    v_cvt_pk_bf16_f32 v88, v96, v97
    v_add_f32 v250, v250, v98
    v_mfma_f32_32x32x16_bf16 a[0:15], a[240:243], v[84:87], a[0:15]
    v_exp_f32 v100, v36
    v_add_f32 v250, v250, v99
    v_exp_f32 v101, v37
    v_cvt_pk_bf16_f32 v89, v98, v99
    v_mfma_f32_32x32x16_bf16 a[16:31], a[244:247], v[84:87], a[16:31]
    v_add_f32 v250, v250, v100
    v_exp_f32 v102, v38
    v_add_f32 v250, v250, v101
    v_exp_f32 v103, v39
    buffer_load_dwordx4 v246, s[16:19], s47 offen offset:2048 lds
    v_mfma_f32_32x32x16_bf16 a[32:47], a[248:251], v[84:87], a[32:47]
    v_cvt_pk_bf16_f32 v90, v100, v101
    v_add_f32 v250, v250, v102
    v_exp_f32 v104, v40
    v_add_f32 v250, v250, v103
    v_mfma_f32_32x32x16_bf16 a[48:63], a[252:255], v[84:87], a[48:63]
    v_exp_f32 v105, v41
    v_cvt_pk_bf16_f32 v91, v102, v103
    v_add_f32 v250, v250, v104
    v_exp_f32 v106, v42
    v_mfma_f32_32x32x16_bf16 v[16:31], a[192:195], v[160:163], v[48:63]
    v_add_f32 v250, v250, v105
    v_exp_f32 v107, v43
    v_cvt_pk_bf16_f32 v92, v104, v105
    v_add_f32 v250, v250, v106
    v_mfma_f32_32x32x16_bf16 v[16:31], a[196:199], v[164:167], v[16:31]
    v_exp_f32 v108, v44
    v_add_f32 v250, v250, v107
    v_exp_f32 v109, v45
    v_cvt_pk_bf16_f32 v93, v106, v107
    buffer_load_dwordx4 v246, s[16:19], s47 offen offset:3072 lds
    s_add_u32 s47, s47, 16384
    v_mfma_f32_32x32x16_bf16 v[16:31], a[200:203], v[168:171], v[16:31]
    v_add_f32 v250, v250, v108
    v_exp_f32 v110, v46
    v_add_f32 v250, v250, v109
    v_exp_f32 v111, v47
    v_mfma_f32_32x32x16_bf16 v[16:31], a[204:207], v[172:175], v[16:31]
    v_cvt_pk_bf16_f32 v94, v108, v109
    v_add_f32 v250, v250, v110
    v_cvt_pk_bf16_f32 v95, v110, v111
    v_add_f32 v250, v250, v111
    v_cmp_nge_f32 vcc, s51, v250
    s_waitcnt lgkmcnt(0)
    v_mfma_f32_32x32x16_bf16 v[16:31], a[208:211], v[176:179], v[16:31]
    s_cbranch_vccnz attn_kernel_stub8
attn_kernel_back8:
    v_add_f32 v248, v248, v250
    v_mfma_f32_32x32x16_bf16 v[16:31], a[212:215], v[180:183], v[16:31]
    s_add_u32 m0, s44, 16384
    s_nop 0
    buffer_load_dwordx4 v242, s[12:15], s46 offen offset:0 lds
    v_mfma_f32_32x32x16_bf16 v[16:31], a[216:219], v[184:187], v[16:31]
    v_mfma_f32_32x32x16_bf16 v[16:31], a[220:223], v[188:191], v[16:31]
    v_mfma_f32_32x32x16_bf16 a[64:79], a[224:227], v[88:91], a[64:79]
    ds_read_b64_tr_b16 a[224:225], v238 offset:32768
    ds_read_b64_tr_b16 a[226:227], v238 offset:34816
    v_mfma_f32_32x32x16_bf16 a[80:95], a[228:231], v[88:91], a[80:95]
    ds_read_b64_tr_b16 a[228:229], v239 offset:32768
    ds_read_b64_tr_b16 a[230:231], v239 offset:34816
    buffer_load_dwordx4 v243, s[12:15], s46 offen offset:1024 lds
    v_mfma_f32_32x32x16_bf16 a[96:111], a[232:235], v[88:91], a[96:111]
    ds_read_b64_tr_b16 a[232:233], v240 offset:32768
    ds_read_b64_tr_b16 a[234:235], v240 offset:34816
    s_nop 1
    v_exp_f32 v96, v16
    v_exp_f32 v97, v17
    v_mfma_f32_32x32x16_bf16 a[112:127], a[236:239], v[88:91], a[112:127]
    ds_read_b64_tr_b16 a[236:237], v241 offset:32768
    ds_read_b64_tr_b16 a[238:239], v241 offset:34816
    v_exp_f32 v98, v18
    v_add_f32 v249, v96, v97
    v_mfma_f32_32x32x16_bf16 a[64:79], a[240:243], v[92:95], a[64:79]
    ds_read_b64_tr_b16 a[240:241], v238 offset:36864
    ds_read_b64_tr_b16 a[242:243], v238 offset:38912
    v_exp_f32 v99, v19
    v_cvt_pk_bf16_f32 v80, v96, v97
    v_add_f32 v249, v249, v98
    v_mfma_f32_32x32x16_bf16 a[80:95], a[244:247], v[92:95], a[80:95]
    ds_read_b64_tr_b16 a[244:245], v239 offset:36864
    ds_read_b64_tr_b16 a[246:247], v239 offset:38912
    v_exp_f32 v100, v20
    v_add_f32 v249, v249, v99
    buffer_load_dwordx4 v244, s[12:15], s46 offen offset:2048 lds
    v_mfma_f32_32x32x16_bf16 a[96:111], a[248:251], v[92:95], a[96:111]
    ds_read_b64_tr_b16 a[248:249], v240 offset:36864
    ds_read_b64_tr_b16 a[250:251], v240 offset:38912
    v_exp_f32 v101, v21
    v_cvt_pk_bf16_f32 v81, v98, v99
    v_add_f32 v249, v249, v100
    v_mfma_f32_32x32x16_bf16 a[112:127], a[252:255], v[92:95], a[112:127]
    ds_read_b64_tr_b16 a[252:253], v241 offset:36864
    ds_read_b64_tr_b16 a[254:255], v241 offset:38912
    v_exp_f32 v102, v22
    v_add_f32 v249, v249, v101
    v_mfma_f32_32x32x16_bf16 v[32:47], a[192:195], v[192:195], v[64:79]
    ds_read_b128 a[192:195], v230 offset:40960
    v_exp_f32 v103, v23
    v_cvt_pk_bf16_f32 v82, v100, v101
    v_add_f32 v249, v249, v102
    v_mfma_f32_32x32x16_bf16 v[32:47], a[196:199], v[196:199], v[32:47]
    ds_read_b128 a[196:199], v231 offset:40960
    v_exp_f32 v104, v24
    v_add_f32 v249, v249, v103
    v_exp_f32 v105, v25
    buffer_load_dwordx4 v245, s[12:15], s46 offen offset:3072 lds
    s_add_u32 s46, s46, 16384
    v_mfma_f32_32x32x16_bf16 v[32:47], a[200:203], v[200:203], v[32:47]
    ds_read_b128 a[200:203], v232 offset:40960
    v_cvt_pk_bf16_f32 v83, v102, v103
    v_add_f32 v249, v249, v104
    v_exp_f32 v106, v26
    v_add_f32 v249, v249, v105
    v_mfma_f32_32x32x16_bf16 v[32:47], a[204:207], v[204:207], v[32:47]
    ds_read_b128 a[204:207], v233 offset:40960
    v_exp_f32 v107, v27
    v_cvt_pk_bf16_f32 v84, v104, v105
    v_add_f32 v249, v249, v106
    v_mfma_f32_32x32x16_bf16 v[32:47], a[208:211], v[208:211], v[32:47]
    ds_read_b128 a[208:211], v234 offset:40960
    v_exp_f32 v108, v28
    v_add_f32 v249, v249, v107
    v_exp_f32 v109, v29
    v_mfma_f32_32x32x16_bf16 v[32:47], a[212:215], v[212:215], v[32:47]
    ds_read_b128 a[212:215], v235 offset:40960
    v_cvt_pk_bf16_f32 v85, v106, v107
    v_add_f32 v249, v249, v108
    v_exp_f32 v110, v30
    v_add_f32 v249, v249, v109
    buffer_load_dwordx4 v[120:123], v229, s[76:79], s49 offen
    v_mfma_f32_32x32x16_bf16 v[32:47], a[216:219], v[216:219], v[32:47]
    ds_read_b128 a[216:219], v236 offset:40960
    v_exp_f32 v111, v31
    v_cvt_pk_bf16_f32 v86, v108, v109
    v_add_f32 v249, v249, v110
    v_cvt_pk_bf16_f32 v87, v110, v111
    v_mfma_f32_32x32x16_bf16 v[32:47], a[220:223], v[220:223], v[32:47]
    ds_read_b128 a[220:223], v237 offset:40960
    v_add_f32 v249, v249, v111
    v_cmp_nge_f32 vcc, s50, v249
    s_cbranch_vccnz attn_kernel_stub9
attn_kernel_back9:
    v_add_f32 v247, v247, v249
    s_waitcnt lgkmcnt(4)
    v_mfma_f32_32x32x16_bf16 a[0:15], a[224:227], v[80:83], a[0:15]
    v_mfma_f32_32x32x16_bf16 a[16:31], a[228:231], v[80:83], a[16:31]
    v_mfma_f32_32x32x16_bf16 a[32:47], a[232:235], v[80:83], a[32:47]
    s_nop 2
    v_exp_f32 v96, v32
    v_exp_f32 v97, v33
    v_exp_f32 v98, v34
    v_mfma_f32_32x32x16_bf16 a[48:63], a[236:239], v[80:83], a[48:63]
    v_add_f32 v250, v96, v97
    v_exp_f32 v99, v35
    v_cvt_pk_bf16_f32 v88, v96, v97
    v_add_f32 v250, v250, v98
    v_mfma_f32_32x32x16_bf16 a[0:15], a[240:243], v[84:87], a[0:15]
    v_exp_f32 v100, v36
    v_add_f32 v250, v250, v99
    v_exp_f32 v101, v37
    v_cvt_pk_bf16_f32 v89, v98, v99
    v_mfma_f32_32x32x16_bf16 a[16:31], a[244:247], v[84:87], a[16:31]
    v_add_f32 v250, v250, v100
    v_exp_f32 v102, v38
    v_add_f32 v250, v250, v101
    v_exp_f32 v103, v39
    v_mfma_f32_32x32x16_bf16 a[32:47], a[248:251], v[84:87], a[32:47]
    v_cvt_pk_bf16_f32 v90, v100, v101
    v_add_f32 v250, v250, v102
    v_exp_f32 v104, v40
    v_add_f32 v250, v250, v103
    v_mfma_f32_32x32x16_bf16 a[48:63], a[252:255], v[84:87], a[48:63]
    v_exp_f32 v105, v41
    v_cvt_pk_bf16_f32 v91, v102, v103
    v_add_f32 v250, v250, v104
    v_exp_f32 v106, v42
    v_mfma_f32_32x32x16_bf16 v[16:31], a[192:195], v[160:163], v[48:63]
    v_add_f32 v250, v250, v105
    v_exp_f32 v107, v43
    v_cvt_pk_bf16_f32 v92, v104, v105
    v_add_f32 v250, v250, v106
    v_mfma_f32_32x32x16_bf16 v[16:31], a[196:199], v[164:167], v[16:31]
    v_exp_f32 v108, v44
    v_add_f32 v250, v250, v107
    v_exp_f32 v109, v45
    v_cvt_pk_bf16_f32 v93, v106, v107
    v_mfma_f32_32x32x16_bf16 v[16:31], a[200:203], v[168:171], v[16:31]
    v_add_f32 v250, v250, v108
    v_exp_f32 v110, v46
    v_add_f32 v250, v250, v109
    v_exp_f32 v111, v47
    v_mfma_f32_32x32x16_bf16 v[16:31], a[204:207], v[172:175], v[16:31]
    v_cvt_pk_bf16_f32 v94, v108, v109
    v_add_f32 v250, v250, v110
    v_cvt_pk_bf16_f32 v95, v110, v111
    v_add_f32 v250, v250, v111
    v_cmp_nge_f32 vcc, s51, v250
    s_waitcnt lgkmcnt(0)
    v_mfma_f32_32x32x16_bf16 v[16:31], a[208:211], v[176:179], v[16:31]
    s_cbranch_vccnz attn_kernel_stub10
attn_kernel_back10:
    v_add_f32 v248, v248, v250
    v_mfma_f32_32x32x16_bf16 v[16:31], a[212:215], v[180:183], v[16:31]
    v_mfma_f32_32x32x16_bf16 v[16:31], a[216:219], v[184:187], v[16:31]
    v_mfma_f32_32x32x16_bf16 v[16:31], a[220:223], v[188:191], v[16:31]
    v_mfma_f32_32x32x16_bf16 a[64:79], a[224:227], v[88:91], a[64:79]
    ds_read_b64_tr_b16 a[224:225], v238 offset:40960
    ds_read_b64_tr_b16 a[226:227], v238 offset:43008
    v_mfma_f32_32x32x16_bf16 a[80:95], a[228:231], v[88:91], a[80:95]
    ds_read_b64_tr_b16 a[228:229], v239 offset:40960
    ds_read_b64_tr_b16 a[230:231], v239 offset:43008
    v_mfma_f32_32x32x16_bf16 a[96:111], a[232:235], v[88:91], a[96:111]
    ds_read_b64_tr_b16 a[232:233], v240 offset:40960
    ds_read_b64_tr_b16 a[234:235], v240 offset:43008
    s_nop 2
    v_exp_f32 v96, v16
    v_exp_f32 v97, v17
    v_mfma_f32_32x32x16_bf16 a[112:127], a[236:239], v[88:91], a[112:127]
    ds_read_b64_tr_b16 a[236:237], v241 offset:40960
    ds_read_b64_tr_b16 a[238:239], v241 offset:43008
    v_exp_f32 v98, v18
    v_add_f32 v249, v96, v97
    v_mfma_f32_32x32x16_bf16 a[64:79], a[240:243], v[92:95], a[64:79]
    ds_read_b64_tr_b16 a[240:241], v238 offset:45056
    ds_read_b64_tr_b16 a[242:243], v238 offset:47104
    v_exp_f32 v99, v19
    v_cvt_pk_bf16_f32 v80, v96, v97
    v_add_f32 v249, v249, v98
    v_mfma_f32_32x32x16_bf16 a[80:95], a[244:247], v[92:95], a[80:95]
    ds_read_b64_tr_b16 a[244:245], v239 offset:45056
    ds_read_b64_tr_b16 a[246:247], v239 offset:47104
    v_exp_f32 v100, v20
    v_add_f32 v249, v249, v99
    v_mfma_f32_32x32x16_bf16 a[96:111], a[248:251], v[92:95], a[96:111]
    ds_read_b64_tr_b16 a[248:249], v240 offset:45056
    ds_read_b64_tr_b16 a[250:251], v240 offset:47104
    v_exp_f32 v101, v21
    v_cvt_pk_bf16_f32 v81, v98, v99
    v_add_f32 v249, v249, v100
    v_mfma_f32_32x32x16_bf16 a[112:127], a[252:255], v[92:95], a[112:127]
    ds_read_b64_tr_b16 a[252:253], v241 offset:45056
    ds_read_b64_tr_b16 a[254:255], v241 offset:47104
    v_exp_f32 v102, v22
    v_add_f32 v249, v249, v101
    s_waitcnt vmcnt(14)
    s_barrier
    v_mfma_f32_32x32x16_bf16 v[32:47], a[192:195], v[192:195], v[64:79]
    ds_read_b128 a[192:195], v230 offset:49152
    v_exp_f32 v103, v23
    v_cvt_pk_bf16_f32 v82, v100, v101
    v_add_f32 v249, v249, v102
    v_mfma_f32_32x32x16_bf16 v[32:47], a[196:199], v[196:199], v[32:47]
    ds_read_b128 a[196:199], v231 offset:49152
    v_exp_f32 v104, v24
    v_add_f32 v249, v249, v103
    v_exp_f32 v105, v25
    v_mfma_f32_32x32x16_bf16 v[32:47], a[200:203], v[200:203], v[32:47]
    ds_read_b128 a[200:203], v232 offset:49152
    v_cvt_pk_bf16_f32 v83, v102, v103
    v_add_f32 v249, v249, v104
    v_exp_f32 v106, v26
    v_add_f32 v249, v249, v105
    v_mfma_f32_32x32x16_bf16 v[32:47], a[204:207], v[204:207], v[32:47]
    ds_read_b128 a[204:207], v233 offset:49152
    v_exp_f32 v107, v27
    v_cvt_pk_bf16_f32 v84, v104, v105
    v_add_f32 v249, v249, v106
    v_mfma_f32_32x32x16_bf16 v[32:47], a[208:211], v[208:211], v[32:47]
    ds_read_b128 a[208:211], v234 offset:49152
    v_exp_f32 v108, v28
    v_add_f32 v249, v249, v107
    v_exp_f32 v109, v29
    v_mfma_f32_32x32x16_bf16 v[32:47], a[212:215], v[212:215], v[32:47]
    ds_read_b128 a[212:215], v235 offset:49152
    v_cvt_pk_bf16_f32 v85, v106, v107
    v_add_f32 v249, v249, v108
    v_exp_f32 v110, v30
    v_add_f32 v249, v249, v109
    s_add_u32 m0, s45, 16384
    s_nop 0
    buffer_load_dwordx4 v246, s[16:19], s47 offen offset:0 lds
    v_mfma_f32_32x32x16_bf16 v[32:47], a[216:219], v[216:219], v[32:47]
    ds_read_b128 a[216:219], v236 offset:49152
    v_exp_f32 v111, v31
    v_cvt_pk_bf16_f32 v86, v108, v109
    v_add_f32 v249, v249, v110
    v_cvt_pk_bf16_f32 v87, v110, v111
    v_mfma_f32_32x32x16_bf16 v[32:47], a[220:223], v[220:223], v[32:47]
    ds_read_b128 a[220:223], v237 offset:49152
    v_add_f32 v249, v249, v111
    v_cmp_nge_f32 vcc, s50, v249
    s_cbranch_vccnz attn_kernel_stub11
attn_kernel_back11:
    v_add_f32 v247, v247, v249
    s_waitcnt lgkmcnt(4)
    v_mfma_f32_32x32x16_bf16 a[0:15], a[224:227], v[80:83], a[0:15]
    v_mfma_f32_32x32x16_bf16 a[16:31], a[228:231], v[80:83], a[16:31]
    buffer_load_dwordx4 v246, s[16:19], s47 offen offset:1024 lds
    v_mfma_f32_32x32x16_bf16 a[32:47], a[232:235], v[80:83], a[32:47]
    s_nop 1
    v_exp_f32 v96, v32
    v_exp_f32 v97, v33
    v_exp_f32 v98, v34
    v_mfma_f32_32x32x16_bf16 a[48:63], a[236:239], v[80:83], a[48:63]
    v_add_f32 v250, v96, v97
    v_exp_f32 v99, v35
    v_cvt_pk_bf16_f32 v88, v96, v97
    v_add_f32 v250, v250, v98
    v_mfma_f32_32x32x16_bf16 a[0:15], a[240:243], v[84:87], a[0:15]
    v_exp_f32 v100, v36
    v_add_f32 v250, v250, v99
    v_exp_f32 v101, v37
    v_cvt_pk_bf16_f32 v89, v98, v99
    v_mfma_f32_32x32x16_bf16 a[16:31], a[244:247], v[84:87], a[16:31]
    v_add_f32 v250, v250, v100
    v_exp_f32 v102, v38
    v_add_f32 v250, v250, v101
    v_exp_f32 v103, v39
    buffer_load_dwordx4 v246, s[16:19], s47 offen offset:2048 lds
    v_mfma_f32_32x32x16_bf16 a[32:47], a[248:251], v[84:87], a[32:47]
    v_cvt_pk_bf16_f32 v90, v100, v101
    v_add_f32 v250, v250, v102
    v_exp_f32 v104, v40
    v_add_f32 v250, v250, v103
    v_mfma_f32_32x32x16_bf16 a[48:63], a[252:255], v[84:87], a[48:63]
    v_exp_f32 v105, v41
    v_cvt_pk_bf16_f32 v91, v102, v103
    v_add_f32 v250, v250, v104
    v_exp_f32 v106, v42
    v_mfma_f32_32x32x16_bf16 v[16:31], a[192:195], v[160:163], v[48:63]
    v_add_f32 v250, v250, v105
    v_exp_f32 v107, v43
    v_cvt_pk_bf16_f32 v92, v104, v105
    v_add_f32 v250, v250, v106
    v_mfma_f32_32x32x16_bf16 v[16:31], a[196:199], v[164:167], v[16:31]
    v_exp_f32 v108, v44
    v_add_f32 v250, v250, v107
    v_exp_f32 v109, v45
    v_cvt_pk_bf16_f32 v93, v106, v107
    buffer_load_dwordx4 v246, s[16:19], s47 offen offset:3072 lds
    s_add_u32 s47, s47, 16384
    v_mfma_f32_32x32x16_bf16 v[16:31], a[200:203], v[168:171], v[16:31]
    v_add_f32 v250, v250, v108
    v_exp_f32 v110, v46
    v_add_f32 v250, v250, v109
    v_exp_f32 v111, v47
    v_mfma_f32_32x32x16_bf16 v[16:31], a[204:207], v[172:175], v[16:31]
    v_cvt_pk_bf16_f32 v94, v108, v109
    v_add_f32 v250, v250, v110
    v_cvt_pk_bf16_f32 v95, v110, v111
    v_add_f32 v250, v250, v111
    v_cmp_nge_f32 vcc, s51, v250
    s_waitcnt lgkmcnt(0)
    v_mfma_f32_32x32x16_bf16 v[16:31], a[208:211], v[176:179], v[16:31]
    s_cbranch_vccnz attn_kernel_stub12
attn_kernel_back12:
    v_add_f32 v248, v248, v250
    v_mfma_f32_32x32x16_bf16 v[16:31], a[212:215], v[180:183], v[16:31]
    s_add_u32 m0, s44, 32768
    s_nop 0
    buffer_load_dwordx4 v242, s[12:15], s46 offen offset:0 lds
    v_mfma_f32_32x32x16_bf16 v[16:31], a[216:219], v[184:187], v[16:31]
    v_mfma_f32_32x32x16_bf16 v[16:31], a[220:223], v[188:191], v[16:31]
    v_mfma_f32_32x32x16_bf16 a[64:79], a[224:227], v[88:91], a[64:79]
    ds_read_b64_tr_b16 a[224:225], v238 offset:49152
    ds_read_b64_tr_b16 a[226:227], v238 offset:51200
    v_mfma_f32_32x32x16_bf16 a[80:95], a[228:231], v[88:91], a[80:95]
    ds_read_b64_tr_b16 a[228:229], v239 offset:49152
    ds_read_b64_tr_b16 a[230:231], v239 offset:51200
    buffer_load_dwordx4 v243, s[12:15], s46 offen offset:1024 lds
    v_mfma_f32_32x32x16_bf16 a[96:111], a[232:235], v[88:91], a[96:111]
    ds_read_b64_tr_b16 a[232:233], v240 offset:49152
    ds_read_b64_tr_b16 a[234:235], v240 offset:51200
    s_nop 1
    v_exp_f32 v96, v16
    v_exp_f32 v97, v17
    v_mfma_f32_32x32x16_bf16 a[112:127], a[236:239], v[88:91], a[112:127]
    ds_read_b64_tr_b16 a[236:237], v241 offset:49152
    ds_read_b64_tr_b16 a[238:239], v241 offset:51200
    v_exp_f32 v98, v18
    v_add_f32 v249, v96, v97
    v_mfma_f32_32x32x16_bf16 a[64:79], a[240:243], v[92:95], a[64:79]
    ds_read_b64_tr_b16 a[240:241], v238 offset:53248
    ds_read_b64_tr_b16 a[242:243], v238 offset:55296
    v_exp_f32 v99, v19
    v_cvt_pk_bf16_f32 v80, v96, v97
    v_add_f32 v249, v249, v98
    v_mfma_f32_32x32x16_bf16 a[80:95], a[244:247], v[92:95], a[80:95]
    ds_read_b64_tr_b16 a[244:245], v239 offset:53248
    ds_read_b64_tr_b16 a[246:247], v239 offset:55296
    v_exp_f32 v100, v20
    v_add_f32 v249, v249, v99
    buffer_load_dwordx4 v244, s[12:15], s46 offen offset:2048 lds
    v_mfma_f32_32x32x16_bf16 a[96:111], a[248:251], v[92:95], a[96:111]
    ds_read_b64_tr_b16 a[248:249], v240 offset:53248
    ds_read_b64_tr_b16 a[250:251], v240 offset:55296
    v_exp_f32 v101, v21
    v_cvt_pk_bf16_f32 v81, v98, v99
    v_add_f32 v249, v249, v100
    v_mfma_f32_32x32x16_bf16 a[112:127], a[252:255], v[92:95], a[112:127]
    ds_read_b64_tr_b16 a[252:253], v241 offset:53248
    ds_read_b64_tr_b16 a[254:255], v241 offset:55296
    v_exp_f32 v102, v22
    v_add_f32 v249, v249, v101
    v_mfma_f32_32x32x16_bf16 v[32:47], a[192:195], v[192:195], v[64:79]
    ds_read_b128 a[192:195], v230 offset:57344
    v_exp_f32 v103, v23
    v_cvt_pk_bf16_f32 v82, v100, v101
    v_add_f32 v249, v249, v102
    v_mfma_f32_32x32x16_bf16 v[32:47], a[196:199], v[196:199], v[32:47]
    ds_read_b128 a[196:199], v231 offset:57344
    v_exp_f32 v104, v24
    v_add_f32 v249, v249, v103
    v_exp_f32 v105, v25
    buffer_load_dwordx4 v245, s[12:15], s46 offen offset:3072 lds
    s_add_u32 s46, s46, 16384
    v_mfma_f32_32x32x16_bf16 v[32:47], a[200:203], v[200:203], v[32:47]
    ds_read_b128 a[200:203], v232 offset:57344
    v_cvt_pk_bf16_f32 v83, v102, v103
    v_add_f32 v249, v249, v104
    v_exp_f32 v106, v26
    v_add_f32 v249, v249, v105
    v_mfma_f32_32x32x16_bf16 v[32:47], a[204:207], v[204:207], v[32:47]
    ds_read_b128 a[204:207], v233 offset:57344
    v_exp_f32 v107, v27
    v_cvt_pk_bf16_f32 v84, v104, v105
    v_add_f32 v249, v249, v106
    v_mfma_f32_32x32x16_bf16 v[32:47], a[208:211], v[208:211], v[32:47]
    ds_read_b128 a[208:211], v234 offset:57344
    v_exp_f32 v108, v28
    v_add_f32 v249, v249, v107
    v_exp_f32 v109, v29
    v_mfma_f32_32x32x16_bf16 v[32:47], a[212:215], v[212:215], v[32:47]
    ds_read_b128 a[212:215], v235 offset:57344
    v_cvt_pk_bf16_f32 v85, v106, v107
    v_add_f32 v249, v249, v108
    v_exp_f32 v110, v30
    v_add_f32 v249, v249, v109
    buffer_load_dwordx4 v[120:123], v229, s[80:83], s49 offen
    v_mfma_f32_32x32x16_bf16 v[32:47], a[216:219], v[216:219], v[32:47]
    ds_read_b128 a[216:219], v236 offset:57344
    v_exp_f32 v111, v31
    v_cvt_pk_bf16_f32 v86, v108, v109
    v_add_f32 v249, v249, v110
    v_cvt_pk_bf16_f32 v87, v110, v111
    v_mfma_f32_32x32x16_bf16 v[32:47], a[220:223], v[220:223], v[32:47]
    ds_read_b128 a[220:223], v237 offset:57344
    v_add_f32 v249, v249, v111
    v_cmp_nge_f32 vcc, s50, v249
    s_cbranch_vccnz attn_kernel_stub13
attn_kernel_back13:
    v_add_f32 v247, v247, v249
    s_waitcnt lgkmcnt(4)
    v_mfma_f32_32x32x16_bf16 a[0:15], a[224:227], v[80:83], a[0:15]
    v_mfma_f32_32x32x16_bf16 a[16:31], a[228:231], v[80:83], a[16:31]
    v_mfma_f32_32x32x16_bf16 a[32:47], a[232:235], v[80:83], a[32:47]
    s_nop 2
    v_exp_f32 v96, v32
    v_exp_f32 v97, v33
    v_exp_f32 v98, v34
    v_mfma_f32_32x32x16_bf16 a[48:63], a[236:239], v[80:83], a[48:63]
    v_add_f32 v250, v96, v97
    v_exp_f32 v99, v35
    v_cvt_pk_bf16_f32 v88, v96, v97
    v_add_f32 v250, v250, v98
    v_mfma_f32_32x32x16_bf16 a[0:15], a[240:243], v[84:87], a[0:15]
    v_exp_f32 v100, v36
    v_add_f32 v250, v250, v99
    v_exp_f32 v101, v37
    v_cvt_pk_bf16_f32 v89, v98, v99
    v_mfma_f32_32x32x16_bf16 a[16:31], a[244:247], v[84:87], a[16:31]
    v_add_f32 v250, v250, v100
    v_exp_f32 v102, v38
    v_add_f32 v250, v250, v101
    v_exp_f32 v103, v39
    v_mfma_f32_32x32x16_bf16 a[32:47], a[248:251], v[84:87], a[32:47]
    v_cvt_pk_bf16_f32 v90, v100, v101
    v_add_f32 v250, v250, v102
    v_exp_f32 v104, v40
    v_add_f32 v250, v250, v103
    v_mfma_f32_32x32x16_bf16 a[48:63], a[252:255], v[84:87], a[48:63]
    v_exp_f32 v105, v41
    v_cvt_pk_bf16_f32 v91, v102, v103
    v_add_f32 v250, v250, v104
    v_exp_f32 v106, v42
    v_mfma_f32_32x32x16_bf16 v[16:31], a[192:195], v[160:163], v[48:63]
    v_add_f32 v250, v250, v105
    v_exp_f32 v107, v43
    v_cvt_pk_bf16_f32 v92, v104, v105
    v_add_f32 v250, v250, v106
    v_mfma_f32_32x32x16_bf16 v[16:31], a[196:199], v[164:167], v[16:31]
    v_exp_f32 v108, v44
    v_add_f32 v250, v250, v107
    v_exp_f32 v109, v45
    v_cvt_pk_bf16_f32 v93, v106, v107
    v_mfma_f32_32x32x16_bf16 v[16:31], a[200:203], v[168:171], v[16:31]
    v_add_f32 v250, v250, v108
    v_exp_f32 v110, v46
    v_add_f32 v250, v250, v109
    v_exp_f32 v111, v47
    v_mfma_f32_32x32x16_bf16 v[16:31], a[204:207], v[172:175], v[16:31]
    v_cvt_pk_bf16_f32 v94, v108, v109
    v_add_f32 v250, v250, v110
    v_cvt_pk_bf16_f32 v95, v110, v111
    v_add_f32 v250, v250, v111
    v_cmp_nge_f32 vcc, s51, v250
    s_waitcnt lgkmcnt(0)
    v_mfma_f32_32x32x16_bf16 v[16:31], a[208:211], v[176:179], v[16:31]
    s_cbranch_vccnz attn_kernel_stub14
attn_kernel_back14:
    v_add_f32 v248, v248, v250
    v_mfma_f32_32x32x16_bf16 v[16:31], a[212:215], v[180:183], v[16:31]
    v_mfma_f32_32x32x16_bf16 v[16:31], a[216:219], v[184:187], v[16:31]
    v_mfma_f32_32x32x16_bf16 v[16:31], a[220:223], v[188:191], v[16:31]
    v_mfma_f32_32x32x16_bf16 a[64:79], a[224:227], v[88:91], a[64:79]
    ds_read_b64_tr_b16 a[224:225], v238 offset:57344
    ds_read_b64_tr_b16 a[226:227], v238 offset:59392
    v_mfma_f32_32x32x16_bf16 a[80:95], a[228:231], v[88:91], a[80:95]
    ds_read_b64_tr_b16 a[228:229], v239 offset:57344
    ds_read_b64_tr_b16 a[230:231], v239 offset:59392
    v_mfma_f32_32x32x16_bf16 a[96:111], a[232:235], v[88:91], a[96:111]
    ds_read_b64_tr_b16 a[232:233], v240 offset:57344
    ds_read_b64_tr_b16 a[234:235], v240 offset:59392
    s_nop 2
    v_exp_f32 v96, v16
    v_exp_f32 v97, v17
    v_mfma_f32_32x32x16_bf16 a[112:127], a[236:239], v[88:91], a[112:127]
    ds_read_b64_tr_b16 a[236:237], v241 offset:57344
    ds_read_b64_tr_b16 a[238:239], v241 offset:59392
    v_exp_f32 v98, v18
    v_add_f32 v249, v96, v97
    v_mfma_f32_32x32x16_bf16 a[64:79], a[240:243], v[92:95], a[64:79]
    ds_read_b64_tr_b16 a[240:241], v238 offset:61440
    ds_read_b64_tr_b16 a[242:243], v238 offset:63488
    v_exp_f32 v99, v19
    v_cvt_pk_bf16_f32 v80, v96, v97
    v_add_f32 v249, v249, v98
    v_mfma_f32_32x32x16_bf16 a[80:95], a[244:247], v[92:95], a[80:95]
    ds_read_b64_tr_b16 a[244:245], v239 offset:61440
    ds_read_b64_tr_b16 a[246:247], v239 offset:63488
    v_exp_f32 v100, v20
    v_add_f32 v249, v249, v99
    v_mfma_f32_32x32x16_bf16 a[96:111], a[248:251], v[92:95], a[96:111]
    ds_read_b64_tr_b16 a[248:249], v240 offset:61440
    ds_read_b64_tr_b16 a[250:251], v240 offset:63488
    v_exp_f32 v101, v21
    v_cvt_pk_bf16_f32 v81, v98, v99
    v_add_f32 v249, v249, v100
    v_mfma_f32_32x32x16_bf16 a[112:127], a[252:255], v[92:95], a[112:127]
    ds_read_b64_tr_b16 a[252:253], v241 offset:61440
    ds_read_b64_tr_b16 a[254:255], v241 offset:63488
    v_exp_f32 v102, v22
    v_add_f32 v249, v249, v101
    s_waitcnt vmcnt(14)
    s_barrier
    v_mfma_f32_32x32x16_bf16 v[32:47], a[192:195], v[192:195], v[64:79]
    ds_read_b128 a[192:195], v230 offset:0
    v_exp_f32 v103, v23
    v_cvt_pk_bf16_f32 v82, v100, v101
    v_add_f32 v249, v249, v102
    v_mfma_f32_32x32x16_bf16 v[32:47], a[196:199], v[196:199], v[32:47]
    ds_read_b128 a[196:199], v231 offset:0
    v_exp_f32 v104, v24
    v_add_f32 v249, v249, v103
    v_exp_f32 v105, v25
    v_mfma_f32_32x32x16_bf16 v[32:47], a[200:203], v[200:203], v[32:47]
    ds_read_b128 a[200:203], v232 offset:0
    v_cvt_pk_bf16_f32 v83, v102, v103
    v_add_f32 v249, v249, v104
    v_exp_f32 v106, v26
    v_add_f32 v249, v249, v105
    v_mfma_f32_32x32x16_bf16 v[32:47], a[204:207], v[204:207], v[32:47]
    ds_read_b128 a[204:207], v233 offset:0
    v_exp_f32 v107, v27
    v_cvt_pk_bf16_f32 v84, v104, v105
    v_add_f32 v249, v249, v106
    v_mfma_f32_32x32x16_bf16 v[32:47], a[208:211], v[208:211], v[32:47]
    ds_read_b128 a[208:211], v234 offset:0
    v_exp_f32 v108, v28
    v_add_f32 v249, v249, v107
    v_exp_f32 v109, v29
    v_mfma_f32_32x32x16_bf16 v[32:47], a[212:215], v[212:215], v[32:47]
    ds_read_b128 a[212:215], v235 offset:0
    v_cvt_pk_bf16_f32 v85, v106, v107
    v_add_f32 v249, v249, v108
    v_exp_f32 v110, v30
    v_add_f32 v249, v249, v109
    s_add_u32 m0, s45, 32768
    s_nop 0
    buffer_load_dwordx4 v246, s[16:19], s47 offen offset:0 lds
    v_mfma_f32_32x32x16_bf16 v[32:47], a[216:219], v[216:219], v[32:47]
    ds_read_b128 a[216:219], v236 offset:0
    v_exp_f32 v111, v31
    v_cvt_pk_bf16_f32 v86, v108, v109
    v_add_f32 v249, v249, v110
    v_cvt_pk_bf16_f32 v87, v110, v111
    v_mfma_f32_32x32x16_bf16 v[32:47], a[220:223], v[220:223], v[32:47]
    ds_read_b128 a[220:223], v237 offset:0
    v_add_f32 v249, v249, v111
    v_cmp_nge_f32 vcc, s50, v249
    s_cbranch_vccnz attn_kernel_stub15
attn_kernel_back15:
    v_add_f32 v247, v247, v249
    s_waitcnt lgkmcnt(4)
    v_mfma_f32_32x32x16_bf16 a[0:15], a[224:227], v[80:83], a[0:15]
    v_mfma_f32_32x32x16_bf16 a[16:31], a[228:231], v[80:83], a[16:31]
    buffer_load_dwordx4 v246, s[16:19], s47 offen offset:1024 lds
    v_mfma_f32_32x32x16_bf16 a[32:47], a[232:235], v[80:83], a[32:47]
    s_nop 1
    v_exp_f32 v96, v32
    v_exp_f32 v97, v33
    v_exp_f32 v98, v34
    v_mfma_f32_32x32x16_bf16 a[48:63], a[236:239], v[80:83], a[48:63]
    v_add_f32 v250, v96, v97
    v_exp_f32 v99, v35
    v_cvt_pk_bf16_f32 v88, v96, v97
    v_add_f32 v250, v250, v98
    v_mfma_f32_32x32x16_bf16 a[0:15], a[240:243], v[84:87], a[0:15]
    v_exp_f32 v100, v36
    v_add_f32 v250, v250, v99
    v_exp_f32 v101, v37
    v_cvt_pk_bf16_f32 v89, v98, v99
    v_mfma_f32_32x32x16_bf16 a[16:31], a[244:247], v[84:87], a[16:31]
    v_add_f32 v250, v250, v100
    v_exp_f32 v102, v38
    v_add_f32 v250, v250, v101
    v_exp_f32 v103, v39
    buffer_load_dwordx4 v246, s[16:19], s47 offen offset:2048 lds
    v_mfma_f32_32x32x16_bf16 a[32:47], a[248:251], v[84:87], a[32:47]
    v_cvt_pk_bf16_f32 v90, v100, v101
    v_add_f32 v250, v250, v102
    v_exp_f32 v104, v40
    v_add_f32 v250, v250, v103
    v_mfma_f32_32x32x16_bf16 a[48:63], a[252:255], v[84:87], a[48:63]
    v_exp_f32 v105, v41
    v_cvt_pk_bf16_f32 v91, v102, v103
    v_add_f32 v250, v250, v104
    v_exp_f32 v106, v42
    s_mov_b32 s48, 0
attn_kernel_loop:
    v_mfma_f32_32x32x16_bf16 v[16:31], a[192:195], v[160:163], v[48:63]
    v_add_f32 v250, v250, v105
    v_exp_f32 v107, v43
    v_cvt_pk_bf16_f32 v92, v104, v105
    v_add_f32 v250, v250, v106
    v_mfma_f32_32x32x16_bf16 v[16:31], a[196:199], v[164:167], v[16:31]
    v_exp_f32 v108, v44
    v_add_f32 v250, v250, v107
    v_exp_f32 v109, v45
    v_cvt_pk_bf16_f32 v93, v106, v107
    buffer_load_dwordx4 v246, s[16:19], s47 offen offset:3072 lds
    s_add_u32 s47, s47, 16384
    v_mfma_f32_32x32x16_bf16 v[16:31], a[200:203], v[168:171], v[16:31]
    v_add_f32 v250, v250, v108
    v_exp_f32 v110, v46
    v_add_f32 v250, v250, v109
    v_exp_f32 v111, v47
    v_mfma_f32_32x32x16_bf16 v[16:31], a[204:207], v[172:175], v[16:31]
    v_cvt_pk_bf16_f32 v94, v108, v109
    v_add_f32 v250, v250, v110
    v_cvt_pk_bf16_f32 v95, v110, v111
    v_add_f32 v250, v250, v111
    v_cmp_nge_f32 vcc, s51, v250
    s_waitcnt lgkmcnt(0)
    v_mfma_f32_32x32x16_bf16 v[16:31], a[208:211], v[176:179], v[16:31]
    s_cbranch_vccnz attn_kernel_stub16
attn_kernel_back16:
    v_add_f32 v248, v248, v250
    v_mfma_f32_32x32x16_bf16 v[16:31], a[212:215], v[180:183], v[16:31]
    s_add_u32 m0, s44, 49152
    s_nop 0
    buffer_load_dwordx4 v242, s[12:15], s46 offen offset:0 lds
    v_mfma_f32_32x32x16_bf16 v[16:31], a[216:219], v[184:187], v[16:31]
    v_mfma_f32_32x32x16_bf16 v[16:31], a[220:223], v[188:191], v[16:31]
    v_mfma_f32_32x32x16_bf16 a[64:79], a[224:227], v[88:91], a[64:79]
    ds_read_b64_tr_b16 a[224:225], v238 offset:0
    ds_read_b64_tr_b16 a[226:227], v238 offset:2048
    v_mfma_f32_32x32x16_bf16 a[80:95], a[228:231], v[88:91], a[80:95]
    ds_read_b64_tr_b16 a[228:229], v239 offset:0
    ds_read_b64_tr_b16 a[230:231], v239 offset:2048
    buffer_load_dwordx4 v243, s[12:15], s46 offen offset:1024 lds
    v_mfma_f32_32x32x16_bf16 a[96:111], a[232:235], v[88:91], a[96:111]
    ds_read_b64_tr_b16 a[232:233], v240 offset:0
    ds_read_b64_tr_b16 a[234:235], v240 offset:2048
    s_nop 1
    v_exp_f32 v96, v16
    v_exp_f32 v97, v17
    v_mfma_f32_32x32x16_bf16 a[112:127], a[236:239], v[88:91], a[112:127]
    ds_read_b64_tr_b16 a[236:237], v241 offset:0
    ds_read_b64_tr_b16 a[238:239], v241 offset:2048
    v_exp_f32 v98, v18
    v_add_f32 v249, v96, v97
    v_mfma_f32_32x32x16_bf16 a[64:79], a[240:243], v[92:95], a[64:79]
    ds_read_b64_tr_b16 a[240:241], v238 offset:4096
    ds_read_b64_tr_b16 a[242:243], v238 offset:6144
    v_exp_f32 v99, v19
    v_cvt_pk_bf16_f32 v80, v96, v97
    v_add_f32 v249, v249, v98
    v_mfma_f32_32x32x16_bf16 a[80:95], a[244:247], v[92:95], a[80:95]
    ds_read_b64_tr_b16 a[244:245], v239 offset:4096
    ds_read_b64_tr_b16 a[246:247], v239 offset:6144
    v_exp_f32 v100, v20
    v_add_f32 v249, v249, v99
    buffer_load_dwordx4 v244, s[12:15], s46 offen offset:2048 lds
    v_mfma_f32_32x32x16_bf16 a[96:111], a[248:251], v[92:95], a[96:111]
    ds_read_b64_tr_b16 a[248:249], v240 offset:4096
    ds_read_b64_tr_b16 a[250:251], v240 offset:6144
    v_exp_f32 v101, v21
    v_cvt_pk_bf16_f32 v81, v98, v99
    v_add_f32 v249, v249, v100
    v_mfma_f32_32x32x16_bf16 a[112:127], a[252:255], v[92:95], a[112:127]
    ds_read_b64_tr_b16 a[252:253], v241 offset:4096
    ds_read_b64_tr_b16 a[254:255], v241 offset:6144
    v_exp_f32 v102, v22
    v_add_f32 v249, v249, v101
    v_mfma_f32_32x32x16_bf16 v[32:47], a[192:195], v[192:195], v[64:79]
    ds_read_b128 a[192:195], v230 offset:8192
    v_exp_f32 v103, v23
    v_cvt_pk_bf16_f32 v82, v100, v101
    v_add_f32 v249, v249, v102
    v_mfma_f32_32x32x16_bf16 v[32:47], a[196:199], v[196:199], v[32:47]
    ds_read_b128 a[196:199], v231 offset:8192
    v_exp_f32 v104, v24
    v_add_f32 v249, v249, v103
    v_exp_f32 v105, v25
    buffer_load_dwordx4 v245, s[12:15], s46 offen offset:3072 lds
    s_add_u32 s46, s46, 16384
    v_mfma_f32_32x32x16_bf16 v[32:47], a[200:203], v[200:203], v[32:47]
    ds_read_b128 a[200:203], v232 offset:8192
    v_cvt_pk_bf16_f32 v83, v102, v103
    v_add_f32 v249, v249, v104
    v_exp_f32 v106, v26
    v_add_f32 v249, v249, v105
    v_mfma_f32_32x32x16_bf16 v[32:47], a[204:207], v[204:207], v[32:47]
    ds_read_b128 a[204:207], v233 offset:8192
    v_exp_f32 v107, v27
    v_cvt_pk_bf16_f32 v84, v104, v105
    v_add_f32 v249, v249, v106
    v_mfma_f32_32x32x16_bf16 v[32:47], a[208:211], v[208:211], v[32:47]
    ds_read_b128 a[208:211], v234 offset:8192
    v_exp_f32 v108, v28
    v_add_f32 v249, v249, v107
    v_exp_f32 v109, v29
    v_mfma_f32_32x32x16_bf16 v[32:47], a[212:215], v[212:215], v[32:47]
    ds_read_b128 a[212:215], v235 offset:8192
    v_cvt_pk_bf16_f32 v85, v106, v107
    v_add_f32 v249, v249, v108
    v_exp_f32 v110, v30
    v_add_f32 v249, v249, v109
    buffer_load_dwordx4 v[120:123], v229, s[84:87], s49 offen
    s_add_u32 s49, s49, 1024
    v_mfma_f32_32x32x16_bf16 v[32:47], a[216:219], v[216:219], v[32:47]
    ds_read_b128 a[216:219], v236 offset:8192
    v_exp_f32 v111, v31
    v_cvt_pk_bf16_f32 v86, v108, v109
    v_add_f32 v249, v249, v110
    v_cvt_pk_bf16_f32 v87, v110, v111
    v_mfma_f32_32x32x16_bf16 v[32:47], a[220:223], v[220:223], v[32:47]
    ds_read_b128 a[220:223], v237 offset:8192
    v_add_f32 v249, v249, v111
    v_cmp_nge_f32 vcc, s50, v249
    s_cbranch_vccnz attn_kernel_stub17
attn_kernel_back17:
    v_add_f32 v247, v247, v249
    s_waitcnt lgkmcnt(4)
    v_mfma_f32_32x32x16_bf16 a[0:15], a[224:227], v[80:83], a[0:15]
    v_mfma_f32_32x32x16_bf16 a[16:31], a[228:231], v[80:83], a[16:31]
    v_mfma_f32_32x32x16_bf16 a[32:47], a[232:235], v[80:83], a[32:47]
    s_nop 2
    v_exp_f32 v96, v32
    v_exp_f32 v97, v33
    v_exp_f32 v98, v34
    v_mfma_f32_32x32x16_bf16 a[48:63], a[236:239], v[80:83], a[48:63]
    v_add_f32 v250, v96, v97
    v_exp_f32 v99, v35
    v_cvt_pk_bf16_f32 v88, v96, v97
    v_add_f32 v250, v250, v98
    v_mfma_f32_32x32x16_bf16 a[0:15], a[240:243], v[84:87], a[0:15]
    v_exp_f32 v100, v36
    v_add_f32 v250, v250, v99
    v_exp_f32 v101, v37
    v_cvt_pk_bf16_f32 v89, v98, v99
    v_mfma_f32_32x32x16_bf16 a[16:31], a[244:247], v[84:87], a[16:31]
    v_add_f32 v250, v250, v100
    v_exp_f32 v102, v38
    v_add_f32 v250, v250, v101
    v_exp_f32 v103, v39
    v_mfma_f32_32x32x16_bf16 a[32:47], a[248:251], v[84:87], a[32:47]
    v_cvt_pk_bf16_f32 v90, v100, v101
    v_add_f32 v250, v250, v102
    v_exp_f32 v104, v40
    v_add_f32 v250, v250, v103
    v_mfma_f32_32x32x16_bf16 a[48:63], a[252:255], v[84:87], a[48:63]
    v_exp_f32 v105, v41
    v_cvt_pk_bf16_f32 v91, v102, v103
    v_add_f32 v250, v250, v104
    v_exp_f32 v106, v42
    v_mfma_f32_32x32x16_bf16 v[16:31], a[192:195], v[160:163], v[48:63]
    v_add_f32 v250, v250, v105
    v_exp_f32 v107, v43
    v_cvt_pk_bf16_f32 v92, v104, v105
    v_add_f32 v250, v250, v106
    v_mfma_f32_32x32x16_bf16 v[16:31], a[196:199], v[164:167], v[16:31]
    v_exp_f32 v108, v44
    v_add_f32 v250, v250, v107
    v_exp_f32 v109, v45
    v_cvt_pk_bf16_f32 v93, v106, v107
    v_mfma_f32_32x32x16_bf16 v[16:31], a[200:203], v[168:171], v[16:31]
    v_add_f32 v250, v250, v108
    v_exp_f32 v110, v46
    v_add_f32 v250, v250, v109
    v_exp_f32 v111, v47
    v_mfma_f32_32x32x16_bf16 v[16:31], a[204:207], v[172:175], v[16:31]
    v_cvt_pk_bf16_f32 v94, v108, v109
    v_add_f32 v250, v250, v110
    v_cvt_pk_bf16_f32 v95, v110, v111
    v_add_f32 v250, v250, v111
    v_cmp_nge_f32 vcc, s51, v250
    s_waitcnt lgkmcnt(0)
    v_mfma_f32_32x32x16_bf16 v[16:31], a[208:211], v[176:179], v[16:31]
    s_cbranch_vccnz attn_kernel_stub18
attn_kernel_back18:
    v_add_f32 v248, v248, v250
    v_mfma_f32_32x32x16_bf16 v[16:31], a[212:215], v[180:183], v[16:31]
    v_mfma_f32_32x32x16_bf16 v[16:31], a[216:219], v[184:187], v[16:31]
    v_mfma_f32_32x32x16_bf16 v[16:31], a[220:223], v[188:191], v[16:31]
    v_mfma_f32_32x32x16_bf16 a[64:79], a[224:227], v[88:91], a[64:79]
    ds_read_b64_tr_b16 a[224:225], v238 offset:8192
    ds_read_b64_tr_b16 a[226:227], v238 offset:10240
    v_mfma_f32_32x32x16_bf16 a[80:95], a[228:231], v[88:91], a[80:95]
    ds_read_b64_tr_b16 a[228:229], v239 offset:8192
    ds_read_b64_tr_b16 a[230:231], v239 offset:10240
    v_mfma_f32_32x32x16_bf16 a[96:111], a[232:235], v[88:91], a[96:111]
    ds_read_b64_tr_b16 a[232:233], v240 offset:8192
    ds_read_b64_tr_b16 a[234:235], v240 offset:10240
    s_nop 2
    v_exp_f32 v96, v16
    v_exp_f32 v97, v17
    v_mfma_f32_32x32x16_bf16 a[112:127], a[236:239], v[88:91], a[112:127]
    ds_read_b64_tr_b16 a[236:237], v241 offset:8192
    ds_read_b64_tr_b16 a[238:239], v241 offset:10240
    v_exp_f32 v98, v18
    v_add_f32 v249, v96, v97
    v_mfma_f32_32x32x16_bf16 a[64:79], a[240:243], v[92:95], a[64:79]
    ds_read_b64_tr_b16 a[240:241], v238 offset:12288
    ds_read_b64_tr_b16 a[242:243], v238 offset:14336
    v_exp_f32 v99, v19
    v_cvt_pk_bf16_f32 v80, v96, v97
    v_add_f32 v249, v249, v98
    v_mfma_f32_32x32x16_bf16 a[80:95], a[244:247], v[92:95], a[80:95]
    ds_read_b64_tr_b16 a[244:245], v239 offset:12288
    ds_read_b64_tr_b16 a[246:247], v239 offset:14336
    v_exp_f32 v100, v20
    v_add_f32 v249, v249, v99
    v_mfma_f32_32x32x16_bf16 a[96:111], a[248:251], v[92:95], a[96:111]
    ds_read_b64_tr_b16 a[248:249], v240 offset:12288
    ds_read_b64_tr_b16 a[250:251], v240 offset:14336
    v_exp_f32 v101, v21
    v_cvt_pk_bf16_f32 v81, v98, v99
    v_add_f32 v249, v249, v100
    v_mfma_f32_32x32x16_bf16 a[112:127], a[252:255], v[92:95], a[112:127]
    ds_read_b64_tr_b16 a[252:253], v241 offset:12288
    ds_read_b64_tr_b16 a[254:255], v241 offset:14336
    v_exp_f32 v102, v22
    v_add_f32 v249, v249, v101
    s_waitcnt vmcnt(14)
    s_barrier
    v_mfma_f32_32x32x16_bf16 v[32:47], a[192:195], v[192:195], v[64:79]
    ds_read_b128 a[192:195], v230 offset:16384
    v_exp_f32 v103, v23
    v_cvt_pk_bf16_f32 v82, v100, v101
    v_add_f32 v249, v249, v102
    v_mfma_f32_32x32x16_bf16 v[32:47], a[196:199], v[196:199], v[32:47]
    ds_read_b128 a[196:199], v231 offset:16384
    v_exp_f32 v104, v24
    v_add_f32 v249, v249, v103
    v_exp_f32 v105, v25
    v_mfma_f32_32x32x16_bf16 v[32:47], a[200:203], v[200:203], v[32:47]
    ds_read_b128 a[200:203], v232 offset:16384
    v_cvt_pk_bf16_f32 v83, v102, v103
    v_add_f32 v249, v249, v104
    v_exp_f32 v106, v26
    v_add_f32 v249, v249, v105
    v_mfma_f32_32x32x16_bf16 v[32:47], a[204:207], v[204:207], v[32:47]
    ds_read_b128 a[204:207], v233 offset:16384
    v_exp_f32 v107, v27
    v_cvt_pk_bf16_f32 v84, v104, v105
    v_add_f32 v249, v249, v106
    v_mfma_f32_32x32x16_bf16 v[32:47], a[208:211], v[208:211], v[32:47]
    ds_read_b128 a[208:211], v234 offset:16384
    v_exp_f32 v108, v28
    v_add_f32 v249, v249, v107
    v_exp_f32 v109, v29
    v_mfma_f32_32x32x16_bf16 v[32:47], a[212:215], v[212:215], v[32:47]
    ds_read_b128 a[212:215], v235 offset:16384
    v_cvt_pk_bf16_f32 v85, v106, v107
    v_add_f32 v249, v249, v108
    v_exp_f32 v110, v30
    v_add_f32 v249, v249, v109
    s_add_u32 m0, s45, 49152
    s_nop 0
    buffer_load_dwordx4 v246, s[16:19], s47 offen offset:0 lds
    v_mfma_f32_32x32x16_bf16 v[32:47], a[216:219], v[216:219], v[32:47]
    ds_read_b128 a[216:219], v236 offset:16384
    v_exp_f32 v111, v31
    v_cvt_pk_bf16_f32 v86, v108, v109
    v_add_f32 v249, v249, v110
    v_cvt_pk_bf16_f32 v87, v110, v111
    v_mfma_f32_32x32x16_bf16 v[32:47], a[220:223], v[220:223], v[32:47]
    ds_read_b128 a[220:223], v237 offset:16384
    v_add_f32 v249, v249, v111
    v_cmp_nge_f32 vcc, s50, v249
    s_cbranch_vccnz attn_kernel_stub19
attn_kernel_back19:
    v_add_f32 v247, v247, v249
    s_waitcnt lgkmcnt(4)
    v_mfma_f32_32x32x16_bf16 a[0:15], a[224:227], v[80:83], a[0:15]
    v_mfma_f32_32x32x16_bf16 a[16:31], a[228:231], v[80:83], a[16:31]
    buffer_load_dwordx4 v246, s[16:19], s47 offen offset:1024 lds
    v_mfma_f32_32x32x16_bf16 a[32:47], a[232:235], v[80:83], a[32:47]
    s_nop 1
    v_exp_f32 v96, v32
    v_exp_f32 v97, v33
    v_exp_f32 v98, v34
    v_mfma_f32_32x32x16_bf16 a[48:63], a[236:239], v[80:83], a[48:63]
    v_add_f32 v250, v96, v97
    v_exp_f32 v99, v35
    v_cvt_pk_bf16_f32 v88, v96, v97
    v_add_f32 v250, v250, v98
    v_mfma_f32_32x32x16_bf16 a[0:15], a[240:243], v[84:87], a[0:15]
    v_exp_f32 v100, v36
    v_add_f32 v250, v250, v99
    v_exp_f32 v101, v37
    v_cvt_pk_bf16_f32 v89, v98, v99
    v_mfma_f32_32x32x16_bf16 a[16:31], a[244:247], v[84:87], a[16:31]
    v_add_f32 v250, v250, v100
    v_exp_f32 v102, v38
    v_add_f32 v250, v250, v101
    v_exp_f32 v103, v39
    buffer_load_dwordx4 v246, s[16:19], s47 offen offset:2048 lds
    v_mfma_f32_32x32x16_bf16 a[32:47], a[248:251], v[84:87], a[32:47]
    v_cvt_pk_bf16_f32 v90, v100, v101
    v_add_f32 v250, v250, v102
    v_exp_f32 v104, v40
    v_add_f32 v250, v250, v103
    v_mfma_f32_32x32x16_bf16 a[48:63], a[252:255], v[84:87], a[48:63]
    v_exp_f32 v105, v41
    v_cvt_pk_bf16_f32 v91, v102, v103
    v_add_f32 v250, v250, v104
    v_exp_f32 v106, v42
    v_mfma_f32_32x32x16_bf16 v[16:31], a[192:195], v[160:163], v[48:63]
    v_add_f32 v250, v250, v105
    v_exp_f32 v107, v43
    v_cvt_pk_bf16_f32 v92, v104, v105
    v_add_f32 v250, v250, v106
    v_mfma_f32_32x32x16_bf16 v[16:31], a[196:199], v[164:167], v[16:31]
    v_exp_f32 v108, v44
    v_add_f32 v250, v250, v107
    v_exp_f32 v109, v45
    v_cvt_pk_bf16_f32 v93, v106, v107
    buffer_load_dwordx4 v246, s[16:19], s47 offen offset:3072 lds
    s_add_u32 s47, s47, 16384
    v_mfma_f32_32x32x16_bf16 v[16:31], a[200:203], v[168:171], v[16:31]
    v_add_f32 v250, v250, v108
    v_exp_f32 v110, v46
    v_add_f32 v250, v250, v109
    v_exp_f32 v111, v47
    v_mfma_f32_32x32x16_bf16 v[16:31], a[204:207], v[172:175], v[16:31]
    v_cvt_pk_bf16_f32 v94, v108, v109
    v_add_f32 v250, v250, v110
    v_cvt_pk_bf16_f32 v95, v110, v111
    v_add_f32 v250, v250, v111
    v_cmp_nge_f32 vcc, s51, v250
    s_waitcnt lgkmcnt(0)
    v_mfma_f32_32x32x16_bf16 v[16:31], a[208:211], v[176:179], v[16:31]
    s_cbranch_vccnz attn_kernel_stub20
attn_kernel_back20:
    v_add_f32 v248, v248, v250
    v_mfma_f32_32x32x16_bf16 v[16:31], a[212:215], v[180:183], v[16:31]
    s_add_u32 m0, s44, 0
    s_nop 0
    buffer_load_dwordx4 v242, s[12:15], s46 offen offset:0 lds
    v_mfma_f32_32x32x16_bf16 v[16:31], a[216:219], v[184:187], v[16:31]
    v_mfma_f32_32x32x16_bf16 v[16:31], a[220:223], v[188:191], v[16:31]
    v_mfma_f32_32x32x16_bf16 a[64:79], a[224:227], v[88:91], a[64:79]
    ds_read_b64_tr_b16 a[224:225], v238 offset:16384
    ds_read_b64_tr_b16 a[226:227], v238 offset:18432
    v_mfma_f32_32x32x16_bf16 a[80:95], a[228:231], v[88:91], a[80:95]
    ds_read_b64_tr_b16 a[228:229], v239 offset:16384
    ds_read_b64_tr_b16 a[230:231], v239 offset:18432
    buffer_load_dwordx4 v243, s[12:15], s46 offen offset:1024 lds
    v_mfma_f32_32x32x16_bf16 a[96:111], a[232:235], v[88:91], a[96:111]
    ds_read_b64_tr_b16 a[232:233], v240 offset:16384
    ds_read_b64_tr_b16 a[234:235], v240 offset:18432
    s_nop 1
    v_exp_f32 v96, v16
    v_exp_f32 v97, v17
    v_mfma_f32_32x32x16_bf16 a[112:127], a[236:239], v[88:91], a[112:127]
    ds_read_b64_tr_b16 a[236:237], v241 offset:16384
    ds_read_b64_tr_b16 a[238:239], v241 offset:18432
    v_exp_f32 v98, v18
    v_add_f32 v249, v96, v97
    v_mfma_f32_32x32x16_bf16 a[64:79], a[240:243], v[92:95], a[64:79]
    ds_read_b64_tr_b16 a[240:241], v238 offset:20480
    ds_read_b64_tr_b16 a[242:243], v238 offset:22528
    v_exp_f32 v99, v19
    v_cvt_pk_bf16_f32 v80, v96, v97
    v_add_f32 v249, v249, v98
    v_mfma_f32_32x32x16_bf16 a[80:95], a[244:247], v[92:95], a[80:95]
    ds_read_b64_tr_b16 a[244:245], v239 offset:20480
    ds_read_b64_tr_b16 a[246:247], v239 offset:22528
    v_exp_f32 v100, v20
    v_add_f32 v249, v249, v99
    buffer_load_dwordx4 v244, s[12:15], s46 offen offset:2048 lds
    v_mfma_f32_32x32x16_bf16 a[96:111], a[248:251], v[92:95], a[96:111]
    ds_read_b64_tr_b16 a[248:249], v240 offset:20480
    ds_read_b64_tr_b16 a[250:251], v240 offset:22528
    v_exp_f32 v101, v21
    v_cvt_pk_bf16_f32 v81, v98, v99
    v_add_f32 v249, v249, v100
    v_mfma_f32_32x32x16_bf16 a[112:127], a[252:255], v[92:95], a[112:127]
    ds_read_b64_tr_b16 a[252:253], v241 offset:20480
    ds_read_b64_tr_b16 a[254:255], v241 offset:22528
    v_exp_f32 v102, v22
    v_add_f32 v249, v249, v101
    v_mfma_f32_32x32x16_bf16 v[32:47], a[192:195], v[192:195], v[64:79]
    ds_read_b128 a[192:195], v230 offset:24576
    v_exp_f32 v103, v23
    v_cvt_pk_bf16_f32 v82, v100, v101
    v_add_f32 v249, v249, v102
    v_mfma_f32_32x32x16_bf16 v[32:47], a[196:199], v[196:199], v[32:47]
    ds_read_b128 a[196:199], v231 offset:24576
    v_exp_f32 v104, v24
    v_add_f32 v249, v249, v103
    v_exp_f32 v105, v25
    buffer_load_dwordx4 v245, s[12:15], s46 offen offset:3072 lds
    s_add_u32 s46, s46, 16384
    v_mfma_f32_32x32x16_bf16 v[32:47], a[200:203], v[200:203], v[32:47]
    ds_read_b128 a[200:203], v232 offset:24576
    v_cvt_pk_bf16_f32 v83, v102, v103
    v_add_f32 v249, v249, v104
    v_exp_f32 v106, v26
    v_add_f32 v249, v249, v105
    v_mfma_f32_32x32x16_bf16 v[32:47], a[204:207], v[204:207], v[32:47]
    ds_read_b128 a[204:207], v233 offset:24576
    v_exp_f32 v107, v27
    v_cvt_pk_bf16_f32 v84, v104, v105
    v_add_f32 v249, v249, v106
    v_mfma_f32_32x32x16_bf16 v[32:47], a[208:211], v[208:211], v[32:47]
    ds_read_b128 a[208:211], v234 offset:24576
    v_exp_f32 v108, v28
    v_add_f32 v249, v249, v107
    v_exp_f32 v109, v29
    v_mfma_f32_32x32x16_bf16 v[32:47], a[212:215], v[212:215], v[32:47]
    ds_read_b128 a[212:215], v235 offset:24576
    v_cvt_pk_bf16_f32 v85, v106, v107
    v_add_f32 v249, v249, v108
    v_exp_f32 v110, v30
    v_add_f32 v249, v249, v109
    buffer_load_dwordx4 v[120:123], v229, s[72:75], s49 offen
    v_mfma_f32_32x32x16_bf16 v[32:47], a[216:219], v[216:219], v[32:47]
    ds_read_b128 a[216:219], v236 offset:24576
    v_exp_f32 v111, v31
    v_cvt_pk_bf16_f32 v86, v108, v109
    v_add_f32 v249, v249, v110
    v_cvt_pk_bf16_f32 v87, v110, v111
    v_mfma_f32_32x32x16_bf16 v[32:47], a[220:223], v[220:223], v[32:47]
    ds_read_b128 a[220:223], v237 offset:24576
    v_add_f32 v249, v249, v111
    v_cmp_nge_f32 vcc, s50, v249
    s_cbranch_vccnz attn_kernel_stub21
attn_kernel_back21:
    v_add_f32 v247, v247, v249
    s_waitcnt lgkmcnt(4)
    v_mfma_f32_32x32x16_bf16 a[0:15], a[224:227], v[80:83], a[0:15]
    v_mfma_f32_32x32x16_bf16 a[16:31], a[228:231], v[80:83], a[16:31]
    v_mfma_f32_32x32x16_bf16 a[32:47], a[232:235], v[80:83], a[32:47]
    s_nop 2
    v_exp_f32 v96, v32
    v_exp_f32 v97, v33
    v_exp_f32 v98, v34
    v_mfma_f32_32x32x16_bf16 a[48:63], a[236:239], v[80:83], a[48:63]
    v_add_f32 v250, v96, v97
    v_exp_f32 v99, v35
    v_cvt_pk_bf16_f32 v88, v96, v97
    v_add_f32 v250, v250, v98
    v_mfma_f32_32x32x16_bf16 a[0:15], a[240:243], v[84:87], a[0:15]
    v_exp_f32 v100, v36
    v_add_f32 v250, v250, v99
    v_exp_f32 v101, v37
    v_cvt_pk_bf16_f32 v89, v98, v99
    v_mfma_f32_32x32x16_bf16 a[16:31], a[244:247], v[84:87], a[16:31]
    v_add_f32 v250, v250, v100
    v_exp_f32 v102, v38
    v_add_f32 v250, v250, v101
    v_exp_f32 v103, v39
    v_mfma_f32_32x32x16_bf16 a[32:47], a[248:251], v[84:87], a[32:47]
    v_cvt_pk_bf16_f32 v90, v100, v101
    v_add_f32 v250, v250, v102
    v_exp_f32 v104, v40
    v_add_f32 v250, v250, v103
    v_mfma_f32_32x32x16_bf16 a[48:63], a[252:255], v[84:87], a[48:63]
    v_exp_f32 v105, v41
    v_cvt_pk_bf16_f32 v91, v102, v103
    v_add_f32 v250, v250, v104
    v_exp_f32 v106, v42
    v_mfma_f32_32x32x16_bf16 v[16:31], a[192:195], v[160:163], v[48:63]
    v_add_f32 v250, v250, v105
    v_exp_f32 v107, v43
    v_cvt_pk_bf16_f32 v92, v104, v105
    v_add_f32 v250, v250, v106
    v_mfma_f32_32x32x16_bf16 v[16:31], a[196:199], v[164:167], v[16:31]
    v_exp_f32 v108, v44
    v_add_f32 v250, v250, v107
    v_exp_f32 v109, v45
    v_cvt_pk_bf16_f32 v93, v106, v107
    v_mfma_f32_32x32x16_bf16 v[16:31], a[200:203], v[168:171], v[16:31]
    v_add_f32 v250, v250, v108
    v_exp_f32 v110, v46
    v_add_f32 v250, v250, v109
    v_exp_f32 v111, v47
    v_mfma_f32_32x32x16_bf16 v[16:31], a[204:207], v[172:175], v[16:31]
    v_cvt_pk_bf16_f32 v94, v108, v109
    v_add_f32 v250, v250, v110
    v_cvt_pk_bf16_f32 v95, v110, v111
    v_add_f32 v250, v250, v111
    v_cmp_nge_f32 vcc, s51, v250
    s_waitcnt lgkmcnt(0)
    v_mfma_f32_32x32x16_bf16 v[16:31], a[208:211], v[176:179], v[16:31]
    s_cbranch_vccnz attn_kernel_stub22
attn_kernel_back22:
    v_add_f32 v248, v248, v250
    v_mfma_f32_32x32x16_bf16 v[16:31], a[212:215], v[180:183], v[16:31]
    v_mfma_f32_32x32x16_bf16 v[16:31], a[216:219], v[184:187], v[16:31]
    v_mfma_f32_32x32x16_bf16 v[16:31], a[220:223], v[188:191], v[16:31]
    v_mfma_f32_32x32x16_bf16 a[64:79], a[224:227], v[88:91], a[64:79]
    ds_read_b64_tr_b16 a[224:225], v238 offset:24576
    ds_read_b64_tr_b16 a[226:227], v238 offset:26624
    v_mfma_f32_32x32x16_bf16 a[80:95], a[228:231], v[88:91], a[80:95]
    ds_read_b64_tr_b16 a[228:229], v239 offset:24576
    ds_read_b64_tr_b16 a[230:231], v239 offset:26624
    v_mfma_f32_32x32x16_bf16 a[96:111], a[232:235], v[88:91], a[96:111]
    ds_read_b64_tr_b16 a[232:233], v240 offset:24576
    ds_read_b64_tr_b16 a[234:235], v240 offset:26624
    s_nop 2
    v_exp_f32 v96, v16
    v_exp_f32 v97, v17
    v_mfma_f32_32x32x16_bf16 a[112:127], a[236:239], v[88:91], a[112:127]
    ds_read_b64_tr_b16 a[236:237], v241 offset:24576
    ds_read_b64_tr_b16 a[238:239], v241 offset:26624
    v_exp_f32 v98, v18
    v_add_f32 v249, v96, v97
    v_mfma_f32_32x32x16_bf16 a[64:79], a[240:243], v[92:95], a[64:79]
    ds_read_b64_tr_b16 a[240:241], v238 offset:28672
    ds_read_b64_tr_b16 a[242:243], v238 offset:30720
    v_exp_f32 v99, v19
    v_cvt_pk_bf16_f32 v80, v96, v97
    v_add_f32 v249, v249, v98
    v_mfma_f32_32x32x16_bf16 a[80:95], a[244:247], v[92:95], a[80:95]
    ds_read_b64_tr_b16 a[244:245], v239 offset:28672
    ds_read_b64_tr_b16 a[246:247], v239 offset:30720
    v_exp_f32 v100, v20
    v_add_f32 v249, v249, v99
    v_mfma_f32_32x32x16_bf16 a[96:111], a[248:251], v[92:95], a[96:111]
    ds_read_b64_tr_b16 a[248:249], v240 offset:28672
    ds_read_b64_tr_b16 a[250:251], v240 offset:30720
    v_exp_f32 v101, v21
    v_cvt_pk_bf16_f32 v81, v98, v99
    v_add_f32 v249, v249, v100
    v_mfma_f32_32x32x16_bf16 a[112:127], a[252:255], v[92:95], a[112:127]
    ds_read_b64_tr_b16 a[252:253], v241 offset:28672
    ds_read_b64_tr_b16 a[254:255], v241 offset:30720
    v_exp_f32 v102, v22
    v_add_f32 v249, v249, v101
    s_waitcnt vmcnt(14)
    s_barrier
    v_mfma_f32_32x32x16_bf16 v[32:47], a[192:195], v[192:195], v[64:79]
    ds_read_b128 a[192:195], v230 offset:32768
    v_exp_f32 v103, v23
    v_cvt_pk_bf16_f32 v82, v100, v101
    v_add_f32 v249, v249, v102
    v_mfma_f32_32x32x16_bf16 v[32:47], a[196:199], v[196:199], v[32:47]
    ds_read_b128 a[196:199], v231 offset:32768
    v_exp_f32 v104, v24
    v_add_f32 v249, v249, v103
    v_exp_f32 v105, v25
    v_mfma_f32_32x32x16_bf16 v[32:47], a[200:203], v[200:203], v[32:47]
    ds_read_b128 a[200:203], v232 offset:32768
    v_cvt_pk_bf16_f32 v83, v102, v103
    v_add_f32 v249, v249, v104
    v_exp_f32 v106, v26
    v_add_f32 v249, v249, v105
    v_mfma_f32_32x32x16_bf16 v[32:47], a[204:207], v[204:207], v[32:47]
    ds_read_b128 a[204:207], v233 offset:32768
    v_exp_f32 v107, v27
    v_cvt_pk_bf16_f32 v84, v104, v105
    v_add_f32 v249, v249, v106
    v_mfma_f32_32x32x16_bf16 v[32:47], a[208:211], v[208:211], v[32:47]
    ds_read_b128 a[208:211], v234 offset:32768
    v_exp_f32 v108, v28
    v_add_f32 v249, v249, v107
    v_exp_f32 v109, v29
    v_mfma_f32_32x32x16_bf16 v[32:47], a[212:215], v[212:215], v[32:47]
    ds_read_b128 a[212:215], v235 offset:32768
    v_cvt_pk_bf16_f32 v85, v106, v107
    v_add_f32 v249, v249, v108
    v_exp_f32 v110, v30
    v_add_f32 v249, v249, v109
    s_add_u32 m0, s45, 0
    s_nop 0
    buffer_load_dwordx4 v246, s[16:19], s47 offen offset:0 lds
    v_mfma_f32_32x32x16_bf16 v[32:47], a[216:219], v[216:219], v[32:47]
    ds_read_b128 a[216:219], v236 offset:32768
    v_exp_f32 v111, v31
    v_cvt_pk_bf16_f32 v86, v108, v109
    v_add_f32 v249, v249, v110
    v_cvt_pk_bf16_f32 v87, v110, v111
    v_mfma_f32_32x32x16_bf16 v[32:47], a[220:223], v[220:223], v[32:47]
    ds_read_b128 a[220:223], v237 offset:32768
    v_add_f32 v249, v249, v111
    v_cmp_nge_f32 vcc, s50, v249
    s_cbranch_vccnz attn_kernel_stub23
attn_kernel_back23:
    v_add_f32 v247, v247, v249
    s_waitcnt lgkmcnt(4)
    v_mfma_f32_32x32x16_bf16 a[0:15], a[224:227], v[80:83], a[0:15]
    v_mfma_f32_32x32x16_bf16 a[16:31], a[228:231], v[80:83], a[16:31]
    buffer_load_dwordx4 v246, s[16:19], s47 offen offset:1024 lds
    v_mfma_f32_32x32x16_bf16 a[32:47], a[232:235], v[80:83], a[32:47]
    s_nop 1
    v_exp_f32 v96, v32
    v_exp_f32 v97, v33
    v_exp_f32 v98, v34
    v_mfma_f32_32x32x16_bf16 a[48:63], a[236:239], v[80:83], a[48:63]
    v_add_f32 v250, v96, v97
    v_exp_f32 v99, v35
    v_cvt_pk_bf16_f32 v88, v96, v97
    v_add_f32 v250, v250, v98
    v_mfma_f32_32x32x16_bf16 a[0:15], a[240:243], v[84:87], a[0:15]
    v_exp_f32 v100, v36
    v_add_f32 v250, v250, v99
    v_exp_f32 v101, v37
    v_cvt_pk_bf16_f32 v89, v98, v99
    v_mfma_f32_32x32x16_bf16 a[16:31], a[244:247], v[84:87], a[16:31]
    v_add_f32 v250, v250, v100
    v_exp_f32 v102, v38
    v_add_f32 v250, v250, v101
    v_exp_f32 v103, v39
    buffer_load_dwordx4 v246, s[16:19], s47 offen offset:2048 lds
    v_mfma_f32_32x32x16_bf16 a[32:47], a[248:251], v[84:87], a[32:47]
    v_cvt_pk_bf16_f32 v90, v100, v101
    v_add_f32 v250, v250, v102
    v_exp_f32 v104, v40
    v_add_f32 v250, v250, v103
    v_mfma_f32_32x32x16_bf16 a[48:63], a[252:255], v[84:87], a[48:63]
    v_exp_f32 v105, v41
    v_cvt_pk_bf16_f32 v91, v102, v103
    v_add_f32 v250, v250, v104
    v_exp_f32 v106, v42
    v_mfma_f32_32x32x16_bf16 v[16:31], a[192:195], v[160:163], v[48:63]
    v_add_f32 v250, v250, v105
    v_exp_f32 v107, v43
    v_cvt_pk_bf16_f32 v92, v104, v105
    v_add_f32 v250, v250, v106
    v_mfma_f32_32x32x16_bf16 v[16:31], a[196:199], v[164:167], v[16:31]
    v_exp_f32 v108, v44
    v_add_f32 v250, v250, v107
    v_exp_f32 v109, v45
    v_cvt_pk_bf16_f32 v93, v106, v107
    buffer_load_dwordx4 v246, s[16:19], s47 offen offset:3072 lds
    s_add_u32 s47, s47, 16384
    v_mfma_f32_32x32x16_bf16 v[16:31], a[200:203], v[168:171], v[16:31]
    v_add_f32 v250, v250, v108
    v_exp_f32 v110, v46
    v_add_f32 v250, v250, v109
    v_exp_f32 v111, v47
    v_mfma_f32_32x32x16_bf16 v[16:31], a[204:207], v[172:175], v[16:31]
    v_cvt_pk_bf16_f32 v94, v108, v109
    v_add_f32 v250, v250, v110
    v_cvt_pk_bf16_f32 v95, v110, v111
    v_add_f32 v250, v250, v111
    v_cmp_nge_f32 vcc, s51, v250
    s_waitcnt lgkmcnt(0)
    v_mfma_f32_32x32x16_bf16 v[16:31], a[208:211], v[176:179], v[16:31]
    s_cbranch_vccnz attn_kernel_stub24
attn_kernel_back24:
    v_add_f32 v248, v248, v250
    v_mfma_f32_32x32x16_bf16 v[16:31], a[212:215], v[180:183], v[16:31]
    s_add_u32 m0, s44, 16384
    s_nop 0
    buffer_load_dwordx4 v242, s[12:15], s46 offen offset:0 lds
    v_mfma_f32_32x32x16_bf16 v[16:31], a[216:219], v[184:187], v[16:31]
    v_mfma_f32_32x32x16_bf16 v[16:31], a[220:223], v[188:191], v[16:31]
    v_mfma_f32_32x32x16_bf16 a[64:79], a[224:227], v[88:91], a[64:79]
    ds_read_b64_tr_b16 a[224:225], v238 offset:32768
    ds_read_b64_tr_b16 a[226:227], v238 offset:34816
    v_mfma_f32_32x32x16_bf16 a[80:95], a[228:231], v[88:91], a[80:95]
    ds_read_b64_tr_b16 a[228:229], v239 offset:32768
    ds_read_b64_tr_b16 a[230:231], v239 offset:34816
    buffer_load_dwordx4 v243, s[12:15], s46 offen offset:1024 lds
    v_mfma_f32_32x32x16_bf16 a[96:111], a[232:235], v[88:91], a[96:111]
    ds_read_b64_tr_b16 a[232:233], v240 offset:32768
    ds_read_b64_tr_b16 a[234:235], v240 offset:34816
    s_nop 1
    v_exp_f32 v96, v16
    v_exp_f32 v97, v17
    v_mfma_f32_32x32x16_bf16 a[112:127], a[236:239], v[88:91], a[112:127]
    ds_read_b64_tr_b16 a[236:237], v241 offset:32768
    ds_read_b64_tr_b16 a[238:239], v241 offset:34816
    v_exp_f32 v98, v18
    v_add_f32 v249, v96, v97
    v_mfma_f32_32x32x16_bf16 a[64:79], a[240:243], v[92:95], a[64:79]
    ds_read_b64_tr_b16 a[240:241], v238 offset:36864
    ds_read_b64_tr_b16 a[242:243], v238 offset:38912
    v_exp_f32 v99, v19
    v_cvt_pk_bf16_f32 v80, v96, v97
    v_add_f32 v249, v249, v98
    v_mfma_f32_32x32x16_bf16 a[80:95], a[244:247], v[92:95], a[80:95]
    ds_read_b64_tr_b16 a[244:245], v239 offset:36864
    ds_read_b64_tr_b16 a[246:247], v239 offset:38912
    v_exp_f32 v100, v20
    v_add_f32 v249, v249, v99
    buffer_load_dwordx4 v244, s[12:15], s46 offen offset:2048 lds
    v_mfma_f32_32x32x16_bf16 a[96:111], a[248:251], v[92:95], a[96:111]
    ds_read_b64_tr_b16 a[248:249], v240 offset:36864
    ds_read_b64_tr_b16 a[250:251], v240 offset:38912
    v_exp_f32 v101, v21
    v_cvt_pk_bf16_f32 v81, v98, v99
    v_add_f32 v249, v249, v100
    v_mfma_f32_32x32x16_bf16 a[112:127], a[252:255], v[92:95], a[112:127]
    ds_read_b64_tr_b16 a[252:253], v241 offset:36864
    ds_read_b64_tr_b16 a[254:255], v241 offset:38912
    v_exp_f32 v102, v22
    v_add_f32 v249, v249, v101
    v_mfma_f32_32x32x16_bf16 v[32:47], a[192:195], v[192:195], v[64:79]
    ds_read_b128 a[192:195], v230 offset:40960
    v_exp_f32 v103, v23
    v_cvt_pk_bf16_f32 v82, v100, v101
    v_add_f32 v249, v249, v102
    v_mfma_f32_32x32x16_bf16 v[32:47], a[196:199], v[196:199], v[32:47]
    ds_read_b128 a[196:199], v231 offset:40960
    v_exp_f32 v104, v24
    v_add_f32 v249, v249, v103
    v_exp_f32 v105, v25
    buffer_load_dwordx4 v245, s[12:15], s46 offen offset:3072 lds
    s_add_u32 s46, s46, 16384
    v_mfma_f32_32x32x16_bf16 v[32:47], a[200:203], v[200:203], v[32:47]
    ds_read_b128 a[200:203], v232 offset:40960
    v_cvt_pk_bf16_f32 v83, v102, v103
    v_add_f32 v249, v249, v104
    v_exp_f32 v106, v26
    v_add_f32 v249, v249, v105
    v_mfma_f32_32x32x16_bf16 v[32:47], a[204:207], v[204:207], v[32:47]
    ds_read_b128 a[204:207], v233 offset:40960
    v_exp_f32 v107, v27
    v_cvt_pk_bf16_f32 v84, v104, v105
    v_add_f32 v249, v249, v106
    v_mfma_f32_32x32x16_bf16 v[32:47], a[208:211], v[208:211], v[32:47]
    ds_read_b128 a[208:211], v234 offset:40960
    v_exp_f32 v108, v28
    v_add_f32 v249, v249, v107
    v_exp_f32 v109, v29
    v_mfma_f32_32x32x16_bf16 v[32:47], a[212:215], v[212:215], v[32:47]
    ds_read_b128 a[212:215], v235 offset:40960
    v_cvt_pk_bf16_f32 v85, v106, v107
    v_add_f32 v249, v249, v108
    v_exp_f32 v110, v30
    v_add_f32 v249, v249, v109
    buffer_load_dwordx4 v[120:123], v229, s[76:79], s49 offen
    v_mfma_f32_32x32x16_bf16 v[32:47], a[216:219], v[216:219], v[32:47]
    ds_read_b128 a[216:219], v236 offset:40960
    v_exp_f32 v111, v31
    v_cvt_pk_bf16_f32 v86, v108, v109
    v_add_f32 v249, v249, v110
    v_cvt_pk_bf16_f32 v87, v110, v111
    v_mfma_f32_32x32x16_bf16 v[32:47], a[220:223], v[220:223], v[32:47]
    ds_read_b128 a[220:223], v237 offset:40960
    v_add_f32 v249, v249, v111
    v_cmp_nge_f32 vcc, s50, v249
    s_cbranch_vccnz attn_kernel_stub25
attn_kernel_back25:
    v_add_f32 v247, v247, v249
    s_waitcnt lgkmcnt(4)
    v_mfma_f32_32x32x16_bf16 a[0:15], a[224:227], v[80:83], a[0:15]
    v_mfma_f32_32x32x16_bf16 a[16:31], a[228:231], v[80:83], a[16:31]
    v_mfma_f32_32x32x16_bf16 a[32:47], a[232:235], v[80:83], a[32:47]
    s_nop 2
    v_exp_f32 v96, v32
    v_exp_f32 v97, v33
    v_exp_f32 v98, v34
    v_mfma_f32_32x32x16_bf16 a[48:63], a[236:239], v[80:83], a[48:63]
    v_add_f32 v250, v96, v97
    v_exp_f32 v99, v35
    v_cvt_pk_bf16_f32 v88, v96, v97
    v_add_f32 v250, v250, v98
    v_mfma_f32_32x32x16_bf16 a[0:15], a[240:243], v[84:87], a[0:15]
    v_exp_f32 v100, v36
    v_add_f32 v250, v250, v99
    v_exp_f32 v101, v37
    v_cvt_pk_bf16_f32 v89, v98, v99
    v_mfma_f32_32x32x16_bf16 a[16:31], a[244:247], v[84:87], a[16:31]
    v_add_f32 v250, v250, v100
    v_exp_f32 v102, v38
    v_add_f32 v250, v250, v101
    v_exp_f32 v103, v39
    v_mfma_f32_32x32x16_bf16 a[32:47], a[248:251], v[84:87], a[32:47]
    v_cvt_pk_bf16_f32 v90, v100, v101
    v_add_f32 v250, v250, v102
    v_exp_f32 v104, v40
    v_add_f32 v250, v250, v103
    v_mfma_f32_32x32x16_bf16 a[48:63], a[252:255], v[84:87], a[48:63]
    v_exp_f32 v105, v41
    v_cvt_pk_bf16_f32 v91, v102, v103
    v_add_f32 v250, v250, v104
    v_exp_f32 v106, v42
    v_mfma_f32_32x32x16_bf16 v[16:31], a[192:195], v[160:163], v[48:63]
    v_add_f32 v250, v250, v105
    v_exp_f32 v107, v43
    v_cvt_pk_bf16_f32 v92, v104, v105
    v_add_f32 v250, v250, v106
    v_mfma_f32_32x32x16_bf16 v[16:31], a[196:199], v[164:167], v[16:31]
    v_exp_f32 v108, v44
    v_add_f32 v250, v250, v107
    v_exp_f32 v109, v45
    v_cvt_pk_bf16_f32 v93, v106, v107
    v_mfma_f32_32x32x16_bf16 v[16:31], a[200:203], v[168:171], v[16:31]
    v_add_f32 v250, v250, v108
    v_exp_f32 v110, v46
    v_add_f32 v250, v250, v109
    v_exp_f32 v111, v47
    v_mfma_f32_32x32x16_bf16 v[16:31], a[204:207], v[172:175], v[16:31]
    v_cvt_pk_bf16_f32 v94, v108, v109
    v_add_f32 v250, v250, v110
    v_cvt_pk_bf16_f32 v95, v110, v111
    v_add_f32 v250, v250, v111
    v_cmp_nge_f32 vcc, s51, v250
    s_waitcnt lgkmcnt(0)
    v_mfma_f32_32x32x16_bf16 v[16:31], a[208:211], v[176:179], v[16:31]
    s_cbranch_vccnz attn_kernel_stub26
attn_kernel_back26:
    v_add_f32 v248, v248, v250
    v_mfma_f32_32x32x16_bf16 v[16:31], a[212:215], v[180:183], v[16:31]
    v_mfma_f32_32x32x16_bf16 v[16:31], a[216:219], v[184:187], v[16:31]
    v_mfma_f32_32x32x16_bf16 v[16:31], a[220:223], v[188:191], v[16:31]
    v_mfma_f32_32x32x16_bf16 a[64:79], a[224:227], v[88:91], a[64:79]
    ds_read_b64_tr_b16 a[224:225], v238 offset:40960
    ds_read_b64_tr_b16 a[226:227], v238 offset:43008
    v_mfma_f32_32x32x16_bf16 a[80:95], a[228:231], v[88:91], a[80:95]
    ds_read_b64_tr_b16 a[228:229], v239 offset:40960
    ds_read_b64_tr_b16 a[230:231], v239 offset:43008
    v_mfma_f32_32x32x16_bf16 a[96:111], a[232:235], v[88:91], a[96:111]
    ds_read_b64_tr_b16 a[232:233], v240 offset:40960
    ds_read_b64_tr_b16 a[234:235], v240 offset:43008
    s_nop 2
    v_exp_f32 v96, v16
    v_exp_f32 v97, v17
    v_mfma_f32_32x32x16_bf16 a[112:127], a[236:239], v[88:91], a[112:127]
    ds_read_b64_tr_b16 a[236:237], v241 offset:40960
    ds_read_b64_tr_b16 a[238:239], v241 offset:43008
    v_exp_f32 v98, v18
    v_add_f32 v249, v96, v97
    v_mfma_f32_32x32x16_bf16 a[64:79], a[240:243], v[92:95], a[64:79]
    ds_read_b64_tr_b16 a[240:241], v238 offset:45056
    ds_read_b64_tr_b16 a[242:243], v238 offset:47104
    v_exp_f32 v99, v19
    v_cvt_pk_bf16_f32 v80, v96, v97
    v_add_f32 v249, v249, v98
    v_mfma_f32_32x32x16_bf16 a[80:95], a[244:247], v[92:95], a[80:95]
    ds_read_b64_tr_b16 a[244:245], v239 offset:45056
    ds_read_b64_tr_b16 a[246:247], v239 offset:47104
    v_exp_f32 v100, v20
    v_add_f32 v249, v249, v99
    v_mfma_f32_32x32x16_bf16 a[96:111], a[248:251], v[92:95], a[96:111]
    ds_read_b64_tr_b16 a[248:249], v240 offset:45056
    ds_read_b64_tr_b16 a[250:251], v240 offset:47104
    v_exp_f32 v101, v21
    v_cvt_pk_bf16_f32 v81, v98, v99
    v_add_f32 v249, v249, v100
    v_mfma_f32_32x32x16_bf16 a[112:127], a[252:255], v[92:95], a[112:127]
    ds_read_b64_tr_b16 a[252:253], v241 offset:45056
    ds_read_b64_tr_b16 a[254:255], v241 offset:47104
    v_exp_f32 v102, v22
    v_add_f32 v249, v249, v101
    s_waitcnt vmcnt(14)
    s_barrier
    v_mfma_f32_32x32x16_bf16 v[32:47], a[192:195], v[192:195], v[64:79]
    ds_read_b128 a[192:195], v230 offset:49152
    v_exp_f32 v103, v23
    v_cvt_pk_bf16_f32 v82, v100, v101
    v_add_f32 v249, v249, v102
    v_mfma_f32_32x32x16_bf16 v[32:47], a[196:199], v[196:199], v[32:47]
    ds_read_b128 a[196:199], v231 offset:49152
    v_exp_f32 v104, v24
    v_add_f32 v249, v249, v103
    v_exp_f32 v105, v25
    v_mfma_f32_32x32x16_bf16 v[32:47], a[200:203], v[200:203], v[32:47]
    ds_read_b128 a[200:203], v232 offset:49152
    v_cvt_pk_bf16_f32 v83, v102, v103
    v_add_f32 v249, v249, v104
    v_exp_f32 v106, v26
    v_add_f32 v249, v249, v105
    v_mfma_f32_32x32x16_bf16 v[32:47], a[204:207], v[204:207], v[32:47]
    ds_read_b128 a[204:207], v233 offset:49152
    v_exp_f32 v107, v27
    v_cvt_pk_bf16_f32 v84, v104, v105
    v_add_f32 v249, v249, v106
    v_mfma_f32_32x32x16_bf16 v[32:47], a[208:211], v[208:211], v[32:47]
    ds_read_b128 a[208:211], v234 offset:49152
    v_exp_f32 v108, v28
    v_add_f32 v249, v249, v107
    v_exp_f32 v109, v29
    v_mfma_f32_32x32x16_bf16 v[32:47], a[212:215], v[212:215], v[32:47]
    ds_read_b128 a[212:215], v235 offset:49152
    v_cvt_pk_bf16_f32 v85, v106, v107
    v_add_f32 v249, v249, v108
    v_exp_f32 v110, v30
    v_add_f32 v249, v249, v109
    s_add_u32 m0, s45, 16384
    s_nop 0
    buffer_load_dwordx4 v246, s[16:19], s47 offen offset:0 lds
    v_mfma_f32_32x32x16_bf16 v[32:47], a[216:219], v[216:219], v[32:47]
    ds_read_b128 a[216:219], v236 offset:49152
    v_exp_f32 v111, v31
    v_cvt_pk_bf16_f32 v86, v108, v109
    v_add_f32 v249, v249, v110
    v_cvt_pk_bf16_f32 v87, v110, v111
    v_mfma_f32_32x32x16_bf16 v[32:47], a[220:223], v[220:223], v[32:47]
    ds_read_b128 a[220:223], v237 offset:49152
    v_add_f32 v249, v249, v111
    v_cmp_nge_f32 vcc, s50, v249
    s_cbranch_vccnz attn_kernel_stub27
attn_kernel_back27:
    v_add_f32 v247, v247, v249
    s_waitcnt lgkmcnt(4)
    v_mfma_f32_32x32x16_bf16 a[0:15], a[224:227], v[80:83], a[0:15]
    v_mfma_f32_32x32x16_bf16 a[16:31], a[228:231], v[80:83], a[16:31]
    buffer_load_dwordx4 v246, s[16:19], s47 offen offset:1024 lds
    v_mfma_f32_32x32x16_bf16 a[32:47], a[232:235], v[80:83], a[32:47]
    s_nop 1
    v_exp_f32 v96, v32
    v_exp_f32 v97, v33
    v_exp_f32 v98, v34
    v_mfma_f32_32x32x16_bf16 a[48:63], a[236:239], v[80:83], a[48:63]
    v_add_f32 v250, v96, v97
    v_exp_f32 v99, v35
    v_cvt_pk_bf16_f32 v88, v96, v97
    v_add_f32 v250, v250, v98
    v_mfma_f32_32x32x16_bf16 a[0:15], a[240:243], v[84:87], a[0:15]
    v_exp_f32 v100, v36
    v_add_f32 v250, v250, v99
    v_exp_f32 v101, v37
    v_cvt_pk_bf16_f32 v89, v98, v99
    v_mfma_f32_32x32x16_bf16 a[16:31], a[244:247], v[84:87], a[16:31]
    v_add_f32 v250, v250, v100
    v_exp_f32 v102, v38
    v_add_f32 v250, v250, v101
    v_exp_f32 v103, v39
    buffer_load_dwordx4 v246, s[16:19], s47 offen offset:2048 lds
    v_mfma_f32_32x32x16_bf16 a[32:47], a[248:251], v[84:87], a[32:47]
    v_cvt_pk_bf16_f32 v90, v100, v101
    v_add_f32 v250, v250, v102
    v_exp_f32 v104, v40
    v_add_f32 v250, v250, v103
    v_mfma_f32_32x32x16_bf16 a[48:63], a[252:255], v[84:87], a[48:63]
    v_exp_f32 v105, v41
    v_cvt_pk_bf16_f32 v91, v102, v103
    v_add_f32 v250, v250, v104
    v_exp_f32 v106, v42
    v_mfma_f32_32x32x16_bf16 v[16:31], a[192:195], v[160:163], v[48:63]
    v_add_f32 v250, v250, v105
    v_exp_f32 v107, v43
    v_cvt_pk_bf16_f32 v92, v104, v105
    v_add_f32 v250, v250, v106
    v_mfma_f32_32x32x16_bf16 v[16:31], a[196:199], v[164:167], v[16:31]
    v_exp_f32 v108, v44
    v_add_f32 v250, v250, v107
    v_exp_f32 v109, v45
    v_cvt_pk_bf16_f32 v93, v106, v107
    buffer_load_dwordx4 v246, s[16:19], s47 offen offset:3072 lds
    s_add_u32 s47, s47, 16384
    v_mfma_f32_32x32x16_bf16 v[16:31], a[200:203], v[168:171], v[16:31]
    v_add_f32 v250, v250, v108
    v_exp_f32 v110, v46
    v_add_f32 v250, v250, v109
    v_exp_f32 v111, v47
    v_mfma_f32_32x32x16_bf16 v[16:31], a[204:207], v[172:175], v[16:31]
    v_cvt_pk_bf16_f32 v94, v108, v109
    v_add_f32 v250, v250, v110
    v_cvt_pk_bf16_f32 v95, v110, v111
    v_add_f32 v250, v250, v111
    v_cmp_nge_f32 vcc, s51, v250
    s_waitcnt lgkmcnt(0)
    v_mfma_f32_32x32x16_bf16 v[16:31], a[208:211], v[176:179], v[16:31]
    s_cbranch_vccnz attn_kernel_stub28
attn_kernel_back28:
    v_add_f32 v248, v248, v250
    v_mfma_f32_32x32x16_bf16 v[16:31], a[212:215], v[180:183], v[16:31]
    s_add_u32 m0, s44, 32768
    s_nop 0
    buffer_load_dwordx4 v242, s[12:15], s46 offen offset:0 lds
    v_mfma_f32_32x32x16_bf16 v[16:31], a[216:219], v[184:187], v[16:31]
    v_mfma_f32_32x32x16_bf16 v[16:31], a[220:223], v[188:191], v[16:31]
    v_mfma_f32_32x32x16_bf16 a[64:79], a[224:227], v[88:91], a[64:79]
    ds_read_b64_tr_b16 a[224:225], v238 offset:49152
    ds_read_b64_tr_b16 a[226:227], v238 offset:51200
    v_mfma_f32_32x32x16_bf16 a[80:95], a[228:231], v[88:91], a[80:95]
    ds_read_b64_tr_b16 a[228:229], v239 offset:49152
    ds_read_b64_tr_b16 a[230:231], v239 offset:51200
    buffer_load_dwordx4 v243, s[12:15], s46 offen offset:1024 lds
    v_mfma_f32_32x32x16_bf16 a[96:111], a[232:235], v[88:91], a[96:111]
    ds_read_b64_tr_b16 a[232:233], v240 offset:49152
    ds_read_b64_tr_b16 a[234:235], v240 offset:51200
    s_nop 1
    v_exp_f32 v96, v16
    v_exp_f32 v97, v17
    v_mfma_f32_32x32x16_bf16 a[112:127], a[236:239], v[88:91], a[112:127]
    ds_read_b64_tr_b16 a[236:237], v241 offset:49152
    ds_read_b64_tr_b16 a[238:239], v241 offset:51200
    v_exp_f32 v98, v18
    v_add_f32 v249, v96, v97
    v_mfma_f32_32x32x16_bf16 a[64:79], a[240:243], v[92:95], a[64:79]
    ds_read_b64_tr_b16 a[240:241], v238 offset:53248
    ds_read_b64_tr_b16 a[242:243], v238 offset:55296
    v_exp_f32 v99, v19
    v_cvt_pk_bf16_f32 v80, v96, v97
    v_add_f32 v249, v249, v98
    v_mfma_f32_32x32x16_bf16 a[80:95], a[244:247], v[92:95], a[80:95]
    ds_read_b64_tr_b16 a[244:245], v239 offset:53248
    ds_read_b64_tr_b16 a[246:247], v239 offset:55296
    v_exp_f32 v100, v20
    v_add_f32 v249, v249, v99
    buffer_load_dwordx4 v244, s[12:15], s46 offen offset:2048 lds
    v_mfma_f32_32x32x16_bf16 a[96:111], a[248:251], v[92:95], a[96:111]
    ds_read_b64_tr_b16 a[248:249], v240 offset:53248
    ds_read_b64_tr_b16 a[250:251], v240 offset:55296
    v_exp_f32 v101, v21
    v_cvt_pk_bf16_f32 v81, v98, v99
    v_add_f32 v249, v249, v100
    v_mfma_f32_32x32x16_bf16 a[112:127], a[252:255], v[92:95], a[112:127]
    ds_read_b64_tr_b16 a[252:253], v241 offset:53248
    ds_read_b64_tr_b16 a[254:255], v241 offset:55296
    v_exp_f32 v102, v22
    v_add_f32 v249, v249, v101
    v_mfma_f32_32x32x16_bf16 v[32:47], a[192:195], v[192:195], v[64:79]
    ds_read_b128 a[192:195], v230 offset:57344
    v_exp_f32 v103, v23
    v_cvt_pk_bf16_f32 v82, v100, v101
    v_add_f32 v249, v249, v102
    v_mfma_f32_32x32x16_bf16 v[32:47], a[196:199], v[196:199], v[32:47]
    ds_read_b128 a[196:199], v231 offset:57344
    v_exp_f32 v104, v24
    v_add_f32 v249, v249, v103
    v_exp_f32 v105, v25
    buffer_load_dwordx4 v245, s[12:15], s46 offen offset:3072 lds
    s_add_u32 s46, s46, 16384
    v_mfma_f32_32x32x16_bf16 v[32:47], a[200:203], v[200:203], v[32:47]
    ds_read_b128 a[200:203], v232 offset:57344
    v_cvt_pk_bf16_f32 v83, v102, v103
    v_add_f32 v249, v249, v104
    v_exp_f32 v106, v26
    v_add_f32 v249, v249, v105
    v_mfma_f32_32x32x16_bf16 v[32:47], a[204:207], v[204:207], v[32:47]
    ds_read_b128 a[204:207], v233 offset:57344
    v_exp_f32 v107, v27
    v_cvt_pk_bf16_f32 v84, v104, v105
    v_add_f32 v249, v249, v106
    v_mfma_f32_32x32x16_bf16 v[32:47], a[208:211], v[208:211], v[32:47]
    ds_read_b128 a[208:211], v234 offset:57344
    v_exp_f32 v108, v28
    v_add_f32 v249, v249, v107
    v_exp_f32 v109, v29
    v_mfma_f32_32x32x16_bf16 v[32:47], a[212:215], v[212:215], v[32:47]
    ds_read_b128 a[212:215], v235 offset:57344
    v_cvt_pk_bf16_f32 v85, v106, v107
    v_add_f32 v249, v249, v108
    v_exp_f32 v110, v30
    v_add_f32 v249, v249, v109
    buffer_load_dwordx4 v[120:123], v229, s[80:83], s49 offen
    v_mfma_f32_32x32x16_bf16 v[32:47], a[216:219], v[216:219], v[32:47]
    ds_read_b128 a[216:219], v236 offset:57344
    v_exp_f32 v111, v31
    v_cvt_pk_bf16_f32 v86, v108, v109
    v_add_f32 v249, v249, v110
    v_cvt_pk_bf16_f32 v87, v110, v111
    v_mfma_f32_32x32x16_bf16 v[32:47], a[220:223], v[220:223], v[32:47]
    ds_read_b128 a[220:223], v237 offset:57344
    v_add_f32 v249, v249, v111
    v_cmp_nge_f32 vcc, s50, v249
    s_cbranch_vccnz attn_kernel_stub29
attn_kernel_back29:
    v_add_f32 v247, v247, v249
    s_waitcnt lgkmcnt(4)
    v_mfma_f32_32x32x16_bf16 a[0:15], a[224:227], v[80:83], a[0:15]
    v_mfma_f32_32x32x16_bf16 a[16:31], a[228:231], v[80:83], a[16:31]
    v_mfma_f32_32x32x16_bf16 a[32:47], a[232:235], v[80:83], a[32:47]
    s_nop 2
    v_exp_f32 v96, v32
    v_exp_f32 v97, v33
    v_exp_f32 v98, v34
    v_mfma_f32_32x32x16_bf16 a[48:63], a[236:239], v[80:83], a[48:63]
    v_add_f32 v250, v96, v97
    v_exp_f32 v99, v35
    v_cvt_pk_bf16_f32 v88, v96, v97
    v_add_f32 v250, v250, v98
    v_mfma_f32_32x32x16_bf16 a[0:15], a[240:243], v[84:87], a[0:15]
    v_exp_f32 v100, v36
    v_add_f32 v250, v250, v99
    v_exp_f32 v101, v37
    v_cvt_pk_bf16_f32 v89, v98, v99
    v_mfma_f32_32x32x16_bf16 a[16:31], a[244:247], v[84:87], a[16:31]
    v_add_f32 v250, v250, v100
    v_exp_f32 v102, v38
    v_add_f32 v250, v250, v101
    v_exp_f32 v103, v39
    v_mfma_f32_32x32x16_bf16 a[32:47], a[248:251], v[84:87], a[32:47]
    v_cvt_pk_bf16_f32 v90, v100, v101
    v_add_f32 v250, v250, v102
    v_exp_f32 v104, v40
    v_add_f32 v250, v250, v103
    v_mfma_f32_32x32x16_bf16 a[48:63], a[252:255], v[84:87], a[48:63]
    v_exp_f32 v105, v41
    v_cvt_pk_bf16_f32 v91, v102, v103
    v_add_f32 v250, v250, v104
    v_exp_f32 v106, v42
    v_mfma_f32_32x32x16_bf16 v[16:31], a[192:195], v[160:163], v[48:63]
    v_add_f32 v250, v250, v105
    v_exp_f32 v107, v43
    v_cvt_pk_bf16_f32 v92, v104, v105
    v_add_f32 v250, v250, v106
    v_mfma_f32_32x32x16_bf16 v[16:31], a[196:199], v[164:167], v[16:31]
    v_exp_f32 v108, v44
    v_add_f32 v250, v250, v107
    v_exp_f32 v109, v45
    v_cvt_pk_bf16_f32 v93, v106, v107
    v_mfma_f32_32x32x16_bf16 v[16:31], a[200:203], v[168:171], v[16:31]
    v_add_f32 v250, v250, v108
    v_exp_f32 v110, v46
    v_add_f32 v250, v250, v109
    v_exp_f32 v111, v47
    v_mfma_f32_32x32x16_bf16 v[16:31], a[204:207], v[172:175], v[16:31]
    v_cvt_pk_bf16_f32 v94, v108, v109
    v_add_f32 v250, v250, v110
    v_cvt_pk_bf16_f32 v95, v110, v111
    v_add_f32 v250, v250, v111
    v_cmp_nge_f32 vcc, s51, v250
    s_waitcnt lgkmcnt(0)
    v_mfma_f32_32x32x16_bf16 v[16:31], a[208:211], v[176:179], v[16:31]
    s_cbranch_vccnz attn_kernel_stub30
attn_kernel_back30:
    v_add_f32 v248, v248, v250
    v_mfma_f32_32x32x16_bf16 v[16:31], a[212:215], v[180:183], v[16:31]
    v_mfma_f32_32x32x16_bf16 v[16:31], a[216:219], v[184:187], v[16:31]
    v_mfma_f32_32x32x16_bf16 v[16:31], a[220:223], v[188:191], v[16:31]
    v_mfma_f32_32x32x16_bf16 a[64:79], a[224:227], v[88:91], a[64:79]
    ds_read_b64_tr_b16 a[224:225], v238 offset:57344
    ds_read_b64_tr_b16 a[226:227], v238 offset:59392
    v_mfma_f32_32x32x16_bf16 a[80:95], a[228:231], v[88:91], a[80:95]
    ds_read_b64_tr_b16 a[228:229], v239 offset:57344
    ds_read_b64_tr_b16 a[230:231], v239 offset:59392
    v_mfma_f32_32x32x16_bf16 a[96:111], a[232:235], v[88:91], a[96:111]
    ds_read_b64_tr_b16 a[232:233], v240 offset:57344
    ds_read_b64_tr_b16 a[234:235], v240 offset:59392
    s_nop 2
    v_exp_f32 v96, v16
    v_exp_f32 v97, v17
    v_mfma_f32_32x32x16_bf16 a[112:127], a[236:239], v[88:91], a[112:127]
    ds_read_b64_tr_b16 a[236:237], v241 offset:57344
    ds_read_b64_tr_b16 a[238:239], v241 offset:59392
    v_exp_f32 v98, v18
    v_add_f32 v249, v96, v97
    v_mfma_f32_32x32x16_bf16 a[64:79], a[240:243], v[92:95], a[64:79]
    ds_read_b64_tr_b16 a[240:241], v238 offset:61440
    ds_read_b64_tr_b16 a[242:243], v238 offset:63488
    v_exp_f32 v99, v19
    v_cvt_pk_bf16_f32 v80, v96, v97
    v_add_f32 v249, v249, v98
    v_mfma_f32_32x32x16_bf16 a[80:95], a[244:247], v[92:95], a[80:95]
    ds_read_b64_tr_b16 a[244:245], v239 offset:61440
    ds_read_b64_tr_b16 a[246:247], v239 offset:63488
    v_exp_f32 v100, v20
    v_add_f32 v249, v249, v99
    v_mfma_f32_32x32x16_bf16 a[96:111], a[248:251], v[92:95], a[96:111]
    ds_read_b64_tr_b16 a[248:249], v240 offset:61440
    ds_read_b64_tr_b16 a[250:251], v240 offset:63488
    v_exp_f32 v101, v21
    v_cvt_pk_bf16_f32 v81, v98, v99
    v_add_f32 v249, v249, v100
    v_mfma_f32_32x32x16_bf16 a[112:127], a[252:255], v[92:95], a[112:127]
    ds_read_b64_tr_b16 a[252:253], v241 offset:61440
    ds_read_b64_tr_b16 a[254:255], v241 offset:63488
    v_exp_f32 v102, v22
    v_add_f32 v249, v249, v101
    s_waitcnt vmcnt(14)
    s_barrier
    v_mfma_f32_32x32x16_bf16 v[32:47], a[192:195], v[192:195], v[64:79]
    ds_read_b128 a[192:195], v230 offset:0
    v_exp_f32 v103, v23
    v_cvt_pk_bf16_f32 v82, v100, v101
    v_add_f32 v249, v249, v102
    v_mfma_f32_32x32x16_bf16 v[32:47], a[196:199], v[196:199], v[32:47]
    ds_read_b128 a[196:199], v231 offset:0
    v_exp_f32 v104, v24
    v_add_f32 v249, v249, v103
    v_exp_f32 v105, v25
    v_mfma_f32_32x32x16_bf16 v[32:47], a[200:203], v[200:203], v[32:47]
    ds_read_b128 a[200:203], v232 offset:0
    v_cvt_pk_bf16_f32 v83, v102, v103
    v_add_f32 v249, v249, v104
    v_exp_f32 v106, v26
    v_add_f32 v249, v249, v105
    v_mfma_f32_32x32x16_bf16 v[32:47], a[204:207], v[204:207], v[32:47]
    ds_read_b128 a[204:207], v233 offset:0
    v_exp_f32 v107, v27
    v_cvt_pk_bf16_f32 v84, v104, v105
    v_add_f32 v249, v249, v106
    v_mfma_f32_32x32x16_bf16 v[32:47], a[208:211], v[208:211], v[32:47]
    ds_read_b128 a[208:211], v234 offset:0
    v_exp_f32 v108, v28
    v_add_f32 v249, v249, v107
    v_exp_f32 v109, v29
    v_mfma_f32_32x32x16_bf16 v[32:47], a[212:215], v[212:215], v[32:47]
    ds_read_b128 a[212:215], v235 offset:0
    v_cvt_pk_bf16_f32 v85, v106, v107
    v_add_f32 v249, v249, v108
    v_exp_f32 v110, v30
    v_add_f32 v249, v249, v109
    s_add_u32 m0, s45, 32768
    s_nop 0
    buffer_load_dwordx4 v246, s[16:19], s47 offen offset:0 lds
    v_mfma_f32_32x32x16_bf16 v[32:47], a[216:219], v[216:219], v[32:47]
    ds_read_b128 a[216:219], v236 offset:0
    v_exp_f32 v111, v31
    v_cvt_pk_bf16_f32 v86, v108, v109
    v_add_f32 v249, v249, v110
    v_cvt_pk_bf16_f32 v87, v110, v111
    v_mfma_f32_32x32x16_bf16 v[32:47], a[220:223], v[220:223], v[32:47]
    ds_read_b128 a[220:223], v237 offset:0
    v_add_f32 v249, v249, v111
    v_cmp_nge_f32 vcc, s50, v249
    s_cbranch_vccnz attn_kernel_stub31
attn_kernel_back31:
    v_add_f32 v247, v247, v249
    s_waitcnt lgkmcnt(4)
    v_mfma_f32_32x32x16_bf16 a[0:15], a[224:227], v[80:83], a[0:15]
    v_mfma_f32_32x32x16_bf16 a[16:31], a[228:231], v[80:83], a[16:31]
    buffer_load_dwordx4 v246, s[16:19], s47 offen offset:1024 lds
    v_mfma_f32_32x32x16_bf16 a[32:47], a[232:235], v[80:83], a[32:47]
    s_nop 1
    v_exp_f32 v96, v32
    v_exp_f32 v97, v33
    v_exp_f32 v98, v34
    v_mfma_f32_32x32x16_bf16 a[48:63], a[236:239], v[80:83], a[48:63]
    v_add_f32 v250, v96, v97
    v_exp_f32 v99, v35
    v_cvt_pk_bf16_f32 v88, v96, v97
    v_add_f32 v250, v250, v98
    v_mfma_f32_32x32x16_bf16 a[0:15], a[240:243], v[84:87], a[0:15]
    v_exp_f32 v100, v36
    v_add_f32 v250, v250, v99
    v_exp_f32 v101, v37
    v_cvt_pk_bf16_f32 v89, v98, v99
    v_mfma_f32_32x32x16_bf16 a[16:31], a[244:247], v[84:87], a[16:31]
    v_add_f32 v250, v250, v100
    v_exp_f32 v102, v38
    v_add_f32 v250, v250, v101
    v_exp_f32 v103, v39
    buffer_load_dwordx4 v246, s[16:19], s47 offen offset:2048 lds
    v_mfma_f32_32x32x16_bf16 a[32:47], a[248:251], v[84:87], a[32:47]
    v_cvt_pk_bf16_f32 v90, v100, v101
    v_add_f32 v250, v250, v102
    v_exp_f32 v104, v40
    v_add_f32 v250, v250, v103
    v_mfma_f32_32x32x16_bf16 a[48:63], a[252:255], v[84:87], a[48:63]
    v_exp_f32 v105, v41
    v_cvt_pk_bf16_f32 v91, v102, v103
    v_add_f32 v250, v250, v104
    v_exp_f32 v106, v42
    s_add_u32 s48, s48, 1
    s_cmp_lt_u32 s48, 7
    s_cbranch_scc1 attn_kernel_loop
    v_add_f32 v250, v250, v105
    v_exp_f32 v107, v43
    v_cvt_pk_bf16_f32 v92, v104, v105
    v_add_f32 v250, v250, v106
    v_exp_f32 v108, v44
    v_add_f32 v250, v250, v107
    v_exp_f32 v109, v45
    v_cvt_pk_bf16_f32 v93, v106, v107
    v_add_f32 v250, v250, v108
    v_exp_f32 v110, v46
    v_add_f32 v250, v250, v109
    v_exp_f32 v111, v47
    v_cvt_pk_bf16_f32 v94, v108, v109
    v_add_f32 v250, v250, v110
    v_cvt_pk_bf16_f32 v95, v110, v111
    v_add_f32 v250, v250, v111
    v_cmp_nge_f32 vcc, s51, v250
    s_cbranch_vccnz attn_kernel_stub32
attn_kernel_back32:
    v_add_f32 v248, v248, v250
    v_mfma_f32_32x32x16_bf16 a[64:79], a[224:227], v[88:91], a[64:79]
    v_mfma_f32_32x32x16_bf16 a[80:95], a[228:231], v[88:91], a[80:95]
    v_mfma_f32_32x32x16_bf16 a[96:111], a[232:235], v[88:91], a[96:111]
    v_mfma_f32_32x32x16_bf16 a[112:127], a[236:239], v[88:91], a[112:127]
    v_mfma_f32_32x32x16_bf16 a[64:79], a[240:243], v[92:95], a[64:79]
    v_mfma_f32_32x32x16_bf16 a[80:95], a[244:247], v[92:95], a[80:95]
    v_mfma_f32_32x32x16_bf16 a[96:111], a[248:251], v[92:95], a[96:111]
    v_mfma_f32_32x32x16_bf16 a[112:127], a[252:255], v[92:95], a[112:127]
    v_mov_b32 v112, v247
    v_mov_b32 v113, v247
    s_nop 1
    v_permlane32_swap_b32 v112, v113
    v_add_f32 v247, v112, v113
    v_rcp_f32 v247, v247
    v_mov_b32 v112, v248
    v_mov_b32 v113, v248
    s_nop 1
    v_permlane32_swap_b32 v112, v113
    v_add_f32 v248, v112, v113
    v_rcp_f32 v248, v248
    v_and_b32 v112, 63, v0
    v_lshrrev_b32 v113, 5, v112
    v_and_b32 v114, 15, v112
    v_xor_b32 v113, v113, v114
    v_xor_b32 v115, 0, v113
    v_lshl_add_u32 v96, v115, 4, v253
    v_xor_b32 v115, 2, v113
    v_lshl_add_u32 v97, v115, 4, v253
    v_xor_b32 v115, 4, v113
    v_lshl_add_u32 v98, v115, 4, v253
    v_xor_b32 v115, 6, v113
    v_lshl_add_u32 v99, v115, 4, v253
    v_xor_b32 v115, 8, v113
    v_lshl_add_u32 v100, v115, 4, v253
    v_xor_b32 v115, 10, v113
    v_lshl_add_u32 v101, v115, 4, v253
    v_xor_b32 v115, 12, v113
    v_lshl_add_u32 v102, v115, 4, v253
    v_xor_b32 v115, 14, v113
    v_lshl_add_u32 v103, v115, 4, v253
    v_lshrrev_b32 v113, 4, v112
    v_add_u32 v115, 0, v113
    v_xor_b32 v115, v115, v114
    v_lshl_add_u32 v104, v115, 4, v254
    v_add_u32 v115, 4, v113
    v_xor_b32 v115, v115, v114
    v_lshl_add_u32 v105, v115, 4, v254
    v_add_u32 v115, 8, v113
    v_xor_b32 v115, v115, v114
    v_lshl_add_u32 v106, v115, 4, v254
    v_add_u32 v115, 12, v113
    v_xor_b32 v115, v115, v114
    v_lshl_add_u32 v107, v115, 4, v254
    v_accvgpr_read_b32 v116, a0
    v_accvgpr_read_b32 v117, a1
    v_mul_f32 v116, v116, v247
    v_mul_f32 v117, v117, v247
    v_cvt_pk_bf16_f32 v16, v116, v117
    v_accvgpr_read_b32 v116, a2
    v_accvgpr_read_b32 v117, a3
    v_mul_f32 v116, v116, v247
    v_mul_f32 v117, v117, v247
    v_cvt_pk_bf16_f32 v17, v116, v117
    v_accvgpr_read_b32 v116, a4
    v_accvgpr_read_b32 v117, a5
    v_mul_f32 v116, v116, v247
    v_mul_f32 v117, v117, v247
    v_cvt_pk_bf16_f32 v18, v116, v117
    v_accvgpr_read_b32 v116, a6
    v_accvgpr_read_b32 v117, a7
    v_mul_f32 v116, v116, v247
    v_mul_f32 v117, v117, v247
    v_cvt_pk_bf16_f32 v19, v116, v117
    v_permlane32_swap_b32 v16, v18
    s_nop 0
    v_permlane32_swap_b32 v17, v19
    ds_write_b128 v96, v[16:19]
    v_accvgpr_read_b32 v116, a8
    v_accvgpr_read_b32 v117, a9
    v_mul_f32 v116, v116, v247
    v_mul_f32 v117, v117, v247
    v_cvt_pk_bf16_f32 v20, v116, v117
    v_accvgpr_read_b32 v116, a10
    v_accvgpr_read_b32 v117, a11
    v_mul_f32 v116, v116, v247
    v_mul_f32 v117, v117, v247
    v_cvt_pk_bf16_f32 v21, v116, v117
    v_accvgpr_read_b32 v116, a12
    v_accvgpr_read_b32 v117, a13
    v_mul_f32 v116, v116, v247
    v_mul_f32 v117, v117, v247
    v_cvt_pk_bf16_f32 v22, v116, v117
    v_accvgpr_read_b32 v116, a14
    v_accvgpr_read_b32 v117, a15
    v_mul_f32 v116, v116, v247
    v_mul_f32 v117, v117, v247
    v_cvt_pk_bf16_f32 v23, v116, v117
    v_permlane32_swap_b32 v20, v22
    s_nop 0
    v_permlane32_swap_b32 v21, v23
    ds_write_b128 v97, v[20:23]
    v_accvgpr_read_b32 v116, a16
    v_accvgpr_read_b32 v117, a17
    v_mul_f32 v116, v116, v247
    v_mul_f32 v117, v117, v247
    v_cvt_pk_bf16_f32 v24, v116, v117
    v_accvgpr_read_b32 v116, a18
    v_accvgpr_read_b32 v117, a19
    v_mul_f32 v116, v116, v247
    v_mul_f32 v117, v117, v247
    v_cvt_pk_bf16_f32 v25, v116, v117
    v_accvgpr_read_b32 v116, a20
    v_accvgpr_read_b32 v117, a21
    v_mul_f32 v116, v116, v247
    v_mul_f32 v117, v117, v247
    v_cvt_pk_bf16_f32 v26, v116, v117
    v_accvgpr_read_b32 v116, a22
    v_accvgpr_read_b32 v117, a23
    v_mul_f32 v116, v116, v247
    v_mul_f32 v117, v117, v247
    v_cvt_pk_bf16_f32 v27, v116, v117
    v_permlane32_swap_b32 v24, v26
    s_nop 0
    v_permlane32_swap_b32 v25, v27
    ds_write_b128 v98, v[24:27]
    v_accvgpr_read_b32 v116, a24
    v_accvgpr_read_b32 v117, a25
    v_mul_f32 v116, v116, v247
    v_mul_f32 v117, v117, v247
    v_cvt_pk_bf16_f32 v28, v116, v117
    v_accvgpr_read_b32 v116, a26
    v_accvgpr_read_b32 v117, a27
    v_mul_f32 v116, v116, v247
    v_mul_f32 v117, v117, v247
    v_cvt_pk_bf16_f32 v29, v116, v117
    v_accvgpr_read_b32 v116, a28
    v_accvgpr_read_b32 v117, a29
    v_mul_f32 v116, v116, v247
    v_mul_f32 v117, v117, v247
    v_cvt_pk_bf16_f32 v30, v116, v117
    v_accvgpr_read_b32 v116, a30
    v_accvgpr_read_b32 v117, a31
    v_mul_f32 v116, v116, v247
    v_mul_f32 v117, v117, v247
    v_cvt_pk_bf16_f32 v31, v116, v117
    v_permlane32_swap_b32 v28, v30
    s_nop 0
    v_permlane32_swap_b32 v29, v31
    ds_write_b128 v99, v[28:31]
    v_accvgpr_read_b32 v116, a32
    v_accvgpr_read_b32 v117, a33
    v_mul_f32 v116, v116, v247
    v_mul_f32 v117, v117, v247
    v_cvt_pk_bf16_f32 v16, v116, v117
    v_accvgpr_read_b32 v116, a34
    v_accvgpr_read_b32 v117, a35
    v_mul_f32 v116, v116, v247
    v_mul_f32 v117, v117, v247
    v_cvt_pk_bf16_f32 v17, v116, v117
    v_accvgpr_read_b32 v116, a36
    v_accvgpr_read_b32 v117, a37
    v_mul_f32 v116, v116, v247
    v_mul_f32 v117, v117, v247
    v_cvt_pk_bf16_f32 v18, v116, v117
    v_accvgpr_read_b32 v116, a38
    v_accvgpr_read_b32 v117, a39
    v_mul_f32 v116, v116, v247
    v_mul_f32 v117, v117, v247
    v_cvt_pk_bf16_f32 v19, v116, v117
    v_permlane32_swap_b32 v16, v18
    s_nop 0
    v_permlane32_swap_b32 v17, v19
    ds_write_b128 v100, v[16:19]
    v_accvgpr_read_b32 v116, a40
    v_accvgpr_read_b32 v117, a41
    v_mul_f32 v116, v116, v247
    v_mul_f32 v117, v117, v247
    v_cvt_pk_bf16_f32 v20, v116, v117
    v_accvgpr_read_b32 v116, a42
    v_accvgpr_read_b32 v117, a43
    v_mul_f32 v116, v116, v247
    v_mul_f32 v117, v117, v247
    v_cvt_pk_bf16_f32 v21, v116, v117
    v_accvgpr_read_b32 v116, a44
    v_accvgpr_read_b32 v117, a45
    v_mul_f32 v116, v116, v247
    v_mul_f32 v117, v117, v247
    v_cvt_pk_bf16_f32 v22, v116, v117
    v_accvgpr_read_b32 v116, a46
    v_accvgpr_read_b32 v117, a47
    v_mul_f32 v116, v116, v247
    v_mul_f32 v117, v117, v247
    v_cvt_pk_bf16_f32 v23, v116, v117
    v_permlane32_swap_b32 v20, v22
    s_nop 0
    v_permlane32_swap_b32 v21, v23
    ds_write_b128 v101, v[20:23]
    v_accvgpr_read_b32 v116, a48
    v_accvgpr_read_b32 v117, a49
    v_mul_f32 v116, v116, v247
    v_mul_f32 v117, v117, v247
    v_cvt_pk_bf16_f32 v24, v116, v117
    v_accvgpr_read_b32 v116, a50
    v_accvgpr_read_b32 v117, a51
    v_mul_f32 v116, v116, v247
    v_mul_f32 v117, v117, v247
    v_cvt_pk_bf16_f32 v25, v116, v117
    v_accvgpr_read_b32 v116, a52
    v_accvgpr_read_b32 v117, a53
    v_mul_f32 v116, v116, v247
    v_mul_f32 v117, v117, v247
    v_cvt_pk_bf16_f32 v26, v116, v117
    v_accvgpr_read_b32 v116, a54
    v_accvgpr_read_b32 v117, a55
    v_mul_f32 v116, v116, v247
    v_mul_f32 v117, v117, v247
    v_cvt_pk_bf16_f32 v27, v116, v117
    v_permlane32_swap_b32 v24, v26
    s_nop 0
    v_permlane32_swap_b32 v25, v27
    ds_write_b128 v102, v[24:27]
    v_accvgpr_read_b32 v116, a56
    v_accvgpr_read_b32 v117, a57
    v_mul_f32 v116, v116, v247
    v_mul_f32 v117, v117, v247
    v_cvt_pk_bf16_f32 v28, v116, v117
    v_accvgpr_read_b32 v116, a58
    v_accvgpr_read_b32 v117, a59
    v_mul_f32 v116, v116, v247
    v_mul_f32 v117, v117, v247
    v_cvt_pk_bf16_f32 v29, v116, v117
    v_accvgpr_read_b32 v116, a60
    v_accvgpr_read_b32 v117, a61
    v_mul_f32 v116, v116, v247
    v_mul_f32 v117, v117, v247
    v_cvt_pk_bf16_f32 v30, v116, v117
    v_accvgpr_read_b32 v116, a62
    v_accvgpr_read_b32 v117, a63
    v_mul_f32 v116, v116, v247
    v_mul_f32 v117, v117, v247
    v_cvt_pk_bf16_f32 v31, v116, v117
    v_permlane32_swap_b32 v28, v30
    s_nop 0
    v_permlane32_swap_b32 v29, v31
    ds_write_b128 v103, v[28:31]
    s_waitcnt lgkmcnt(0)
    ds_read_b128 v[32:35], v104 offset:0
    ds_read_b128 v[36:39], v105 offset:1024
    ds_read_b128 v[40:43], v106 offset:2048
    ds_read_b128 v[44:47], v107 offset:3072
    ds_read_b128 v[48:51], v104 offset:4096
    ds_read_b128 v[52:55], v105 offset:5120
    ds_read_b128 v[56:59], v106 offset:6144
    ds_read_b128 v[60:63], v107 offset:7168
    s_mov_b32 s40, 0
    s_waitcnt lgkmcnt(7)
    buffer_store_dwordx4 v[32:35], v255, s[24:27], s40 offen
    s_mov_b32 s40, 32768
    s_waitcnt lgkmcnt(6)
    buffer_store_dwordx4 v[36:39], v255, s[24:27], s40 offen
    s_mov_b32 s40, 65536
    s_waitcnt lgkmcnt(5)
    buffer_store_dwordx4 v[40:43], v255, s[24:27], s40 offen
    s_mov_b32 s40, 98304
    s_waitcnt lgkmcnt(4)
    buffer_store_dwordx4 v[44:47], v255, s[24:27], s40 offen
    s_mov_b32 s40, 131072
    s_waitcnt lgkmcnt(3)
    buffer_store_dwordx4 v[48:51], v255, s[24:27], s40 offen
    s_mov_b32 s40, 163840
    s_waitcnt lgkmcnt(2)
    buffer_store_dwordx4 v[52:55], v255, s[24:27], s40 offen
    s_mov_b32 s40, 196608
    s_waitcnt lgkmcnt(1)
    buffer_store_dwordx4 v[56:59], v255, s[24:27], s40 offen
    s_mov_b32 s40, 229376
    s_waitcnt lgkmcnt(0)
    buffer_store_dwordx4 v[60:63], v255, s[24:27], s40 offen
    v_accvgpr_read_b32 v116, a64
    v_accvgpr_read_b32 v117, a65
    v_mul_f32 v116, v116, v248
    v_mul_f32 v117, v117, v248
    v_cvt_pk_bf16_f32 v16, v116, v117
    v_accvgpr_read_b32 v116, a66
    v_accvgpr_read_b32 v117, a67
    v_mul_f32 v116, v116, v248
    v_mul_f32 v117, v117, v248
    v_cvt_pk_bf16_f32 v17, v116, v117
    v_accvgpr_read_b32 v116, a68
    v_accvgpr_read_b32 v117, a69
    v_mul_f32 v116, v116, v248
    v_mul_f32 v117, v117, v248
    v_cvt_pk_bf16_f32 v18, v116, v117
    v_accvgpr_read_b32 v116, a70
    v_accvgpr_read_b32 v117, a71
    v_mul_f32 v116, v116, v248
    v_mul_f32 v117, v117, v248
    v_cvt_pk_bf16_f32 v19, v116, v117
    v_permlane32_swap_b32 v16, v18
    s_nop 0
    v_permlane32_swap_b32 v17, v19
    ds_write_b128 v96, v[16:19]
    v_accvgpr_read_b32 v116, a72
    v_accvgpr_read_b32 v117, a73
    v_mul_f32 v116, v116, v248
    v_mul_f32 v117, v117, v248
    v_cvt_pk_bf16_f32 v20, v116, v117
    v_accvgpr_read_b32 v116, a74
    v_accvgpr_read_b32 v117, a75
    v_mul_f32 v116, v116, v248
    v_mul_f32 v117, v117, v248
    v_cvt_pk_bf16_f32 v21, v116, v117
    v_accvgpr_read_b32 v116, a76
    v_accvgpr_read_b32 v117, a77
    v_mul_f32 v116, v116, v248
    v_mul_f32 v117, v117, v248
    v_cvt_pk_bf16_f32 v22, v116, v117
    v_accvgpr_read_b32 v116, a78
    v_accvgpr_read_b32 v117, a79
    v_mul_f32 v116, v116, v248
    v_mul_f32 v117, v117, v248
    v_cvt_pk_bf16_f32 v23, v116, v117
    v_permlane32_swap_b32 v20, v22
    s_nop 0
    v_permlane32_swap_b32 v21, v23
    ds_write_b128 v97, v[20:23]
    v_accvgpr_read_b32 v116, a80
    v_accvgpr_read_b32 v117, a81
    v_mul_f32 v116, v116, v248
    v_mul_f32 v117, v117, v248
    v_cvt_pk_bf16_f32 v24, v116, v117
    v_accvgpr_read_b32 v116, a82
    v_accvgpr_read_b32 v117, a83
    v_mul_f32 v116, v116, v248
    v_mul_f32 v117, v117, v248
    v_cvt_pk_bf16_f32 v25, v116, v117
    v_accvgpr_read_b32 v116, a84
    v_accvgpr_read_b32 v117, a85
    v_mul_f32 v116, v116, v248
    v_mul_f32 v117, v117, v248
    v_cvt_pk_bf16_f32 v26, v116, v117
    v_accvgpr_read_b32 v116, a86
    v_accvgpr_read_b32 v117, a87
    v_mul_f32 v116, v116, v248
    v_mul_f32 v117, v117, v248
    v_cvt_pk_bf16_f32 v27, v116, v117
    v_permlane32_swap_b32 v24, v26
    s_nop 0
    v_permlane32_swap_b32 v25, v27
    ds_write_b128 v98, v[24:27]
    v_accvgpr_read_b32 v116, a88
    v_accvgpr_read_b32 v117, a89
    v_mul_f32 v116, v116, v248
    v_mul_f32 v117, v117, v248
    v_cvt_pk_bf16_f32 v28, v116, v117
    v_accvgpr_read_b32 v116, a90
    v_accvgpr_read_b32 v117, a91
    v_mul_f32 v116, v116, v248
    v_mul_f32 v117, v117, v248
    v_cvt_pk_bf16_f32 v29, v116, v117
    v_accvgpr_read_b32 v116, a92
    v_accvgpr_read_b32 v117, a93
    v_mul_f32 v116, v116, v248
    v_mul_f32 v117, v117, v248
    v_cvt_pk_bf16_f32 v30, v116, v117
    v_accvgpr_read_b32 v116, a94
    v_accvgpr_read_b32 v117, a95
    v_mul_f32 v116, v116, v248
    v_mul_f32 v117, v117, v248
    v_cvt_pk_bf16_f32 v31, v116, v117
    v_permlane32_swap_b32 v28, v30
    s_nop 0
    v_permlane32_swap_b32 v29, v31
    ds_write_b128 v99, v[28:31]
    v_accvgpr_read_b32 v116, a96
    v_accvgpr_read_b32 v117, a97
    v_mul_f32 v116, v116, v248
    v_mul_f32 v117, v117, v248
    v_cvt_pk_bf16_f32 v16, v116, v117
    v_accvgpr_read_b32 v116, a98
    v_accvgpr_read_b32 v117, a99
    v_mul_f32 v116, v116, v248
    v_mul_f32 v117, v117, v248
    v_cvt_pk_bf16_f32 v17, v116, v117
    v_accvgpr_read_b32 v116, a100
    v_accvgpr_read_b32 v117, a101
    v_mul_f32 v116, v116, v248
    v_mul_f32 v117, v117, v248
    v_cvt_pk_bf16_f32 v18, v116, v117
    v_accvgpr_read_b32 v116, a102
    v_accvgpr_read_b32 v117, a103
    v_mul_f32 v116, v116, v248
    v_mul_f32 v117, v117, v248
    v_cvt_pk_bf16_f32 v19, v116, v117
    v_permlane32_swap_b32 v16, v18
    s_nop 0
    v_permlane32_swap_b32 v17, v19
    ds_write_b128 v100, v[16:19]
    v_accvgpr_read_b32 v116, a104
    v_accvgpr_read_b32 v117, a105
    v_mul_f32 v116, v116, v248
    v_mul_f32 v117, v117, v248
    v_cvt_pk_bf16_f32 v20, v116, v117
    v_accvgpr_read_b32 v116, a106
    v_accvgpr_read_b32 v117, a107
    v_mul_f32 v116, v116, v248
    v_mul_f32 v117, v117, v248
    v_cvt_pk_bf16_f32 v21, v116, v117
    v_accvgpr_read_b32 v116, a108
    v_accvgpr_read_b32 v117, a109
    v_mul_f32 v116, v116, v248
    v_mul_f32 v117, v117, v248
    v_cvt_pk_bf16_f32 v22, v116, v117
    v_accvgpr_read_b32 v116, a110
    v_accvgpr_read_b32 v117, a111
    v_mul_f32 v116, v116, v248
    v_mul_f32 v117, v117, v248
    v_cvt_pk_bf16_f32 v23, v116, v117
    v_permlane32_swap_b32 v20, v22
    s_nop 0
    v_permlane32_swap_b32 v21, v23
    ds_write_b128 v101, v[20:23]
    v_accvgpr_read_b32 v116, a112
    v_accvgpr_read_b32 v117, a113
    v_mul_f32 v116, v116, v248
    v_mul_f32 v117, v117, v248
    v_cvt_pk_bf16_f32 v24, v116, v117
    v_accvgpr_read_b32 v116, a114
    v_accvgpr_read_b32 v117, a115
    v_mul_f32 v116, v116, v248
    v_mul_f32 v117, v117, v248
    v_cvt_pk_bf16_f32 v25, v116, v117
    v_accvgpr_read_b32 v116, a116
    v_accvgpr_read_b32 v117, a117
    v_mul_f32 v116, v116, v248
    v_mul_f32 v117, v117, v248
    v_cvt_pk_bf16_f32 v26, v116, v117
    v_accvgpr_read_b32 v116, a118
    v_accvgpr_read_b32 v117, a119
    v_mul_f32 v116, v116, v248
    v_mul_f32 v117, v117, v248
    v_cvt_pk_bf16_f32 v27, v116, v117
    v_permlane32_swap_b32 v24, v26
    s_nop 0
    v_permlane32_swap_b32 v25, v27
    ds_write_b128 v102, v[24:27]
    v_accvgpr_read_b32 v116, a120
    v_accvgpr_read_b32 v117, a121
    v_mul_f32 v116, v116, v248
    v_mul_f32 v117, v117, v248
    v_cvt_pk_bf16_f32 v28, v116, v117
    v_accvgpr_read_b32 v116, a122
    v_accvgpr_read_b32 v117, a123
    v_mul_f32 v116, v116, v248
    v_mul_f32 v117, v117, v248
    v_cvt_pk_bf16_f32 v29, v116, v117
    v_accvgpr_read_b32 v116, a124
    v_accvgpr_read_b32 v117, a125
    v_mul_f32 v116, v116, v248
    v_mul_f32 v117, v117, v248
    v_cvt_pk_bf16_f32 v30, v116, v117
    v_accvgpr_read_b32 v116, a126
    v_accvgpr_read_b32 v117, a127
    v_mul_f32 v116, v116, v248
    v_mul_f32 v117, v117, v248
    v_cvt_pk_bf16_f32 v31, v116, v117
    v_permlane32_swap_b32 v28, v30
    s_nop 0
    v_permlane32_swap_b32 v29, v31
    ds_write_b128 v103, v[28:31]
    s_waitcnt lgkmcnt(0)
    ds_read_b128 v[64:67], v104 offset:0
    ds_read_b128 v[68:71], v105 offset:1024
    ds_read_b128 v[72:75], v106 offset:2048
    ds_read_b128 v[76:79], v107 offset:3072
    ds_read_b128 v[80:83], v104 offset:4096
    ds_read_b128 v[84:87], v105 offset:5120
    ds_read_b128 v[88:91], v106 offset:6144
    ds_read_b128 v[92:95], v107 offset:7168
    s_mov_b32 s40, 262144
    s_waitcnt lgkmcnt(7)
    buffer_store_dwordx4 v[64:67], v255, s[24:27], s40 offen
    s_mov_b32 s40, 294912
    s_waitcnt lgkmcnt(6)
    buffer_store_dwordx4 v[68:71], v255, s[24:27], s40 offen
    s_mov_b32 s40, 327680
    s_waitcnt lgkmcnt(5)
    buffer_store_dwordx4 v[72:75], v255, s[24:27], s40 offen
    s_mov_b32 s40, 360448
    s_waitcnt lgkmcnt(4)
    buffer_store_dwordx4 v[76:79], v255, s[24:27], s40 offen
    s_mov_b32 s40, 393216
    s_waitcnt lgkmcnt(3)
    buffer_store_dwordx4 v[80:83], v255, s[24:27], s40 offen
    s_mov_b32 s40, 425984
    s_waitcnt lgkmcnt(2)
    buffer_store_dwordx4 v[84:87], v255, s[24:27], s40 offen
    s_mov_b32 s40, 458752
    s_waitcnt lgkmcnt(1)
    buffer_store_dwordx4 v[88:91], v255, s[24:27], s40 offen
    s_mov_b32 s40, 491520
    s_waitcnt lgkmcnt(0)
    buffer_store_dwordx4 v[92:95], v255, s[24:27], s40 offen
attn_kernel_end:
    s_endpgm
attn_kernel_stub1:
    s_call_b64 s[60:61], attn_kernel_slow0
    s_branch attn_kernel_back1
attn_kernel_stub2:
    s_call_b64 s[60:61], attn_kernel_slow1
    s_branch attn_kernel_back2
attn_kernel_stub3:
    s_call_b64 s[60:61], attn_kernel_slow0
    s_branch attn_kernel_back3
attn_kernel_stub4:
    s_call_b64 s[60:61], attn_kernel_slow1
    s_branch attn_kernel_back4
attn_kernel_stub5:
    s_call_b64 s[60:61], attn_kernel_slow0
    s_branch attn_kernel_back5
attn_kernel_stub6:
    s_call_b64 s[60:61], attn_kernel_slow1
    s_branch attn_kernel_back6
attn_kernel_stub7:
    s_call_b64 s[60:61], attn_kernel_slow0
    s_branch attn_kernel_back7
attn_kernel_stub8:
    s_call_b64 s[60:61], attn_kernel_slow1
    s_branch attn_kernel_back8
attn_kernel_stub9:
    s_call_b64 s[60:61], attn_kernel_slow0
    s_branch attn_kernel_back9
attn_kernel_stub10:
    s_call_b64 s[60:61], attn_kernel_slow1
    s_branch attn_kernel_back10
attn_kernel_stub11:
    s_call_b64 s[60:61], attn_kernel_slow0
    s_branch attn_kernel_back11
attn_kernel_stub12:
    s_call_b64 s[60:61], attn_kernel_slow1
    s_branch attn_kernel_back12
attn_kernel_stub13:
    s_call_b64 s[60:61], attn_kernel_slow0
    s_branch attn_kernel_back13
attn_kernel_stub14:
    s_call_b64 s[60:61], attn_kernel_slow1
    s_branch attn_kernel_back14
attn_kernel_stub15:
    s_call_b64 s[60:61], attn_kernel_slow0
    s_branch attn_kernel_back15
attn_kernel_stub16:
    s_call_b64 s[60:61], attn_kernel_slow1
    s_branch attn_kernel_back16
attn_kernel_stub17:
    s_call_b64 s[60:61], attn_kernel_slow0
    s_branch attn_kernel_back17
attn_kernel_stub18:
    s_call_b64 s[60:61], attn_kernel_slow1
    s_branch attn_kernel_back18
attn_kernel_stub19:
    s_call_b64 s[60:61], attn_kernel_slow0
    s_branch attn_kernel_back19
attn_kernel_stub20:
    s_call_b64 s[60:61], attn_kernel_slow1
    s_branch attn_kernel_back20
attn_kernel_stub21:
    s_call_b64 s[60:61], attn_kernel_slow0
    s_branch attn_kernel_back21
attn_kernel_stub22:
    s_call_b64 s[60:61], attn_kernel_slow1
    s_branch attn_kernel_back22
attn_kernel_stub23:
    s_call_b64 s[60:61], attn_kernel_slow0
    s_branch attn_kernel_back23
attn_kernel_stub24:
    s_call_b64 s[60:61], attn_kernel_slow1
    s_branch attn_kernel_back24
attn_kernel_stub25:
    s_call_b64 s[60:61], attn_kernel_slow0
    s_branch attn_kernel_back25
attn_kernel_stub26:
    s_call_b64 s[60:61], attn_kernel_slow1
    s_branch attn_kernel_back26
attn_kernel_stub27:
    s_call_b64 s[60:61], attn_kernel_slow0
    s_branch attn_kernel_back27
attn_kernel_stub28:
    s_call_b64 s[60:61], attn_kernel_slow1
    s_branch attn_kernel_back28
attn_kernel_stub29:
    s_call_b64 s[60:61], attn_kernel_slow0
    s_branch attn_kernel_back29
attn_kernel_stub30:
    s_call_b64 s[60:61], attn_kernel_slow1
    s_branch attn_kernel_back30
attn_kernel_stub31:
    s_call_b64 s[60:61], attn_kernel_slow0
    s_branch attn_kernel_back31
attn_kernel_stub32:
    s_call_b64 s[60:61], attn_kernel_slow1
    s_branch attn_kernel_back32
attn_kernel_slow0:
    s_nop 15
    s_nop 3
    v_max_f32 v112, v16, v17
    v_max3_f32 v112, v112, v18, v19
    v_max3_f32 v112, v112, v20, v21
    v_max3_f32 v112, v112, v22, v23
    v_max3_f32 v112, v112, v24, v25
    v_max3_f32 v112, v112, v26, v27
    v_max3_f32 v112, v112, v28, v29
    v_max3_f32 v112, v112, v30, v31
    v_mov_b32 v113, v112
    s_nop 1
    v_permlane32_swap_b32 v112, v113
    v_max_f32 v112, v112, v113
    v_max_f32 v112, v112, v251
    v_max_f32 v113, 0, v112
    v_exp_f32 v113, -v113
    v_mov_b32 v251, 0
    v_sub_f32 v48, v48, v112
    v_sub_f32 v49, v49, v112
    v_sub_f32 v50, v50, v112
    v_sub_f32 v51, v51, v112
    v_sub_f32 v52, v52, v112
    v_sub_f32 v53, v53, v112
    v_sub_f32 v54, v54, v112
    v_sub_f32 v55, v55, v112
    v_sub_f32 v56, v56, v112
    v_sub_f32 v57, v57, v112
    v_sub_f32 v58, v58, v112
    v_sub_f32 v59, v59, v112
    v_sub_f32 v60, v60, v112
    v_sub_f32 v61, v61, v112
    v_sub_f32 v62, v62, v112
    v_sub_f32 v63, v63, v112
    s_cmp_lt_i32 s50, 0
    s_mov_b32 s50, 0x4f800000
    s_cbranch_scc1 attn_kernel_slowskip0
    v_mul_f32 v247, v247, v113
    v_accvgpr_read_b32 v114, a0
    v_mul_f32 v114, v114, v113
    v_accvgpr_write_b32 a0, v114
    v_accvgpr_read_b32 v114, a1
    v_mul_f32 v114, v114, v113
    v_accvgpr_write_b32 a1, v114
    v_accvgpr_read_b32 v114, a2
    v_mul_f32 v114, v114, v113
    v_accvgpr_write_b32 a2, v114
    v_accvgpr_read_b32 v114, a3
    v_mul_f32 v114, v114, v113
    v_accvgpr_write_b32 a3, v114
    v_accvgpr_read_b32 v114, a4
    v_mul_f32 v114, v114, v113
    v_accvgpr_write_b32 a4, v114
    v_accvgpr_read_b32 v114, a5
    v_mul_f32 v114, v114, v113
    v_accvgpr_write_b32 a5, v114
    v_accvgpr_read_b32 v114, a6
    v_mul_f32 v114, v114, v113
    v_accvgpr_write_b32 a6, v114
    v_accvgpr_read_b32 v114, a7
    v_mul_f32 v114, v114, v113
    v_accvgpr_write_b32 a7, v114
    v_accvgpr_read_b32 v114, a8
    v_mul_f32 v114, v114, v113
    v_accvgpr_write_b32 a8, v114
    v_accvgpr_read_b32 v114, a9
    v_mul_f32 v114, v114, v113
    v_accvgpr_write_b32 a9, v114
    v_accvgpr_read_b32 v114, a10
    v_mul_f32 v114, v114, v113
    v_accvgpr_write_b32 a10, v114
    v_accvgpr_read_b32 v114, a11
    v_mul_f32 v114, v114, v113
    v_accvgpr_write_b32 a11, v114
    v_accvgpr_read_b32 v114, a12
    v_mul_f32 v114, v114, v113
    v_accvgpr_write_b32 a12, v114
    v_accvgpr_read_b32 v114, a13
    v_mul_f32 v114, v114, v113
    v_accvgpr_write_b32 a13, v114
    v_accvgpr_read_b32 v114, a14
    v_mul_f32 v114, v114, v113
    v_accvgpr_write_b32 a14, v114
    v_accvgpr_read_b32 v114, a15
    v_mul_f32 v114, v114, v113
    v_accvgpr_write_b32 a15, v114
    v_accvgpr_read_b32 v114, a16
    v_mul_f32 v114, v114, v113
    v_accvgpr_write_b32 a16, v114
    v_accvgpr_read_b32 v114, a17
    v_mul_f32 v114, v114, v113
    v_accvgpr_write_b32 a17, v114
    v_accvgpr_read_b32 v114, a18
    v_mul_f32 v114, v114, v113
    v_accvgpr_write_b32 a18, v114
    v_accvgpr_read_b32 v114, a19
    v_mul_f32 v114, v114, v113
    v_accvgpr_write_b32 a19, v114
    v_accvgpr_read_b32 v114, a20
    v_mul_f32 v114, v114, v113
    v_accvgpr_write_b32 a20, v114
    v_accvgpr_read_b32 v114, a21
    v_mul_f32 v114, v114, v113
    v_accvgpr_write_b32 a21, v114
    v_accvgpr_read_b32 v114, a22
    v_mul_f32 v114, v114, v113
    v_accvgpr_write_b32 a22, v114
    v_accvgpr_read_b32 v114, a23
    v_mul_f32 v114, v114, v113
    v_accvgpr_write_b32 a23, v114
    v_accvgpr_read_b32 v114, a24
    v_mul_f32 v114, v114, v113
    v_accvgpr_write_b32 a24, v114
    v_accvgpr_read_b32 v114, a25
    v_mul_f32 v114, v114, v113
    v_accvgpr_write_b32 a25, v114
    v_accvgpr_read_b32 v114, a26
    v_mul_f32 v114, v114, v113
    v_accvgpr_write_b32 a26, v114
    v_accvgpr_read_b32 v114, a27
    v_mul_f32 v114, v114, v113
    v_accvgpr_write_b32 a27, v114
    v_accvgpr_read_b32 v114, a28
    v_mul_f32 v114, v114, v113
    v_accvgpr_write_b32 a28, v114
    v_accvgpr_read_b32 v114, a29
    v_mul_f32 v114, v114, v113
    v_accvgpr_write_b32 a29, v114
    v_accvgpr_read_b32 v114, a30
    v_mul_f32 v114, v114, v113
    v_accvgpr_write_b32 a30, v114
    v_accvgpr_read_b32 v114, a31
    v_mul_f32 v114, v114, v113
    v_accvgpr_write_b32 a31, v114
    v_accvgpr_read_b32 v114, a32
    v_mul_f32 v114, v114, v113
    v_accvgpr_write_b32 a32, v114
    v_accvgpr_read_b32 v114, a33
    v_mul_f32 v114, v114, v113
    v_accvgpr_write_b32 a33, v114
    v_accvgpr_read_b32 v114, a34
    v_mul_f32 v114, v114, v113
    v_accvgpr_write_b32 a34, v114
    v_accvgpr_read_b32 v114, a35
    v_mul_f32 v114, v114, v113
    v_accvgpr_write_b32 a35, v114
    v_accvgpr_read_b32 v114, a36
    v_mul_f32 v114, v114, v113
    v_accvgpr_write_b32 a36, v114
    v_accvgpr_read_b32 v114, a37
    v_mul_f32 v114, v114, v113
    v_accvgpr_write_b32 a37, v114
    v_accvgpr_read_b32 v114, a38
    v_mul_f32 v114, v114, v113
    v_accvgpr_write_b32 a38, v114
    v_accvgpr_read_b32 v114, a39
    v_mul_f32 v114, v114, v113
    v_accvgpr_write_b32 a39, v114
    v_accvgpr_read_b32 v114, a40
    v_mul_f32 v114, v114, v113
    v_accvgpr_write_b32 a40, v114
    v_accvgpr_read_b32 v114, a41
    v_mul_f32 v114, v114, v113
    v_accvgpr_write_b32 a41, v114
    v_accvgpr_read_b32 v114, a42
    v_mul_f32 v114, v114, v113
    v_accvgpr_write_b32 a42, v114
    v_accvgpr_read_b32 v114, a43
    v_mul_f32 v114, v114, v113
    v_accvgpr_write_b32 a43, v114
    v_accvgpr_read_b32 v114, a44
    v_mul_f32 v114, v114, v113
    v_accvgpr_write_b32 a44, v114
    v_accvgpr_read_b32 v114, a45
    v_mul_f32 v114, v114, v113
    v_accvgpr_write_b32 a45, v114
    v_accvgpr_read_b32 v114, a46
    v_mul_f32 v114, v114, v113
    v_accvgpr_write_b32 a46, v114
    v_accvgpr_read_b32 v114, a47
    v_mul_f32 v114, v114, v113
    v_accvgpr_write_b32 a47, v114
    v_accvgpr_read_b32 v114, a48
    v_mul_f32 v114, v114, v113
    v_accvgpr_write_b32 a48, v114
    v_accvgpr_read_b32 v114, a49
    v_mul_f32 v114, v114, v113
    v_accvgpr_write_b32 a49, v114
    v_accvgpr_read_b32 v114, a50
    v_mul_f32 v114, v114, v113
    v_accvgpr_write_b32 a50, v114
    v_accvgpr_read_b32 v114, a51
    v_mul_f32 v114, v114, v113
    v_accvgpr_write_b32 a51, v114
    v_accvgpr_read_b32 v114, a52
    v_mul_f32 v114, v114, v113
    v_accvgpr_write_b32 a52, v114
    v_accvgpr_read_b32 v114, a53
    v_mul_f32 v114, v114, v113
    v_accvgpr_write_b32 a53, v114
    v_accvgpr_read_b32 v114, a54
    v_mul_f32 v114, v114, v113
    v_accvgpr_write_b32 a54, v114
    v_accvgpr_read_b32 v114, a55
    v_mul_f32 v114, v114, v113
    v_accvgpr_write_b32 a55, v114
    v_accvgpr_read_b32 v114, a56
    v_mul_f32 v114, v114, v113
    v_accvgpr_write_b32 a56, v114
    v_accvgpr_read_b32 v114, a57
    v_mul_f32 v114, v114, v113
    v_accvgpr_write_b32 a57, v114
    v_accvgpr_read_b32 v114, a58
    v_mul_f32 v114, v114, v113
    v_accvgpr_write_b32 a58, v114
    v_accvgpr_read_b32 v114, a59
    v_mul_f32 v114, v114, v113
    v_accvgpr_write_b32 a59, v114
    v_accvgpr_read_b32 v114, a60
    v_mul_f32 v114, v114, v113
    v_accvgpr_write_b32 a60, v114
    v_accvgpr_read_b32 v114, a61
    v_mul_f32 v114, v114, v113
    v_accvgpr_write_b32 a61, v114
    v_accvgpr_read_b32 v114, a62
    v_mul_f32 v114, v114, v113
    v_accvgpr_write_b32 a62, v114
    v_accvgpr_read_b32 v114, a63
    v_mul_f32 v114, v114, v113
    v_accvgpr_write_b32 a63, v114
attn_kernel_slowskip0:
    v_sub_f32 v96, v16, v112
    v_exp_f32 v96, v96
    v_sub_f32 v97, v17, v112
    v_exp_f32 v97, v97
    v_sub_f32 v98, v18, v112
    v_exp_f32 v98, v98
    v_sub_f32 v99, v19, v112
    v_exp_f32 v99, v99
    v_sub_f32 v100, v20, v112
    v_exp_f32 v100, v100
    v_sub_f32 v101, v21, v112
    v_exp_f32 v101, v101
    v_sub_f32 v102, v22, v112
    v_exp_f32 v102, v102
    v_sub_f32 v103, v23, v112
    v_exp_f32 v103, v103
    v_sub_f32 v104, v24, v112
    v_exp_f32 v104, v104
    v_sub_f32 v105, v25, v112
    v_exp_f32 v105, v105
    v_sub_f32 v106, v26, v112
    v_exp_f32 v106, v106
    v_sub_f32 v107, v27, v112
    v_exp_f32 v107, v107
    v_sub_f32 v108, v28, v112
    v_exp_f32 v108, v108
    v_sub_f32 v109, v29, v112
    v_exp_f32 v109, v109
    v_sub_f32 v110, v30, v112
    v_exp_f32 v110, v110
    v_sub_f32 v111, v31, v112
    v_exp_f32 v111, v111
    v_add_f32 v249, v96, v97
    v_add_f32 v249, v249, v98
    v_add_f32 v249, v249, v99
    v_add_f32 v249, v249, v100
    v_add_f32 v249, v249, v101
    v_add_f32 v249, v249, v102
    v_add_f32 v249, v249, v103
    v_add_f32 v249, v249, v104
    v_add_f32 v249, v249, v105
    v_add_f32 v249, v249, v106
    v_add_f32 v249, v249, v107
    v_add_f32 v249, v249, v108
    v_add_f32 v249, v249, v109
    v_add_f32 v249, v249, v110
    v_add_f32 v249, v249, v111
    v_cvt_pk_bf16_f32 v80, v96, v97
    v_cvt_pk_bf16_f32 v81, v98, v99
    v_cvt_pk_bf16_f32 v82, v100, v101
    v_cvt_pk_bf16_f32 v83, v102, v103
    v_cvt_pk_bf16_f32 v84, v104, v105
    v_cvt_pk_bf16_f32 v85, v106, v107
    v_cvt_pk_bf16_f32 v86, v108, v109
    v_cvt_pk_bf16_f32 v87, v110, v111
    s_nop 3
    s_setpc_b64 s[60:61]
attn_kernel_slow1:
    s_nop 15
    s_nop 3
    v_max_f32 v112, v32, v33
    v_max3_f32 v112, v112, v34, v35
    v_max3_f32 v112, v112, v36, v37
    v_max3_f32 v112, v112, v38, v39
    v_max3_f32 v112, v112, v40, v41
    v_max3_f32 v112, v112, v42, v43
    v_max3_f32 v112, v112, v44, v45
    v_max3_f32 v112, v112, v46, v47
    v_mov_b32 v113, v112
    s_nop 1
    v_permlane32_swap_b32 v112, v113
    v_max_f32 v112, v112, v113
    v_max_f32 v112, v112, v252
    v_max_f32 v113, 0, v112
    v_exp_f32 v113, -v113
    v_mov_b32 v252, 0
    v_sub_f32 v64, v64, v112
    v_sub_f32 v65, v65, v112
    v_sub_f32 v66, v66, v112
    v_sub_f32 v67, v67, v112
    v_sub_f32 v68, v68, v112
    v_sub_f32 v69, v69, v112
    v_sub_f32 v70, v70, v112
    v_sub_f32 v71, v71, v112
    v_sub_f32 v72, v72, v112
    v_sub_f32 v73, v73, v112
    v_sub_f32 v74, v74, v112
    v_sub_f32 v75, v75, v112
    v_sub_f32 v76, v76, v112
    v_sub_f32 v77, v77, v112
    v_sub_f32 v78, v78, v112
    v_sub_f32 v79, v79, v112
    s_cmp_lt_i32 s51, 0
    s_mov_b32 s51, 0x4f800000
    s_cbranch_scc1 attn_kernel_slowskip1
    v_mul_f32 v248, v248, v113
    v_accvgpr_read_b32 v114, a64
    v_mul_f32 v114, v114, v113
    v_accvgpr_write_b32 a64, v114
    v_accvgpr_read_b32 v114, a65
    v_mul_f32 v114, v114, v113
    v_accvgpr_write_b32 a65, v114
    v_accvgpr_read_b32 v114, a66
    v_mul_f32 v114, v114, v113
    v_accvgpr_write_b32 a66, v114
    v_accvgpr_read_b32 v114, a67
    v_mul_f32 v114, v114, v113
    v_accvgpr_write_b32 a67, v114
    v_accvgpr_read_b32 v114, a68
    v_mul_f32 v114, v114, v113
    v_accvgpr_write_b32 a68, v114
    v_accvgpr_read_b32 v114, a69
    v_mul_f32 v114, v114, v113
    v_accvgpr_write_b32 a69, v114
    v_accvgpr_read_b32 v114, a70
    v_mul_f32 v114, v114, v113
    v_accvgpr_write_b32 a70, v114
    v_accvgpr_read_b32 v114, a71
    v_mul_f32 v114, v114, v113
    v_accvgpr_write_b32 a71, v114
    v_accvgpr_read_b32 v114, a72
    v_mul_f32 v114, v114, v113
    v_accvgpr_write_b32 a72, v114
    v_accvgpr_read_b32 v114, a73
    v_mul_f32 v114, v114, v113
    v_accvgpr_write_b32 a73, v114
    v_accvgpr_read_b32 v114, a74
    v_mul_f32 v114, v114, v113
    v_accvgpr_write_b32 a74, v114
    v_accvgpr_read_b32 v114, a75
    v_mul_f32 v114, v114, v113
    v_accvgpr_write_b32 a75, v114
    v_accvgpr_read_b32 v114, a76
    v_mul_f32 v114, v114, v113
    v_accvgpr_write_b32 a76, v114
    v_accvgpr_read_b32 v114, a77
    v_mul_f32 v114, v114, v113
    v_accvgpr_write_b32 a77, v114
    v_accvgpr_read_b32 v114, a78
    v_mul_f32 v114, v114, v113
    v_accvgpr_write_b32 a78, v114
    v_accvgpr_read_b32 v114, a79
    v_mul_f32 v114, v114, v113
    v_accvgpr_write_b32 a79, v114
    v_accvgpr_read_b32 v114, a80
    v_mul_f32 v114, v114, v113
    v_accvgpr_write_b32 a80, v114
    v_accvgpr_read_b32 v114, a81
    v_mul_f32 v114, v114, v113
    v_accvgpr_write_b32 a81, v114
    v_accvgpr_read_b32 v114, a82
    v_mul_f32 v114, v114, v113
    v_accvgpr_write_b32 a82, v114
    v_accvgpr_read_b32 v114, a83
    v_mul_f32 v114, v114, v113
    v_accvgpr_write_b32 a83, v114
    v_accvgpr_read_b32 v114, a84
    v_mul_f32 v114, v114, v113
    v_accvgpr_write_b32 a84, v114
    v_accvgpr_read_b32 v114, a85
    v_mul_f32 v114, v114, v113
    v_accvgpr_write_b32 a85, v114
    v_accvgpr_read_b32 v114, a86
    v_mul_f32 v114, v114, v113
    v_accvgpr_write_b32 a86, v114
    v_accvgpr_read_b32 v114, a87
    v_mul_f32 v114, v114, v113
    v_accvgpr_write_b32 a87, v114
    v_accvgpr_read_b32 v114, a88
    v_mul_f32 v114, v114, v113
    v_accvgpr_write_b32 a88, v114
    v_accvgpr_read_b32 v114, a89
    v_mul_f32 v114, v114, v113
    v_accvgpr_write_b32 a89, v114
    v_accvgpr_read_b32 v114, a90
    v_mul_f32 v114, v114, v113
    v_accvgpr_write_b32 a90, v114
    v_accvgpr_read_b32 v114, a91
    v_mul_f32 v114, v114, v113
    v_accvgpr_write_b32 a91, v114
    v_accvgpr_read_b32 v114, a92
    v_mul_f32 v114, v114, v113
    v_accvgpr_write_b32 a92, v114
    v_accvgpr_read_b32 v114, a93
    v_mul_f32 v114, v114, v113
    v_accvgpr_write_b32 a93, v114
    v_accvgpr_read_b32 v114, a94
    v_mul_f32 v114, v114, v113
    v_accvgpr_write_b32 a94, v114
    v_accvgpr_read_b32 v114, a95
    v_mul_f32 v114, v114, v113
    v_accvgpr_write_b32 a95, v114
    v_accvgpr_read_b32 v114, a96
    v_mul_f32 v114, v114, v113
    v_accvgpr_write_b32 a96, v114
    v_accvgpr_read_b32 v114, a97
    v_mul_f32 v114, v114, v113
    v_accvgpr_write_b32 a97, v114
    v_accvgpr_read_b32 v114, a98
    v_mul_f32 v114, v114, v113
    v_accvgpr_write_b32 a98, v114
    v_accvgpr_read_b32 v114, a99
    v_mul_f32 v114, v114, v113
    v_accvgpr_write_b32 a99, v114
    v_accvgpr_read_b32 v114, a100
    v_mul_f32 v114, v114, v113
    v_accvgpr_write_b32 a100, v114
    v_accvgpr_read_b32 v114, a101
    v_mul_f32 v114, v114, v113
    v_accvgpr_write_b32 a101, v114
    v_accvgpr_read_b32 v114, a102
    v_mul_f32 v114, v114, v113
    v_accvgpr_write_b32 a102, v114
    v_accvgpr_read_b32 v114, a103
    v_mul_f32 v114, v114, v113
    v_accvgpr_write_b32 a103, v114
    v_accvgpr_read_b32 v114, a104
    v_mul_f32 v114, v114, v113
    v_accvgpr_write_b32 a104, v114
    v_accvgpr_read_b32 v114, a105
    v_mul_f32 v114, v114, v113
    v_accvgpr_write_b32 a105, v114
    v_accvgpr_read_b32 v114, a106
    v_mul_f32 v114, v114, v113
    v_accvgpr_write_b32 a106, v114
    v_accvgpr_read_b32 v114, a107
    v_mul_f32 v114, v114, v113
    v_accvgpr_write_b32 a107, v114
    v_accvgpr_read_b32 v114, a108
    v_mul_f32 v114, v114, v113
    v_accvgpr_write_b32 a108, v114
    v_accvgpr_read_b32 v114, a109
    v_mul_f32 v114, v114, v113
    v_accvgpr_write_b32 a109, v114
    v_accvgpr_read_b32 v114, a110
    v_mul_f32 v114, v114, v113
    v_accvgpr_write_b32 a110, v114
    v_accvgpr_read_b32 v114, a111
    v_mul_f32 v114, v114, v113
    v_accvgpr_write_b32 a111, v114
    v_accvgpr_read_b32 v114, a112
    v_mul_f32 v114, v114, v113
    v_accvgpr_write_b32 a112, v114
    v_accvgpr_read_b32 v114, a113
    v_mul_f32 v114, v114, v113
    v_accvgpr_write_b32 a113, v114
    v_accvgpr_read_b32 v114, a114
    v_mul_f32 v114, v114, v113
    v_accvgpr_write_b32 a114, v114
    v_accvgpr_read_b32 v114, a115
    v_mul_f32 v114, v114, v113
    v_accvgpr_write_b32 a115, v114
    v_accvgpr_read_b32 v114, a116
    v_mul_f32 v114, v114, v113
    v_accvgpr_write_b32 a116, v114
    v_accvgpr_read_b32 v114, a117
    v_mul_f32 v114, v114, v113
    v_accvgpr_write_b32 a117, v114
    v_accvgpr_read_b32 v114, a118
    v_mul_f32 v114, v114, v113
    v_accvgpr_write_b32 a118, v114
    v_accvgpr_read_b32 v114, a119
    v_mul_f32 v114, v114, v113
    v_accvgpr_write_b32 a119, v114
    v_accvgpr_read_b32 v114, a120
    v_mul_f32 v114, v114, v113
    v_accvgpr_write_b32 a120, v114
    v_accvgpr_read_b32 v114, a121
    v_mul_f32 v114, v114, v113
    v_accvgpr_write_b32 a121, v114
    v_accvgpr_read_b32 v114, a122
    v_mul_f32 v114, v114, v113
    v_accvgpr_write_b32 a122, v114
    v_accvgpr_read_b32 v114, a123
    v_mul_f32 v114, v114, v113
    v_accvgpr_write_b32 a123, v114
    v_accvgpr_read_b32 v114, a124
    v_mul_f32 v114, v114, v113
    v_accvgpr_write_b32 a124, v114
    v_accvgpr_read_b32 v114, a125
    v_mul_f32 v114, v114, v113
    v_accvgpr_write_b32 a125, v114
    v_accvgpr_read_b32 v114, a126
    v_mul_f32 v114, v114, v113
    v_accvgpr_write_b32 a126, v114
    v_accvgpr_read_b32 v114, a127
    v_mul_f32 v114, v114, v113
    v_accvgpr_write_b32 a127, v114
attn_kernel_slowskip1:
    v_sub_f32 v96, v32, v112
    v_exp_f32 v96, v96
    v_sub_f32 v97, v33, v112
    v_exp_f32 v97, v97
    v_sub_f32 v98, v34, v112
    v_exp_f32 v98, v98
    v_sub_f32 v99, v35, v112
    v_exp_f32 v99, v99
    v_sub_f32 v100, v36, v112
    v_exp_f32 v100, v100
    v_sub_f32 v101, v37, v112
    v_exp_f32 v101, v101
    v_sub_f32 v102, v38, v112
    v_exp_f32 v102, v102
    v_sub_f32 v103, v39, v112
    v_exp_f32 v103, v103
    v_sub_f32 v104, v40, v112
    v_exp_f32 v104, v104
    v_sub_f32 v105, v41, v112
    v_exp_f32 v105, v105
    v_sub_f32 v106, v42, v112
    v_exp_f32 v106, v106
    v_sub_f32 v107, v43, v112
    v_exp_f32 v107, v107
    v_sub_f32 v108, v44, v112
    v_exp_f32 v108, v108
    v_sub_f32 v109, v45, v112
    v_exp_f32 v109, v109
    v_sub_f32 v110, v46, v112
    v_exp_f32 v110, v110
    v_sub_f32 v111, v47, v112
    v_exp_f32 v111, v111
    v_add_f32 v250, v96, v97
    v_add_f32 v250, v250, v98
    v_add_f32 v250, v250, v99
    v_add_f32 v250, v250, v100
    v_add_f32 v250, v250, v101
    v_add_f32 v250, v250, v102
    v_add_f32 v250, v250, v103
    v_add_f32 v250, v250, v104
    v_add_f32 v250, v250, v105
    v_add_f32 v250, v250, v106
    v_add_f32 v250, v250, v107
    v_add_f32 v250, v250, v108
    v_add_f32 v250, v250, v109
    v_add_f32 v250, v250, v110
    v_add_f32 v250, v250, v111
    v_cvt_pk_bf16_f32 v88, v96, v97
    v_cvt_pk_bf16_f32 v89, v98, v99
    v_cvt_pk_bf16_f32 v90, v100, v101
    v_cvt_pk_bf16_f32 v91, v102, v103
    v_cvt_pk_bf16_f32 v92, v104, v105
    v_cvt_pk_bf16_f32 v93, v106, v107
    v_cvt_pk_bf16_f32 v94, v108, v109
    v_cvt_pk_bf16_f32 v95, v110, v111
    s_nop 3
    s_setpc_b64 s[60:61]
.globl oproj_kernel
.p2align 8
.type oproj_kernel,@function
oproj_kernel:

    s_cmp_ge_u32 s2, 256
    s_cbranch_scc1 oproj_kernel_end
    s_and_b32 s38, s2, 7
    s_lshr_b32 s40, s2, 3
    s_cmp_lt_u32 s38, 4
    s_cbranch_scc1 oproj_kernel_ta
    s_sub_u32 s38, s38, 4
    s_cmp_lt_u32 s40, 26
    s_cbranch_scc1 oproj_kernel_tb
    s_cmp_lg_u32 s40, 26
    s_cbranch_scc1 oproj_kernel_end
    s_cmp_ge_u32 s38, 2
    s_cbranch_scc1 oproj_kernel_end
    s_add_u32 s40, s38, 128
    s_branch oproj_kernel_tc
oproj_kernel_tb:
    s_mul_i32 s38, s38, 26
    s_add_u32 s40, s40, s38
    s_add_u32 s40, s40, 130
    s_branch oproj_kernel_tc
oproj_kernel_ta:
    s_lshl_b32 s38, s38, 5
    s_add_u32 s40, s40, s38
oproj_kernel_tc:
    s_load_dwordx2 s[6:7], s[0:1], 32
    s_load_dwordx2 s[10:11], s[0:1], 104
    s_load_dwordx2 s[4:5], s[0:1], 0
    v_lshrrev_b32 v236, 6, v0
    v_and_b32 v237, 63, v0
    v_readfirstlane_b32 s36, v236
    s_mul_i32 s38, s40, 13108
    s_lshr_b32 s38, s38, 16
    s_mul_i32 s37, s38, 5
    s_sub_u32 s37, s40, s37
    s_sub_u32 s41, s40, 130
    s_lshr_b32 s42, s41, 2
    s_and_b32 s41, s41, 3
    s_add_u32 s41, s41, 5
    s_cmp_ge_u32 s40, 130
    s_cselect_b32 s38, s42, s38
    s_cselect_b32 s37, s41, s37
    v_lshrrev_b32 v238, 4, v237
    v_and_b32 v239, 15, v237
    s_mul_i32 s41, s36, 20
    s_movk_i32 s40, 8192
    v_add_u32 v240, 0, v238
    v_add_u32 v240, s41, v240
    v_and_b32 v241, 15, v240
    v_xor_b32 v241, v241, v239
    v_mul_lo_u32 v240, v240, s40
    v_lshl_add_u32 v240, v241, 4, v240
    v_add_u32 v1, 4096, v240
    v_add_u32 v240, 4, v238
    v_add_u32 v240, s41, v240
    v_and_b32 v241, 15, v240
    v_xor_b32 v241, v241, v239
    v_mul_lo_u32 v240, v240, s40
    v_lshl_add_u32 v240, v241, 4, v240
    v_add_u32 v2, 3072, v240
    v_add_u32 v240, 8, v238
    v_add_u32 v240, s41, v240
    v_and_b32 v241, 15, v240
    v_xor_b32 v241, v241, v239
    v_mul_lo_u32 v240, v240, s40
    v_lshl_add_u32 v240, v241, 4, v240
    v_add_u32 v3, 2048, v240
    v_add_u32 v240, 12, v238
    v_add_u32 v240, s41, v240
    v_and_b32 v241, 15, v240
    v_xor_b32 v241, v241, v239
    v_mul_lo_u32 v240, v240, s40
    v_lshl_add_u32 v240, v241, 4, v240
    v_add_u32 v4, 1024, v240
    v_add_u32 v240, 16, v238
    v_add_u32 v240, s41, v240
    v_and_b32 v241, 15, v240
    v_xor_b32 v241, v241, v239
    v_mul_lo_u32 v240, v240, s40
    v_lshl_add_u32 v240, v241, 4, v240
    v_add_u32 v5, 4096, v240
    v_lshrrev_b32 v240, 3, v237
    s_lshl_b32 s41, s36, 5
    v_add_u32 v240, s41, v240
    v_mul_u32_u24 v240, 1152, v240
    s_lshl_b32 s41, s37, 7
    v_add_u32 v240, s41, v240
    v_and_b32 v241, 7, v237
    v_and_b32 v242, 1, v238
    v_lshlrev_b32 v242, 1, v242
    v_xor_b32 v241, v241, v242
    v_lshl_add_u32 v6, v241, 4, v240
    v_xor_b32 v241, 4, v241
    v_lshl_add_u32 v7, v241, 4, v240
    s_mov_b32 s24, 0
    s_mov_b32 s25, 8192
    s_mov_b32 s26, 16384
    s_mov_b32 s27, 24576
    s_waitcnt lgkmcnt(0)
    s_mul_i32 s40, s38, 655360
    s_add_u32 s41, s40, 0x12ff000
    s_add_u32 s12, s10, s41
    s_addc_u32 s13, s11, 0
    s_sub_u32 s14, 16777216, s40
    s_min_u32 s14, s14, 655360
    s_add_u32 s14, s14, 4096
    s_mov_b32 s15, 0x00020000
    s_mov_b32 s16, s6
    s_mov_b32 s17, s7
    s_mov_b32 s18, 0x480000
    s_mov_b32 s19, 0x00020000
    s_mul_i32 s44, s36, 5120
    s_lshl_b32 s45, s36, 12
    s_add_u32 s45, s45, 20480
    s_add_u32 m0, s44, 0
    s_nop 0
    buffer_load_dwordx4 v1, s[12:15], 0 offen offset:0 lds
    buffer_load_dwordx4 v2, s[12:15], 0 offen offset:1024 lds
    buffer_load_dwordx4 v3, s[12:15], 0 offen offset:2048 lds
    buffer_load_dwordx4 v4, s[12:15], 0 offen offset:3072 lds
    s_add_u32 m0, s44, 4096
    s_nop 0
    buffer_load_dwordx4 v5, s[12:15], 0 offen offset:0 lds
    s_add_u32 m0, s45, 0
    s_nop 0
    buffer_load_dwordx4 v6, s[16:19], s24 offen offset:0 lds
    buffer_load_dwordx4 v7, s[16:19], s25 offen offset:1024 lds
    buffer_load_dwordx4 v6, s[16:19], s26 offen offset:2048 lds
    buffer_load_dwordx4 v7, s[16:19], s27 offen offset:3072 lds
    s_add_u32 s12, s12, 256
    s_addc_u32 s13, s13, 0
    s_sub_u32 s14, s14, 256
    s_add_u32 s16, s16, 147456
    s_addc_u32 s17, s17, 0
    s_sub_u32 s18, s18, 147456
    s_add_u32 m0, s44, 36864
    s_nop 0
    buffer_load_dwordx4 v1, s[12:15], 0 offen offset:0 lds
    buffer_load_dwordx4 v2, s[12:15], 0 offen offset:1024 lds
    buffer_load_dwordx4 v3, s[12:15], 0 offen offset:2048 lds
    buffer_load_dwordx4 v4, s[12:15], 0 offen offset:3072 lds
    s_add_u32 m0, s44, 40960
    s_nop 0
    buffer_load_dwordx4 v5, s[12:15], 0 offen offset:0 lds
    s_add_u32 m0, s45, 36864
    s_nop 0
    buffer_load_dwordx4 v6, s[16:19], s24 offen offset:0 lds
    buffer_load_dwordx4 v7, s[16:19], s25 offen offset:1024 lds
    buffer_load_dwordx4 v6, s[16:19], s26 offen offset:2048 lds
    buffer_load_dwordx4 v7, s[16:19], s27 offen offset:3072 lds
    s_add_u32 s12, s12, 256
    s_addc_u32 s13, s13, 0
    s_sub_u32 s14, s14, 256
    s_add_u32 s16, s16, 147456
    s_addc_u32 s17, s17, 0
    s_sub_u32 s18, s18, 147456
    s_lshl_b32 s40, s36, 2
    v_add_u32 v240, s40, v238
    v_xor_b32 v240, v240, v239
    v_lshlrev_b32 v240, 4, v240
    v_lshl_add_u32 v240, v239, 8, v240
    v_lshrrev_b32 v241, 2, v239
    v_lshl_add_u32 v242, v238, 3, v241
    s_lshl_b32 s40, s36, 5
    v_add_u32 v242, s40, v242
    v_lshlrev_b32 v242, 7, v242
    v_and_b32 v243, 3, v237
    v_lshl_add_u32 v242, v243, 3, v242
    v_and_b32 v241, 2, v241
    v_and_b32 v243, 1, v238
    v_lshl_add_u32 v241, v243, 2, v241
    v_add_u32 v8, 0, v240
    v_add_u32 v9, 36864, v240
    v_add_u32 v10, 73728, v240
    v_add_u32 v11, 110592, v240
    v_xor_b32 v243, 0, v241
    v_lshl_add_u32 v243, v243, 4, v242
    v_add_u32 v12, 20480, v243
    v_add_u32 v16, 57344, v243
    v_add_u32 v20, 94208, v243
    v_add_u32 v24, 131072, v243
    v_xor_b32 v243, 2, v241
    v_lshl_add_u32 v243, v243, 4, v242
    v_add_u32 v13, 20480, v243
    v_add_u32 v17, 57344, v243
    v_add_u32 v21, 94208, v243
    v_add_u32 v25, 131072, v243
    v_xor_b32 v243, 4, v241
    v_lshl_add_u32 v243, v243, 4, v242
    v_add_u32 v14, 20480, v243
    v_add_u32 v18, 57344, v243
    v_add_u32 v22, 94208, v243
    v_add_u32 v26, 131072, v243
    v_xor_b32 v243, 6, v241
    v_lshl_add_u32 v243, v243, 4, v242
    v_add_u32 v15, 20480, v243
    v_add_u32 v19, 57344, v243
    v_add_u32 v23, 94208, v243
    v_add_u32 v27, 131072, v243
    s_mul_i32 s40, s38, 80
    v_add_u32 v240, s40, v239
    v_mul_u32_u24 v28, 1152, v240
    v_lshl_add_u32 v28, v238, 3, v28
    s_lshl_b32 s40, s37, 7
    s_lshl_b32 s41, s36, 5
    s_add_u32 s40, s40, s41
    v_add_u32 v28, s40, v28
    s_lshl_b32 s40, s40, 1
    s_add_u32 s40, s40, 4608
    v_lshlrev_b32 v29, 4, v238
    v_add_u32 v29, s40, v29
    s_mov_b32 s56, s10
    s_mov_b32 s57, s11
    s_mov_b32 s58, 0x3600
    s_mov_b32 s59, 0x00020000
    s_mov_b32 s20, s4
    s_mov_b32 s21, s5
    s_mov_b32 s22, 0x240000
    s_mov_b32 s23, 0x00020000
    s_add_u32 s28, s10, 0x3500000
    s_addc_u32 s29, s11, 0
    s_mov_b32 s30, 0x240000
    s_mov_b32 s31, 0x00020000
    s_add_u32 s52, s10, 0x2300000
    s_addc_u32 s53, s11, 0
    s_mov_b32 s54, 0x28000
    s_mov_b32 s55, 0x00020000
    s_mov_b32 s32, 0
    s_mov_b32 s33, 18432
    s_mov_b32 s34, 36864
    s_mov_b32 s35, 55296
    s_mov_b32 s49, 73728
    buffer_load_dwordx2 v[200:201], v28, s[20:23], s32 offen
    buffer_load_dwordx2 v[202:203], v28, s[20:23], s33 offen
    buffer_load_dwordx2 v[204:205], v28, s[20:23], s34 offen
    buffer_load_dwordx2 v[206:207], v28, s[20:23], s35 offen
    buffer_load_dwordx2 v[208:209], v28, s[20:23], s49 offen
    buffer_load_dwordx4 v[212:215], v29, s[56:59], 0 offen
    s_waitcnt vmcnt(15)
    s_barrier
    ds_read_b128 v[112:115], v8 offset:0
    ds_read_b64_tr_b16 v[132:133], v12 offset:0
    ds_read_b64_tr_b16 v[134:135], v12 offset:512
    ds_read_b128 v[116:119], v8 offset:4096
    ds_read_b128 v[120:123], v8 offset:8192
    ds_read_b128 v[124:127], v8 offset:12288
    ds_read_b128 v[128:131], v8 offset:16384
    ds_read_b64_tr_b16 v[136:137], v13 offset:0
    ds_read_b64_tr_b16 v[138:139], v13 offset:512
    ds_read_b64_tr_b16 v[140:141], v14 offset:0
    ds_read_b64_tr_b16 v[142:143], v14 offset:512
    ds_read_b64_tr_b16 v[144:145], v15 offset:0
    ds_read_b64_tr_b16 v[146:147], v15 offset:512
    s_waitcnt lgkmcnt(0)
    v_mfma_f32_16x16x32_bf16 v[32:35], v[132:135], v[112:115], 0
    v_mfma_f32_16x16x32_bf16 v[36:39], v[132:135], v[116:119], 0
    s_waitcnt vmcnt(6)
    s_barrier
    v_mfma_f32_16x16x32_bf16 v[40:43], v[132:135], v[120:123], 0
    ds_read_b128 v[148:151], v9 offset:0
    s_add_u32 m0, s44, 73728
    s_nop 0
    buffer_load_dwordx4 v1, s[12:15], 0 offen offset:0 lds
    v_mfma_f32_16x16x32_bf16 v[44:47], v[132:135], v[124:127], 0
    buffer_load_dwordx4 v2, s[12:15], 0 offen offset:1024 lds
    ds_read_b64_tr_b16 v[168:169], v16 offset:0
    buffer_load_dwordx4 v3, s[12:15], 0 offen offset:2048 lds
    v_mfma_f32_16x16x32_bf16 v[48:51], v[132:135], v[128:131], 0
    buffer_load_dwordx4 v4, s[12:15], 0 offen offset:3072 lds
    s_add_u32 m0, s44, 77824
    ds_read_b64_tr_b16 v[170:171], v16 offset:512
    v_mfma_f32_16x16x32_bf16 v[52:55], v[136:139], v[112:115], 0
    buffer_load_dwordx4 v5, s[12:15], 0 offen offset:0 lds
    s_add_u32 m0, s45, 73728
    v_mfma_f32_16x16x32_bf16 v[56:59], v[136:139], v[116:119], 0
    buffer_load_dwordx4 v6, s[16:19], s24 offen offset:0 lds
    ds_read_b128 v[152:155], v9 offset:4096
    buffer_load_dwordx4 v7, s[16:19], s25 offen offset:1024 lds
    v_mfma_f32_16x16x32_bf16 v[60:63], v[136:139], v[120:123], 0
    buffer_load_dwordx4 v6, s[16:19], s26 offen offset:2048 lds
    buffer_load_dwordx4 v7, s[16:19], s27 offen offset:3072 lds
    ds_read_b128 v[156:159], v9 offset:8192
    v_mfma_f32_16x16x32_bf16 v[64:67], v[136:139], v[124:127], 0
    s_add_u32 s12, s12, 256
    s_addc_u32 s13, s13, 0
    ds_read_b128 v[160:163], v9 offset:12288
    v_mfma_f32_16x16x32_bf16 v[68:71], v[136:139], v[128:131], 0
    s_sub_u32 s14, s14, 256
    s_add_u32 s16, s16, 147456
    v_mfma_f32_16x16x32_bf16 v[72:75], v[140:143], v[112:115], 0
    s_addc_u32 s17, s17, 0
    ds_read_b128 v[164:167], v9 offset:16384
    s_sub_u32 s18, s18, 147456
    v_mfma_f32_16x16x32_bf16 v[76:79], v[140:143], v[116:119], 0
    s_add_u32 m0, s44, 110592
    s_nop 0
    buffer_load_dwordx4 v1, s[12:15], 0 offen offset:0 lds
    ds_read_b64_tr_b16 v[172:173], v17 offset:0
    v_mfma_f32_16x16x32_bf16 v[80:83], v[140:143], v[120:123], 0
    buffer_load_dwordx4 v2, s[12:15], 0 offen offset:1024 lds
    buffer_load_dwordx4 v3, s[12:15], 0 offen offset:2048 lds
    v_mfma_f32_16x16x32_bf16 v[84:87], v[140:143], v[124:127], 0
    buffer_load_dwordx4 v4, s[12:15], 0 offen offset:3072 lds
    ds_read_b64_tr_b16 v[174:175], v17 offset:512
    s_add_u32 m0, s44, 114688
    v_mfma_f32_16x16x32_bf16 v[88:91], v[140:143], v[128:131], 0
    buffer_load_dwordx4 v5, s[12:15], 0 offen offset:0 lds
    ds_read_b64_tr_b16 v[176:177], v18 offset:0
    s_add_u32 m0, s45, 110592
    v_mfma_f32_16x16x32_bf16 v[92:95], v[144:147], v[112:115], 0
    buffer_load_dwordx4 v6, s[16:19], s24 offen offset:0 lds
    buffer_load_dwordx4 v7, s[16:19], s25 offen offset:1024 lds
    ds_read_b64_tr_b16 v[178:179], v18 offset:512
    v_mfma_f32_16x16x32_bf16 v[96:99], v[144:147], v[116:119], 0
    buffer_load_dwordx4 v6, s[16:19], s26 offen offset:2048 lds
    buffer_load_dwordx4 v7, s[16:19], s27 offen offset:3072 lds
    v_mfma_f32_16x16x32_bf16 v[100:103], v[144:147], v[120:123], 0
    s_add_u32 s12, s12, 256
    ds_read_b64_tr_b16 v[180:181], v19 offset:0
    s_addc_u32 s13, s13, 0
    v_mfma_f32_16x16x32_bf16 v[104:107], v[144:147], v[124:127], 0
    s_sub_u32 s14, s14, 256
    s_add_u32 s16, s16, 147456
    ds_read_b64_tr_b16 v[182:183], v19 offset:512
    v_mfma_f32_16x16x32_bf16 v[108:111], v[144:147], v[128:131], 0
    s_addc_u32 s17, s17, 0
    s_sub_u32 s18, s18, 147456
    s_waitcnt lgkmcnt(0)
    v_mfma_f32_16x16x32_bf16 v[32:35], v[168:171], v[148:151], v[32:35]
    v_mfma_f32_16x16x32_bf16 v[36:39], v[168:171], v[152:155], v[36:39]
    s_waitcnt vmcnt(9)
    s_barrier
    v_mfma_f32_16x16x32_bf16 v[40:43], v[168:171], v[156:159], v[40:43]
    ds_read_b128 v[112:115], v10 offset:0
    s_add_u32 m0, s44, 0
    s_nop 0
    buffer_load_dwordx4 v1, s[12:15], 0 offen offset:0 lds
    v_mfma_f32_16x16x32_bf16 v[44:47], v[168:171], v[160:163], v[44:47]
    buffer_load_dwordx4 v2, s[12:15], 0 offen offset:1024 lds
    ds_read_b64_tr_b16 v[132:133], v20 offset:0
    buffer_load_dwordx4 v3, s[12:15], 0 offen offset:2048 lds
    v_mfma_f32_16x16x32_bf16 v[48:51], v[168:171], v[164:167], v[48:51]
    buffer_load_dwordx4 v4, s[12:15], 0 offen offset:3072 lds
    s_add_u32 m0, s44, 4096
    ds_read_b64_tr_b16 v[134:135], v20 offset:512
    v_mfma_f32_16x16x32_bf16 v[52:55], v[172:175], v[148:151], v[52:55]
    buffer_load_dwordx4 v5, s[12:15], 0 offen offset:0 lds
    s_add_u32 m0, s45, 0
    v_mfma_f32_16x16x32_bf16 v[56:59], v[172:175], v[152:155], v[56:59]
    buffer_load_dwordx4 v6, s[16:19], s24 offen offset:0 lds
    ds_read_b128 v[116:119], v10 offset:4096
    buffer_load_dwordx4 v7, s[16:19], s25 offen offset:1024 lds
    v_mfma_f32_16x16x32_bf16 v[60:63], v[172:175], v[156:159], v[60:63]
    buffer_load_dwordx4 v6, s[16:19], s26 offen offset:2048 lds
    buffer_load_dwordx4 v7, s[16:19], s27 offen offset:3072 lds
    ds_read_b128 v[120:123], v10 offset:8192
    v_mfma_f32_16x16x32_bf16 v[64:67], v[172:175], v[160:163], v[64:67]
    s_add_u32 s12, s12, 256
    s_addc_u32 s13, s13, 0
    ds_read_b128 v[124:127], v10 offset:12288
    v_mfma_f32_16x16x32_bf16 v[68:71], v[172:175], v[164:167], v[68:71]
    s_sub_u32 s14, s14, 256
    s_add_u32 s16, s16, 147456
    v_mfma_f32_16x16x32_bf16 v[72:75], v[176:179], v[148:151], v[72:75]
    s_addc_u32 s17, s17, 0
    ds_read_b128 v[128:131], v10 offset:16384
    s_sub_u32 s18, s18, 147456
    v_mfma_f32_16x16x32_bf16 v[76:79], v[176:179], v[152:155], v[76:79]
    s_add_u32 m0, s44, 36864
    s_nop 0
    buffer_load_dwordx4 v1, s[12:15], 0 offen offset:0 lds
    ds_read_b64_tr_b16 v[136:137], v21 offset:0
    v_mfma_f32_16x16x32_bf16 v[80:83], v[176:179], v[156:159], v[80:83]
    buffer_load_dwordx4 v2, s[12:15], 0 offen offset:1024 lds
    buffer_load_dwordx4 v3, s[12:15], 0 offen offset:2048 lds
    v_mfma_f32_16x16x32_bf16 v[84:87], v[176:179], v[160:163], v[84:87]
    buffer_load_dwordx4 v4, s[12:15], 0 offen offset:3072 lds
    ds_read_b64_tr_b16 v[138:139], v21 offset:512
    s_add_u32 m0, s44, 40960
    v_mfma_f32_16x16x32_bf16 v[88:91], v[176:179], v[164:167], v[88:91]
    buffer_load_dwordx4 v5, s[12:15], 0 offen offset:0 lds
    ds_read_b64_tr_b16 v[140:141], v22 offset:0
    s_add_u32 m0, s45, 36864
    v_mfma_f32_16x16x32_bf16 v[92:95], v[180:183], v[148:151], v[92:95]
    buffer_load_dwordx4 v6, s[16:19], s24 offen offset:0 lds
    buffer_load_dwordx4 v7, s[16:19], s25 offen offset:1024 lds
    ds_read_b64_tr_b16 v[142:143], v22 offset:512
    v_mfma_f32_16x16x32_bf16 v[96:99], v[180:183], v[152:155], v[96:99]
    buffer_load_dwordx4 v6, s[16:19], s26 offen offset:2048 lds
    buffer_load_dwordx4 v7, s[16:19], s27 offen offset:3072 lds
    v_mfma_f32_16x16x32_bf16 v[100:103], v[180:183], v[156:159], v[100:103]
    s_add_u32 s12, s12, 256
    ds_read_b64_tr_b16 v[144:145], v23 offset:0
    s_addc_u32 s13, s13, 0
    v_mfma_f32_16x16x32_bf16 v[104:107], v[180:183], v[160:163], v[104:107]
    s_sub_u32 s14, s14, 256
    s_add_u32 s16, s16, 147456
    ds_read_b64_tr_b16 v[146:147], v23 offset:512
    v_mfma_f32_16x16x32_bf16 v[108:111], v[180:183], v[164:167], v[108:111]
    s_addc_u32 s17, s17, 0
    s_sub_u32 s18, s18, 147456
    s_waitcnt lgkmcnt(0)
    v_mfma_f32_16x16x32_bf16 v[32:35], v[132:135], v[112:115], v[32:35]
    v_mfma_f32_16x16x32_bf16 v[36:39], v[132:135], v[116:119], v[36:39]
    s_waitcnt vmcnt(18)
    s_barrier
    v_mfma_f32_16x16x32_bf16 v[40:43], v[132:135], v[120:123], v[40:43]
    ds_read_b128 v[148:151], v11 offset:0
    s_add_u32 m0, s44, 73728
    v_mfma_f32_16x16x32_bf16 v[44:47], v[132:135], v[124:127], v[44:47]
    buffer_load_dwordx4 v1, s[12:15], 0 offen offset:0 lds
    ds_read_b64_tr_b16 v[168:169], v24 offset:0
    v_mfma_f32_16x16x32_bf16 v[48:51], v[132:135], v[128:131], v[48:51]
    buffer_load_dwordx4 v2, s[12:15], 0 offen offset:1024 lds
    ds_read_b64_tr_b16 v[170:171], v24 offset:512
    v_mfma_f32_16x16x32_bf16 v[52:55], v[136:139], v[112:115], v[52:55]
    buffer_load_dwordx4 v3, s[12:15], 0 offen offset:2048 lds
    v_mfma_f32_16x16x32_bf16 v[56:59], v[136:139], v[116:119], v[56:59]
    buffer_load_dwordx4 v4, s[12:15], 0 offen offset:3072 lds
    ds_read_b128 v[152:155], v11 offset:4096
    v_mfma_f32_16x16x32_bf16 v[60:63], v[136:139], v[120:123], v[60:63]
    s_add_u32 m0, s44, 77824
    ds_read_b128 v[156:159], v11 offset:8192
    v_mfma_f32_16x16x32_bf16 v[64:67], v[136:139], v[124:127], v[64:67]
    buffer_load_dwordx4 v5, s[12:15], 0 offen offset:0 lds
    ds_read_b128 v[160:163], v11 offset:12288
    v_mfma_f32_16x16x32_bf16 v[68:71], v[136:139], v[128:131], v[68:71]
    s_add_u32 m0, s45, 73728
    v_mfma_f32_16x16x32_bf16 v[72:75], v[140:143], v[112:115], v[72:75]
    buffer_load_dwordx4 v6, s[16:19], s24 offen offset:0 lds
    ds_read_b128 v[164:167], v11 offset:16384
    v_mfma_f32_16x16x32_bf16 v[76:79], v[140:143], v[116:119], v[76:79]
    buffer_load_dwordx4 v7, s[16:19], s25 offen offset:1024 lds
    ds_read_b64_tr_b16 v[172:173], v25 offset:0
    v_mfma_f32_16x16x32_bf16 v[80:83], v[140:143], v[120:123], v[80:83]
    buffer_load_dwordx4 v6, s[16:19], s26 offen offset:2048 lds
    v_mfma_f32_16x16x32_bf16 v[84:87], v[140:143], v[124:127], v[84:87]
    buffer_load_dwordx4 v7, s[16:19], s27 offen offset:3072 lds
    ds_read_b64_tr_b16 v[174:175], v25 offset:512
    v_mfma_f32_16x16x32_bf16 v[88:91], v[140:143], v[128:131], v[88:91]
    s_add_u32 s12, s12, 256
    ds_read_b64_tr_b16 v[176:177], v26 offset:0
    v_mfma_f32_16x16x32_bf16 v[92:95], v[144:147], v[112:115], v[92:95]
    s_addc_u32 s13, s13, 0
    ds_read_b64_tr_b16 v[178:179], v26 offset:512
    v_mfma_f32_16x16x32_bf16 v[96:99], v[144:147], v[116:119], v[96:99]
    s_sub_u32 s14, s14, 256
    v_mfma_f32_16x16x32_bf16 v[100:103], v[144:147], v[120:123], v[100:103]
    s_add_u32 s16, s16, 147456
    ds_read_b64_tr_b16 v[180:181], v27 offset:0
    v_mfma_f32_16x16x32_bf16 v[104:107], v[144:147], v[124:127], v[104:107]
    s_addc_u32 s17, s17, 0
    ds_read_b64_tr_b16 v[182:183], v27 offset:512
    v_mfma_f32_16x16x32_bf16 v[108:111], v[144:147], v[128:131], v[108:111]
    s_sub_u32 s18, s18, 147456
    s_waitcnt lgkmcnt(0)
    v_mfma_f32_16x16x32_bf16 v[32:35], v[168:171], v[148:151], v[32:35]
    v_mfma_f32_16x16x32_bf16 v[36:39], v[168:171], v[152:155], v[36:39]
    s_waitcnt vmcnt(18)
    s_barrier
    v_mfma_f32_16x16x32_bf16 v[40:43], v[168:171], v[156:159], v[40:43]
    ds_read_b128 v[112:115], v8 offset:0
    s_add_u32 m0, s44, 110592
    v_mfma_f32_16x16x32_bf16 v[44:47], v[168:171], v[160:163], v[44:47]
    buffer_load_dwordx4 v1, s[12:15], 0 offen offset:0 lds
    ds_read_b64_tr_b16 v[132:133], v12 offset:0
    v_mfma_f32_16x16x32_bf16 v[48:51], v[168:171], v[164:167], v[48:51]
    buffer_load_dwordx4 v2, s[12:15], 0 offen offset:1024 lds
    ds_read_b64_tr_b16 v[134:135], v12 offset:512
    v_mfma_f32_16x16x32_bf16 v[52:55], v[172:175], v[148:151], v[52:55]
    buffer_load_dwordx4 v3, s[12:15], 0 offen offset:2048 lds
    v_mfma_f32_16x16x32_bf16 v[56:59], v[172:175], v[152:155], v[56:59]
    buffer_load_dwordx4 v4, s[12:15], 0 offen offset:3072 lds
    ds_read_b128 v[116:119], v8 offset:4096
    v_mfma_f32_16x16x32_bf16 v[60:63], v[172:175], v[156:159], v[60:63]
    s_add_u32 m0, s44, 114688
    ds_read_b128 v[120:123], v8 offset:8192
    v_mfma_f32_16x16x32_bf16 v[64:67], v[172:175], v[160:163], v[64:67]
    buffer_load_dwordx4 v5, s[12:15], 0 offen offset:0 lds
    ds_read_b128 v[124:127], v8 offset:12288
    v_mfma_f32_16x16x32_bf16 v[68:71], v[172:175], v[164:167], v[68:71]
    s_add_u32 m0, s45, 110592
    v_mfma_f32_16x16x32_bf16 v[72:75], v[176:179], v[148:151], v[72:75]
    buffer_load_dwordx4 v6, s[16:19], s24 offen offset:0 lds
    ds_read_b128 v[128:131], v8 offset:16384
    v_mfma_f32_16x16x32_bf16 v[76:79], v[176:179], v[152:155], v[76:79]
    buffer_load_dwordx4 v7, s[16:19], s25 offen offset:1024 lds
    ds_read_b64_tr_b16 v[136:137], v13 offset:0
    v_mfma_f32_16x16x32_bf16 v[80:83], v[176:179], v[156:159], v[80:83]
    buffer_load_dwordx4 v6, s[16:19], s26 offen offset:2048 lds
    v_mfma_f32_16x16x32_bf16 v[84:87], v[176:179], v[160:163], v[84:87]
    buffer_load_dwordx4 v7, s[16:19], s27 offen offset:3072 lds
    ds_read_b64_tr_b16 v[138:139], v13 offset:512
    v_mfma_f32_16x16x32_bf16 v[88:91], v[176:179], v[164:167], v[88:91]
    s_add_u32 s12, s12, 256
    ds_read_b64_tr_b16 v[140:141], v14 offset:0
    v_mfma_f32_16x16x32_bf16 v[92:95], v[180:183], v[148:151], v[92:95]
    s_addc_u32 s13, s13, 0
    ds_read_b64_tr_b16 v[142:143], v14 offset:512
    v_mfma_f32_16x16x32_bf16 v[96:99], v[180:183], v[152:155], v[96:99]
    s_sub_u32 s14, s14, 256
    v_mfma_f32_16x16x32_bf16 v[100:103], v[180:183], v[156:159], v[100:103]
    s_add_u32 s16, s16, 147456
    ds_read_b64_tr_b16 v[144:145], v15 offset:0
    v_mfma_f32_16x16x32_bf16 v[104:107], v[180:183], v[160:163], v[104:107]
    s_addc_u32 s17, s17, 0
    ds_read_b64_tr_b16 v[146:147], v15 offset:512
    v_mfma_f32_16x16x32_bf16 v[108:111], v[180:183], v[164:167], v[108:111]
    s_sub_u32 s18, s18, 147456
    s_mov_b32 s48, 0
oproj_kernel_loop:
    s_waitcnt lgkmcnt(0)
    v_mfma_f32_16x16x32_bf16 v[32:35], v[132:135], v[112:115], v[32:35]
    v_mfma_f32_16x16x32_bf16 v[36:39], v[132:135], v[116:119], v[36:39]
    s_waitcnt vmcnt(18)
    s_barrier
    v_mfma_f32_16x16x32_bf16 v[40:43], v[132:135], v[120:123], v[40:43]
    ds_read_b128 v[148:151], v9 offset:0
    s_add_u32 m0, s44, 0
    v_mfma_f32_16x16x32_bf16 v[44:47], v[132:135], v[124:127], v[44:47]
    buffer_load_dwordx4 v1, s[12:15], 0 offen offset:0 lds
    ds_read_b64_tr_b16 v[168:169], v16 offset:0
    v_mfma_f32_16x16x32_bf16 v[48:51], v[132:135], v[128:131], v[48:51]
    buffer_load_dwordx4 v2, s[12:15], 0 offen offset:1024 lds
    ds_read_b64_tr_b16 v[170:171], v16 offset:512
    v_mfma_f32_16x16x32_bf16 v[52:55], v[136:139], v[112:115], v[52:55]
    buffer_load_dwordx4 v3, s[12:15], 0 offen offset:2048 lds
    v_mfma_f32_16x16x32_bf16 v[56:59], v[136:139], v[116:119], v[56:59]
    buffer_load_dwordx4 v4, s[12:15], 0 offen offset:3072 lds
    ds_read_b128 v[152:155], v9 offset:4096
    v_mfma_f32_16x16x32_bf16 v[60:63], v[136:139], v[120:123], v[60:63]
    s_add_u32 m0, s44, 4096
    ds_read_b128 v[156:159], v9 offset:8192
    v_mfma_f32_16x16x32_bf16 v[64:67], v[136:139], v[124:127], v[64:67]
    buffer_load_dwordx4 v5, s[12:15], 0 offen offset:0 lds
    ds_read_b128 v[160:163], v9 offset:12288
    v_mfma_f32_16x16x32_bf16 v[68:71], v[136:139], v[128:131], v[68:71]
    s_add_u32 m0, s45, 0
    v_mfma_f32_16x16x32_bf16 v[72:75], v[140:143], v[112:115], v[72:75]
    buffer_load_dwordx4 v6, s[16:19], s24 offen offset:0 lds
    ds_read_b128 v[164:167], v9 offset:16384
    v_mfma_f32_16x16x32_bf16 v[76:79], v[140:143], v[116:119], v[76:79]
    buffer_load_dwordx4 v7, s[16:19], s25 offen offset:1024 lds
    ds_read_b64_tr_b16 v[172:173], v17 offset:0
    v_mfma_f32_16x16x32_bf16 v[80:83], v[140:143], v[120:123], v[80:83]
    buffer_load_dwordx4 v6, s[16:19], s26 offen offset:2048 lds
    v_mfma_f32_16x16x32_bf16 v[84:87], v[140:143], v[124:127], v[84:87]
    buffer_load_dwordx4 v7, s[16:19], s27 offen offset:3072 lds
    ds_read_b64_tr_b16 v[174:175], v17 offset:512
    v_mfma_f32_16x16x32_bf16 v[88:91], v[140:143], v[128:131], v[88:91]
    s_add_u32 s12, s12, 256
    ds_read_b64_tr_b16 v[176:177], v18 offset:0
    v_mfma_f32_16x16x32_bf16 v[92:95], v[144:147], v[112:115], v[92:95]
    s_addc_u32 s13, s13, 0
    ds_read_b64_tr_b16 v[178:179], v18 offset:512
    v_mfma_f32_16x16x32_bf16 v[96:99], v[144:147], v[116:119], v[96:99]
    s_sub_u32 s14, s14, 256
    v_mfma_f32_16x16x32_bf16 v[100:103], v[144:147], v[120:123], v[100:103]
    s_add_u32 s16, s16, 147456
    ds_read_b64_tr_b16 v[180:181], v19 offset:0
    v_mfma_f32_16x16x32_bf16 v[104:107], v[144:147], v[124:127], v[104:107]
    s_addc_u32 s17, s17, 0
    ds_read_b64_tr_b16 v[182:183], v19 offset:512
    v_mfma_f32_16x16x32_bf16 v[108:111], v[144:147], v[128:131], v[108:111]
    s_sub_u32 s18, s18, 147456
    s_waitcnt lgkmcnt(0)
    v_mfma_f32_16x16x32_bf16 v[32:35], v[168:171], v[148:151], v[32:35]
    v_mfma_f32_16x16x32_bf16 v[36:39], v[168:171], v[152:155], v[36:39]
    s_waitcnt vmcnt(18)
    s_barrier
    v_mfma_f32_16x16x32_bf16 v[40:43], v[168:171], v[156:159], v[40:43]
    ds_read_b128 v[112:115], v10 offset:0
    s_add_u32 m0, s44, 36864
    v_mfma_f32_16x16x32_bf16 v[44:47], v[168:171], v[160:163], v[44:47]
    buffer_load_dwordx4 v1, s[12:15], 0 offen offset:0 lds
    ds_read_b64_tr_b16 v[132:133], v20 offset:0
    v_mfma_f32_16x16x32_bf16 v[48:51], v[168:171], v[164:167], v[48:51]
    buffer_load_dwordx4 v2, s[12:15], 0 offen offset:1024 lds
    ds_read_b64_tr_b16 v[134:135], v20 offset:512
    v_mfma_f32_16x16x32_bf16 v[52:55], v[172:175], v[148:151], v[52:55]
    buffer_load_dwordx4 v3, s[12:15], 0 offen offset:2048 lds
    v_mfma_f32_16x16x32_bf16 v[56:59], v[172:175], v[152:155], v[56:59]
    buffer_load_dwordx4 v4, s[12:15], 0 offen offset:3072 lds
    ds_read_b128 v[116:119], v10 offset:4096
    v_mfma_f32_16x16x32_bf16 v[60:63], v[172:175], v[156:159], v[60:63]
    s_add_u32 m0, s44, 40960
    ds_read_b128 v[120:123], v10 offset:8192
    v_mfma_f32_16x16x32_bf16 v[64:67], v[172:175], v[160:163], v[64:67]
    buffer_load_dwordx4 v5, s[12:15], 0 offen offset:0 lds
    ds_read_b128 v[124:127], v10 offset:12288
    v_mfma_f32_16x16x32_bf16 v[68:71], v[172:175], v[164:167], v[68:71]
    s_add_u32 m0, s45, 36864
    v_mfma_f32_16x16x32_bf16 v[72:75], v[176:179], v[148:151], v[72:75]
    buffer_load_dwordx4 v6, s[16:19], s24 offen offset:0 lds
    ds_read_b128 v[128:131], v10 offset:16384
    v_mfma_f32_16x16x32_bf16 v[76:79], v[176:179], v[152:155], v[76:79]
    buffer_load_dwordx4 v7, s[16:19], s25 offen offset:1024 lds
    ds_read_b64_tr_b16 v[136:137], v21 offset:0
    v_mfma_f32_16x16x32_bf16 v[80:83], v[176:179], v[156:159], v[80:83]
    buffer_load_dwordx4 v6, s[16:19], s26 offen offset:2048 lds
    v_mfma_f32_16x16x32_bf16 v[84:87], v[176:179], v[160:163], v[84:87]
    buffer_load_dwordx4 v7, s[16:19], s27 offen offset:3072 lds
    ds_read_b64_tr_b16 v[138:139], v21 offset:512
    v_mfma_f32_16x16x32_bf16 v[88:91], v[176:179], v[164:167], v[88:91]
    s_add_u32 s12, s12, 256
    ds_read_b64_tr_b16 v[140:141], v22 offset:0
    v_mfma_f32_16x16x32_bf16 v[92:95], v[180:183], v[148:151], v[92:95]
    s_addc_u32 s13, s13, 0
    ds_read_b64_tr_b16 v[142:143], v22 offset:512
    v_mfma_f32_16x16x32_bf16 v[96:99], v[180:183], v[152:155], v[96:99]
    s_sub_u32 s14, s14, 256
    v_mfma_f32_16x16x32_bf16 v[100:103], v[180:183], v[156:159], v[100:103]
    s_add_u32 s16, s16, 147456
    ds_read_b64_tr_b16 v[144:145], v23 offset:0
    v_mfma_f32_16x16x32_bf16 v[104:107], v[180:183], v[160:163], v[104:107]
    s_addc_u32 s17, s17, 0
    ds_read_b64_tr_b16 v[146:147], v23 offset:512
    v_mfma_f32_16x16x32_bf16 v[108:111], v[180:183], v[164:167], v[108:111]
    s_sub_u32 s18, s18, 147456
    s_waitcnt lgkmcnt(0)
    v_mfma_f32_16x16x32_bf16 v[32:35], v[132:135], v[112:115], v[32:35]
    v_mfma_f32_16x16x32_bf16 v[36:39], v[132:135], v[116:119], v[36:39]
    s_waitcnt vmcnt(18)
    s_barrier
    v_mfma_f32_16x16x32_bf16 v[40:43], v[132:135], v[120:123], v[40:43]
    ds_read_b128 v[148:151], v11 offset:0
    s_add_u32 m0, s44, 73728
    v_mfma_f32_16x16x32_bf16 v[44:47], v[132:135], v[124:127], v[44:47]
    buffer_load_dwordx4 v1, s[12:15], 0 offen offset:0 lds
    ds_read_b64_tr_b16 v[168:169], v24 offset:0
    v_mfma_f32_16x16x32_bf16 v[48:51], v[132:135], v[128:131], v[48:51]
    buffer_load_dwordx4 v2, s[12:15], 0 offen offset:1024 lds
    ds_read_b64_tr_b16 v[170:171], v24 offset:512
    v_mfma_f32_16x16x32_bf16 v[52:55], v[136:139], v[112:115], v[52:55]
    buffer_load_dwordx4 v3, s[12:15], 0 offen offset:2048 lds
    v_mfma_f32_16x16x32_bf16 v[56:59], v[136:139], v[116:119], v[56:59]
    buffer_load_dwordx4 v4, s[12:15], 0 offen offset:3072 lds
    ds_read_b128 v[152:155], v11 offset:4096
    v_mfma_f32_16x16x32_bf16 v[60:63], v[136:139], v[120:123], v[60:63]
    s_add_u32 m0, s44, 77824
    ds_read_b128 v[156:159], v11 offset:8192
    v_mfma_f32_16x16x32_bf16 v[64:67], v[136:139], v[124:127], v[64:67]
    buffer_load_dwordx4 v5, s[12:15], 0 offen offset:0 lds
    ds_read_b128 v[160:163], v11 offset:12288
    v_mfma_f32_16x16x32_bf16 v[68:71], v[136:139], v[128:131], v[68:71]
    s_add_u32 m0, s45, 73728
    v_mfma_f32_16x16x32_bf16 v[72:75], v[140:143], v[112:115], v[72:75]
    buffer_load_dwordx4 v6, s[16:19], s24 offen offset:0 lds
    ds_read_b128 v[164:167], v11 offset:16384
    v_mfma_f32_16x16x32_bf16 v[76:79], v[140:143], v[116:119], v[76:79]
    buffer_load_dwordx4 v7, s[16:19], s25 offen offset:1024 lds
    ds_read_b64_tr_b16 v[172:173], v25 offset:0
    v_mfma_f32_16x16x32_bf16 v[80:83], v[140:143], v[120:123], v[80:83]
    buffer_load_dwordx4 v6, s[16:19], s26 offen offset:2048 lds
    v_mfma_f32_16x16x32_bf16 v[84:87], v[140:143], v[124:127], v[84:87]
    buffer_load_dwordx4 v7, s[16:19], s27 offen offset:3072 lds
    ds_read_b64_tr_b16 v[174:175], v25 offset:512
    v_mfma_f32_16x16x32_bf16 v[88:91], v[140:143], v[128:131], v[88:91]
    s_add_u32 s12, s12, 256
    ds_read_b64_tr_b16 v[176:177], v26 offset:0
    v_mfma_f32_16x16x32_bf16 v[92:95], v[144:147], v[112:115], v[92:95]
    s_addc_u32 s13, s13, 0
    ds_read_b64_tr_b16 v[178:179], v26 offset:512
    v_mfma_f32_16x16x32_bf16 v[96:99], v[144:147], v[116:119], v[96:99]
    s_sub_u32 s14, s14, 256
    v_mfma_f32_16x16x32_bf16 v[100:103], v[144:147], v[120:123], v[100:103]
    s_add_u32 s16, s16, 147456
    ds_read_b64_tr_b16 v[180:181], v27 offset:0
    v_mfma_f32_16x16x32_bf16 v[104:107], v[144:147], v[124:127], v[104:107]
    s_addc_u32 s17, s17, 0
    ds_read_b64_tr_b16 v[182:183], v27 offset:512
    v_mfma_f32_16x16x32_bf16 v[108:111], v[144:147], v[128:131], v[108:111]
    s_sub_u32 s18, s18, 147456
    s_waitcnt lgkmcnt(0)
    v_mfma_f32_16x16x32_bf16 v[32:35], v[168:171], v[148:151], v[32:35]
    v_mfma_f32_16x16x32_bf16 v[36:39], v[168:171], v[152:155], v[36:39]
    s_waitcnt vmcnt(18)
    s_barrier
    v_mfma_f32_16x16x32_bf16 v[40:43], v[168:171], v[156:159], v[40:43]
    ds_read_b128 v[112:115], v8 offset:0
    s_add_u32 m0, s44, 110592
    v_mfma_f32_16x16x32_bf16 v[44:47], v[168:171], v[160:163], v[44:47]
    buffer_load_dwordx4 v1, s[12:15], 0 offen offset:0 lds
    ds_read_b64_tr_b16 v[132:133], v12 offset:0
    v_mfma_f32_16x16x32_bf16 v[48:51], v[168:171], v[164:167], v[48:51]
    buffer_load_dwordx4 v2, s[12:15], 0 offen offset:1024 lds
    ds_read_b64_tr_b16 v[134:135], v12 offset:512
    v_mfma_f32_16x16x32_bf16 v[52:55], v[172:175], v[148:151], v[52:55]
    buffer_load_dwordx4 v3, s[12:15], 0 offen offset:2048 lds
    v_mfma_f32_16x16x32_bf16 v[56:59], v[172:175], v[152:155], v[56:59]
    buffer_load_dwordx4 v4, s[12:15], 0 offen offset:3072 lds
    ds_read_b128 v[116:119], v8 offset:4096
    v_mfma_f32_16x16x32_bf16 v[60:63], v[172:175], v[156:159], v[60:63]
    s_add_u32 m0, s44, 114688
    ds_read_b128 v[120:123], v8 offset:8192
    v_mfma_f32_16x16x32_bf16 v[64:67], v[172:175], v[160:163], v[64:67]
    buffer_load_dwordx4 v5, s[12:15], 0 offen offset:0 lds
    ds_read_b128 v[124:127], v8 offset:12288
    v_mfma_f32_16x16x32_bf16 v[68:71], v[172:175], v[164:167], v[68:71]
    s_add_u32 m0, s45, 110592
    v_mfma_f32_16x16x32_bf16 v[72:75], v[176:179], v[148:151], v[72:75]
    buffer_load_dwordx4 v6, s[16:19], s24 offen offset:0 lds
    ds_read_b128 v[128:131], v8 offset:16384
    v_mfma_f32_16x16x32_bf16 v[76:79], v[176:179], v[152:155], v[76:79]
    buffer_load_dwordx4 v7, s[16:19], s25 offen offset:1024 lds
    ds_read_b64_tr_b16 v[136:137], v13 offset:0
    v_mfma_f32_16x16x32_bf16 v[80:83], v[176:179], v[156:159], v[80:83]
    buffer_load_dwordx4 v6, s[16:19], s26 offen offset:2048 lds
    v_mfma_f32_16x16x32_bf16 v[84:87], v[176:179], v[160:163], v[84:87]
    buffer_load_dwordx4 v7, s[16:19], s27 offen offset:3072 lds
    ds_read_b64_tr_b16 v[138:139], v13 offset:512
    v_mfma_f32_16x16x32_bf16 v[88:91], v[176:179], v[164:167], v[88:91]
    s_add_u32 s12, s12, 256
    ds_read_b64_tr_b16 v[140:141], v14 offset:0
    v_mfma_f32_16x16x32_bf16 v[92:95], v[180:183], v[148:151], v[92:95]
    s_addc_u32 s13, s13, 0
    ds_read_b64_tr_b16 v[142:143], v14 offset:512
    v_mfma_f32_16x16x32_bf16 v[96:99], v[180:183], v[152:155], v[96:99]
    s_sub_u32 s14, s14, 256
    v_mfma_f32_16x16x32_bf16 v[100:103], v[180:183], v[156:159], v[100:103]
    s_add_u32 s16, s16, 147456
    ds_read_b64_tr_b16 v[144:145], v15 offset:0
    v_mfma_f32_16x16x32_bf16 v[104:107], v[180:183], v[160:163], v[104:107]
    s_addc_u32 s17, s17, 0
    ds_read_b64_tr_b16 v[146:147], v15 offset:512
    v_mfma_f32_16x16x32_bf16 v[108:111], v[180:183], v[164:167], v[108:111]
    s_sub_u32 s18, s18, 147456
    s_add_u32 s48, s48, 1
    s_cmp_lt_u32 s48, 6
    s_cbranch_scc1 oproj_kernel_loop
    s_waitcnt lgkmcnt(0)
    v_mfma_f32_16x16x32_bf16 v[32:35], v[132:135], v[112:115], v[32:35]
    v_mfma_f32_16x16x32_bf16 v[36:39], v[132:135], v[116:119], v[36:39]
    s_waitcnt vmcnt(18)
    s_barrier
    v_mfma_f32_16x16x32_bf16 v[40:43], v[132:135], v[120:123], v[40:43]
    ds_read_b128 v[148:151], v9 offset:0
    v_mfma_f32_16x16x32_bf16 v[44:47], v[132:135], v[124:127], v[44:47]
    ds_read_b64_tr_b16 v[168:169], v16 offset:0
    v_mfma_f32_16x16x32_bf16 v[48:51], v[132:135], v[128:131], v[48:51]
    ds_read_b64_tr_b16 v[170:171], v16 offset:512
    v_mfma_f32_16x16x32_bf16 v[52:55], v[136:139], v[112:115], v[52:55]
    v_mfma_f32_16x16x32_bf16 v[56:59], v[136:139], v[116:119], v[56:59]
    ds_read_b128 v[152:155], v9 offset:4096
    v_mfma_f32_16x16x32_bf16 v[60:63], v[136:139], v[120:123], v[60:63]
    ds_read_b128 v[156:159], v9 offset:8192
    v_mfma_f32_16x16x32_bf16 v[64:67], v[136:139], v[124:127], v[64:67]
    ds_read_b128 v[160:163], v9 offset:12288
    v_mfma_f32_16x16x32_bf16 v[68:71], v[136:139], v[128:131], v[68:71]
    v_mfma_f32_16x16x32_bf16 v[72:75], v[140:143], v[112:115], v[72:75]
    ds_read_b128 v[164:167], v9 offset:16384
    v_mfma_f32_16x16x32_bf16 v[76:79], v[140:143], v[116:119], v[76:79]
    ds_read_b64_tr_b16 v[172:173], v17 offset:0
    v_mfma_f32_16x16x32_bf16 v[80:83], v[140:143], v[120:123], v[80:83]
    v_mfma_f32_16x16x32_bf16 v[84:87], v[140:143], v[124:127], v[84:87]
    ds_read_b64_tr_b16 v[174:175], v17 offset:512
    v_mfma_f32_16x16x32_bf16 v[88:91], v[140:143], v[128:131], v[88:91]
    ds_read_b64_tr_b16 v[176:177], v18 offset:0
    v_mfma_f32_16x16x32_bf16 v[92:95], v[144:147], v[112:115], v[92:95]
    ds_read_b64_tr_b16 v[178:179], v18 offset:512
    v_mfma_f32_16x16x32_bf16 v[96:99], v[144:147], v[116:119], v[96:99]
    v_mfma_f32_16x16x32_bf16 v[100:103], v[144:147], v[120:123], v[100:103]
    ds_read_b64_tr_b16 v[180:181], v19 offset:0
    v_mfma_f32_16x16x32_bf16 v[104:107], v[144:147], v[124:127], v[104:107]
    ds_read_b64_tr_b16 v[182:183], v19 offset:512
    v_mfma_f32_16x16x32_bf16 v[108:111], v[144:147], v[128:131], v[108:111]
    s_waitcnt lgkmcnt(0)
    v_mfma_f32_16x16x32_bf16 v[32:35], v[168:171], v[148:151], v[32:35]
    v_mfma_f32_16x16x32_bf16 v[36:39], v[168:171], v[152:155], v[36:39]
    s_waitcnt vmcnt(9)
    s_barrier
    v_mfma_f32_16x16x32_bf16 v[40:43], v[168:171], v[156:159], v[40:43]
    ds_read_b128 v[112:115], v10 offset:0
    v_mfma_f32_16x16x32_bf16 v[44:47], v[168:171], v[160:163], v[44:47]
    ds_read_b64_tr_b16 v[132:133], v20 offset:0
    v_mfma_f32_16x16x32_bf16 v[48:51], v[168:171], v[164:167], v[48:51]
    ds_read_b64_tr_b16 v[134:135], v20 offset:512
    v_mfma_f32_16x16x32_bf16 v[52:55], v[172:175], v[148:151], v[52:55]
    v_mfma_f32_16x16x32_bf16 v[56:59], v[172:175], v[152:155], v[56:59]
    ds_read_b128 v[116:119], v10 offset:4096
    v_mfma_f32_16x16x32_bf16 v[60:63], v[172:175], v[156:159], v[60:63]
    ds_read_b128 v[120:123], v10 offset:8192
    v_mfma_f32_16x16x32_bf16 v[64:67], v[172:175], v[160:163], v[64:67]
    ds_read_b128 v[124:127], v10 offset:12288
    v_mfma_f32_16x16x32_bf16 v[68:71], v[172:175], v[164:167], v[68:71]
    v_mfma_f32_16x16x32_bf16 v[72:75], v[176:179], v[148:151], v[72:75]
    ds_read_b128 v[128:131], v10 offset:16384
    v_mfma_f32_16x16x32_bf16 v[76:79], v[176:179], v[152:155], v[76:79]
    ds_read_b64_tr_b16 v[136:137], v21 offset:0
    v_mfma_f32_16x16x32_bf16 v[80:83], v[176:179], v[156:159], v[80:83]
    v_mfma_f32_16x16x32_bf16 v[84:87], v[176:179], v[160:163], v[84:87]
    ds_read_b64_tr_b16 v[138:139], v21 offset:512
    v_mfma_f32_16x16x32_bf16 v[88:91], v[176:179], v[164:167], v[88:91]
    ds_read_b64_tr_b16 v[140:141], v22 offset:0
    v_mfma_f32_16x16x32_bf16 v[92:95], v[180:183], v[148:151], v[92:95]
    ds_read_b64_tr_b16 v[142:143], v22 offset:512
    v_mfma_f32_16x16x32_bf16 v[96:99], v[180:183], v[152:155], v[96:99]
    v_mfma_f32_16x16x32_bf16 v[100:103], v[180:183], v[156:159], v[100:103]
    ds_read_b64_tr_b16 v[144:145], v23 offset:0
    v_mfma_f32_16x16x32_bf16 v[104:107], v[180:183], v[160:163], v[104:107]
    ds_read_b64_tr_b16 v[146:147], v23 offset:512
    v_mfma_f32_16x16x32_bf16 v[108:111], v[180:183], v[164:167], v[108:111]
    s_waitcnt lgkmcnt(0)
    v_mfma_f32_16x16x32_bf16 v[32:35], v[132:135], v[112:115], v[32:35]
    v_mfma_f32_16x16x32_bf16 v[36:39], v[132:135], v[116:119], v[36:39]
    s_waitcnt vmcnt(0)
    s_barrier
    v_mfma_f32_16x16x32_bf16 v[40:43], v[132:135], v[120:123], v[40:43]
    ds_read_b128 v[148:151], v11 offset:0
    v_mfma_f32_16x16x32_bf16 v[44:47], v[132:135], v[124:127], v[44:47]
    ds_read_b64_tr_b16 v[168:169], v24 offset:0
    v_mfma_f32_16x16x32_bf16 v[48:51], v[132:135], v[128:131], v[48:51]
    ds_read_b64_tr_b16 v[170:171], v24 offset:512
    v_mfma_f32_16x16x32_bf16 v[52:55], v[136:139], v[112:115], v[52:55]
    v_mfma_f32_16x16x32_bf16 v[56:59], v[136:139], v[116:119], v[56:59]
    ds_read_b128 v[152:155], v11 offset:4096
    v_mfma_f32_16x16x32_bf16 v[60:63], v[136:139], v[120:123], v[60:63]
    ds_read_b128 v[156:159], v11 offset:8192
    v_mfma_f32_16x16x32_bf16 v[64:67], v[136:139], v[124:127], v[64:67]
    ds_read_b128 v[160:163], v11 offset:12288
    v_mfma_f32_16x16x32_bf16 v[68:71], v[136:139], v[128:131], v[68:71]
    v_mfma_f32_16x16x32_bf16 v[72:75], v[140:143], v[112:115], v[72:75]
    ds_read_b128 v[164:167], v11 offset:16384
    v_mfma_f32_16x16x32_bf16 v[76:79], v[140:143], v[116:119], v[76:79]
    ds_read_b64_tr_b16 v[172:173], v25 offset:0
    v_mfma_f32_16x16x32_bf16 v[80:83], v[140:143], v[120:123], v[80:83]
    v_mfma_f32_16x16x32_bf16 v[84:87], v[140:143], v[124:127], v[84:87]
    ds_read_b64_tr_b16 v[174:175], v25 offset:512
    v_mfma_f32_16x16x32_bf16 v[88:91], v[140:143], v[128:131], v[88:91]
    ds_read_b64_tr_b16 v[176:177], v26 offset:0
    v_mfma_f32_16x16x32_bf16 v[92:95], v[144:147], v[112:115], v[92:95]
    ds_read_b64_tr_b16 v[178:179], v26 offset:512
    v_mfma_f32_16x16x32_bf16 v[96:99], v[144:147], v[116:119], v[96:99]
    v_mfma_f32_16x16x32_bf16 v[100:103], v[144:147], v[120:123], v[100:103]
    ds_read_b64_tr_b16 v[180:181], v27 offset:0
    v_mfma_f32_16x16x32_bf16 v[104:107], v[144:147], v[124:127], v[104:107]
    ds_read_b64_tr_b16 v[182:183], v27 offset:512
    v_mfma_f32_16x16x32_bf16 v[108:111], v[144:147], v[128:131], v[108:111]
    s_waitcnt lgkmcnt(10)
    v_mfma_f32_16x16x32_bf16 v[32:35], v[168:171], v[148:151], v[32:35]
    s_waitcnt lgkmcnt(9)
    v_mfma_f32_16x16x32_bf16 v[36:39], v[168:171], v[152:155], v[36:39]
    s_waitcnt lgkmcnt(8)
    v_mfma_f32_16x16x32_bf16 v[40:43], v[168:171], v[156:159], v[40:43]
    s_waitcnt lgkmcnt(7)
    v_mfma_f32_16x16x32_bf16 v[44:47], v[168:171], v[160:163], v[44:47]
    s_waitcnt lgkmcnt(6)
    v_mfma_f32_16x16x32_bf16 v[48:51], v[168:171], v[164:167], v[48:51]
    s_waitcnt lgkmcnt(4)
    v_mfma_f32_16x16x32_bf16 v[52:55], v[172:175], v[148:151], v[52:55]
    v_mfma_f32_16x16x32_bf16 v[56:59], v[172:175], v[152:155], v[56:59]
    v_mfma_f32_16x16x32_bf16 v[60:63], v[172:175], v[156:159], v[60:63]
    v_mfma_f32_16x16x32_bf16 v[64:67], v[172:175], v[160:163], v[64:67]
    v_mfma_f32_16x16x32_bf16 v[68:71], v[172:175], v[164:167], v[68:71]
    s_waitcnt lgkmcnt(2)
    v_mfma_f32_16x16x32_bf16 v[72:75], v[176:179], v[148:151], v[72:75]
    v_mfma_f32_16x16x32_bf16 v[76:79], v[176:179], v[152:155], v[76:79]
    v_mfma_f32_16x16x32_bf16 v[80:83], v[176:179], v[156:159], v[80:83]
    v_mfma_f32_16x16x32_bf16 v[84:87], v[176:179], v[160:163], v[84:87]
    v_mfma_f32_16x16x32_bf16 v[88:91], v[176:179], v[164:167], v[88:91]
    s_waitcnt lgkmcnt(0)
    v_mfma_f32_16x16x32_bf16 v[92:95], v[180:183], v[148:151], v[92:95]
    v_mfma_f32_16x16x32_bf16 v[96:99], v[180:183], v[152:155], v[96:99]
    v_mfma_f32_16x16x32_bf16 v[100:103], v[180:183], v[156:159], v[100:103]
    v_mfma_f32_16x16x32_bf16 v[104:107], v[180:183], v[160:163], v[104:107]
    v_mfma_f32_16x16x32_bf16 v[108:111], v[180:183], v[164:167], v[108:111]
    s_barrier
    v_lshlrev_b32 v240, 4, v237
    s_mul_i32 s40, s36, 20480
    v_add_u32 v241, s40, v240
    s_mul_i32 s40, s36, 5120
    v_add_u32 v242, s40, v240
    ds_write_b128 v241, v[32:35] offset:0
    ds_write_b128 v241, v[36:39] offset:1024
    ds_write_b128 v241, v[40:43] offset:2048
    ds_write_b128 v241, v[44:47] offset:3072
    ds_write_b128 v241, v[48:51] offset:4096
    ds_write_b128 v241, v[52:55] offset:5120
    ds_write_b128 v241, v[56:59] offset:6144
    ds_write_b128 v241, v[60:63] offset:7168
    ds_write_b128 v241, v[64:67] offset:8192
    ds_write_b128 v241, v[68:71] offset:9216
    ds_write_b128 v241, v[72:75] offset:10240
    ds_write_b128 v241, v[76:79] offset:11264
    ds_write_b128 v241, v[80:83] offset:12288
    ds_write_b128 v241, v[84:87] offset:13312
    ds_write_b128 v241, v[88:91] offset:14336
    ds_write_b128 v241, v[92:95] offset:15360
    ds_write_b128 v241, v[96:99] offset:16384
    ds_write_b128 v241, v[100:103] offset:17408
    ds_write_b128 v241, v[104:107] offset:18432
    ds_write_b128 v241, v[108:111] offset:19456
    s_waitcnt lgkmcnt(0)
    s_barrier
    v_add_u32 v241, 40960, v242
    ds_read_b128 v[112:115], v242 offset:0
    ds_read_b128 v[116:119], v242 offset:1024
    ds_read_b128 v[120:123], v242 offset:2048
    ds_read_b128 v[124:127], v242 offset:3072
    ds_read_b128 v[128:131], v242 offset:4096
    ds_read_b128 v[132:135], v242 offset:20480
    ds_read_b128 v[136:139], v242 offset:21504
    ds_read_b128 v[140:143], v242 offset:22528
    ds_read_b128 v[144:147], v242 offset:23552
    ds_read_b128 v[148:151], v242 offset:24576
    ds_read_b128 v[152:155], v241 offset:0
    ds_read_b128 v[156:159], v241 offset:1024
    ds_read_b128 v[160:163], v241 offset:2048
    ds_read_b128 v[164:167], v241 offset:3072
    ds_read_b128 v[168:171], v241 offset:4096
    ds_read_b128 v[172:175], v241 offset:20480
    ds_read_b128 v[176:179], v241 offset:21504
    ds_read_b128 v[180:183], v241 offset:22528
    ds_read_b128 v[184:187], v241 offset:23552
    ds_read_b128 v[188:191], v241 offset:24576
    s_waitcnt lgkmcnt(14)
    v_add_f32 v32, v112, v132
    s_waitcnt lgkmcnt(4)
    v_add_f32 v152, v152, v172
    v_add_f32 v32, v32, v152
    v_add_f32 v33, v113, v133
    v_add_f32 v153, v153, v173
    v_add_f32 v33, v33, v153
    v_add_f32 v34, v114, v134
    v_add_f32 v154, v154, v174
    v_add_f32 v34, v34, v154
    v_add_f32 v35, v115, v135
    v_add_f32 v155, v155, v175
    v_add_f32 v35, v35, v155
    v_add_f32 v36, v116, v136
    s_waitcnt lgkmcnt(3)
    v_add_f32 v156, v156, v176
    v_add_f32 v36, v36, v156
    v_add_f32 v37, v117, v137
    v_add_f32 v157, v157, v177
    v_add_f32 v37, v37, v157
    v_add_f32 v38, v118, v138
    v_add_f32 v158, v158, v178
    v_add_f32 v38, v38, v158
    v_add_f32 v39, v119, v139
    v_add_f32 v159, v159, v179
    v_add_f32 v39, v39, v159
    v_add_f32 v40, v120, v140
    s_waitcnt lgkmcnt(2)
    v_add_f32 v160, v160, v180
    v_add_f32 v40, v40, v160
    v_add_f32 v41, v121, v141
    v_add_f32 v161, v161, v181
    v_add_f32 v41, v41, v161
    v_add_f32 v42, v122, v142
    v_add_f32 v162, v162, v182
    v_add_f32 v42, v42, v162
    v_add_f32 v43, v123, v143
    v_add_f32 v163, v163, v183
    v_add_f32 v43, v43, v163
    v_add_f32 v44, v124, v144
    s_waitcnt lgkmcnt(0)
    v_add_f32 v164, v164, v184
    v_add_f32 v44, v44, v164
    v_add_f32 v45, v125, v145
    v_add_f32 v165, v165, v185
    v_add_f32 v45, v45, v165
    v_add_f32 v46, v126, v146
    v_add_f32 v166, v166, v186
    v_add_f32 v46, v46, v166
    v_add_f32 v47, v127, v147
    v_add_f32 v167, v167, v187
    v_add_f32 v47, v47, v167
    v_add_f32 v48, v128, v148
    v_add_f32 v168, v168, v188
    v_add_f32 v48, v48, v168
    v_add_f32 v49, v129, v149
    v_add_f32 v169, v169, v189
    v_add_f32 v49, v49, v169
    v_add_f32 v50, v130, v150
    v_add_f32 v170, v170, v190
    v_add_f32 v50, v50, v170
    v_add_f32 v51, v131, v151
    v_add_f32 v171, v171, v191
    v_add_f32 v51, v51, v171
    v_cvt_pk_bf16_f32 v243, v32, v33
    v_lshlrev_b32 v32, 16, v243
    v_and_b32 v33, 0xffff0000, v243
    v_mul_f32 v32, v32, v212
    v_mul_f32 v33, v33, v213
    v_cvt_pk_bf16_f32 v243, v32, v33
    v_lshlrev_b32 v32, 16, v243
    v_and_b32 v33, 0xffff0000, v243
    v_lshlrev_b32 v243, 16, v200
    v_and_b32 v244, 0xffff0000, v200
    v_add_f32 v32, v32, v243
    v_add_f32 v33, v33, v244
    v_cvt_pk_bf16_f32 v200, v32, v33
    v_cvt_pk_bf16_f32 v243, v34, v35
    v_lshlrev_b32 v34, 16, v243
    v_and_b32 v35, 0xffff0000, v243
    v_mul_f32 v34, v34, v214
    v_mul_f32 v35, v35, v215
    v_cvt_pk_bf16_f32 v243, v34, v35
    v_lshlrev_b32 v34, 16, v243
    v_and_b32 v35, 0xffff0000, v243
    v_lshlrev_b32 v243, 16, v201
    v_and_b32 v244, 0xffff0000, v201
    v_add_f32 v34, v34, v243
    v_add_f32 v35, v35, v244
    v_cvt_pk_bf16_f32 v201, v34, v35
    buffer_store_dwordx2 v[200:201], v28, s[28:31], s32 offen
    v_cvt_pk_bf16_f32 v243, v36, v37
    v_lshlrev_b32 v36, 16, v243
    v_and_b32 v37, 0xffff0000, v243
    v_mul_f32 v36, v36, v212
    v_mul_f32 v37, v37, v213
    v_cvt_pk_bf16_f32 v243, v36, v37
    v_lshlrev_b32 v36, 16, v243
    v_and_b32 v37, 0xffff0000, v243
    v_lshlrev_b32 v243, 16, v202
    v_and_b32 v244, 0xffff0000, v202
    v_add_f32 v36, v36, v243
    v_add_f32 v37, v37, v244
    v_cvt_pk_bf16_f32 v202, v36, v37
    v_cvt_pk_bf16_f32 v243, v38, v39
    v_lshlrev_b32 v38, 16, v243
    v_and_b32 v39, 0xffff0000, v243
    v_mul_f32 v38, v38, v214
    v_mul_f32 v39, v39, v215
    v_cvt_pk_bf16_f32 v243, v38, v39
    v_lshlrev_b32 v38, 16, v243
    v_and_b32 v39, 0xffff0000, v243
    v_lshlrev_b32 v243, 16, v203
    v_and_b32 v244, 0xffff0000, v203
    v_add_f32 v38, v38, v243
    v_add_f32 v39, v39, v244
    v_cvt_pk_bf16_f32 v203, v38, v39
    buffer_store_dwordx2 v[202:203], v28, s[28:31], s33 offen
    v_cvt_pk_bf16_f32 v243, v40, v41
    v_lshlrev_b32 v40, 16, v243
    v_and_b32 v41, 0xffff0000, v243
    v_mul_f32 v40, v40, v212
    v_mul_f32 v41, v41, v213
    v_cvt_pk_bf16_f32 v243, v40, v41
    v_lshlrev_b32 v40, 16, v243
    v_and_b32 v41, 0xffff0000, v243
    v_lshlrev_b32 v243, 16, v204
    v_and_b32 v244, 0xffff0000, v204
    v_add_f32 v40, v40, v243
    v_add_f32 v41, v41, v244
    v_cvt_pk_bf16_f32 v204, v40, v41
    v_cvt_pk_bf16_f32 v243, v42, v43
    v_lshlrev_b32 v42, 16, v243
    v_and_b32 v43, 0xffff0000, v243
    v_mul_f32 v42, v42, v214
    v_mul_f32 v43, v43, v215
    v_cvt_pk_bf16_f32 v243, v42, v43
    v_lshlrev_b32 v42, 16, v243
    v_and_b32 v43, 0xffff0000, v243
    v_lshlrev_b32 v243, 16, v205
    v_and_b32 v244, 0xffff0000, v205
    v_add_f32 v42, v42, v243
    v_add_f32 v43, v43, v244
    v_cvt_pk_bf16_f32 v205, v42, v43
    buffer_store_dwordx2 v[204:205], v28, s[28:31], s34 offen
    v_cvt_pk_bf16_f32 v243, v44, v45
    v_lshlrev_b32 v44, 16, v243
    v_and_b32 v45, 0xffff0000, v243
    v_mul_f32 v44, v44, v212
    v_mul_f32 v45, v45, v213
    v_cvt_pk_bf16_f32 v243, v44, v45
    v_lshlrev_b32 v44, 16, v243
    v_and_b32 v45, 0xffff0000, v243
    v_lshlrev_b32 v243, 16, v206
    v_and_b32 v244, 0xffff0000, v206
    v_add_f32 v44, v44, v243
    v_add_f32 v45, v45, v244
    v_cvt_pk_bf16_f32 v206, v44, v45
    v_cvt_pk_bf16_f32 v243, v46, v47
    v_lshlrev_b32 v46, 16, v243
    v_and_b32 v47, 0xffff0000, v243
    v_mul_f32 v46, v46, v214
    v_mul_f32 v47, v47, v215
    v_cvt_pk_bf16_f32 v243, v46, v47
    v_lshlrev_b32 v46, 16, v243
    v_and_b32 v47, 0xffff0000, v243
    v_lshlrev_b32 v243, 16, v207
    v_and_b32 v244, 0xffff0000, v207
    v_add_f32 v46, v46, v243
    v_add_f32 v47, v47, v244
    v_cvt_pk_bf16_f32 v207, v46, v47
    buffer_store_dwordx2 v[206:207], v28, s[28:31], s35 offen
    v_cvt_pk_bf16_f32 v243, v48, v49
    v_lshlrev_b32 v48, 16, v243
    v_and_b32 v49, 0xffff0000, v243
    v_mul_f32 v48, v48, v212
    v_mul_f32 v49, v49, v213
    v_cvt_pk_bf16_f32 v243, v48, v49
    v_lshlrev_b32 v48, 16, v243
    v_and_b32 v49, 0xffff0000, v243
    v_lshlrev_b32 v243, 16, v208
    v_and_b32 v244, 0xffff0000, v208
    v_add_f32 v48, v48, v243
    v_add_f32 v49, v49, v244
    v_cvt_pk_bf16_f32 v208, v48, v49
    v_cvt_pk_bf16_f32 v243, v50, v51
    v_lshlrev_b32 v50, 16, v243
    v_and_b32 v51, 0xffff0000, v243
    v_mul_f32 v50, v50, v214
    v_mul_f32 v51, v51, v215
    v_cvt_pk_bf16_f32 v243, v50, v51
    v_lshlrev_b32 v50, 16, v243
    v_and_b32 v51, 0xffff0000, v243
    v_lshlrev_b32 v243, 16, v209
    v_and_b32 v244, 0xffff0000, v209
    v_add_f32 v50, v50, v243
    v_add_f32 v51, v51, v244
    v_cvt_pk_bf16_f32 v209, v50, v51
    buffer_store_dwordx2 v[208:209], v28, s[28:31], s49 offen
    v_lshlrev_b32 v32, 16, v200
    v_and_b32 v33, 0xffff0000, v200
    v_lshlrev_b32 v34, 16, v201
    v_and_b32 v35, 0xffff0000, v201
    v_add_f32 v64, v32, v33
    v_add_f32 v65, v34, v35
    v_add_f32 v64, v64, v65
    v_lshlrev_b32 v36, 16, v202
    v_and_b32 v37, 0xffff0000, v202
    v_lshlrev_b32 v38, 16, v203
    v_and_b32 v39, 0xffff0000, v203
    v_add_f32 v66, v36, v37
    v_add_f32 v67, v38, v39
    v_add_f32 v66, v66, v67
    v_lshlrev_b32 v40, 16, v204
    v_and_b32 v41, 0xffff0000, v204
    v_lshlrev_b32 v42, 16, v205
    v_and_b32 v43, 0xffff0000, v205
    v_add_f32 v68, v40, v41
    v_add_f32 v69, v42, v43
    v_add_f32 v68, v68, v69
    v_lshlrev_b32 v44, 16, v206
    v_and_b32 v45, 0xffff0000, v206
    v_lshlrev_b32 v46, 16, v207
    v_and_b32 v47, 0xffff0000, v207
    v_add_f32 v70, v44, v45
    v_add_f32 v71, v46, v47
    v_add_f32 v70, v70, v71
    v_lshlrev_b32 v48, 16, v208
    v_and_b32 v49, 0xffff0000, v208
    v_lshlrev_b32 v50, 16, v209
    v_and_b32 v51, 0xffff0000, v209
    v_add_f32 v72, v48, v49
    v_add_f32 v73, v50, v51
    v_add_f32 v72, v72, v73
    ds_swizzle_b32 v80, v64 offset:0x401F
    ds_swizzle_b32 v81, v66 offset:0x401F
    ds_swizzle_b32 v82, v68 offset:0x401F
    ds_swizzle_b32 v83, v70 offset:0x401F
    ds_swizzle_b32 v84, v72 offset:0x401F
    s_waitcnt lgkmcnt(4)
    v_add_f32 v64, v64, v80
    s_waitcnt lgkmcnt(3)
    v_add_f32 v66, v66, v81
    s_waitcnt lgkmcnt(2)
    v_add_f32 v68, v68, v82
    s_waitcnt lgkmcnt(1)
    v_add_f32 v70, v70, v83
    s_waitcnt lgkmcnt(0)
    v_add_f32 v72, v72, v84
    v_mov_b32 v80, v64
    v_mov_b32 v88, v64
    v_mov_b32 v81, v66
    v_mov_b32 v89, v66
    v_mov_b32 v82, v68
    v_mov_b32 v90, v68
    v_mov_b32 v83, v70
    v_mov_b32 v91, v70
    v_mov_b32 v84, v72
    v_mov_b32 v92, v72
    v_permlane32_swap_b32 v80, v88
    v_permlane32_swap_b32 v81, v89
    v_permlane32_swap_b32 v82, v90
    v_permlane32_swap_b32 v83, v91
    v_permlane32_swap_b32 v84, v92
    v_add_f32 v64, v80, v88
    v_add_f32 v66, v81, v89
    v_add_f32 v68, v82, v90
    v_add_f32 v70, v83, v91
    v_add_f32 v72, v84, v92
    v_mul_f32 v60, 0x3d800000, v64
    v_mov_b32 v65, 0
    v_sub_f32 v61, v32, v60
    v_fmac_f32 v65, v61, v61
    v_sub_f32 v61, v33, v60
    v_fmac_f32 v65, v61, v61
    v_sub_f32 v61, v34, v60
    v_fmac_f32 v65, v61, v61
    v_sub_f32 v61, v35, v60
    v_fmac_f32 v65, v61, v61
    v_mul_f32 v60, 0x3d800000, v66
    v_mov_b32 v67, 0
    v_sub_f32 v61, v36, v60
    v_fmac_f32 v67, v61, v61
    v_sub_f32 v61, v37, v60
    v_fmac_f32 v67, v61, v61
    v_sub_f32 v61, v38, v60
    v_fmac_f32 v67, v61, v61
    v_sub_f32 v61, v39, v60
    v_fmac_f32 v67, v61, v61
    v_mul_f32 v60, 0x3d800000, v68
    v_mov_b32 v69, 0
    v_sub_f32 v61, v40, v60
    v_fmac_f32 v69, v61, v61
    v_sub_f32 v61, v41, v60
    v_fmac_f32 v69, v61, v61
    v_sub_f32 v61, v42, v60
    v_fmac_f32 v69, v61, v61
    v_sub_f32 v61, v43, v60
    v_fmac_f32 v69, v61, v61
    v_mul_f32 v60, 0x3d800000, v70
    v_mov_b32 v71, 0
    v_sub_f32 v61, v44, v60
    v_fmac_f32 v71, v61, v61
    v_sub_f32 v61, v45, v60
    v_fmac_f32 v71, v61, v61
    v_sub_f32 v61, v46, v60
    v_fmac_f32 v71, v61, v61
    v_sub_f32 v61, v47, v60
    v_fmac_f32 v71, v61, v61
    v_mul_f32 v60, 0x3d800000, v72
    v_mov_b32 v73, 0
    v_sub_f32 v61, v48, v60
    v_fmac_f32 v73, v61, v61
    v_sub_f32 v61, v49, v60
    v_fmac_f32 v73, v61, v61
    v_sub_f32 v61, v50, v60
    v_fmac_f32 v73, v61, v61
    v_sub_f32 v61, v51, v60
    v_fmac_f32 v73, v61, v61
    ds_swizzle_b32 v80, v65 offset:0x401F
    ds_swizzle_b32 v81, v67 offset:0x401F
    ds_swizzle_b32 v82, v69 offset:0x401F
    ds_swizzle_b32 v83, v71 offset:0x401F
    ds_swizzle_b32 v84, v73 offset:0x401F
    s_waitcnt lgkmcnt(4)
    v_add_f32 v65, v65, v80
    s_waitcnt lgkmcnt(3)
    v_add_f32 v67, v67, v81
    s_waitcnt lgkmcnt(2)
    v_add_f32 v69, v69, v82
    s_waitcnt lgkmcnt(1)
    v_add_f32 v71, v71, v83
    s_waitcnt lgkmcnt(0)
    v_add_f32 v73, v73, v84
    v_mov_b32 v80, v65
    v_mov_b32 v88, v65
    v_mov_b32 v81, v67
    v_mov_b32 v89, v67
    v_mov_b32 v82, v69
    v_mov_b32 v90, v69
    v_mov_b32 v83, v71
    v_mov_b32 v91, v71
    v_mov_b32 v84, v73
    v_mov_b32 v92, v73
    v_permlane32_swap_b32 v80, v88
    v_permlane32_swap_b32 v81, v89
    v_permlane32_swap_b32 v82, v90
    v_permlane32_swap_b32 v83, v91
    v_permlane32_swap_b32 v84, v92
    v_add_f32 v65, v80, v88
    v_add_f32 v67, v81, v89
    v_add_f32 v69, v82, v90
    v_add_f32 v71, v83, v91
    v_add_f32 v73, v84, v92
    v_lshlrev_b32 v60, 5, v239
    s_lshl_b32 s40, s36, 3
    s_add_u32 s40, s40, 98304
    v_add_u32 v60, s40, v60
    v_cmp_gt_u32 vcc, 16, v237
    s_and_saveexec_b64 s[46:47], vcc
    ds_write_b64 v60, v[64:65] offset:0
    ds_write_b64 v60, v[66:67] offset:512
    ds_write_b64 v60, v[68:69] offset:1024
    ds_write_b64 v60, v[70:71] offset:1536
    ds_write_b64 v60, v[72:73] offset:2048
    s_mov_b64 exec, s[46:47]
    s_waitcnt lgkmcnt(0)
    s_barrier
    v_lshlrev_b32 v60, 5, v0
    v_add_u32 v60, 98304, v60
    v_cmp_gt_u32 vcc, 80, v0
    s_and_saveexec_b64 s[46:47], vcc
    s_cbranch_execz oproj_kernel_end
    ds_read_b128 v[64:67], v60
    ds_read_b128 v[68:71], v60 offset:16
    s_waitcnt lgkmcnt(1)
    v_add_f32 v72, v64, v66
    s_waitcnt lgkmcnt(0)
    v_add_f32 v73, v68, v70
    v_add_f32 v72, v72, v73
    v_mul_f32 v74, 0x3c800000, v72
    v_add_f32 v73, v65, v67
    v_add_f32 v75, v69, v71
    v_add_f32 v73, v73, v75
    s_mov_b32 s40, 0x3d800000
    s_mov_b32 s41, 0x41800000
    v_fma_f32 v75, v64, s40, -v74
    v_mul_f32 v75, v75, v75
    v_fmac_f32 v73, s41, v75
    v_fma_f32 v75, v66, s40, -v74
    v_mul_f32 v75, v75, v75
    v_fmac_f32 v73, s41, v75
    v_fma_f32 v75, v68, s40, -v74
    v_mul_f32 v75, v75, v75
    v_fmac_f32 v73, s41, v75
    v_fma_f32 v75, v70, s40, -v74
    v_mul_f32 v75, v75, v75
    v_fmac_f32 v73, s41, v75
    s_mul_i32 s40, s38, 80
    v_add_u32 v60, s40, v0
    v_mul_u32_u24 v60, 80, v60
    s_lshl_b32 s40, s37, 3
    v_add_u32 v60, s40, v60
    buffer_store_dwordx2 v[72:73], v60, s[52:55], 0 offen
    s_mov_b64 exec, s[46:47]
oproj_kernel_end:
    s_endpgm
.globl glu_kernel
.p2align 8
.type glu_kernel,@function
glu_kernel:

    s_cmp_ge_u32 s2, 256
    s_cbranch_scc1 glu_kernel_end
    s_load_dwordx2 s[6:7], s[0:1], 48
    s_load_dwordx2 s[8:9], s[0:1], 56
    s_load_dwordx2 s[10:11], s[0:1], 104
    v_lshrrev_b32 v100, 6, v0
    v_and_b32 v101, 63, v0
    v_readfirstlane_b32 s36, v100
    s_and_b32 s37, s2, 7
    s_lshl_b32 s37, s37, 2
    s_lshr_b32 s38, s2, 3
    s_and_b32 s38, s38, 3
    s_add_u32 s37, s37, s38
    s_lshr_b32 s38, s2, 5
    v_lshrrev_b32 v102, 3, v101
    s_movk_i32 s39, 1152
    v_mul_lo_u32 v102, v102, s39
    s_mul_i32 s40, s36, 73728
    v_add_u32 v102, s40, v102
    v_and_b32 v103, 7, v101
    v_lshrrev_b32 v104, 4, v101
    v_xor_b32 v105, v103, v104
    v_lshl_add_u32 v1, v105, 4, v102
    v_xor_b32 v105, 4, v105
    v_lshl_add_u32 v2, v105, 4, v102
    s_mov_b32 s24, 0
    s_mov_b32 s25, 8192
    s_mov_b32 s26, 16384
    s_mov_b32 s27, 24576
    s_mov_b32 s28, 36864
    s_mov_b32 s29, 45056
    s_mov_b32 s30, 53248
    s_mov_b32 s31, 61440
    s_and_b32 s40, s36, 1
    s_mul_i32 s40, s40, 576
    s_mul_i32 s41, s37, 288
    s_mov_b32 s42, 58255
    s_movk_i32 s43, 9216
    v_add_u32 v103, 0, v101
    v_add_u32 v103, s40, v103
    v_mul_lo_u32 v105, v103, s42
    v_lshrrev_b32 v105, 20, v105
    v_mul_u32_u24 v106, 18, v105
    v_sub_u32 v106, v103, v106
    v_mul_lo_u32 v105, v105, s43
    v_lshl_add_u32 v105, v106, 4, v105
    v_add_u32 v105, s41, v105
    v_subrev_u32 v3, 0, v105
    v_add_u32 v103, 64, v101
    v_add_u32 v103, s40, v103
    v_mul_lo_u32 v105, v103, s42
    v_lshrrev_b32 v105, 20, v105
    v_mul_u32_u24 v106, 18, v105
    v_sub_u32 v106, v103, v106
    v_mul_lo_u32 v105, v105, s43
    v_lshl_add_u32 v105, v106, 4, v105
    v_add_u32 v105, s41, v105
    v_subrev_u32 v4, 1024, v105
    v_add_u32 v103, 128, v101
    v_add_u32 v103, s40, v103
    v_mul_lo_u32 v105, v103, s42
    v_lshrrev_b32 v105, 20, v105
    v_mul_u32_u24 v106, 18, v105
    v_sub_u32 v106, v103, v106
    v_mul_lo_u32 v105, v105, s43
    v_lshl_add_u32 v105, v106, 4, v105
    v_add_u32 v105, s41, v105
    v_subrev_u32 v5, 2048, v105
    v_add_u32 v103, 192, v101
    v_add_u32 v103, s40, v103
    v_mul_lo_u32 v105, v103, s42
    v_lshrrev_b32 v105, 20, v105
    v_mul_u32_u24 v106, 18, v105
    v_sub_u32 v106, v103, v106
    v_mul_lo_u32 v105, v105, s43
    v_lshl_add_u32 v105, v106, 4, v105
    v_add_u32 v105, s41, v105
    v_subrev_u32 v6, 3072, v105
    v_add_u32 v103, 256, v101
    v_add_u32 v103, s40, v103
    v_mul_lo_u32 v105, v103, s42
    v_lshrrev_b32 v105, 20, v105
    v_mul_u32_u24 v106, 18, v105
    v_sub_u32 v106, v103, v106
    v_mul_lo_u32 v105, v105, s43
    v_lshl_add_u32 v105, v106, 4, v105
    v_add_u32 v105, s41, v105
    v_subrev_u32 v7, 0, v105
    v_add_u32 v103, 320, v101
    v_add_u32 v103, s40, v103
    v_mul_lo_u32 v105, v103, s42
    v_lshrrev_b32 v105, 20, v105
    v_mul_u32_u24 v106, 18, v105
    v_sub_u32 v106, v103, v106
    v_mul_lo_u32 v105, v105, s43
    v_lshl_add_u32 v105, v106, 4, v105
    v_add_u32 v105, s41, v105
    v_subrev_u32 v8, 1024, v105
    v_add_u32 v103, 384, v101
    v_add_u32 v103, s40, v103
    v_mul_lo_u32 v105, v103, s42
    v_lshrrev_b32 v105, 20, v105
    v_mul_u32_u24 v106, 18, v105
    v_sub_u32 v106, v103, v106
    v_mul_lo_u32 v105, v105, s43
    v_lshl_add_u32 v105, v106, 4, v105
    v_add_u32 v105, s41, v105
    v_subrev_u32 v9, 2048, v105
    v_add_u32 v103, 448, v101
    v_add_u32 v103, s40, v103
    v_mul_lo_u32 v105, v103, s42
    v_lshrrev_b32 v105, 20, v105
    v_mul_u32_u24 v106, 18, v105
    v_sub_u32 v106, v103, v106
    v_mul_lo_u32 v105, v105, s43
    v_lshl_add_u32 v105, v106, 4, v105
    v_add_u32 v105, s41, v105
    v_subrev_u32 v10, 3072, v105
    v_add_u32 v103, 512, v101
    v_add_u32 v103, s40, v103
    v_mul_lo_u32 v105, v103, s42
    v_lshrrev_b32 v105, 20, v105
    v_mul_u32_u24 v106, 18, v105
    v_sub_u32 v106, v103, v106
    v_mul_lo_u32 v105, v105, s43
    v_lshl_add_u32 v105, v106, 4, v105
    v_add_u32 v105, s41, v105
    v_subrev_u32 v11, 0, v105
    v_and_b32 v103, 31, v101
    v_lshrrev_b32 v105, 5, v101
    v_lshrrev_b32 v106, 1, v103
    v_and_b32 v106, 7, v106
    v_lshlrev_b32 v107, 7, v103
    s_lshl_b32 s40, s36, 13
    v_add_u32 v107, s40, v107
    v_add_u32 v108, 0, v105
    v_xor_b32 v108, v108, v106
    v_lshl_add_u32 v108, v108, 4, v107
    v_add_u32 v12, 0, v108
    v_add_u32 v16, 69760, v108
    v_add_u32 v108, 2, v105
    v_xor_b32 v108, v108, v106
    v_lshl_add_u32 v108, v108, 4, v107
    v_add_u32 v13, 0, v108
    v_add_u32 v17, 69760, v108
    v_add_u32 v108, 4, v105
    v_xor_b32 v108, v108, v106
    v_lshl_add_u32 v108, v108, 4, v107
    v_add_u32 v14, 0, v108
    v_add_u32 v18, 69760, v108
    v_add_u32 v108, 6, v105
    v_xor_b32 v108, v108, v106
    v_lshl_add_u32 v108, v108, 4, v107
    v_add_u32 v15, 0, v108
    v_add_u32 v19, 69760, v108
    v_and_b32 v103, 15, v101
    v_lshrrev_b32 v103, 2, v103
    v_and_b32 v106, 3, v101
    v_lshrrev_b32 v107, 4, v101
    v_and_b32 v107, 1, v107
    v_lshl_add_u32 v108, v105, 3, v103
    v_mul_u32_u24 v108, 288, v108
    v_mul_u32_u24 v109, 18560, v107
    v_add_u32 v108, v108, v109
    v_lshl_add_u32 v108, v106, 3, v108
    v_add_u32 v20, 32768, v108
    v_add_u32 v21, 102528, v108
    s_waitcnt lgkmcnt(0)
    s_mul_i32 s40, s38, 294912
    s_add_u32 s40, s40, 0x3500000
    s_add_u32 s12, s10, s40
    s_addc_u32 s13, s11, 0
    s_mov_b32 s14, 0x48000
    s_mov_b32 s15, 0x00020000
    s_cmp_ge_u32 s36, 2
    s_cselect_b32 s6, s8, s6
    s_cselect_b32 s7, s9, s7
    s_mov_b32 s16, s6
    s_mov_b32 s17, s7
    s_mov_b32 s18, 0x510000
    s_mov_b32 s19, 0x00020000
    s_add_u32 s20, s10, 0x3b00000
    s_addc_u32 s21, s11, 0
    s_mov_b32 s22, 0x1200000
    s_mov_b32 s23, 0x00020000
    s_lshl_b32 s44, s36, 13
    s_and_b32 s45, s36, 1
    s_mul_i32 s45, s45, 9216
    s_lshr_b32 s46, s36, 1
    s_mul_i32 s46, s46, 18560
    s_add_u32 s45, s45, s46
    s_add_u32 s45, s45, 32768
    s_add_u32 s48, s10, 0x1b00
    s_addc_u32 s49, s11, 0
    s_mov_b32 s50, 0x1b00
    s_mov_b32 s51, 0x00020000
    s_add_u32 s52, s10, 0x2300000
    s_addc_u32 s53, s11, 0
    s_mov_b32 s54, 0x28000
    s_mov_b32 s55, 0x00020000
    s_lshl_b32 s40, s36, 11
    s_add_u32 m0, s40, 139520
    v_lshlrev_b32 v110, 4, v101
    buffer_load_dwordx4 v110, s[48:51], s40 offen lds
    buffer_load_dwordx4 v110, s[48:51], s40 offen offset:1024 lds
    v_and_b32 v110, 31, v101
    s_lshl_b32 s40, s38, 8
    s_lshl_b32 s41, s36, 6
    s_add_u32 s40, s40, s41
    v_add_u32 v110, s40, v110
    v_mul_u32_u24 v110, 80, v110
    v_lshlrev_b32 v22, 5, v105
    v_add_u32 v22, 139520, v22
    buffer_load_dwordx4 v[128:131], v110, s[52:55], 0 offen offset:0
    buffer_load_dwordx4 v[132:135], v110, s[52:55], 0 offen offset:16
    buffer_load_dwordx4 v[136:139], v110, s[52:55], 0 offen offset:32
    buffer_load_dwordx4 v[140:143], v110, s[52:55], 0 offen offset:48
    buffer_load_dwordx2 v[144:145], v110, s[52:55], 0 offen offset:64
    buffer_load_dwordx4 v[148:151], v110, s[52:55], 0 offen offset:2560
    buffer_load_dwordx4 v[152:155], v110, s[52:55], 0 offen offset:2576
    buffer_load_dwordx4 v[156:159], v110, s[52:55], 0 offen offset:2592
    buffer_load_dwordx4 v[160:163], v110, s[52:55], 0 offen offset:2608
    buffer_load_dwordx2 v[164:165], v110, s[52:55], 0 offen offset:2624
    s_add_u32 m0, s44, 0
    s_nop 0
    buffer_load_dwordx4 v1, s[12:15], s24 offen offset:0 lds
    buffer_load_dwordx4 v2, s[12:15], s25 offen offset:1024 lds
    buffer_load_dwordx4 v1, s[12:15], s26 offen offset:2048 lds
    buffer_load_dwordx4 v2, s[12:15], s27 offen offset:3072 lds
    s_add_u32 m0, s44, 4096
    s_nop 0
    buffer_load_dwordx4 v1, s[12:15], s28 offen offset:0 lds
    buffer_load_dwordx4 v2, s[12:15], s29 offen offset:1024 lds
    buffer_load_dwordx4 v1, s[12:15], s30 offen offset:2048 lds
    buffer_load_dwordx4 v2, s[12:15], s31 offen offset:3072 lds
    s_add_u32 m0, s45, 0
    s_nop 0
    buffer_load_dwordx4 v3, s[16:19], 0 offen offset:0 lds
    buffer_load_dwordx4 v4, s[16:19], 0 offen offset:1024 lds
    buffer_load_dwordx4 v5, s[16:19], 0 offen offset:2048 lds
    buffer_load_dwordx4 v6, s[16:19], 0 offen offset:3072 lds
    s_add_u32 m0, s45, 4096
    s_nop 0
    buffer_load_dwordx4 v7, s[16:19], 0 offen offset:0 lds
    buffer_load_dwordx4 v8, s[16:19], 0 offen offset:1024 lds
    buffer_load_dwordx4 v9, s[16:19], 0 offen offset:2048 lds
    buffer_load_dwordx4 v10, s[16:19], 0 offen offset:3072 lds
    s_add_u32 m0, s45, 8192
    s_nop 0
    buffer_load_dwordx4 v11, s[16:19], 0 offen offset:0 lds
    s_add_u32 s12, s12, 128
    s_addc_u32 s13, s13, 0
    s_sub_u32 s14, s14, 128
    s_add_u32 s16, s16, 589824
    s_addc_u32 s17, s17, 0
    s_sub_u32 s18, s18, 589824
    s_add_u32 m0, s44, 69760
    s_nop 0
    buffer_load_dwordx4 v1, s[12:15], s24 offen offset:0 lds
    buffer_load_dwordx4 v2, s[12:15], s25 offen offset:1024 lds
    buffer_load_dwordx4 v1, s[12:15], s26 offen offset:2048 lds
    buffer_load_dwordx4 v2, s[12:15], s27 offen offset:3072 lds
    s_add_u32 m0, s44, 73856
    s_nop 0
    buffer_load_dwordx4 v1, s[12:15], s28 offen offset:0 lds
    buffer_load_dwordx4 v2, s[12:15], s29 offen offset:1024 lds
    buffer_load_dwordx4 v1, s[12:15], s30 offen offset:2048 lds
    buffer_load_dwordx4 v2, s[12:15], s31 offen offset:3072 lds
    s_add_u32 m0, s45, 69760
    s_nop 0
    buffer_load_dwordx4 v3, s[16:19], 0 offen offset:0 lds
    buffer_load_dwordx4 v4, s[16:19], 0 offen offset:1024 lds
    buffer_load_dwordx4 v5, s[16:19], 0 offen offset:2048 lds
    buffer_load_dwordx4 v6, s[16:19], 0 offen offset:3072 lds
    s_add_u32 m0, s45, 73856
    s_nop 0
    buffer_load_dwordx4 v7, s[16:19], 0 offen offset:0 lds
    buffer_load_dwordx4 v8, s[16:19], 0 offen offset:1024 lds
    buffer_load_dwordx4 v9, s[16:19], 0 offen offset:2048 lds
    buffer_load_dwordx4 v10, s[16:19], 0 offen offset:3072 lds
    s_add_u32 m0, s45, 77952
    s_nop 0
    buffer_load_dwordx4 v11, s[16:19], 0 offen offset:0 lds
    s_add_u32 s12, s12, 128
    s_addc_u32 s13, s13, 0
    s_sub_u32 s14, s14, 128
    s_add_u32 s16, s16, 589824
    s_addc_u32 s17, s17, 0
    s_sub_u32 s18, s18, 589824
    s_waitcnt vmcnt(34)
    s_mov_b32 s40, 0x3ae38e39
    s_mov_b32 s41, 0x3c800000
    s_mov_b32 s42, 0x42800000
    v_add_f32 v170, v128, v130
    v_add_f32 v170, v170, v132
    v_add_f32 v170, v170, v134
    v_add_f32 v170, v170, v136
    v_add_f32 v170, v170, v138
    v_add_f32 v170, v170, v140
    v_add_f32 v170, v170, v142
    v_add_f32 v170, v170, v144
    v_mul_f32 v170, s40, v170
    v_add_f32 v171, v129, v131
    v_add_f32 v171, v171, v133
    v_add_f32 v171, v171, v135
    v_add_f32 v171, v171, v137
    v_add_f32 v171, v171, v139
    v_add_f32 v171, v171, v141
    v_add_f32 v171, v171, v143
    v_add_f32 v171, v171, v145
    v_fma_f32 v172, v128, s41, -v170
    v_mul_f32 v172, v172, v172
    v_fmac_f32 v171, s42, v172
    v_fma_f32 v172, v130, s41, -v170
    v_mul_f32 v172, v172, v172
    v_fmac_f32 v171, s42, v172
    v_fma_f32 v172, v132, s41, -v170
    v_mul_f32 v172, v172, v172
    v_fmac_f32 v171, s42, v172
    v_fma_f32 v172, v134, s41, -v170
    v_mul_f32 v172, v172, v172
    v_fmac_f32 v171, s42, v172
    v_fma_f32 v172, v136, s41, -v170
    v_mul_f32 v172, v172, v172
    v_fmac_f32 v171, s42, v172
    v_fma_f32 v172, v138, s41, -v170
    v_mul_f32 v172, v172, v172
    v_fmac_f32 v171, s42, v172
    v_fma_f32 v172, v140, s41, -v170
    v_mul_f32 v172, v172, v172
    v_fmac_f32 v171, s42, v172
    v_fma_f32 v172, v142, s41, -v170
    v_mul_f32 v172, v172, v172
    v_fmac_f32 v171, s42, v172
    v_fma_f32 v172, v144, s41, -v170
    v_mul_f32 v172, v172, v172
    v_fmac_f32 v171, s42, v172
    v_mul_f32 v171, s40, v171
    v_cvt_pk_bf16_f32 v171, v171, v171
    v_lshlrev_b32 v171, 16, v171
    v_add_f32 v171, 0x3727c5ac, v171
    v_cvt_pk_bf16_f32 v171, v171, v171
    v_lshlrev_b32 v171, 16, v171
    v_sqrt_f32 v171, v171
    s_nop 0
    v_cvt_pk_bf16_f32 v171, v171, v171
    v_lshlrev_b32 v171, 16, v171
    v_rcp_f32 v84, v171
    v_cvt_pk_bf16_f32 v170, v170, v170
    v_lshlrev_b32 v170, 16, v170
    v_mul_f32 v85, v170, v84
    v_sub_f32 v85, 0, v85
    v_mov_b32 v88, v84
    v_mov_b32 v90, v85
    v_mov_b32 v89, v84
    v_mov_b32 v91, v85
    v_add_f32 v170, v148, v150
    v_add_f32 v170, v170, v152
    v_add_f32 v170, v170, v154
    v_add_f32 v170, v170, v156
    v_add_f32 v170, v170, v158
    v_add_f32 v170, v170, v160
    v_add_f32 v170, v170, v162
    v_add_f32 v170, v170, v164
    v_mul_f32 v170, s40, v170
    v_add_f32 v171, v149, v151
    v_add_f32 v171, v171, v153
    v_add_f32 v171, v171, v155
    v_add_f32 v171, v171, v157
    v_add_f32 v171, v171, v159
    v_add_f32 v171, v171, v161
    v_add_f32 v171, v171, v163
    v_add_f32 v171, v171, v165
    v_fma_f32 v172, v148, s41, -v170
    v_mul_f32 v172, v172, v172
    v_fmac_f32 v171, s42, v172
    v_fma_f32 v172, v150, s41, -v170
    v_mul_f32 v172, v172, v172
    v_fmac_f32 v171, s42, v172
    v_fma_f32 v172, v152, s41, -v170
    v_mul_f32 v172, v172, v172
    v_fmac_f32 v171, s42, v172
    v_fma_f32 v172, v154, s41, -v170
    v_mul_f32 v172, v172, v172
    v_fmac_f32 v171, s42, v172
    v_fma_f32 v172, v156, s41, -v170
    v_mul_f32 v172, v172, v172
    v_fmac_f32 v171, s42, v172
    v_fma_f32 v172, v158, s41, -v170
    v_mul_f32 v172, v172, v172
    v_fmac_f32 v171, s42, v172
    v_fma_f32 v172, v160, s41, -v170
    v_mul_f32 v172, v172, v172
    v_fmac_f32 v171, s42, v172
    v_fma_f32 v172, v162, s41, -v170
    v_mul_f32 v172, v172, v172
    v_fmac_f32 v171, s42, v172
    v_fma_f32 v172, v164, s41, -v170
    v_mul_f32 v172, v172, v172
    v_fmac_f32 v171, s42, v172
    v_mul_f32 v171, s40, v171
    v_cvt_pk_bf16_f32 v171, v171, v171
    v_lshlrev_b32 v171, 16, v171
    v_add_f32 v171, 0x3727c5ac, v171
    v_cvt_pk_bf16_f32 v171, v171, v171
    v_lshlrev_b32 v171, 16, v171
    v_sqrt_f32 v171, v171
    s_nop 0
    v_cvt_pk_bf16_f32 v171, v171, v171
    v_lshlrev_b32 v171, 16, v171
    v_rcp_f32 v86, v171
    v_cvt_pk_bf16_f32 v170, v170, v170
    v_lshlrev_b32 v170, 16, v170
    v_mul_f32 v87, v170, v86
    v_sub_f32 v87, 0, v87
    v_mov_b32 v92, v86
    v_mov_b32 v94, v87
    v_mov_b32 v93, v86
    v_mov_b32 v95, v87
    s_waitcnt vmcnt(17)
    s_barrier
    ds_read_b128 v[32:35], v12 offset:0
    ds_read_b128 v[36:39], v12 offset:4096
    ds_read_b128 v[48:51], v22 offset:0
    ds_read_b128 v[52:55], v22 offset:16
    ds_read_b128 v[56:59], v22 offset:2304
    ds_read_b128 v[60:63], v22 offset:2320
    ds_read_b64_tr_b16 a[128:129], v20 offset:0
    ds_read_b64_tr_b16 a[130:131], v20 offset:1152
    ds_read_b64_tr_b16 a[132:133], v20 offset:32
    ds_read_b64_tr_b16 a[134:135], v20 offset:1184
    ds_read_b64_tr_b16 a[136:137], v20 offset:64
    ds_read_b64_tr_b16 a[138:139], v20 offset:1216
    ds_read_b64_tr_b16 a[140:141], v20 offset:96
    ds_read_b64_tr_b16 a[142:143], v20 offset:1248
    ds_read_b64_tr_b16 a[144:145], v20 offset:128
    ds_read_b64_tr_b16 a[146:147], v20 offset:1280
    ds_read_b64_tr_b16 a[148:149], v20 offset:160
    ds_read_b64_tr_b16 a[150:151], v20 offset:1312
    ds_read_b64_tr_b16 a[152:153], v20 offset:192
    ds_read_b64_tr_b16 a[154:155], v20 offset:1344
    ds_read_b64_tr_b16 a[156:157], v20 offset:224
    ds_read_b64_tr_b16 a[158:159], v20 offset:1376
    ds_read_b64_tr_b16 a[160:161], v20 offset:256
    ds_read_b64_tr_b16 a[162:163], v20 offset:1408
    s_waitcnt lgkmcnt(15)
    v_lshlrev_b32 v80, 16, v32
    v_and_b32 v81, 0xffff0000, v32
    v_fma_f32 v80, v80, v84, v85
    v_fma_f32 v81, v81, v84, v85
    v_fma_f32 v80, v80, v56, v48
    v_fma_f32 v81, v81, v57, v49
    v_cvt_pk_bf16_f32 v32, v80, v81
    v_lshlrev_b32 v82, 16, v33
    v_and_b32 v83, 0xffff0000, v33
    v_fma_f32 v82, v82, v84, v85
    v_fma_f32 v83, v83, v84, v85
    v_fma_f32 v82, v82, v58, v50
    v_fma_f32 v83, v83, v59, v51
    v_cvt_pk_bf16_f32 v33, v82, v83
    v_lshlrev_b32 v80, 16, v34
    v_and_b32 v81, 0xffff0000, v34
    v_fma_f32 v80, v80, v84, v85
    v_fma_f32 v81, v81, v84, v85
    v_fma_f32 v80, v80, v60, v52
    v_fma_f32 v81, v81, v61, v53
    v_cvt_pk_bf16_f32 v34, v80, v81
    v_lshlrev_b32 v82, 16, v35
    v_and_b32 v83, 0xffff0000, v35
    v_fma_f32 v82, v82, v84, v85
    v_fma_f32 v83, v83, v84, v85
    v_fma_f32 v82, v82, v62, v54
    v_fma_f32 v83, v83, v63, v55
    v_cvt_pk_bf16_f32 v35, v82, v83
    v_lshlrev_b32 v80, 16, v36
    v_and_b32 v81, 0xffff0000, v36
    v_fma_f32 v80, v80, v86, v87
    v_fma_f32 v81, v81, v86, v87
    v_fma_f32 v80, v80, v56, v48
    v_fma_f32 v81, v81, v57, v49
    v_cvt_pk_bf16_f32 v36, v80, v81
    v_lshlrev_b32 v82, 16, v37
    v_and_b32 v83, 0xffff0000, v37
    v_fma_f32 v82, v82, v86, v87
    v_fma_f32 v83, v83, v86, v87
    v_fma_f32 v82, v82, v58, v50
    v_fma_f32 v83, v83, v59, v51
    v_cvt_pk_bf16_f32 v37, v82, v83
    v_lshlrev_b32 v80, 16, v38
    v_and_b32 v81, 0xffff0000, v38
    v_fma_f32 v80, v80, v86, v87
    v_fma_f32 v81, v81, v86, v87
    v_fma_f32 v80, v80, v60, v52
    v_fma_f32 v81, v81, v61, v53
    v_cvt_pk_bf16_f32 v38, v80, v81
    v_lshlrev_b32 v82, 16, v39
    v_and_b32 v83, 0xffff0000, v39
    v_fma_f32 v82, v82, v86, v87
    v_fma_f32 v83, v83, v86, v87
    v_fma_f32 v82, v82, v62, v54
    v_fma_f32 v83, v83, v63, v55
    v_cvt_pk_bf16_f32 v39, v82, v83
    v_mfma_f32_32x32x16_bf16 v[96:111], a[128:131], v[32:35], 0
    ds_read_b128 v[40:43], v13 offset:0
    ds_read_b128 v[44:47], v13 offset:4096
    ds_read_b128 v[64:67], v22 offset:64
    ds_read_b128 v[68:71], v22 offset:80
    ds_read_b128 v[72:75], v22 offset:2368
    v_mfma_f32_32x32x16_bf16 v[112:127], a[128:131], v[36:39], 0
    ds_read_b128 v[76:79], v22 offset:2384
    ds_read_b64_tr_b16 a[164:165], v20 offset:4608
    ds_read_b64_tr_b16 a[166:167], v20 offset:5760
    ds_read_b64_tr_b16 a[168:169], v20 offset:4640
    s_waitcnt lgkmcnt(15)
    v_mfma_f32_32x32x16_bf16 v[128:143], a[132:135], v[32:35], 0
    ds_read_b64_tr_b16 a[170:171], v20 offset:5792
    ds_read_b64_tr_b16 a[172:173], v20 offset:4672
    ds_read_b64_tr_b16 a[174:175], v20 offset:5824
    ds_read_b64_tr_b16 a[176:177], v20 offset:4704
    s_waitcnt lgkmcnt(12)
    v_lshlrev_b32 v80, 16, v40
    v_mfma_f32_32x32x16_bf16 v[144:159], a[132:135], v[36:39], 0
    v_and_b32 v81, 0xffff0000, v40
    v_fma_f32 v80, v80, v84, v85
    v_fma_f32 v81, v81, v84, v85
    s_waitcnt lgkmcnt(8)
    v_fma_f32 v80, v80, v72, v64
    v_mfma_f32_32x32x16_bf16 v[160:175], a[136:139], v[32:35], 0
    ds_read_b64_tr_b16 a[178:179], v20 offset:5856
    v_fma_f32 v81, v81, v73, v65
    v_cvt_pk_bf16_f32 v40, v80, v81
    v_lshlrev_b32 v82, 16, v41
    v_and_b32 v83, 0xffff0000, v41
    v_mfma_f32_32x32x16_bf16 v[176:191], a[136:139], v[36:39], 0
    v_fma_f32 v82, v82, v84, v85
    ds_read_b64_tr_b16 a[180:181], v20 offset:4736
    v_fma_f32 v83, v83, v84, v85
    v_fma_f32 v82, v82, v74, v66
    v_mfma_f32_32x32x16_bf16 v[192:207], a[140:143], v[32:35], 0
    v_fma_f32 v83, v83, v75, v67
    v_cvt_pk_bf16_f32 v41, v82, v83
    ds_read_b64_tr_b16 a[182:183], v20 offset:5888
    v_lshlrev_b32 v80, 16, v42
    v_and_b32 v81, 0xffff0000, v42
    v_mfma_f32_32x32x16_bf16 v[208:223], a[140:143], v[36:39], 0
    v_fma_f32 v80, v80, v84, v85
    v_fma_f32 v81, v81, v84, v85
    s_waitcnt lgkmcnt(10)
    v_fma_f32 v80, v80, v76, v68
    ds_read_b64_tr_b16 a[184:185], v20 offset:4768
    v_mfma_f32_32x32x16_bf16 v[224:239], a[144:147], v[32:35], 0
    v_fma_f32 v81, v81, v77, v69
    v_cvt_pk_bf16_f32 v42, v80, v81
    v_lshlrev_b32 v82, 16, v43
    v_and_b32 v83, 0xffff0000, v43
    v_mfma_f32_32x32x16_bf16 v[240:255], a[144:147], v[36:39], 0
    v_fma_f32 v82, v82, v84, v85
    ds_read_b64_tr_b16 a[186:187], v20 offset:5920
    v_fma_f32 v83, v83, v84, v85
    v_fma_f32 v82, v82, v78, v70
    v_fma_f32 v83, v83, v79, v71
    v_mfma_f32_32x32x16_bf16 a[0:15], a[148:151], v[32:35], 0
    v_cvt_pk_bf16_f32 v43, v82, v83
    ds_read_b64_tr_b16 a[188:189], v20 offset:4800
    v_lshlrev_b32 v80, 16, v44
    v_and_b32 v81, 0xffff0000, v44
    v_mfma_f32_32x32x16_bf16 a[16:31], a[148:151], v[36:39], 0
    v_fma_f32 v80, v80, v86, v87
    v_fma_f32 v81, v81, v86, v87
    v_fma_f32 v80, v80, v72, v64
    ds_read_b64_tr_b16 a[190:191], v20 offset:5952
    v_fma_f32 v81, v81, v73, v65
    v_mfma_f32_32x32x16_bf16 a[32:47], a[152:155], v[32:35], 0
    v_cvt_pk_bf16_f32 v44, v80, v81
    v_lshlrev_b32 v82, 16, v45
    v_and_b32 v83, 0xffff0000, v45
    v_fma_f32 v82, v82, v86, v87
    v_mfma_f32_32x32x16_bf16 a[48:63], a[152:155], v[36:39], 0
    ds_read_b64_tr_b16 a[192:193], v20 offset:4832
    v_fma_f32 v83, v83, v86, v87
    v_fma_f32 v82, v82, v74, v66
    v_fma_f32 v83, v83, v75, v67
    v_cvt_pk_bf16_f32 v45, v82, v83
    v_mfma_f32_32x32x16_bf16 a[64:79], a[156:159], v[32:35], 0
    ds_read_b64_tr_b16 a[194:195], v20 offset:5984
    v_lshlrev_b32 v80, 16, v46
    v_and_b32 v81, 0xffff0000, v46
    v_fma_f32 v80, v80, v86, v87
    v_mfma_f32_32x32x16_bf16 a[80:95], a[156:159], v[36:39], 0
    v_fma_f32 v81, v81, v86, v87
    v_fma_f32 v80, v80, v76, v68
    ds_read_b64_tr_b16 a[196:197], v20 offset:4864
    v_fma_f32 v81, v81, v77, v69
    v_cvt_pk_bf16_f32 v46, v80, v81
    v_mfma_f32_32x32x16_bf16 a[96:111], a[160:163], v[32:35], 0
    v_lshlrev_b32 v82, 16, v47
    v_and_b32 v83, 0xffff0000, v47
    v_fma_f32 v82, v82, v86, v87
    ds_read_b64_tr_b16 a[198:199], v20 offset:6016
    v_mfma_f32_32x32x16_bf16 a[112:127], a[160:163], v[36:39], 0
    v_fma_f32 v83, v83, v86, v87
    v_fma_f32 v82, v82, v78, v70
    v_fma_f32 v83, v83, v79, v71
    v_cvt_pk_bf16_f32 v47, v82, v83
    s_waitcnt lgkmcnt(15)
    v_mfma_f32_32x32x16_bf16 v[96:111], a[164:167], v[40:43], v[96:111]
    ds_read_b128 v[32:35], v14 offset:0
    ds_read_b128 v[36:39], v14 offset:4096
    ds_read_b128 v[48:51], v22 offset:128
    ds_read_b128 v[52:55], v22 offset:144
    ds_read_b128 v[56:59], v22 offset:2432
    v_mfma_f32_32x32x16_bf16 v[112:127], a[164:167], v[44:47], v[112:127]
    ds_read_b128 v[60:63], v22 offset:2448
    ds_read_b64_tr_b16 a[128:129], v20 offset:9216
    ds_read_b64_tr_b16 a[130:131], v20 offset:10368
    ds_read_b64_tr_b16 a[132:133], v20 offset:9248
    s_waitcnt lgkmcnt(15)
    v_mfma_f32_32x32x16_bf16 v[128:143], a[168:171], v[40:43], v[128:143]
    ds_read_b64_tr_b16 a[134:135], v20 offset:10400
    ds_read_b64_tr_b16 a[136:137], v20 offset:9280
    ds_read_b64_tr_b16 a[138:139], v20 offset:10432
    ds_read_b64_tr_b16 a[140:141], v20 offset:9312
    s_waitcnt lgkmcnt(12)
    v_lshlrev_b32 v80, 16, v32
    v_mfma_f32_32x32x16_bf16 v[144:159], a[168:171], v[44:47], v[144:159]
    v_and_b32 v81, 0xffff0000, v32
    v_fma_f32 v80, v80, v84, v85
    v_fma_f32 v81, v81, v84, v85
    s_waitcnt lgkmcnt(8)
    v_fma_f32 v80, v80, v56, v48
    v_mfma_f32_32x32x16_bf16 v[160:175], a[172:175], v[40:43], v[160:175]
    ds_read_b64_tr_b16 a[142:143], v20 offset:10464
    v_fma_f32 v81, v81, v57, v49
    v_cvt_pk_bf16_f32 v32, v80, v81
    v_lshlrev_b32 v82, 16, v33
    v_and_b32 v83, 0xffff0000, v33
    v_mfma_f32_32x32x16_bf16 v[176:191], a[172:175], v[44:47], v[176:191]
    v_fma_f32 v82, v82, v84, v85
    ds_read_b64_tr_b16 a[144:145], v20 offset:9344
    v_fma_f32 v83, v83, v84, v85
    v_fma_f32 v82, v82, v58, v50
    v_mfma_f32_32x32x16_bf16 v[192:207], a[176:179], v[40:43], v[192:207]
    v_fma_f32 v83, v83, v59, v51
    v_cvt_pk_bf16_f32 v33, v82, v83
    ds_read_b64_tr_b16 a[146:147], v20 offset:10496
    v_lshlrev_b32 v80, 16, v34
    v_and_b32 v81, 0xffff0000, v34
    v_mfma_f32_32x32x16_bf16 v[208:223], a[176:179], v[44:47], v[208:223]
    v_fma_f32 v80, v80, v84, v85
    v_fma_f32 v81, v81, v84, v85
    s_waitcnt lgkmcnt(10)
    v_fma_f32 v80, v80, v60, v52
    ds_read_b64_tr_b16 a[148:149], v20 offset:9376
    v_mfma_f32_32x32x16_bf16 v[224:239], a[180:183], v[40:43], v[224:239]
    v_fma_f32 v81, v81, v61, v53
    v_cvt_pk_bf16_f32 v34, v80, v81
    v_lshlrev_b32 v82, 16, v35
    v_and_b32 v83, 0xffff0000, v35
    v_mfma_f32_32x32x16_bf16 v[240:255], a[180:183], v[44:47], v[240:255]
    v_fma_f32 v82, v82, v84, v85
    ds_read_b64_tr_b16 a[150:151], v20 offset:10528
    v_fma_f32 v83, v83, v84, v85
    v_fma_f32 v82, v82, v62, v54
    v_fma_f32 v83, v83, v63, v55
    v_mfma_f32_32x32x16_bf16 a[0:15], a[184:187], v[40:43], a[0:15]
    v_cvt_pk_bf16_f32 v35, v82, v83
    ds_read_b64_tr_b16 a[152:153], v20 offset:9408
    v_lshlrev_b32 v80, 16, v36
    v_and_b32 v81, 0xffff0000, v36
    v_mfma_f32_32x32x16_bf16 a[16:31], a[184:187], v[44:47], a[16:31]
    v_fma_f32 v80, v80, v86, v87
    v_fma_f32 v81, v81, v86, v87
    v_fma_f32 v80, v80, v56, v48
    ds_read_b64_tr_b16 a[154:155], v20 offset:10560
    v_fma_f32 v81, v81, v57, v49
    v_mfma_f32_32x32x16_bf16 a[32:47], a[188:191], v[40:43], a[32:47]
    v_cvt_pk_bf16_f32 v36, v80, v81
    v_lshlrev_b32 v82, 16, v37
    v_and_b32 v83, 0xffff0000, v37
    v_fma_f32 v82, v82, v86, v87
    v_mfma_f32_32x32x16_bf16 a[48:63], a[188:191], v[44:47], a[48:63]
    ds_read_b64_tr_b16 a[156:157], v20 offset:9440
    v_fma_f32 v83, v83, v86, v87
    v_fma_f32 v82, v82, v58, v50
    v_fma_f32 v83, v83, v59, v51
    v_cvt_pk_bf16_f32 v37, v82, v83
    v_mfma_f32_32x32x16_bf16 a[64:79], a[192:195], v[40:43], a[64:79]
    ds_read_b64_tr_b16 a[158:159], v20 offset:10592
    v_lshlrev_b32 v80, 16, v38
    v_and_b32 v81, 0xffff0000, v38
    v_fma_f32 v80, v80, v86, v87
    v_mfma_f32_32x32x16_bf16 a[80:95], a[192:195], v[44:47], a[80:95]
    v_fma_f32 v81, v81, v86, v87
    v_fma_f32 v80, v80, v60, v52
    ds_read_b64_tr_b16 a[160:161], v20 offset:9472
    v_fma_f32 v81, v81, v61, v53
    v_cvt_pk_bf16_f32 v38, v80, v81
    v_mfma_f32_32x32x16_bf16 a[96:111], a[196:199], v[40:43], a[96:111]
    v_lshlrev_b32 v82, 16, v39
    v_and_b32 v83, 0xffff0000, v39
    v_fma_f32 v82, v82, v86, v87
    ds_read_b64_tr_b16 a[162:163], v20 offset:10624
    v_mfma_f32_32x32x16_bf16 a[112:127], a[196:199], v[44:47], a[112:127]
    v_fma_f32 v83, v83, v86, v87
    v_fma_f32 v82, v82, v62, v54
    v_fma_f32 v83, v83, v63, v55
    v_cvt_pk_bf16_f32 v39, v82, v83
    s_waitcnt lgkmcnt(15)
    v_mfma_f32_32x32x16_bf16 v[96:111], a[128:131], v[32:35], v[96:111]
    ds_read_b128 v[40:43], v15 offset:0
    ds_read_b128 v[44:47], v15 offset:4096
    ds_read_b128 v[64:67], v22 offset:192
    ds_read_b128 v[68:71], v22 offset:208
    ds_read_b128 v[72:75], v22 offset:2496
    v_mfma_f32_32x32x16_bf16 v[112:127], a[128:131], v[36:39], v[112:127]
    ds_read_b128 v[76:79], v22 offset:2512
    ds_read_b64_tr_b16 a[164:165], v20 offset:13824
    ds_read_b64_tr_b16 a[166:167], v20 offset:14976
    ds_read_b64_tr_b16 a[168:169], v20 offset:13856
    s_waitcnt lgkmcnt(15)
    v_mfma_f32_32x32x16_bf16 v[128:143], a[132:135], v[32:35], v[128:143]
    ds_read_b64_tr_b16 a[170:171], v20 offset:15008
    ds_read_b64_tr_b16 a[172:173], v20 offset:13888
    ds_read_b64_tr_b16 a[174:175], v20 offset:15040
    ds_read_b64_tr_b16 a[176:177], v20 offset:13920
    s_waitcnt lgkmcnt(12)
    v_lshlrev_b32 v80, 16, v40
    v_mfma_f32_32x32x16_bf16 v[144:159], a[132:135], v[36:39], v[144:159]
    v_and_b32 v81, 0xffff0000, v40
    v_fma_f32 v80, v80, v84, v85
    v_fma_f32 v81, v81, v84, v85
    s_waitcnt lgkmcnt(8)
    v_fma_f32 v80, v80, v72, v64
    v_mfma_f32_32x32x16_bf16 v[160:175], a[136:139], v[32:35], v[160:175]
    ds_read_b64_tr_b16 a[178:179], v20 offset:15072
    v_fma_f32 v81, v81, v73, v65
    v_cvt_pk_bf16_f32 v40, v80, v81
    v_lshlrev_b32 v82, 16, v41
    v_and_b32 v83, 0xffff0000, v41
    v_mfma_f32_32x32x16_bf16 v[176:191], a[136:139], v[36:39], v[176:191]
    v_fma_f32 v82, v82, v84, v85
    ds_read_b64_tr_b16 a[180:181], v20 offset:13952
    v_fma_f32 v83, v83, v84, v85
    v_fma_f32 v82, v82, v74, v66
    v_mfma_f32_32x32x16_bf16 v[192:207], a[140:143], v[32:35], v[192:207]
    v_fma_f32 v83, v83, v75, v67
    v_cvt_pk_bf16_f32 v41, v82, v83
    ds_read_b64_tr_b16 a[182:183], v20 offset:15104
    v_lshlrev_b32 v80, 16, v42
    v_and_b32 v81, 0xffff0000, v42
    v_mfma_f32_32x32x16_bf16 v[208:223], a[140:143], v[36:39], v[208:223]
    v_fma_f32 v80, v80, v84, v85
    v_fma_f32 v81, v81, v84, v85
    s_waitcnt lgkmcnt(10)
    v_fma_f32 v80, v80, v76, v68
    ds_read_b64_tr_b16 a[184:185], v20 offset:13984
    v_mfma_f32_32x32x16_bf16 v[224:239], a[144:147], v[32:35], v[224:239]
    v_fma_f32 v81, v81, v77, v69
    v_cvt_pk_bf16_f32 v42, v80, v81
    v_lshlrev_b32 v82, 16, v43
    v_and_b32 v83, 0xffff0000, v43
    v_mfma_f32_32x32x16_bf16 v[240:255], a[144:147], v[36:39], v[240:255]
    v_fma_f32 v82, v82, v84, v85
    ds_read_b64_tr_b16 a[186:187], v20 offset:15136
    v_fma_f32 v83, v83, v84, v85
    v_fma_f32 v82, v82, v78, v70
    v_fma_f32 v83, v83, v79, v71
    v_mfma_f32_32x32x16_bf16 a[0:15], a[148:151], v[32:35], a[0:15]
    v_cvt_pk_bf16_f32 v43, v82, v83
    ds_read_b64_tr_b16 a[188:189], v20 offset:14016
    v_lshlrev_b32 v80, 16, v44
    v_and_b32 v81, 0xffff0000, v44
    v_mfma_f32_32x32x16_bf16 a[16:31], a[148:151], v[36:39], a[16:31]
    v_fma_f32 v80, v80, v86, v87
    v_fma_f32 v81, v81, v86, v87
    v_fma_f32 v80, v80, v72, v64
    ds_read_b64_tr_b16 a[190:191], v20 offset:15168
    v_fma_f32 v81, v81, v73, v65
    v_mfma_f32_32x32x16_bf16 a[32:47], a[152:155], v[32:35], a[32:47]
    v_cvt_pk_bf16_f32 v44, v80, v81
    v_lshlrev_b32 v82, 16, v45
    v_and_b32 v83, 0xffff0000, v45
    v_fma_f32 v82, v82, v86, v87
    v_mfma_f32_32x32x16_bf16 a[48:63], a[152:155], v[36:39], a[48:63]
    ds_read_b64_tr_b16 a[192:193], v20 offset:14048
    v_fma_f32 v83, v83, v86, v87
    v_fma_f32 v82, v82, v74, v66
    v_fma_f32 v83, v83, v75, v67
    v_cvt_pk_bf16_f32 v45, v82, v83
    v_mfma_f32_32x32x16_bf16 a[64:79], a[156:159], v[32:35], a[64:79]
    ds_read_b64_tr_b16 a[194:195], v20 offset:15200
    v_lshlrev_b32 v80, 16, v46
    v_and_b32 v81, 0xffff0000, v46
    v_fma_f32 v80, v80, v86, v87
    v_mfma_f32_32x32x16_bf16 a[80:95], a[156:159], v[36:39], a[80:95]
    v_fma_f32 v81, v81, v86, v87
    v_fma_f32 v80, v80, v76, v68
    ds_read_b64_tr_b16 a[196:197], v20 offset:14080
    v_fma_f32 v81, v81, v77, v69
    v_cvt_pk_bf16_f32 v46, v80, v81
    v_mfma_f32_32x32x16_bf16 a[96:111], a[160:163], v[32:35], a[96:111]
    v_lshlrev_b32 v82, 16, v47
    v_and_b32 v83, 0xffff0000, v47
    v_fma_f32 v82, v82, v86, v87
    ds_read_b64_tr_b16 a[198:199], v20 offset:15232
    v_mfma_f32_32x32x16_bf16 a[112:127], a[160:163], v[36:39], a[112:127]
    v_fma_f32 v83, v83, v86, v87
    v_fma_f32 v82, v82, v78, v70
    v_fma_f32 v83, v83, v79, v71
    v_cvt_pk_bf16_f32 v47, v82, v83
    s_waitcnt lgkmcnt(0)
    v_mfma_f32_32x32x16_bf16 v[96:111], a[164:167], v[40:43], v[96:111]
    v_mfma_f32_32x32x16_bf16 v[112:127], a[164:167], v[44:47], v[112:127]
    s_waitcnt vmcnt(0)
    s_barrier
    v_mfma_f32_32x32x16_bf16 v[128:143], a[168:171], v[40:43], v[128:143]
    ds_read_b128 v[32:35], v16 offset:0
    ds_read_b128 v[36:39], v16 offset:4096
    ds_read_b128 v[48:51], v22 offset:256
    ds_read_b128 v[52:55], v22 offset:272
    s_add_u32 m0, s44, 0
    ds_read_b128 v[56:59], v22 offset:2560
    v_mfma_f32_32x32x16_bf16 v[144:159], a[168:171], v[44:47], v[144:159]
    ds_read_b128 v[60:63], v22 offset:2576
    buffer_load_dwordx4 v1, s[12:15], s24 offen offset:0 lds
    ds_read_b64_tr_b16 a[128:129], v21 offset:0
    ds_read_b64_tr_b16 a[130:131], v21 offset:1152
    buffer_load_dwordx4 v2, s[12:15], s25 offen offset:1024 lds
    ds_read_b64_tr_b16 a[132:133], v21 offset:32
    v_mfma_f32_32x32x16_bf16 v[160:175], a[172:175], v[40:43], v[160:175]
    ds_read_b64_tr_b16 a[134:135], v21 offset:1184
    s_waitcnt lgkmcnt(9)
    v_lshlrev_b32 v80, 16, v32
    v_and_b32 v81, 0xffff0000, v32
    v_fma_f32 v80, v80, v84, v85
    buffer_load_dwordx4 v1, s[12:15], s26 offen offset:2048 lds
    v_mfma_f32_32x32x16_bf16 v[176:191], a[172:175], v[44:47], v[176:191]
    v_fma_f32 v81, v81, v84, v85
    s_waitcnt lgkmcnt(5)
    v_fma_f32 v80, v80, v56, v48
    v_fma_f32 v81, v81, v57, v49
    ds_read_b64_tr_b16 a[136:137], v21 offset:64
    v_cvt_pk_bf16_f32 v32, v80, v81
    v_lshlrev_b32 v82, 16, v33
    v_mfma_f32_32x32x16_bf16 v[192:207], a[176:179], v[40:43], v[192:207]
    ds_read_b64_tr_b16 a[138:139], v21 offset:1216
    v_and_b32 v83, 0xffff0000, v33
    v_fma_f32 v82, v82, v84, v85
    v_fma_f32 v83, v83, v84, v85
    buffer_load_dwordx4 v2, s[12:15], s27 offen offset:3072 lds
    v_fma_f32 v82, v82, v58, v50
    v_mfma_f32_32x32x16_bf16 v[208:223], a[176:179], v[44:47], v[208:223]
    v_fma_f32 v83, v83, v59, v51
    ds_read_b64_tr_b16 a[140:141], v21 offset:96
    v_cvt_pk_bf16_f32 v33, v82, v83
    v_lshlrev_b32 v80, 16, v34
    v_and_b32 v81, 0xffff0000, v34
    v_mfma_f32_32x32x16_bf16 v[224:239], a[180:183], v[40:43], v[224:239]
    ds_read_b64_tr_b16 a[142:143], v21 offset:1248
    v_fma_f32 v80, v80, v84, v85
    v_fma_f32 v81, v81, v84, v85
    s_add_u32 m0, s44, 4096
    s_waitcnt lgkmcnt(8)
    v_fma_f32 v80, v80, v60, v52
    v_fma_f32 v81, v81, v61, v53
    v_mfma_f32_32x32x16_bf16 v[240:255], a[180:183], v[44:47], v[240:255]
    v_cvt_pk_bf16_f32 v34, v80, v81
    ds_read_b64_tr_b16 a[144:145], v21 offset:128
    v_lshlrev_b32 v82, 16, v35
    v_and_b32 v83, 0xffff0000, v35
    ds_read_b64_tr_b16 a[146:147], v21 offset:1280
    v_mfma_f32_32x32x16_bf16 a[0:15], a[184:187], v[40:43], a[0:15]
    v_fma_f32 v82, v82, v84, v85
    v_fma_f32 v83, v83, v84, v85
    v_fma_f32 v82, v82, v62, v54
    buffer_load_dwordx4 v1, s[12:15], s28 offen offset:0 lds
    v_fma_f32 v83, v83, v63, v55
    v_cvt_pk_bf16_f32 v35, v82, v83
    v_mfma_f32_32x32x16_bf16 a[16:31], a[184:187], v[44:47], a[16:31]
    ds_read_b64_tr_b16 a[148:149], v21 offset:160
    v_lshlrev_b32 v80, 16, v36
    v_and_b32 v81, 0xffff0000, v36
    v_fma_f32 v80, v80, v86, v87
    ds_read_b64_tr_b16 a[150:151], v21 offset:1312
    v_fma_f32 v81, v81, v86, v87
    v_mfma_f32_32x32x16_bf16 a[32:47], a[188:191], v[40:43], a[32:47]
    v_fma_f32 v80, v80, v56, v48
    v_fma_f32 v81, v81, v57, v49
    buffer_load_dwordx4 v2, s[12:15], s29 offen offset:1024 lds
    v_cvt_pk_bf16_f32 v36, v80, v81
    v_lshlrev_b32 v82, 16, v37
    v_mfma_f32_32x32x16_bf16 a[48:63], a[188:191], v[44:47], a[48:63]
    ds_read_b64_tr_b16 a[152:153], v21 offset:192
    v_and_b32 v83, 0xffff0000, v37
    v_fma_f32 v82, v82, v86, v87
    v_fma_f32 v83, v83, v86, v87
    ds_read_b64_tr_b16 a[154:155], v21 offset:1344
    v_fma_f32 v82, v82, v58, v50
    v_mfma_f32_32x32x16_bf16 a[64:79], a[192:195], v[40:43], a[64:79]
    v_fma_f32 v83, v83, v59, v51
    buffer_load_dwordx4 v1, s[12:15], s30 offen offset:2048 lds
    v_cvt_pk_bf16_f32 v37, v82, v83
    v_lshlrev_b32 v80, 16, v38
    v_and_b32 v81, 0xffff0000, v38
    ds_read_b64_tr_b16 a[156:157], v21 offset:224
    v_mfma_f32_32x32x16_bf16 a[80:95], a[192:195], v[44:47], a[80:95]
    v_fma_f32 v80, v80, v86, v87
    v_fma_f32 v81, v81, v86, v87
    ds_read_b64_tr_b16 a[158:159], v21 offset:1376
    v_fma_f32 v80, v80, v60, v52
    v_fma_f32 v81, v81, v61, v53
    v_mfma_f32_32x32x16_bf16 a[96:111], a[196:199], v[40:43], a[96:111]
    v_cvt_pk_bf16_f32 v38, v80, v81
    buffer_load_dwordx4 v2, s[12:15], s31 offen offset:3072 lds
    v_lshlrev_b32 v82, 16, v39
    v_and_b32 v83, 0xffff0000, v39
    ds_read_b64_tr_b16 a[160:161], v21 offset:256
    v_fma_f32 v82, v82, v86, v87
    v_mfma_f32_32x32x16_bf16 a[112:127], a[196:199], v[44:47], a[112:127]
    v_fma_f32 v83, v83, v86, v87
    v_fma_f32 v82, v82, v62, v54
    ds_read_b64_tr_b16 a[162:163], v21 offset:1408
    v_fma_f32 v83, v83, v63, v55
    v_cvt_pk_bf16_f32 v39, v82, v83
    s_waitcnt lgkmcnt(15)
    v_mfma_f32_32x32x16_bf16 v[96:111], a[128:131], v[32:35], v[96:111]
    ds_read_b128 v[40:43], v17 offset:0
    ds_read_b128 v[44:47], v17 offset:4096
    ds_read_b128 v[64:67], v22 offset:320
    ds_read_b128 v[68:71], v22 offset:336
    s_add_u32 m0, s45, 0
    v_mfma_f32_32x32x16_bf16 v[112:127], a[128:131], v[36:39], v[112:127]
    ds_read_b128 v[72:75], v22 offset:2624
    ds_read_b128 v[76:79], v22 offset:2640
    buffer_load_dwordx4 v3, s[16:19], 0 offen offset:0 lds
    ds_read_b64_tr_b16 a[164:165], v21 offset:4608
    ds_read_b64_tr_b16 a[166:167], v21 offset:5760
    s_waitcnt lgkmcnt(15)
    v_mfma_f32_32x32x16_bf16 v[128:143], a[132:135], v[32:35], v[128:143]
    buffer_load_dwordx4 v4, s[16:19], 0 offen offset:1024 lds
    ds_read_b64_tr_b16 a[168:169], v21 offset:4640
    ds_read_b64_tr_b16 a[170:171], v21 offset:5792
    s_waitcnt lgkmcnt(9)
    v_lshlrev_b32 v80, 16, v40
    v_and_b32 v81, 0xffff0000, v40
    v_mfma_f32_32x32x16_bf16 v[144:159], a[132:135], v[36:39], v[144:159]
    v_fma_f32 v80, v80, v84, v85
    ds_read_b64_tr_b16 a[172:173], v21 offset:4672
    v_fma_f32 v81, v81, v84, v85
    s_waitcnt lgkmcnt(6)
    v_fma_f32 v80, v80, v72, v64
    v_fma_f32 v81, v81, v73, v65
    v_mfma_f32_32x32x16_bf16 v[160:175], a[136:139], v[32:35], v[160:175]
    buffer_load_dwordx4 v5, s[16:19], 0 offen offset:2048 lds
    v_cvt_pk_bf16_f32 v40, v80, v81
    v_lshlrev_b32 v82, 16, v41
    ds_read_b64_tr_b16 a[174:175], v21 offset:5824
    v_and_b32 v83, 0xffff0000, v41
    v_mfma_f32_32x32x16_bf16 v[176:191], a[136:139], v[36:39], v[176:191]
    v_fma_f32 v82, v82, v84, v85
    v_fma_f32 v83, v83, v84, v85
    ds_read_b64_tr_b16 a[176:177], v21 offset:4704
    v_fma_f32 v82, v82, v74, v66
    v_fma_f32 v83, v83, v75, v67
    v_mfma_f32_32x32x16_bf16 v[192:207], a[140:143], v[32:35], v[192:207]
    v_cvt_pk_bf16_f32 v41, v82, v83
    buffer_load_dwordx4 v6, s[16:19], 0 offen offset:3072 lds
    v_lshlrev_b32 v80, 16, v42
    v_and_b32 v81, 0xffff0000, v42
    ds_read_b64_tr_b16 a[178:179], v21 offset:5856
    v_mfma_f32_32x32x16_bf16 v[208:223], a[140:143], v[36:39], v[208:223]
    v_fma_f32 v80, v80, v84, v85
    v_fma_f32 v81, v81, v84, v85
    s_waitcnt lgkmcnt(8)
    v_fma_f32 v80, v80, v76, v68
    ds_read_b64_tr_b16 a[180:181], v21 offset:4736
    v_fma_f32 v81, v81, v77, v69
    v_mfma_f32_32x32x16_bf16 v[224:239], a[144:147], v[32:35], v[224:239]
    v_cvt_pk_bf16_f32 v42, v80, v81
    v_lshlrev_b32 v82, 16, v43
    s_add_u32 m0, s45, 4096
    v_and_b32 v83, 0xffff0000, v43
    v_fma_f32 v82, v82, v84, v85
    v_mfma_f32_32x32x16_bf16 v[240:255], a[144:147], v[36:39], v[240:255]
    ds_read_b64_tr_b16 a[182:183], v21 offset:5888
    v_fma_f32 v83, v83, v84, v85
    v_fma_f32 v82, v82, v78, v70
    v_fma_f32 v83, v83, v79, v71
    ds_read_b64_tr_b16 a[184:185], v21 offset:4768
    v_mfma_f32_32x32x16_bf16 a[0:15], a[148:151], v[32:35], a[0:15]
    v_cvt_pk_bf16_f32 v43, v82, v83
    v_lshlrev_b32 v80, 16, v44
    v_and_b32 v81, 0xffff0000, v44
    ds_read_b64_tr_b16 a[186:187], v21 offset:5920
    v_fma_f32 v80, v80, v86, v87
    v_mfma_f32_32x32x16_bf16 a[16:31], a[148:151], v[36:39], a[16:31]
    v_fma_f32 v81, v81, v86, v87
    buffer_load_dwordx4 v7, s[16:19], 0 offen offset:0 lds
    v_fma_f32 v80, v80, v72, v64
    v_fma_f32 v81, v81, v73, v65
    v_cvt_pk_bf16_f32 v44, v80, v81
    v_mfma_f32_32x32x16_bf16 a[32:47], a[152:155], v[32:35], a[32:47]
    ds_read_b64_tr_b16 a[188:189], v21 offset:4800
    v_lshlrev_b32 v82, 16, v45
    v_and_b32 v83, 0xffff0000, v45
    v_fma_f32 v82, v82, v86, v87
    ds_read_b64_tr_b16 a[190:191], v21 offset:5952
    v_mfma_f32_32x32x16_bf16 a[48:63], a[152:155], v[36:39], a[48:63]
    v_fma_f32 v83, v83, v86, v87
    v_fma_f32 v82, v82, v74, v66
    buffer_load_dwordx4 v8, s[16:19], 0 offen offset:1024 lds
    v_fma_f32 v83, v83, v75, v67
    v_cvt_pk_bf16_f32 v45, v82, v83
    v_mfma_f32_32x32x16_bf16 a[64:79], a[156:159], v[32:35], a[64:79]
    v_lshlrev_b32 v80, 16, v46
    ds_read_b64_tr_b16 a[192:193], v21 offset:4832
    v_and_b32 v81, 0xffff0000, v46
    v_fma_f32 v80, v80, v86, v87
    v_fma_f32 v81, v81, v86, v87
    v_mfma_f32_32x32x16_bf16 a[80:95], a[156:159], v[36:39], a[80:95]
    ds_read_b64_tr_b16 a[194:195], v21 offset:5984
    v_fma_f32 v80, v80, v76, v68
    v_fma_f32 v81, v81, v77, v69
    buffer_load_dwordx4 v9, s[16:19], 0 offen offset:2048 lds
    v_cvt_pk_bf16_f32 v46, v80, v81
    v_mfma_f32_32x32x16_bf16 a[96:111], a[160:163], v[32:35], a[96:111]
    v_lshlrev_b32 v82, 16, v47
    v_and_b32 v83, 0xffff0000, v47
    ds_read_b64_tr_b16 a[196:197], v21 offset:4864
    v_fma_f32 v82, v82, v86, v87
    v_fma_f32 v83, v83, v86, v87
    v_mfma_f32_32x32x16_bf16 a[112:127], a[160:163], v[36:39], a[112:127]
    v_fma_f32 v82, v82, v78, v70
    ds_read_b64_tr_b16 a[198:199], v21 offset:6016
    v_fma_f32 v83, v83, v79, v71
    v_cvt_pk_bf16_f32 v47, v82, v83
    s_waitcnt lgkmcnt(15)
    v_mfma_f32_32x32x16_bf16 v[96:111], a[164:167], v[40:43], v[96:111]
    ds_read_b128 v[32:35], v18 offset:0
    ds_read_b128 v[36:39], v18 offset:4096
    ds_read_b128 v[48:51], v22 offset:384
    ds_read_b128 v[52:55], v22 offset:400
    buffer_load_dwordx4 v10, s[16:19], 0 offen offset:3072 lds
    v_mfma_f32_32x32x16_bf16 v[112:127], a[164:167], v[44:47], v[112:127]
    ds_read_b128 v[56:59], v22 offset:2688
    ds_read_b128 v[60:63], v22 offset:2704
    s_add_u32 m0, s45, 8192
    ds_read_b64_tr_b16 a[128:129], v21 offset:9216
    ds_read_b64_tr_b16 a[130:131], v21 offset:10368
    s_waitcnt lgkmcnt(15)
    v_mfma_f32_32x32x16_bf16 v[128:143], a[168:171], v[40:43], v[128:143]
    buffer_load_dwordx4 v11, s[16:19], 0 offen offset:0 lds
    ds_read_b64_tr_b16 a[132:133], v21 offset:9248
    ds_read_b64_tr_b16 a[134:135], v21 offset:10400
    s_waitcnt lgkmcnt(9)
    v_lshlrev_b32 v80, 16, v32
    v_and_b32 v81, 0xffff0000, v32
    v_mfma_f32_32x32x16_bf16 v[144:159], a[168:171], v[44:47], v[144:159]
    v_fma_f32 v80, v80, v84, v85
    ds_read_b64_tr_b16 a[136:137], v21 offset:9280
    v_fma_f32 v81, v81, v84, v85
    s_waitcnt lgkmcnt(6)
    v_fma_f32 v80, v80, v56, v48
    v_fma_f32 v81, v81, v57, v49
    v_mfma_f32_32x32x16_bf16 v[160:175], a[172:175], v[40:43], v[160:175]
    s_add_u32 s12, s12, 128
    v_cvt_pk_bf16_f32 v32, v80, v81
    v_lshlrev_b32 v82, 16, v33
    ds_read_b64_tr_b16 a[138:139], v21 offset:10432
    v_and_b32 v83, 0xffff0000, v33
    v_mfma_f32_32x32x16_bf16 v[176:191], a[172:175], v[44:47], v[176:191]
    v_fma_f32 v82, v82, v84, v85
    v_fma_f32 v83, v83, v84, v85
    ds_read_b64_tr_b16 a[140:141], v21 offset:9312
    v_fma_f32 v82, v82, v58, v50
    v_fma_f32 v83, v83, v59, v51
    v_mfma_f32_32x32x16_bf16 v[192:207], a[176:179], v[40:43], v[192:207]
    v_cvt_pk_bf16_f32 v33, v82, v83
    s_addc_u32 s13, s13, 0
    v_lshlrev_b32 v80, 16, v34
    v_and_b32 v81, 0xffff0000, v34
    ds_read_b64_tr_b16 a[142:143], v21 offset:10464
    v_mfma_f32_32x32x16_bf16 v[208:223], a[176:179], v[44:47], v[208:223]
    v_fma_f32 v80, v80, v84, v85
    v_fma_f32 v81, v81, v84, v85
    s_waitcnt lgkmcnt(8)
    v_fma_f32 v80, v80, v60, v52
    ds_read_b64_tr_b16 a[144:145], v21 offset:9344
    v_fma_f32 v81, v81, v61, v53
    v_mfma_f32_32x32x16_bf16 v[224:239], a[180:183], v[40:43], v[224:239]
    v_cvt_pk_bf16_f32 v34, v80, v81
    v_lshlrev_b32 v82, 16, v35
    s_sub_u32 s14, s14, 128
    v_and_b32 v83, 0xffff0000, v35
    v_fma_f32 v82, v82, v84, v85
    v_mfma_f32_32x32x16_bf16 v[240:255], a[180:183], v[44:47], v[240:255]
    ds_read_b64_tr_b16 a[146:147], v21 offset:10496
    v_fma_f32 v83, v83, v84, v85
    v_fma_f32 v82, v82, v62, v54
    v_fma_f32 v83, v83, v63, v55
    ds_read_b64_tr_b16 a[148:149], v21 offset:9376
    v_mfma_f32_32x32x16_bf16 a[0:15], a[184:187], v[40:43], a[0:15]
    v_cvt_pk_bf16_f32 v35, v82, v83
    v_lshlrev_b32 v80, 16, v36
    v_and_b32 v81, 0xffff0000, v36
    ds_read_b64_tr_b16 a[150:151], v21 offset:10528
    v_fma_f32 v80, v80, v86, v87
    v_mfma_f32_32x32x16_bf16 a[16:31], a[184:187], v[44:47], a[16:31]
    v_fma_f32 v81, v81, v86, v87
    s_add_u32 s16, s16, 589824
    v_fma_f32 v80, v80, v56, v48
    v_fma_f32 v81, v81, v57, v49
    v_cvt_pk_bf16_f32 v36, v80, v81
    v_mfma_f32_32x32x16_bf16 a[32:47], a[188:191], v[40:43], a[32:47]
    ds_read_b64_tr_b16 a[152:153], v21 offset:9408
    v_lshlrev_b32 v82, 16, v37
    v_and_b32 v83, 0xffff0000, v37
    v_fma_f32 v82, v82, v86, v87
    ds_read_b64_tr_b16 a[154:155], v21 offset:10560
    v_mfma_f32_32x32x16_bf16 a[48:63], a[188:191], v[44:47], a[48:63]
    v_fma_f32 v83, v83, v86, v87
    v_fma_f32 v82, v82, v58, v50
    s_addc_u32 s17, s17, 0
    v_fma_f32 v83, v83, v59, v51
    v_cvt_pk_bf16_f32 v37, v82, v83
    v_mfma_f32_32x32x16_bf16 a[64:79], a[192:195], v[40:43], a[64:79]
    v_lshlrev_b32 v80, 16, v38
    ds_read_b64_tr_b16 a[156:157], v21 offset:9440
    v_and_b32 v81, 0xffff0000, v38
    v_fma_f32 v80, v80, v86, v87
    v_fma_f32 v81, v81, v86, v87
    v_mfma_f32_32x32x16_bf16 a[80:95], a[192:195], v[44:47], a[80:95]
    ds_read_b64_tr_b16 a[158:159], v21 offset:10592
    v_fma_f32 v80, v80, v60, v52
    v_fma_f32 v81, v81, v61, v53
    s_sub_u32 s18, s18, 589824
    v_cvt_pk_bf16_f32 v38, v80, v81
    v_mfma_f32_32x32x16_bf16 a[96:111], a[196:199], v[40:43], a[96:111]
    v_lshlrev_b32 v82, 16, v39
    v_and_b32 v83, 0xffff0000, v39
    ds_read_b64_tr_b16 a[160:161], v21 offset:9472
    v_fma_f32 v82, v82, v86, v87
    v_fma_f32 v83, v83, v86, v87
    v_mfma_f32_32x32x16_bf16 a[112:127], a[196:199], v[44:47], a[112:127]
    v_fma_f32 v82, v82, v62, v54
    ds_read_b64_tr_b16 a[162:163], v21 offset:10624
    v_fma_f32 v83, v83, v63, v55
    v_cvt_pk_bf16_f32 v39, v82, v83
    s_waitcnt lgkmcnt(15)
    v_mfma_f32_32x32x16_bf16 v[96:111], a[128:131], v[32:35], v[96:111]
    ds_read_b128 v[40:43], v19 offset:0
    ds_read_b128 v[44:47], v19 offset:4096
    ds_read_b128 v[64:67], v22 offset:448
    ds_read_b128 v[68:71], v22 offset:464
    ds_read_b128 v[72:75], v22 offset:2752
    v_mfma_f32_32x32x16_bf16 v[112:127], a[128:131], v[36:39], v[112:127]
    ds_read_b128 v[76:79], v22 offset:2768
    ds_read_b64_tr_b16 a[164:165], v21 offset:13824
    ds_read_b64_tr_b16 a[166:167], v21 offset:14976
    ds_read_b64_tr_b16 a[168:169], v21 offset:13856
    s_waitcnt lgkmcnt(15)
    v_mfma_f32_32x32x16_bf16 v[128:143], a[132:135], v[32:35], v[128:143]
    ds_read_b64_tr_b16 a[170:171], v21 offset:15008
    ds_read_b64_tr_b16 a[172:173], v21 offset:13888
    ds_read_b64_tr_b16 a[174:175], v21 offset:15040
    ds_read_b64_tr_b16 a[176:177], v21 offset:13920
    s_waitcnt lgkmcnt(12)
    v_lshlrev_b32 v80, 16, v40
    v_mfma_f32_32x32x16_bf16 v[144:159], a[132:135], v[36:39], v[144:159]
    v_and_b32 v81, 0xffff0000, v40
    v_fma_f32 v80, v80, v84, v85
    v_fma_f32 v81, v81, v84, v85
    s_waitcnt lgkmcnt(8)
    v_fma_f32 v80, v80, v72, v64
    v_mfma_f32_32x32x16_bf16 v[160:175], a[136:139], v[32:35], v[160:175]
    ds_read_b64_tr_b16 a[178:179], v21 offset:15072
    v_fma_f32 v81, v81, v73, v65
    v_cvt_pk_bf16_f32 v40, v80, v81
    v_lshlrev_b32 v82, 16, v41
    v_and_b32 v83, 0xffff0000, v41
    v_mfma_f32_32x32x16_bf16 v[176:191], a[136:139], v[36:39], v[176:191]
    v_fma_f32 v82, v82, v84, v85
    ds_read_b64_tr_b16 a[180:181], v21 offset:13952
    v_fma_f32 v83, v83, v84, v85
    v_fma_f32 v82, v82, v74, v66
    v_mfma_f32_32x32x16_bf16 v[192:207], a[140:143], v[32:35], v[192:207]
    v_fma_f32 v83, v83, v75, v67
    v_cvt_pk_bf16_f32 v41, v82, v83
    ds_read_b64_tr_b16 a[182:183], v21 offset:15104
    v_lshlrev_b32 v80, 16, v42
    v_and_b32 v81, 0xffff0000, v42
    v_mfma_f32_32x32x16_bf16 v[208:223], a[140:143], v[36:39], v[208:223]
    v_fma_f32 v80, v80, v84, v85
    v_fma_f32 v81, v81, v84, v85
    s_waitcnt lgkmcnt(10)
    v_fma_f32 v80, v80, v76, v68
    ds_read_b64_tr_b16 a[184:185], v21 offset:13984
    v_mfma_f32_32x32x16_bf16 v[224:239], a[144:147], v[32:35], v[224:239]
    v_fma_f32 v81, v81, v77, v69
    v_cvt_pk_bf16_f32 v42, v80, v81
    v_lshlrev_b32 v82, 16, v43
    v_and_b32 v83, 0xffff0000, v43
    v_mfma_f32_32x32x16_bf16 v[240:255], a[144:147], v[36:39], v[240:255]
    v_fma_f32 v82, v82, v84, v85
    ds_read_b64_tr_b16 a[186:187], v21 offset:15136
    v_fma_f32 v83, v83, v84, v85
    v_fma_f32 v82, v82, v78, v70
    v_fma_f32 v83, v83, v79, v71
    v_mfma_f32_32x32x16_bf16 a[0:15], a[148:151], v[32:35], a[0:15]
    v_cvt_pk_bf16_f32 v43, v82, v83
    ds_read_b64_tr_b16 a[188:189], v21 offset:14016
    v_lshlrev_b32 v80, 16, v44
    v_and_b32 v81, 0xffff0000, v44
    v_mfma_f32_32x32x16_bf16 a[16:31], a[148:151], v[36:39], a[16:31]
    v_fma_f32 v80, v80, v86, v87
    v_fma_f32 v81, v81, v86, v87
    v_fma_f32 v80, v80, v72, v64
    ds_read_b64_tr_b16 a[190:191], v21 offset:15168
    v_fma_f32 v81, v81, v73, v65
    v_mfma_f32_32x32x16_bf16 a[32:47], a[152:155], v[32:35], a[32:47]
    v_cvt_pk_bf16_f32 v44, v80, v81
    v_lshlrev_b32 v82, 16, v45
    v_and_b32 v83, 0xffff0000, v45
    v_fma_f32 v82, v82, v86, v87
    v_mfma_f32_32x32x16_bf16 a[48:63], a[152:155], v[36:39], a[48:63]
    ds_read_b64_tr_b16 a[192:193], v21 offset:14048
    v_fma_f32 v83, v83, v86, v87
    v_fma_f32 v82, v82, v74, v66
    v_fma_f32 v83, v83, v75, v67
    v_cvt_pk_bf16_f32 v45, v82, v83
    v_mfma_f32_32x32x16_bf16 a[64:79], a[156:159], v[32:35], a[64:79]
    ds_read_b64_tr_b16 a[194:195], v21 offset:15200
    v_lshlrev_b32 v80, 16, v46
    v_and_b32 v81, 0xffff0000, v46
    v_fma_f32 v80, v80, v86, v87
    v_mfma_f32_32x32x16_bf16 a[80:95], a[156:159], v[36:39], a[80:95]
    v_fma_f32 v81, v81, v86, v87
    v_fma_f32 v80, v80, v76, v68
    ds_read_b64_tr_b16 a[196:197], v21 offset:14080
    v_fma_f32 v81, v81, v77, v69
    v_cvt_pk_bf16_f32 v46, v80, v81
    v_mfma_f32_32x32x16_bf16 a[96:111], a[160:163], v[32:35], a[96:111]
    v_lshlrev_b32 v82, 16, v47
    v_and_b32 v83, 0xffff0000, v47
    v_fma_f32 v82, v82, v86, v87
    ds_read_b64_tr_b16 a[198:199], v21 offset:15232
    v_mfma_f32_32x32x16_bf16 a[112:127], a[160:163], v[36:39], a[112:127]
    v_fma_f32 v83, v83, v86, v87
    v_fma_f32 v82, v82, v78, v70
    v_fma_f32 v83, v83, v79, v71
    v_cvt_pk_bf16_f32 v47, v82, v83
    s_waitcnt lgkmcnt(0)
    v_mfma_f32_32x32x16_bf16 v[96:111], a[164:167], v[40:43], v[96:111]
    v_mfma_f32_32x32x16_bf16 v[112:127], a[164:167], v[44:47], v[112:127]
    s_waitcnt vmcnt(0)
    s_barrier
    v_mfma_f32_32x32x16_bf16 v[128:143], a[168:171], v[40:43], v[128:143]
    ds_read_b128 v[32:35], v12 offset:0
    ds_read_b128 v[36:39], v12 offset:4096
    ds_read_b128 v[48:51], v22 offset:512
    ds_read_b128 v[52:55], v22 offset:528
    s_add_u32 m0, s44, 69760
    ds_read_b128 v[56:59], v22 offset:2816
    v_mfma_f32_32x32x16_bf16 v[144:159], a[168:171], v[44:47], v[144:159]
    ds_read_b128 v[60:63], v22 offset:2832
    buffer_load_dwordx4 v1, s[12:15], s24 offen offset:0 lds
    ds_read_b64_tr_b16 a[128:129], v20 offset:0
    ds_read_b64_tr_b16 a[130:131], v20 offset:1152
    buffer_load_dwordx4 v2, s[12:15], s25 offen offset:1024 lds
    ds_read_b64_tr_b16 a[132:133], v20 offset:32
    v_mfma_f32_32x32x16_bf16 v[160:175], a[172:175], v[40:43], v[160:175]
    ds_read_b64_tr_b16 a[134:135], v20 offset:1184
    s_waitcnt lgkmcnt(9)
    v_lshlrev_b32 v80, 16, v32
    v_and_b32 v81, 0xffff0000, v32
    v_fma_f32 v80, v80, v84, v85
    buffer_load_dwordx4 v1, s[12:15], s26 offen offset:2048 lds
    v_mfma_f32_32x32x16_bf16 v[176:191], a[172:175], v[44:47], v[176:191]
    v_fma_f32 v81, v81, v84, v85
    s_waitcnt lgkmcnt(5)
    v_fma_f32 v80, v80, v56, v48
    v_fma_f32 v81, v81, v57, v49
    ds_read_b64_tr_b16 a[136:137], v20 offset:64
    v_cvt_pk_bf16_f32 v32, v80, v81
    v_lshlrev_b32 v82, 16, v33
    v_mfma_f32_32x32x16_bf16 v[192:207], a[176:179], v[40:43], v[192:207]
    ds_read_b64_tr_b16 a[138:139], v20 offset:1216
    v_and_b32 v83, 0xffff0000, v33
    v_fma_f32 v82, v82, v84, v85
    v_fma_f32 v83, v83, v84, v85
    buffer_load_dwordx4 v2, s[12:15], s27 offen offset:3072 lds
    v_fma_f32 v82, v82, v58, v50
    v_mfma_f32_32x32x16_bf16 v[208:223], a[176:179], v[44:47], v[208:223]
    v_fma_f32 v83, v83, v59, v51
    ds_read_b64_tr_b16 a[140:141], v20 offset:96
    v_cvt_pk_bf16_f32 v33, v82, v83
    v_lshlrev_b32 v80, 16, v34
    v_and_b32 v81, 0xffff0000, v34
    v_mfma_f32_32x32x16_bf16 v[224:239], a[180:183], v[40:43], v[224:239]
    ds_read_b64_tr_b16 a[142:143], v20 offset:1248
    v_fma_f32 v80, v80, v84, v85
    v_fma_f32 v81, v81, v84, v85
    s_add_u32 m0, s44, 73856
    s_waitcnt lgkmcnt(8)
    v_fma_f32 v80, v80, v60, v52
    v_fma_f32 v81, v81, v61, v53
    v_mfma_f32_32x32x16_bf16 v[240:255], a[180:183], v[44:47], v[240:255]
    v_cvt_pk_bf16_f32 v34, v80, v81
    ds_read_b64_tr_b16 a[144:145], v20 offset:128
    v_lshlrev_b32 v82, 16, v35
    v_and_b32 v83, 0xffff0000, v35
    ds_read_b64_tr_b16 a[146:147], v20 offset:1280
    v_mfma_f32_32x32x16_bf16 a[0:15], a[184:187], v[40:43], a[0:15]
    v_fma_f32 v82, v82, v84, v85
    v_fma_f32 v83, v83, v84, v85
    v_fma_f32 v82, v82, v62, v54
    buffer_load_dwordx4 v1, s[12:15], s28 offen offset:0 lds
    v_fma_f32 v83, v83, v63, v55
    v_cvt_pk_bf16_f32 v35, v82, v83
    v_mfma_f32_32x32x16_bf16 a[16:31], a[184:187], v[44:47], a[16:31]
    ds_read_b64_tr_b16 a[148:149], v20 offset:160
    v_lshlrev_b32 v80, 16, v36
    v_and_b32 v81, 0xffff0000, v36
    v_fma_f32 v80, v80, v86, v87
    ds_read_b64_tr_b16 a[150:151], v20 offset:1312
    v_fma_f32 v81, v81, v86, v87
    v_mfma_f32_32x32x16_bf16 a[32:47], a[188:191], v[40:43], a[32:47]
    v_fma_f32 v80, v80, v56, v48
    v_fma_f32 v81, v81, v57, v49
    buffer_load_dwordx4 v2, s[12:15], s29 offen offset:1024 lds
    v_cvt_pk_bf16_f32 v36, v80, v81
    v_lshlrev_b32 v82, 16, v37
    v_mfma_f32_32x32x16_bf16 a[48:63], a[188:191], v[44:47], a[48:63]
    ds_read_b64_tr_b16 a[152:153], v20 offset:192
    v_and_b32 v83, 0xffff0000, v37
    v_fma_f32 v82, v82, v86, v87
    v_fma_f32 v83, v83, v86, v87
    ds_read_b64_tr_b16 a[154:155], v20 offset:1344
    v_fma_f32 v82, v82, v58, v50
    v_mfma_f32_32x32x16_bf16 a[64:79], a[192:195], v[40:43], a[64:79]
    v_fma_f32 v83, v83, v59, v51
    buffer_load_dwordx4 v1, s[12:15], s30 offen offset:2048 lds
    v_cvt_pk_bf16_f32 v37, v82, v83
    v_lshlrev_b32 v80, 16, v38
    v_and_b32 v81, 0xffff0000, v38
    ds_read_b64_tr_b16 a[156:157], v20 offset:224
    v_mfma_f32_32x32x16_bf16 a[80:95], a[192:195], v[44:47], a[80:95]
    v_fma_f32 v80, v80, v86, v87
    v_fma_f32 v81, v81, v86, v87
    ds_read_b64_tr_b16 a[158:159], v20 offset:1376
    v_fma_f32 v80, v80, v60, v52
    v_fma_f32 v81, v81, v61, v53
    v_mfma_f32_32x32x16_bf16 a[96:111], a[196:199], v[40:43], a[96:111]
    v_cvt_pk_bf16_f32 v38, v80, v81
    buffer_load_dwordx4 v2, s[12:15], s31 offen offset:3072 lds
    v_lshlrev_b32 v82, 16, v39
    v_and_b32 v83, 0xffff0000, v39
    ds_read_b64_tr_b16 a[160:161], v20 offset:256
    v_fma_f32 v82, v82, v86, v87
    v_mfma_f32_32x32x16_bf16 a[112:127], a[196:199], v[44:47], a[112:127]
    v_fma_f32 v83, v83, v86, v87
    v_fma_f32 v82, v82, v62, v54
    ds_read_b64_tr_b16 a[162:163], v20 offset:1408
    v_fma_f32 v83, v83, v63, v55
    v_cvt_pk_bf16_f32 v39, v82, v83
    s_waitcnt lgkmcnt(15)
    v_mfma_f32_32x32x16_bf16 v[96:111], a[128:131], v[32:35], v[96:111]
    ds_read_b128 v[40:43], v13 offset:0
    ds_read_b128 v[44:47], v13 offset:4096
    ds_read_b128 v[64:67], v22 offset:576
    ds_read_b128 v[68:71], v22 offset:592
    s_add_u32 m0, s45, 69760
    v_mfma_f32_32x32x16_bf16 v[112:127], a[128:131], v[36:39], v[112:127]
    ds_read_b128 v[72:75], v22 offset:2880
    ds_read_b128 v[76:79], v22 offset:2896
    buffer_load_dwordx4 v3, s[16:19], 0 offen offset:0 lds
    ds_read_b64_tr_b16 a[164:165], v20 offset:4608
    ds_read_b64_tr_b16 a[166:167], v20 offset:5760
    s_waitcnt lgkmcnt(15)
    v_mfma_f32_32x32x16_bf16 v[128:143], a[132:135], v[32:35], v[128:143]
    buffer_load_dwordx4 v4, s[16:19], 0 offen offset:1024 lds
    ds_read_b64_tr_b16 a[168:169], v20 offset:4640
    ds_read_b64_tr_b16 a[170:171], v20 offset:5792
    s_waitcnt lgkmcnt(9)
    v_lshlrev_b32 v80, 16, v40
    v_and_b32 v81, 0xffff0000, v40
    v_mfma_f32_32x32x16_bf16 v[144:159], a[132:135], v[36:39], v[144:159]
    v_fma_f32 v80, v80, v84, v85
    ds_read_b64_tr_b16 a[172:173], v20 offset:4672
    v_fma_f32 v81, v81, v84, v85
    s_waitcnt lgkmcnt(6)
    v_fma_f32 v80, v80, v72, v64
    v_fma_f32 v81, v81, v73, v65
    v_mfma_f32_32x32x16_bf16 v[160:175], a[136:139], v[32:35], v[160:175]
    buffer_load_dwordx4 v5, s[16:19], 0 offen offset:2048 lds
    v_cvt_pk_bf16_f32 v40, v80, v81
    v_lshlrev_b32 v82, 16, v41
    ds_read_b64_tr_b16 a[174:175], v20 offset:5824
    v_and_b32 v83, 0xffff0000, v41
    v_mfma_f32_32x32x16_bf16 v[176:191], a[136:139], v[36:39], v[176:191]
    v_fma_f32 v82, v82, v84, v85
    v_fma_f32 v83, v83, v84, v85
    ds_read_b64_tr_b16 a[176:177], v20 offset:4704
    v_fma_f32 v82, v82, v74, v66
    v_fma_f32 v83, v83, v75, v67
    v_mfma_f32_32x32x16_bf16 v[192:207], a[140:143], v[32:35], v[192:207]
    v_cvt_pk_bf16_f32 v41, v82, v83
    buffer_load_dwordx4 v6, s[16:19], 0 offen offset:3072 lds
    v_lshlrev_b32 v80, 16, v42
    v_and_b32 v81, 0xffff0000, v42
    ds_read_b64_tr_b16 a[178:179], v20 offset:5856
    v_mfma_f32_32x32x16_bf16 v[208:223], a[140:143], v[36:39], v[208:223]
    v_fma_f32 v80, v80, v84, v85
    v_fma_f32 v81, v81, v84, v85
    s_waitcnt lgkmcnt(8)
    v_fma_f32 v80, v80, v76, v68
    ds_read_b64_tr_b16 a[180:181], v20 offset:4736
    v_fma_f32 v81, v81, v77, v69
    v_mfma_f32_32x32x16_bf16 v[224:239], a[144:147], v[32:35], v[224:239]
    v_cvt_pk_bf16_f32 v42, v80, v81
    v_lshlrev_b32 v82, 16, v43
    s_add_u32 m0, s45, 73856
    v_and_b32 v83, 0xffff0000, v43
    v_fma_f32 v82, v82, v84, v85
    v_mfma_f32_32x32x16_bf16 v[240:255], a[144:147], v[36:39], v[240:255]
    ds_read_b64_tr_b16 a[182:183], v20 offset:5888
    v_fma_f32 v83, v83, v84, v85
    v_fma_f32 v82, v82, v78, v70
    v_fma_f32 v83, v83, v79, v71
    ds_read_b64_tr_b16 a[184:185], v20 offset:4768
    v_mfma_f32_32x32x16_bf16 a[0:15], a[148:151], v[32:35], a[0:15]
    v_cvt_pk_bf16_f32 v43, v82, v83
    v_lshlrev_b32 v80, 16, v44
    v_and_b32 v81, 0xffff0000, v44
    ds_read_b64_tr_b16 a[186:187], v20 offset:5920
    v_fma_f32 v80, v80, v86, v87
    v_mfma_f32_32x32x16_bf16 a[16:31], a[148:151], v[36:39], a[16:31]
    v_fma_f32 v81, v81, v86, v87
    buffer_load_dwordx4 v7, s[16:19], 0 offen offset:0 lds
    v_fma_f32 v80, v80, v72, v64
    v_fma_f32 v81, v81, v73, v65
    v_cvt_pk_bf16_f32 v44, v80, v81
    v_mfma_f32_32x32x16_bf16 a[32:47], a[152:155], v[32:35], a[32:47]
    ds_read_b64_tr_b16 a[188:189], v20 offset:4800
    v_lshlrev_b32 v82, 16, v45
    v_and_b32 v83, 0xffff0000, v45
    v_fma_f32 v82, v82, v86, v87
    ds_read_b64_tr_b16 a[190:191], v20 offset:5952
    v_mfma_f32_32x32x16_bf16 a[48:63], a[152:155], v[36:39], a[48:63]
    v_fma_f32 v83, v83, v86, v87
    v_fma_f32 v82, v82, v74, v66
    buffer_load_dwordx4 v8, s[16:19], 0 offen offset:1024 lds
    v_fma_f32 v83, v83, v75, v67
    v_cvt_pk_bf16_f32 v45, v82, v83
    v_mfma_f32_32x32x16_bf16 a[64:79], a[156:159], v[32:35], a[64:79]
    v_lshlrev_b32 v80, 16, v46
    ds_read_b64_tr_b16 a[192:193], v20 offset:4832
    v_and_b32 v81, 0xffff0000, v46
    v_fma_f32 v80, v80, v86, v87
    v_fma_f32 v81, v81, v86, v87
    v_mfma_f32_32x32x16_bf16 a[80:95], a[156:159], v[36:39], a[80:95]
    ds_read_b64_tr_b16 a[194:195], v20 offset:5984
    v_fma_f32 v80, v80, v76, v68
    v_fma_f32 v81, v81, v77, v69
    buffer_load_dwordx4 v9, s[16:19], 0 offen offset:2048 lds
    v_cvt_pk_bf16_f32 v46, v80, v81
    v_mfma_f32_32x32x16_bf16 a[96:111], a[160:163], v[32:35], a[96:111]
    v_lshlrev_b32 v82, 16, v47
    v_and_b32 v83, 0xffff0000, v47
    ds_read_b64_tr_b16 a[196:197], v20 offset:4864
    v_fma_f32 v82, v82, v86, v87
    v_fma_f32 v83, v83, v86, v87
    v_mfma_f32_32x32x16_bf16 a[112:127], a[160:163], v[36:39], a[112:127]
    v_fma_f32 v82, v82, v78, v70
    ds_read_b64_tr_b16 a[198:199], v20 offset:6016
    v_fma_f32 v83, v83, v79, v71
    v_cvt_pk_bf16_f32 v47, v82, v83
    s_waitcnt lgkmcnt(15)
    v_mfma_f32_32x32x16_bf16 v[96:111], a[164:167], v[40:43], v[96:111]
    ds_read_b128 v[32:35], v14 offset:0
    ds_read_b128 v[36:39], v14 offset:4096
    ds_read_b128 v[48:51], v22 offset:640
    ds_read_b128 v[52:55], v22 offset:656
    buffer_load_dwordx4 v10, s[16:19], 0 offen offset:3072 lds
    v_mfma_f32_32x32x16_bf16 v[112:127], a[164:167], v[44:47], v[112:127]
    ds_read_b128 v[56:59], v22 offset:2944
    ds_read_b128 v[60:63], v22 offset:2960
    s_add_u32 m0, s45, 77952
    ds_read_b64_tr_b16 a[128:129], v20 offset:9216
    ds_read_b64_tr_b16 a[130:131], v20 offset:10368
    s_waitcnt lgkmcnt(15)
    v_mfma_f32_32x32x16_bf16 v[128:143], a[168:171], v[40:43], v[128:143]
    buffer_load_dwordx4 v11, s[16:19], 0 offen offset:0 lds
    ds_read_b64_tr_b16 a[132:133], v20 offset:9248
    ds_read_b64_tr_b16 a[134:135], v20 offset:10400
    s_waitcnt lgkmcnt(9)
    v_lshlrev_b32 v80, 16, v32
    v_and_b32 v81, 0xffff0000, v32
    v_mfma_f32_32x32x16_bf16 v[144:159], a[168:171], v[44:47], v[144:159]
    v_fma_f32 v80, v80, v84, v85
    ds_read_b64_tr_b16 a[136:137], v20 offset:9280
    v_fma_f32 v81, v81, v84, v85
    s_waitcnt lgkmcnt(6)
    v_fma_f32 v80, v80, v56, v48
    v_fma_f32 v81, v81, v57, v49
    v_mfma_f32_32x32x16_bf16 v[160:175], a[172:175], v[40:43], v[160:175]
    s_add_u32 s12, s12, 128
    v_cvt_pk_bf16_f32 v32, v80, v81
    v_lshlrev_b32 v82, 16, v33
    ds_read_b64_tr_b16 a[138:139], v20 offset:10432
    v_and_b32 v83, 0xffff0000, v33
    v_mfma_f32_32x32x16_bf16 v[176:191], a[172:175], v[44:47], v[176:191]
    v_fma_f32 v82, v82, v84, v85
    v_fma_f32 v83, v83, v84, v85
    ds_read_b64_tr_b16 a[140:141], v20 offset:9312
    v_fma_f32 v82, v82, v58, v50
    v_fma_f32 v83, v83, v59, v51
    v_mfma_f32_32x32x16_bf16 v[192:207], a[176:179], v[40:43], v[192:207]
    v_cvt_pk_bf16_f32 v33, v82, v83
    s_addc_u32 s13, s13, 0
    v_lshlrev_b32 v80, 16, v34
    v_and_b32 v81, 0xffff0000, v34
    ds_read_b64_tr_b16 a[142:143], v20 offset:10464
    v_mfma_f32_32x32x16_bf16 v[208:223], a[176:179], v[44:47], v[208:223]
    v_fma_f32 v80, v80, v84, v85
    v_fma_f32 v81, v81, v84, v85
    s_waitcnt lgkmcnt(8)
    v_fma_f32 v80, v80, v60, v52
    ds_read_b64_tr_b16 a[144:145], v20 offset:9344
    v_fma_f32 v81, v81, v61, v53
    v_mfma_f32_32x32x16_bf16 v[224:239], a[180:183], v[40:43], v[224:239]
    v_cvt_pk_bf16_f32 v34, v80, v81
    v_lshlrev_b32 v82, 16, v35
    s_sub_u32 s14, s14, 128
    v_and_b32 v83, 0xffff0000, v35
    v_fma_f32 v82, v82, v84, v85
    v_mfma_f32_32x32x16_bf16 v[240:255], a[180:183], v[44:47], v[240:255]
    ds_read_b64_tr_b16 a[146:147], v20 offset:10496
    v_fma_f32 v83, v83, v84, v85
    v_fma_f32 v82, v82, v62, v54
    v_fma_f32 v83, v83, v63, v55
    ds_read_b64_tr_b16 a[148:149], v20 offset:9376
    v_mfma_f32_32x32x16_bf16 a[0:15], a[184:187], v[40:43], a[0:15]
    v_cvt_pk_bf16_f32 v35, v82, v83
    v_lshlrev_b32 v80, 16, v36
    v_and_b32 v81, 0xffff0000, v36
    ds_read_b64_tr_b16 a[150:151], v20 offset:10528
    v_fma_f32 v80, v80, v86, v87
    v_mfma_f32_32x32x16_bf16 a[16:31], a[184:187], v[44:47], a[16:31]
    v_fma_f32 v81, v81, v86, v87
    s_add_u32 s16, s16, 589824
    v_fma_f32 v80, v80, v56, v48
    v_fma_f32 v81, v81, v57, v49
    v_cvt_pk_bf16_f32 v36, v80, v81
    v_mfma_f32_32x32x16_bf16 a[32:47], a[188:191], v[40:43], a[32:47]
    ds_read_b64_tr_b16 a[152:153], v20 offset:9408
    v_lshlrev_b32 v82, 16, v37
    v_and_b32 v83, 0xffff0000, v37
    v_fma_f32 v82, v82, v86, v87
    ds_read_b64_tr_b16 a[154:155], v20 offset:10560
    v_mfma_f32_32x32x16_bf16 a[48:63], a[188:191], v[44:47], a[48:63]
    v_fma_f32 v83, v83, v86, v87
    v_fma_f32 v82, v82, v58, v50
    s_addc_u32 s17, s17, 0
    v_fma_f32 v83, v83, v59, v51
    v_cvt_pk_bf16_f32 v37, v82, v83
    v_mfma_f32_32x32x16_bf16 a[64:79], a[192:195], v[40:43], a[64:79]
    v_lshlrev_b32 v80, 16, v38
    ds_read_b64_tr_b16 a[156:157], v20 offset:9440
    v_and_b32 v81, 0xffff0000, v38
    v_fma_f32 v80, v80, v86, v87
    v_fma_f32 v81, v81, v86, v87
    v_mfma_f32_32x32x16_bf16 a[80:95], a[192:195], v[44:47], a[80:95]
    ds_read_b64_tr_b16 a[158:159], v20 offset:10592
    v_fma_f32 v80, v80, v60, v52
    v_fma_f32 v81, v81, v61, v53
    s_sub_u32 s18, s18, 589824
    v_cvt_pk_bf16_f32 v38, v80, v81
    v_mfma_f32_32x32x16_bf16 a[96:111], a[196:199], v[40:43], a[96:111]
    v_lshlrev_b32 v82, 16, v39
    v_and_b32 v83, 0xffff0000, v39
    ds_read_b64_tr_b16 a[160:161], v20 offset:9472
    v_fma_f32 v82, v82, v86, v87
    v_fma_f32 v83, v83, v86, v87
    v_mfma_f32_32x32x16_bf16 a[112:127], a[196:199], v[44:47], a[112:127]
    v_fma_f32 v82, v82, v62, v54
    ds_read_b64_tr_b16 a[162:163], v20 offset:10624
    v_fma_f32 v83, v83, v63, v55
    v_cvt_pk_bf16_f32 v39, v82, v83
    s_waitcnt lgkmcnt(15)
    v_mfma_f32_32x32x16_bf16 v[96:111], a[128:131], v[32:35], v[96:111]
    ds_read_b128 v[40:43], v15 offset:0
    ds_read_b128 v[44:47], v15 offset:4096
    ds_read_b128 v[64:67], v22 offset:704
    ds_read_b128 v[68:71], v22 offset:720
    ds_read_b128 v[72:75], v22 offset:3008
    v_mfma_f32_32x32x16_bf16 v[112:127], a[128:131], v[36:39], v[112:127]
    ds_read_b128 v[76:79], v22 offset:3024
    ds_read_b64_tr_b16 a[164:165], v20 offset:13824
    ds_read_b64_tr_b16 a[166:167], v20 offset:14976
    ds_read_b64_tr_b16 a[168:169], v20 offset:13856
    s_waitcnt lgkmcnt(15)
    v_mfma_f32_32x32x16_bf16 v[128:143], a[132:135], v[32:35], v[128:143]
    ds_read_b64_tr_b16 a[170:171], v20 offset:15008
    ds_read_b64_tr_b16 a[172:173], v20 offset:13888
    ds_read_b64_tr_b16 a[174:175], v20 offset:15040
    ds_read_b64_tr_b16 a[176:177], v20 offset:13920
    s_waitcnt lgkmcnt(12)
    v_lshlrev_b32 v80, 16, v40
    v_mfma_f32_32x32x16_bf16 v[144:159], a[132:135], v[36:39], v[144:159]
    v_and_b32 v81, 0xffff0000, v40
    v_fma_f32 v80, v80, v84, v85
    v_fma_f32 v81, v81, v84, v85
    s_waitcnt lgkmcnt(8)
    v_fma_f32 v80, v80, v72, v64
    v_mfma_f32_32x32x16_bf16 v[160:175], a[136:139], v[32:35], v[160:175]
    ds_read_b64_tr_b16 a[178:179], v20 offset:15072
    v_fma_f32 v81, v81, v73, v65
    v_cvt_pk_bf16_f32 v40, v80, v81
    v_lshlrev_b32 v82, 16, v41
    v_and_b32 v83, 0xffff0000, v41
    v_mfma_f32_32x32x16_bf16 v[176:191], a[136:139], v[36:39], v[176:191]
    v_fma_f32 v82, v82, v84, v85
    ds_read_b64_tr_b16 a[180:181], v20 offset:13952
    v_fma_f32 v83, v83, v84, v85
    v_fma_f32 v82, v82, v74, v66
    v_mfma_f32_32x32x16_bf16 v[192:207], a[140:143], v[32:35], v[192:207]
    v_fma_f32 v83, v83, v75, v67
    v_cvt_pk_bf16_f32 v41, v82, v83
    ds_read_b64_tr_b16 a[182:183], v20 offset:15104
    v_lshlrev_b32 v80, 16, v42
    v_and_b32 v81, 0xffff0000, v42
    v_mfma_f32_32x32x16_bf16 v[208:223], a[140:143], v[36:39], v[208:223]
    v_fma_f32 v80, v80, v84, v85
    v_fma_f32 v81, v81, v84, v85
    s_waitcnt lgkmcnt(10)
    v_fma_f32 v80, v80, v76, v68
    ds_read_b64_tr_b16 a[184:185], v20 offset:13984
    v_mfma_f32_32x32x16_bf16 v[224:239], a[144:147], v[32:35], v[224:239]
    v_fma_f32 v81, v81, v77, v69
    v_cvt_pk_bf16_f32 v42, v80, v81
    v_lshlrev_b32 v82, 16, v43
    v_and_b32 v83, 0xffff0000, v43
    v_mfma_f32_32x32x16_bf16 v[240:255], a[144:147], v[36:39], v[240:255]
    v_fma_f32 v82, v82, v84, v85
    ds_read_b64_tr_b16 a[186:187], v20 offset:15136
    v_fma_f32 v83, v83, v84, v85
    v_fma_f32 v82, v82, v78, v70
    v_fma_f32 v83, v83, v79, v71
    v_mfma_f32_32x32x16_bf16 a[0:15], a[148:151], v[32:35], a[0:15]
    v_cvt_pk_bf16_f32 v43, v82, v83
    ds_read_b64_tr_b16 a[188:189], v20 offset:14016
    v_lshlrev_b32 v80, 16, v44
    v_and_b32 v81, 0xffff0000, v44
    v_mfma_f32_32x32x16_bf16 a[16:31], a[148:151], v[36:39], a[16:31]
    v_fma_f32 v80, v80, v86, v87
    v_fma_f32 v81, v81, v86, v87
    v_fma_f32 v80, v80, v72, v64
    ds_read_b64_tr_b16 a[190:191], v20 offset:15168
    v_fma_f32 v81, v81, v73, v65
    v_mfma_f32_32x32x16_bf16 a[32:47], a[152:155], v[32:35], a[32:47]
    v_cvt_pk_bf16_f32 v44, v80, v81
    v_lshlrev_b32 v82, 16, v45
    v_and_b32 v83, 0xffff0000, v45
    v_fma_f32 v82, v82, v86, v87
    v_mfma_f32_32x32x16_bf16 a[48:63], a[152:155], v[36:39], a[48:63]
    ds_read_b64_tr_b16 a[192:193], v20 offset:14048
    v_fma_f32 v83, v83, v86, v87
    v_fma_f32 v82, v82, v74, v66
    v_fma_f32 v83, v83, v75, v67
    v_cvt_pk_bf16_f32 v45, v82, v83
    v_mfma_f32_32x32x16_bf16 a[64:79], a[156:159], v[32:35], a[64:79]
    ds_read_b64_tr_b16 a[194:195], v20 offset:15200
    v_lshlrev_b32 v80, 16, v46
    v_and_b32 v81, 0xffff0000, v46
    v_fma_f32 v80, v80, v86, v87
    v_mfma_f32_32x32x16_bf16 a[80:95], a[156:159], v[36:39], a[80:95]
    v_fma_f32 v81, v81, v86, v87
    v_fma_f32 v80, v80, v76, v68
    ds_read_b64_tr_b16 a[196:197], v20 offset:14080
    v_fma_f32 v81, v81, v77, v69
    v_cvt_pk_bf16_f32 v46, v80, v81
    v_mfma_f32_32x32x16_bf16 a[96:111], a[160:163], v[32:35], a[96:111]
    v_lshlrev_b32 v82, 16, v47
    v_and_b32 v83, 0xffff0000, v47
    v_fma_f32 v82, v82, v86, v87
    ds_read_b64_tr_b16 a[198:199], v20 offset:15232
    v_mfma_f32_32x32x16_bf16 a[112:127], a[160:163], v[36:39], a[112:127]
    v_fma_f32 v83, v83, v86, v87
    v_fma_f32 v82, v82, v78, v70
    v_fma_f32 v83, v83, v79, v71
    v_cvt_pk_bf16_f32 v47, v82, v83
    s_waitcnt lgkmcnt(0)
    v_mfma_f32_32x32x16_bf16 v[96:111], a[164:167], v[40:43], v[96:111]
    v_mfma_f32_32x32x16_bf16 v[112:127], a[164:167], v[44:47], v[112:127]
    s_waitcnt vmcnt(0)
    s_barrier
    v_mfma_f32_32x32x16_bf16 v[128:143], a[168:171], v[40:43], v[128:143]
    ds_read_b128 v[32:35], v16 offset:0
    ds_read_b128 v[36:39], v16 offset:4096
    ds_read_b128 v[48:51], v22 offset:768
    ds_read_b128 v[52:55], v22 offset:784
    s_add_u32 m0, s44, 0
    ds_read_b128 v[56:59], v22 offset:3072
    v_mfma_f32_32x32x16_bf16 v[144:159], a[168:171], v[44:47], v[144:159]
    ds_read_b128 v[60:63], v22 offset:3088
    buffer_load_dwordx4 v1, s[12:15], s24 offen offset:0 lds
    ds_read_b64_tr_b16 a[128:129], v21 offset:0
    ds_read_b64_tr_b16 a[130:131], v21 offset:1152
    buffer_load_dwordx4 v2, s[12:15], s25 offen offset:1024 lds
    ds_read_b64_tr_b16 a[132:133], v21 offset:32
    v_mfma_f32_32x32x16_bf16 v[160:175], a[172:175], v[40:43], v[160:175]
    ds_read_b64_tr_b16 a[134:135], v21 offset:1184
    s_waitcnt lgkmcnt(9)
    v_lshlrev_b32 v80, 16, v32
    v_and_b32 v81, 0xffff0000, v32
    v_fma_f32 v80, v80, v84, v85
    buffer_load_dwordx4 v1, s[12:15], s26 offen offset:2048 lds
    v_mfma_f32_32x32x16_bf16 v[176:191], a[172:175], v[44:47], v[176:191]
    v_fma_f32 v81, v81, v84, v85
    s_waitcnt lgkmcnt(5)
    v_fma_f32 v80, v80, v56, v48
    v_fma_f32 v81, v81, v57, v49
    ds_read_b64_tr_b16 a[136:137], v21 offset:64
    v_cvt_pk_bf16_f32 v32, v80, v81
    v_lshlrev_b32 v82, 16, v33
    v_mfma_f32_32x32x16_bf16 v[192:207], a[176:179], v[40:43], v[192:207]
    ds_read_b64_tr_b16 a[138:139], v21 offset:1216
    v_and_b32 v83, 0xffff0000, v33
    v_fma_f32 v82, v82, v84, v85
    v_fma_f32 v83, v83, v84, v85
    buffer_load_dwordx4 v2, s[12:15], s27 offen offset:3072 lds
    v_fma_f32 v82, v82, v58, v50
    v_mfma_f32_32x32x16_bf16 v[208:223], a[176:179], v[44:47], v[208:223]
    v_fma_f32 v83, v83, v59, v51
    ds_read_b64_tr_b16 a[140:141], v21 offset:96
    v_cvt_pk_bf16_f32 v33, v82, v83
    v_lshlrev_b32 v80, 16, v34
    v_and_b32 v81, 0xffff0000, v34
    v_mfma_f32_32x32x16_bf16 v[224:239], a[180:183], v[40:43], v[224:239]
    ds_read_b64_tr_b16 a[142:143], v21 offset:1248
    v_fma_f32 v80, v80, v84, v85
    v_fma_f32 v81, v81, v84, v85
    s_add_u32 m0, s44, 4096
    s_waitcnt lgkmcnt(8)
    v_fma_f32 v80, v80, v60, v52
    v_fma_f32 v81, v81, v61, v53
    v_mfma_f32_32x32x16_bf16 v[240:255], a[180:183], v[44:47], v[240:255]
    v_cvt_pk_bf16_f32 v34, v80, v81
    ds_read_b64_tr_b16 a[144:145], v21 offset:128
    v_lshlrev_b32 v82, 16, v35
    v_and_b32 v83, 0xffff0000, v35
    ds_read_b64_tr_b16 a[146:147], v21 offset:1280
    v_mfma_f32_32x32x16_bf16 a[0:15], a[184:187], v[40:43], a[0:15]
    v_fma_f32 v82, v82, v84, v85
    v_fma_f32 v83, v83, v84, v85
    v_fma_f32 v82, v82, v62, v54
    buffer_load_dwordx4 v1, s[12:15], s28 offen offset:0 lds
    v_fma_f32 v83, v83, v63, v55
    v_cvt_pk_bf16_f32 v35, v82, v83
    v_mfma_f32_32x32x16_bf16 a[16:31], a[184:187], v[44:47], a[16:31]
    ds_read_b64_tr_b16 a[148:149], v21 offset:160
    v_lshlrev_b32 v80, 16, v36
    v_and_b32 v81, 0xffff0000, v36
    v_fma_f32 v80, v80, v86, v87
    ds_read_b64_tr_b16 a[150:151], v21 offset:1312
    v_fma_f32 v81, v81, v86, v87
    v_mfma_f32_32x32x16_bf16 a[32:47], a[188:191], v[40:43], a[32:47]
    v_fma_f32 v80, v80, v56, v48
    v_fma_f32 v81, v81, v57, v49
    buffer_load_dwordx4 v2, s[12:15], s29 offen offset:1024 lds
    v_cvt_pk_bf16_f32 v36, v80, v81
    v_lshlrev_b32 v82, 16, v37
    v_mfma_f32_32x32x16_bf16 a[48:63], a[188:191], v[44:47], a[48:63]
    ds_read_b64_tr_b16 a[152:153], v21 offset:192
    v_and_b32 v83, 0xffff0000, v37
    v_fma_f32 v82, v82, v86, v87
    v_fma_f32 v83, v83, v86, v87
    ds_read_b64_tr_b16 a[154:155], v21 offset:1344
    v_fma_f32 v82, v82, v58, v50
    v_mfma_f32_32x32x16_bf16 a[64:79], a[192:195], v[40:43], a[64:79]
    v_fma_f32 v83, v83, v59, v51
    buffer_load_dwordx4 v1, s[12:15], s30 offen offset:2048 lds
    v_cvt_pk_bf16_f32 v37, v82, v83
    v_lshlrev_b32 v80, 16, v38
    v_and_b32 v81, 0xffff0000, v38
    ds_read_b64_tr_b16 a[156:157], v21 offset:224
    v_mfma_f32_32x32x16_bf16 a[80:95], a[192:195], v[44:47], a[80:95]
    v_fma_f32 v80, v80, v86, v87
    v_fma_f32 v81, v81, v86, v87
    ds_read_b64_tr_b16 a[158:159], v21 offset:1376
    v_fma_f32 v80, v80, v60, v52
    v_fma_f32 v81, v81, v61, v53
    v_mfma_f32_32x32x16_bf16 a[96:111], a[196:199], v[40:43], a[96:111]
    v_cvt_pk_bf16_f32 v38, v80, v81
    buffer_load_dwordx4 v2, s[12:15], s31 offen offset:3072 lds
    v_lshlrev_b32 v82, 16, v39
    v_and_b32 v83, 0xffff0000, v39
    ds_read_b64_tr_b16 a[160:161], v21 offset:256
    v_fma_f32 v82, v82, v86, v87
    v_mfma_f32_32x32x16_bf16 a[112:127], a[196:199], v[44:47], a[112:127]
    v_fma_f32 v83, v83, v86, v87
    v_fma_f32 v82, v82, v62, v54
    ds_read_b64_tr_b16 a[162:163], v21 offset:1408
    v_fma_f32 v83, v83, v63, v55
    v_cvt_pk_bf16_f32 v39, v82, v83
    s_waitcnt lgkmcnt(15)
    v_mfma_f32_32x32x16_bf16 v[96:111], a[128:131], v[32:35], v[96:111]
    ds_read_b128 v[40:43], v17 offset:0
    ds_read_b128 v[44:47], v17 offset:4096
    ds_read_b128 v[64:67], v22 offset:832
    ds_read_b128 v[68:71], v22 offset:848
    s_add_u32 m0, s45, 0
    v_mfma_f32_32x32x16_bf16 v[112:127], a[128:131], v[36:39], v[112:127]
    ds_read_b128 v[72:75], v22 offset:3136
    ds_read_b128 v[76:79], v22 offset:3152
    buffer_load_dwordx4 v3, s[16:19], 0 offen offset:0 lds
    ds_read_b64_tr_b16 a[164:165], v21 offset:4608
    ds_read_b64_tr_b16 a[166:167], v21 offset:5760
    s_waitcnt lgkmcnt(15)
    v_mfma_f32_32x32x16_bf16 v[128:143], a[132:135], v[32:35], v[128:143]
    buffer_load_dwordx4 v4, s[16:19], 0 offen offset:1024 lds
    ds_read_b64_tr_b16 a[168:169], v21 offset:4640
    ds_read_b64_tr_b16 a[170:171], v21 offset:5792
    s_waitcnt lgkmcnt(9)
    v_lshlrev_b32 v80, 16, v40
    v_and_b32 v81, 0xffff0000, v40
    v_mfma_f32_32x32x16_bf16 v[144:159], a[132:135], v[36:39], v[144:159]
    v_fma_f32 v80, v80, v84, v85
    ds_read_b64_tr_b16 a[172:173], v21 offset:4672
    v_fma_f32 v81, v81, v84, v85
    s_waitcnt lgkmcnt(6)
    v_fma_f32 v80, v80, v72, v64
    v_fma_f32 v81, v81, v73, v65
    v_mfma_f32_32x32x16_bf16 v[160:175], a[136:139], v[32:35], v[160:175]
    buffer_load_dwordx4 v5, s[16:19], 0 offen offset:2048 lds
    v_cvt_pk_bf16_f32 v40, v80, v81
    v_lshlrev_b32 v82, 16, v41
    ds_read_b64_tr_b16 a[174:175], v21 offset:5824
    v_and_b32 v83, 0xffff0000, v41
    v_mfma_f32_32x32x16_bf16 v[176:191], a[136:139], v[36:39], v[176:191]
    v_fma_f32 v82, v82, v84, v85
    v_fma_f32 v83, v83, v84, v85
    ds_read_b64_tr_b16 a[176:177], v21 offset:4704
    v_fma_f32 v82, v82, v74, v66
    v_fma_f32 v83, v83, v75, v67
    v_mfma_f32_32x32x16_bf16 v[192:207], a[140:143], v[32:35], v[192:207]
    v_cvt_pk_bf16_f32 v41, v82, v83
    buffer_load_dwordx4 v6, s[16:19], 0 offen offset:3072 lds
    v_lshlrev_b32 v80, 16, v42
    v_and_b32 v81, 0xffff0000, v42
    ds_read_b64_tr_b16 a[178:179], v21 offset:5856
    v_mfma_f32_32x32x16_bf16 v[208:223], a[140:143], v[36:39], v[208:223]
    v_fma_f32 v80, v80, v84, v85
    v_fma_f32 v81, v81, v84, v85
    s_waitcnt lgkmcnt(8)
    v_fma_f32 v80, v80, v76, v68
    ds_read_b64_tr_b16 a[180:181], v21 offset:4736
    v_fma_f32 v81, v81, v77, v69
    v_mfma_f32_32x32x16_bf16 v[224:239], a[144:147], v[32:35], v[224:239]
    v_cvt_pk_bf16_f32 v42, v80, v81
    v_lshlrev_b32 v82, 16, v43
    s_add_u32 m0, s45, 4096
    v_and_b32 v83, 0xffff0000, v43
    v_fma_f32 v82, v82, v84, v85
    v_mfma_f32_32x32x16_bf16 v[240:255], a[144:147], v[36:39], v[240:255]
    ds_read_b64_tr_b16 a[182:183], v21 offset:5888
    v_fma_f32 v83, v83, v84, v85
    v_fma_f32 v82, v82, v78, v70
    v_fma_f32 v83, v83, v79, v71
    ds_read_b64_tr_b16 a[184:185], v21 offset:4768
    v_mfma_f32_32x32x16_bf16 a[0:15], a[148:151], v[32:35], a[0:15]
    v_cvt_pk_bf16_f32 v43, v82, v83
    v_lshlrev_b32 v80, 16, v44
    v_and_b32 v81, 0xffff0000, v44
    ds_read_b64_tr_b16 a[186:187], v21 offset:5920
    v_fma_f32 v80, v80, v86, v87
    v_mfma_f32_32x32x16_bf16 a[16:31], a[148:151], v[36:39], a[16:31]
    v_fma_f32 v81, v81, v86, v87
    buffer_load_dwordx4 v7, s[16:19], 0 offen offset:0 lds
    v_fma_f32 v80, v80, v72, v64
    v_fma_f32 v81, v81, v73, v65
    v_cvt_pk_bf16_f32 v44, v80, v81
    v_mfma_f32_32x32x16_bf16 a[32:47], a[152:155], v[32:35], a[32:47]
    ds_read_b64_tr_b16 a[188:189], v21 offset:4800
    v_lshlrev_b32 v82, 16, v45
    v_and_b32 v83, 0xffff0000, v45
    v_fma_f32 v82, v82, v86, v87
    ds_read_b64_tr_b16 a[190:191], v21 offset:5952
    v_mfma_f32_32x32x16_bf16 a[48:63], a[152:155], v[36:39], a[48:63]
    v_fma_f32 v83, v83, v86, v87
    v_fma_f32 v82, v82, v74, v66
    buffer_load_dwordx4 v8, s[16:19], 0 offen offset:1024 lds
    v_fma_f32 v83, v83, v75, v67
    v_cvt_pk_bf16_f32 v45, v82, v83
    v_mfma_f32_32x32x16_bf16 a[64:79], a[156:159], v[32:35], a[64:79]
    v_lshlrev_b32 v80, 16, v46
    ds_read_b64_tr_b16 a[192:193], v21 offset:4832
    v_and_b32 v81, 0xffff0000, v46
    v_fma_f32 v80, v80, v86, v87
    v_fma_f32 v81, v81, v86, v87
    v_mfma_f32_32x32x16_bf16 a[80:95], a[156:159], v[36:39], a[80:95]
    ds_read_b64_tr_b16 a[194:195], v21 offset:5984
    v_fma_f32 v80, v80, v76, v68
    v_fma_f32 v81, v81, v77, v69
    buffer_load_dwordx4 v9, s[16:19], 0 offen offset:2048 lds
    v_cvt_pk_bf16_f32 v46, v80, v81
    v_mfma_f32_32x32x16_bf16 a[96:111], a[160:163], v[32:35], a[96:111]
    v_lshlrev_b32 v82, 16, v47
    v_and_b32 v83, 0xffff0000, v47
    ds_read_b64_tr_b16 a[196:197], v21 offset:4864
    v_fma_f32 v82, v82, v86, v87
    v_fma_f32 v83, v83, v86, v87
    v_mfma_f32_32x32x16_bf16 a[112:127], a[160:163], v[36:39], a[112:127]
    v_fma_f32 v82, v82, v78, v70
    ds_read_b64_tr_b16 a[198:199], v21 offset:6016
    v_fma_f32 v83, v83, v79, v71
    v_cvt_pk_bf16_f32 v47, v82, v83
    s_waitcnt lgkmcnt(15)
    v_mfma_f32_32x32x16_bf16 v[96:111], a[164:167], v[40:43], v[96:111]
    ds_read_b128 v[32:35], v18 offset:0
    ds_read_b128 v[36:39], v18 offset:4096
    ds_read_b128 v[48:51], v22 offset:896
    ds_read_b128 v[52:55], v22 offset:912
    buffer_load_dwordx4 v10, s[16:19], 0 offen offset:3072 lds
    v_mfma_f32_32x32x16_bf16 v[112:127], a[164:167], v[44:47], v[112:127]
    ds_read_b128 v[56:59], v22 offset:3200
    ds_read_b128 v[60:63], v22 offset:3216
    s_add_u32 m0, s45, 8192
    ds_read_b64_tr_b16 a[128:129], v21 offset:9216
    ds_read_b64_tr_b16 a[130:131], v21 offset:10368
    s_waitcnt lgkmcnt(15)
    v_mfma_f32_32x32x16_bf16 v[128:143], a[168:171], v[40:43], v[128:143]
    buffer_load_dwordx4 v11, s[16:19], 0 offen offset:0 lds
    ds_read_b64_tr_b16 a[132:133], v21 offset:9248
    ds_read_b64_tr_b16 a[134:135], v21 offset:10400
    s_waitcnt lgkmcnt(9)
    v_lshlrev_b32 v80, 16, v32
    v_and_b32 v81, 0xffff0000, v32
    v_mfma_f32_32x32x16_bf16 v[144:159], a[168:171], v[44:47], v[144:159]
    v_fma_f32 v80, v80, v84, v85
    ds_read_b64_tr_b16 a[136:137], v21 offset:9280
    v_fma_f32 v81, v81, v84, v85
    s_waitcnt lgkmcnt(6)
    v_fma_f32 v80, v80, v56, v48
    v_fma_f32 v81, v81, v57, v49
    v_mfma_f32_32x32x16_bf16 v[160:175], a[172:175], v[40:43], v[160:175]
    s_add_u32 s12, s12, 128
    v_cvt_pk_bf16_f32 v32, v80, v81
    v_lshlrev_b32 v82, 16, v33
    ds_read_b64_tr_b16 a[138:139], v21 offset:10432
    v_and_b32 v83, 0xffff0000, v33
    v_mfma_f32_32x32x16_bf16 v[176:191], a[172:175], v[44:47], v[176:191]
    v_fma_f32 v82, v82, v84, v85
    v_fma_f32 v83, v83, v84, v85
    ds_read_b64_tr_b16 a[140:141], v21 offset:9312
    v_fma_f32 v82, v82, v58, v50
    v_fma_f32 v83, v83, v59, v51
    v_mfma_f32_32x32x16_bf16 v[192:207], a[176:179], v[40:43], v[192:207]
    v_cvt_pk_bf16_f32 v33, v82, v83
    s_addc_u32 s13, s13, 0
    v_lshlrev_b32 v80, 16, v34
    v_and_b32 v81, 0xffff0000, v34
    ds_read_b64_tr_b16 a[142:143], v21 offset:10464
    v_mfma_f32_32x32x16_bf16 v[208:223], a[176:179], v[44:47], v[208:223]
    v_fma_f32 v80, v80, v84, v85
    v_fma_f32 v81, v81, v84, v85
    s_waitcnt lgkmcnt(8)
    v_fma_f32 v80, v80, v60, v52
    ds_read_b64_tr_b16 a[144:145], v21 offset:9344
    v_fma_f32 v81, v81, v61, v53
    v_mfma_f32_32x32x16_bf16 v[224:239], a[180:183], v[40:43], v[224:239]
    v_cvt_pk_bf16_f32 v34, v80, v81
    v_lshlrev_b32 v82, 16, v35
    s_sub_u32 s14, s14, 128
    v_and_b32 v83, 0xffff0000, v35
    v_fma_f32 v82, v82, v84, v85
    v_mfma_f32_32x32x16_bf16 v[240:255], a[180:183], v[44:47], v[240:255]
    ds_read_b64_tr_b16 a[146:147], v21 offset:10496
    v_fma_f32 v83, v83, v84, v85
    v_fma_f32 v82, v82, v62, v54
    v_fma_f32 v83, v83, v63, v55
    ds_read_b64_tr_b16 a[148:149], v21 offset:9376
    v_mfma_f32_32x32x16_bf16 a[0:15], a[184:187], v[40:43], a[0:15]
    v_cvt_pk_bf16_f32 v35, v82, v83
    v_lshlrev_b32 v80, 16, v36
    v_and_b32 v81, 0xffff0000, v36
    ds_read_b64_tr_b16 a[150:151], v21 offset:10528
    v_fma_f32 v80, v80, v86, v87
    v_mfma_f32_32x32x16_bf16 a[16:31], a[184:187], v[44:47], a[16:31]
    v_fma_f32 v81, v81, v86, v87
    s_add_u32 s16, s16, 589824
    v_fma_f32 v80, v80, v56, v48
    v_fma_f32 v81, v81, v57, v49
    v_cvt_pk_bf16_f32 v36, v80, v81
    v_mfma_f32_32x32x16_bf16 a[32:47], a[188:191], v[40:43], a[32:47]
    ds_read_b64_tr_b16 a[152:153], v21 offset:9408
    v_lshlrev_b32 v82, 16, v37
    v_and_b32 v83, 0xffff0000, v37
    v_fma_f32 v82, v82, v86, v87
    ds_read_b64_tr_b16 a[154:155], v21 offset:10560
    v_mfma_f32_32x32x16_bf16 a[48:63], a[188:191], v[44:47], a[48:63]
    v_fma_f32 v83, v83, v86, v87
    v_fma_f32 v82, v82, v58, v50
    s_addc_u32 s17, s17, 0
    v_fma_f32 v83, v83, v59, v51
    v_cvt_pk_bf16_f32 v37, v82, v83
    v_mfma_f32_32x32x16_bf16 a[64:79], a[192:195], v[40:43], a[64:79]
    v_lshlrev_b32 v80, 16, v38
    ds_read_b64_tr_b16 a[156:157], v21 offset:9440
    v_and_b32 v81, 0xffff0000, v38
    v_fma_f32 v80, v80, v86, v87
    v_fma_f32 v81, v81, v86, v87
    v_mfma_f32_32x32x16_bf16 a[80:95], a[192:195], v[44:47], a[80:95]
    ds_read_b64_tr_b16 a[158:159], v21 offset:10592
    v_fma_f32 v80, v80, v60, v52
    v_fma_f32 v81, v81, v61, v53
    s_sub_u32 s18, s18, 589824
    v_cvt_pk_bf16_f32 v38, v80, v81
    v_mfma_f32_32x32x16_bf16 a[96:111], a[196:199], v[40:43], a[96:111]
    v_lshlrev_b32 v82, 16, v39
    v_and_b32 v83, 0xffff0000, v39
    ds_read_b64_tr_b16 a[160:161], v21 offset:9472
    v_fma_f32 v82, v82, v86, v87
    v_fma_f32 v83, v83, v86, v87
    v_mfma_f32_32x32x16_bf16 a[112:127], a[196:199], v[44:47], a[112:127]
    v_fma_f32 v82, v82, v62, v54
    ds_read_b64_tr_b16 a[162:163], v21 offset:10624
    v_fma_f32 v83, v83, v63, v55
    v_cvt_pk_bf16_f32 v39, v82, v83
    s_waitcnt lgkmcnt(15)
    v_mfma_f32_32x32x16_bf16 v[96:111], a[128:131], v[32:35], v[96:111]
    ds_read_b128 v[40:43], v19 offset:0
    ds_read_b128 v[44:47], v19 offset:4096
    ds_read_b128 v[64:67], v22 offset:960
    ds_read_b128 v[68:71], v22 offset:976
    ds_read_b128 v[72:75], v22 offset:3264
    v_mfma_f32_32x32x16_bf16 v[112:127], a[128:131], v[36:39], v[112:127]
    ds_read_b128 v[76:79], v22 offset:3280
    ds_read_b64_tr_b16 a[164:165], v21 offset:13824
    ds_read_b64_tr_b16 a[166:167], v21 offset:14976
    ds_read_b64_tr_b16 a[168:169], v21 offset:13856
    s_waitcnt lgkmcnt(15)
    v_mfma_f32_32x32x16_bf16 v[128:143], a[132:135], v[32:35], v[128:143]
    ds_read_b64_tr_b16 a[170:171], v21 offset:15008
    ds_read_b64_tr_b16 a[172:173], v21 offset:13888
    ds_read_b64_tr_b16 a[174:175], v21 offset:15040
    ds_read_b64_tr_b16 a[176:177], v21 offset:13920
    s_waitcnt lgkmcnt(12)
    v_lshlrev_b32 v80, 16, v40
    v_mfma_f32_32x32x16_bf16 v[144:159], a[132:135], v[36:39], v[144:159]
    v_and_b32 v81, 0xffff0000, v40
    v_fma_f32 v80, v80, v84, v85
    v_fma_f32 v81, v81, v84, v85
    s_waitcnt lgkmcnt(8)
    v_fma_f32 v80, v80, v72, v64
    v_mfma_f32_32x32x16_bf16 v[160:175], a[136:139], v[32:35], v[160:175]
    ds_read_b64_tr_b16 a[178:179], v21 offset:15072
    v_fma_f32 v81, v81, v73, v65
    v_cvt_pk_bf16_f32 v40, v80, v81
    v_lshlrev_b32 v82, 16, v41
    v_and_b32 v83, 0xffff0000, v41
    v_mfma_f32_32x32x16_bf16 v[176:191], a[136:139], v[36:39], v[176:191]
    v_fma_f32 v82, v82, v84, v85
    ds_read_b64_tr_b16 a[180:181], v21 offset:13952
    v_fma_f32 v83, v83, v84, v85
    v_fma_f32 v82, v82, v74, v66
    v_mfma_f32_32x32x16_bf16 v[192:207], a[140:143], v[32:35], v[192:207]
    v_fma_f32 v83, v83, v75, v67
    v_cvt_pk_bf16_f32 v41, v82, v83
    ds_read_b64_tr_b16 a[182:183], v21 offset:15104
    v_lshlrev_b32 v80, 16, v42
    v_and_b32 v81, 0xffff0000, v42
    v_mfma_f32_32x32x16_bf16 v[208:223], a[140:143], v[36:39], v[208:223]
    v_fma_f32 v80, v80, v84, v85
    v_fma_f32 v81, v81, v84, v85
    s_waitcnt lgkmcnt(10)
    v_fma_f32 v80, v80, v76, v68
    ds_read_b64_tr_b16 a[184:185], v21 offset:13984
    v_mfma_f32_32x32x16_bf16 v[224:239], a[144:147], v[32:35], v[224:239]
    v_fma_f32 v81, v81, v77, v69
    v_cvt_pk_bf16_f32 v42, v80, v81
    v_lshlrev_b32 v82, 16, v43
    v_and_b32 v83, 0xffff0000, v43
    v_mfma_f32_32x32x16_bf16 v[240:255], a[144:147], v[36:39], v[240:255]
    v_fma_f32 v82, v82, v84, v85
    ds_read_b64_tr_b16 a[186:187], v21 offset:15136
    v_fma_f32 v83, v83, v84, v85
    v_fma_f32 v82, v82, v78, v70
    v_fma_f32 v83, v83, v79, v71
    v_mfma_f32_32x32x16_bf16 a[0:15], a[148:151], v[32:35], a[0:15]
    v_cvt_pk_bf16_f32 v43, v82, v83
    ds_read_b64_tr_b16 a[188:189], v21 offset:14016
    v_lshlrev_b32 v80, 16, v44
    v_and_b32 v81, 0xffff0000, v44
    v_mfma_f32_32x32x16_bf16 a[16:31], a[148:151], v[36:39], a[16:31]
    v_fma_f32 v80, v80, v86, v87
    v_fma_f32 v81, v81, v86, v87
    v_fma_f32 v80, v80, v72, v64
    ds_read_b64_tr_b16 a[190:191], v21 offset:15168
    v_fma_f32 v81, v81, v73, v65
    v_mfma_f32_32x32x16_bf16 a[32:47], a[152:155], v[32:35], a[32:47]
    v_cvt_pk_bf16_f32 v44, v80, v81
    v_lshlrev_b32 v82, 16, v45
    v_and_b32 v83, 0xffff0000, v45
    v_fma_f32 v82, v82, v86, v87
    v_mfma_f32_32x32x16_bf16 a[48:63], a[152:155], v[36:39], a[48:63]
    ds_read_b64_tr_b16 a[192:193], v21 offset:14048
    v_fma_f32 v83, v83, v86, v87
    v_fma_f32 v82, v82, v74, v66
    v_fma_f32 v83, v83, v75, v67
    v_cvt_pk_bf16_f32 v45, v82, v83
    v_mfma_f32_32x32x16_bf16 a[64:79], a[156:159], v[32:35], a[64:79]
    ds_read_b64_tr_b16 a[194:195], v21 offset:15200
    v_lshlrev_b32 v80, 16, v46
    v_and_b32 v81, 0xffff0000, v46
    v_fma_f32 v80, v80, v86, v87
    v_mfma_f32_32x32x16_bf16 a[80:95], a[156:159], v[36:39], a[80:95]
    v_fma_f32 v81, v81, v86, v87
    v_fma_f32 v80, v80, v76, v68
    ds_read_b64_tr_b16 a[196:197], v21 offset:14080
    v_fma_f32 v81, v81, v77, v69
    v_cvt_pk_bf16_f32 v46, v80, v81
    v_mfma_f32_32x32x16_bf16 a[96:111], a[160:163], v[32:35], a[96:111]
    v_lshlrev_b32 v82, 16, v47
    v_and_b32 v83, 0xffff0000, v47
    v_fma_f32 v82, v82, v86, v87
    ds_read_b64_tr_b16 a[198:199], v21 offset:15232
    v_mfma_f32_32x32x16_bf16 a[112:127], a[160:163], v[36:39], a[112:127]
    v_fma_f32 v83, v83, v86, v87
    v_fma_f32 v82, v82, v78, v70
    v_fma_f32 v83, v83, v79, v71
    v_cvt_pk_bf16_f32 v47, v82, v83
    s_waitcnt lgkmcnt(0)
    v_mfma_f32_32x32x16_bf16 v[96:111], a[164:167], v[40:43], v[96:111]
    v_mfma_f32_32x32x16_bf16 v[112:127], a[164:167], v[44:47], v[112:127]
    s_waitcnt vmcnt(0)
    s_barrier
    v_mfma_f32_32x32x16_bf16 v[128:143], a[168:171], v[40:43], v[128:143]
    ds_read_b128 v[32:35], v12 offset:0
    ds_read_b128 v[36:39], v12 offset:4096
    ds_read_b128 v[48:51], v22 offset:1024
    ds_read_b128 v[52:55], v22 offset:1040
    s_add_u32 m0, s44, 69760
    ds_read_b128 v[56:59], v22 offset:3328
    v_mfma_f32_32x32x16_bf16 v[144:159], a[168:171], v[44:47], v[144:159]
    ds_read_b128 v[60:63], v22 offset:3344
    buffer_load_dwordx4 v1, s[12:15], s24 offen offset:0 lds
    ds_read_b64_tr_b16 a[128:129], v20 offset:0
    ds_read_b64_tr_b16 a[130:131], v20 offset:1152
    buffer_load_dwordx4 v2, s[12:15], s25 offen offset:1024 lds
    ds_read_b64_tr_b16 a[132:133], v20 offset:32
    v_mfma_f32_32x32x16_bf16 v[160:175], a[172:175], v[40:43], v[160:175]
    ds_read_b64_tr_b16 a[134:135], v20 offset:1184
    s_waitcnt lgkmcnt(9)
    v_lshlrev_b32 v80, 16, v32
    v_and_b32 v81, 0xffff0000, v32
    v_fma_f32 v80, v80, v84, v85
    buffer_load_dwordx4 v1, s[12:15], s26 offen offset:2048 lds
    v_mfma_f32_32x32x16_bf16 v[176:191], a[172:175], v[44:47], v[176:191]
    v_fma_f32 v81, v81, v84, v85
    s_waitcnt lgkmcnt(5)
    v_fma_f32 v80, v80, v56, v48
    v_fma_f32 v81, v81, v57, v49
    ds_read_b64_tr_b16 a[136:137], v20 offset:64
    v_cvt_pk_bf16_f32 v32, v80, v81
    v_lshlrev_b32 v82, 16, v33
    v_mfma_f32_32x32x16_bf16 v[192:207], a[176:179], v[40:43], v[192:207]
    ds_read_b64_tr_b16 a[138:139], v20 offset:1216
    v_and_b32 v83, 0xffff0000, v33
    v_fma_f32 v82, v82, v84, v85
    v_fma_f32 v83, v83, v84, v85
    buffer_load_dwordx4 v2, s[12:15], s27 offen offset:3072 lds
    v_fma_f32 v82, v82, v58, v50
    v_mfma_f32_32x32x16_bf16 v[208:223], a[176:179], v[44:47], v[208:223]
    v_fma_f32 v83, v83, v59, v51
    ds_read_b64_tr_b16 a[140:141], v20 offset:96
    v_cvt_pk_bf16_f32 v33, v82, v83
    v_lshlrev_b32 v80, 16, v34
    v_and_b32 v81, 0xffff0000, v34
    v_mfma_f32_32x32x16_bf16 v[224:239], a[180:183], v[40:43], v[224:239]
    ds_read_b64_tr_b16 a[142:143], v20 offset:1248
    v_fma_f32 v80, v80, v84, v85
    v_fma_f32 v81, v81, v84, v85
    s_add_u32 m0, s44, 73856
    s_waitcnt lgkmcnt(8)
    v_fma_f32 v80, v80, v60, v52
    v_fma_f32 v81, v81, v61, v53
    v_mfma_f32_32x32x16_bf16 v[240:255], a[180:183], v[44:47], v[240:255]
    v_cvt_pk_bf16_f32 v34, v80, v81
    ds_read_b64_tr_b16 a[144:145], v20 offset:128
    v_lshlrev_b32 v82, 16, v35
    v_and_b32 v83, 0xffff0000, v35
    ds_read_b64_tr_b16 a[146:147], v20 offset:1280
    v_mfma_f32_32x32x16_bf16 a[0:15], a[184:187], v[40:43], a[0:15]
    v_fma_f32 v82, v82, v84, v85
    v_fma_f32 v83, v83, v84, v85
    v_fma_f32 v82, v82, v62, v54
    buffer_load_dwordx4 v1, s[12:15], s28 offen offset:0 lds
    v_fma_f32 v83, v83, v63, v55
    v_cvt_pk_bf16_f32 v35, v82, v83
    v_mfma_f32_32x32x16_bf16 a[16:31], a[184:187], v[44:47], a[16:31]
    ds_read_b64_tr_b16 a[148:149], v20 offset:160
    v_lshlrev_b32 v80, 16, v36
    v_and_b32 v81, 0xffff0000, v36
    v_fma_f32 v80, v80, v86, v87
    ds_read_b64_tr_b16 a[150:151], v20 offset:1312
    v_fma_f32 v81, v81, v86, v87
    v_mfma_f32_32x32x16_bf16 a[32:47], a[188:191], v[40:43], a[32:47]
    v_fma_f32 v80, v80, v56, v48
    v_fma_f32 v81, v81, v57, v49
    buffer_load_dwordx4 v2, s[12:15], s29 offen offset:1024 lds
    v_cvt_pk_bf16_f32 v36, v80, v81
    v_lshlrev_b32 v82, 16, v37
    v_mfma_f32_32x32x16_bf16 a[48:63], a[188:191], v[44:47], a[48:63]
    ds_read_b64_tr_b16 a[152:153], v20 offset:192
    v_and_b32 v83, 0xffff0000, v37
    v_fma_f32 v82, v82, v86, v87
    v_fma_f32 v83, v83, v86, v87
    ds_read_b64_tr_b16 a[154:155], v20 offset:1344
    v_fma_f32 v82, v82, v58, v50
    v_mfma_f32_32x32x16_bf16 a[64:79], a[192:195], v[40:43], a[64:79]
    v_fma_f32 v83, v83, v59, v51
    buffer_load_dwordx4 v1, s[12:15], s30 offen offset:2048 lds
    v_cvt_pk_bf16_f32 v37, v82, v83
    v_lshlrev_b32 v80, 16, v38
    v_and_b32 v81, 0xffff0000, v38
    ds_read_b64_tr_b16 a[156:157], v20 offset:224
    v_mfma_f32_32x32x16_bf16 a[80:95], a[192:195], v[44:47], a[80:95]
    v_fma_f32 v80, v80, v86, v87
    v_fma_f32 v81, v81, v86, v87
    ds_read_b64_tr_b16 a[158:159], v20 offset:1376
    v_fma_f32 v80, v80, v60, v52
    v_fma_f32 v81, v81, v61, v53
    v_mfma_f32_32x32x16_bf16 a[96:111], a[196:199], v[40:43], a[96:111]
    v_cvt_pk_bf16_f32 v38, v80, v81
    buffer_load_dwordx4 v2, s[12:15], s31 offen offset:3072 lds
    v_lshlrev_b32 v82, 16, v39
    v_and_b32 v83, 0xffff0000, v39
    ds_read_b64_tr_b16 a[160:161], v20 offset:256
    v_fma_f32 v82, v82, v86, v87
    v_mfma_f32_32x32x16_bf16 a[112:127], a[196:199], v[44:47], a[112:127]
    v_fma_f32 v83, v83, v86, v87
    v_fma_f32 v82, v82, v62, v54
    ds_read_b64_tr_b16 a[162:163], v20 offset:1408
    v_fma_f32 v83, v83, v63, v55
    v_cvt_pk_bf16_f32 v39, v82, v83
    s_waitcnt lgkmcnt(15)
    v_mfma_f32_32x32x16_bf16 v[96:111], a[128:131], v[32:35], v[96:111]
    ds_read_b128 v[40:43], v13 offset:0
    ds_read_b128 v[44:47], v13 offset:4096
    ds_read_b128 v[64:67], v22 offset:1088
    ds_read_b128 v[68:71], v22 offset:1104
    s_add_u32 m0, s45, 69760
    v_mfma_f32_32x32x16_bf16 v[112:127], a[128:131], v[36:39], v[112:127]
    ds_read_b128 v[72:75], v22 offset:3392
    ds_read_b128 v[76:79], v22 offset:3408
    buffer_load_dwordx4 v3, s[16:19], 0 offen offset:0 lds
    ds_read_b64_tr_b16 a[164:165], v20 offset:4608
    ds_read_b64_tr_b16 a[166:167], v20 offset:5760
    s_waitcnt lgkmcnt(15)
    v_mfma_f32_32x32x16_bf16 v[128:143], a[132:135], v[32:35], v[128:143]
    buffer_load_dwordx4 v4, s[16:19], 0 offen offset:1024 lds
    ds_read_b64_tr_b16 a[168:169], v20 offset:4640
    ds_read_b64_tr_b16 a[170:171], v20 offset:5792
    s_waitcnt lgkmcnt(9)
    v_lshlrev_b32 v80, 16, v40
    v_and_b32 v81, 0xffff0000, v40
    v_mfma_f32_32x32x16_bf16 v[144:159], a[132:135], v[36:39], v[144:159]
    v_fma_f32 v80, v80, v84, v85
    ds_read_b64_tr_b16 a[172:173], v20 offset:4672
    v_fma_f32 v81, v81, v84, v85
    s_waitcnt lgkmcnt(6)
    v_fma_f32 v80, v80, v72, v64
    v_fma_f32 v81, v81, v73, v65
    v_mfma_f32_32x32x16_bf16 v[160:175], a[136:139], v[32:35], v[160:175]
    buffer_load_dwordx4 v5, s[16:19], 0 offen offset:2048 lds
    v_cvt_pk_bf16_f32 v40, v80, v81
    v_lshlrev_b32 v82, 16, v41
    ds_read_b64_tr_b16 a[174:175], v20 offset:5824
    v_and_b32 v83, 0xffff0000, v41
    v_mfma_f32_32x32x16_bf16 v[176:191], a[136:139], v[36:39], v[176:191]
    v_fma_f32 v82, v82, v84, v85
    v_fma_f32 v83, v83, v84, v85
    ds_read_b64_tr_b16 a[176:177], v20 offset:4704
    v_fma_f32 v82, v82, v74, v66
    v_fma_f32 v83, v83, v75, v67
    v_mfma_f32_32x32x16_bf16 v[192:207], a[140:143], v[32:35], v[192:207]
    v_cvt_pk_bf16_f32 v41, v82, v83
    buffer_load_dwordx4 v6, s[16:19], 0 offen offset:3072 lds
    v_lshlrev_b32 v80, 16, v42
    v_and_b32 v81, 0xffff0000, v42
    ds_read_b64_tr_b16 a[178:179], v20 offset:5856
    v_mfma_f32_32x32x16_bf16 v[208:223], a[140:143], v[36:39], v[208:223]
    v_fma_f32 v80, v80, v84, v85
    v_fma_f32 v81, v81, v84, v85
    s_waitcnt lgkmcnt(8)
    v_fma_f32 v80, v80, v76, v68
    ds_read_b64_tr_b16 a[180:181], v20 offset:4736
    v_fma_f32 v81, v81, v77, v69
    v_mfma_f32_32x32x16_bf16 v[224:239], a[144:147], v[32:35], v[224:239]
    v_cvt_pk_bf16_f32 v42, v80, v81
    v_lshlrev_b32 v82, 16, v43
    s_add_u32 m0, s45, 73856
    v_and_b32 v83, 0xffff0000, v43
    v_fma_f32 v82, v82, v84, v85
    v_mfma_f32_32x32x16_bf16 v[240:255], a[144:147], v[36:39], v[240:255]
    ds_read_b64_tr_b16 a[182:183], v20 offset:5888
    v_fma_f32 v83, v83, v84, v85
    v_fma_f32 v82, v82, v78, v70
    v_fma_f32 v83, v83, v79, v71
    ds_read_b64_tr_b16 a[184:185], v20 offset:4768
    v_mfma_f32_32x32x16_bf16 a[0:15], a[148:151], v[32:35], a[0:15]
    v_cvt_pk_bf16_f32 v43, v82, v83
    v_lshlrev_b32 v80, 16, v44
    v_and_b32 v81, 0xffff0000, v44
    ds_read_b64_tr_b16 a[186:187], v20 offset:5920
    v_fma_f32 v80, v80, v86, v87
    v_mfma_f32_32x32x16_bf16 a[16:31], a[148:151], v[36:39], a[16:31]
    v_fma_f32 v81, v81, v86, v87
    buffer_load_dwordx4 v7, s[16:19], 0 offen offset:0 lds
    v_fma_f32 v80, v80, v72, v64
    v_fma_f32 v81, v81, v73, v65
    v_cvt_pk_bf16_f32 v44, v80, v81
    v_mfma_f32_32x32x16_bf16 a[32:47], a[152:155], v[32:35], a[32:47]
    ds_read_b64_tr_b16 a[188:189], v20 offset:4800
    v_lshlrev_b32 v82, 16, v45
    v_and_b32 v83, 0xffff0000, v45
    v_fma_f32 v82, v82, v86, v87
    ds_read_b64_tr_b16 a[190:191], v20 offset:5952
    v_mfma_f32_32x32x16_bf16 a[48:63], a[152:155], v[36:39], a[48:63]
    v_fma_f32 v83, v83, v86, v87
    v_fma_f32 v82, v82, v74, v66
    buffer_load_dwordx4 v8, s[16:19], 0 offen offset:1024 lds
    v_fma_f32 v83, v83, v75, v67
    v_cvt_pk_bf16_f32 v45, v82, v83
    v_mfma_f32_32x32x16_bf16 a[64:79], a[156:159], v[32:35], a[64:79]
    v_lshlrev_b32 v80, 16, v46
    ds_read_b64_tr_b16 a[192:193], v20 offset:4832
    v_and_b32 v81, 0xffff0000, v46
    v_fma_f32 v80, v80, v86, v87
    v_fma_f32 v81, v81, v86, v87
    v_mfma_f32_32x32x16_bf16 a[80:95], a[156:159], v[36:39], a[80:95]
    ds_read_b64_tr_b16 a[194:195], v20 offset:5984
    v_fma_f32 v80, v80, v76, v68
    v_fma_f32 v81, v81, v77, v69
    buffer_load_dwordx4 v9, s[16:19], 0 offen offset:2048 lds
    v_cvt_pk_bf16_f32 v46, v80, v81
    v_mfma_f32_32x32x16_bf16 a[96:111], a[160:163], v[32:35], a[96:111]
    v_lshlrev_b32 v82, 16, v47
    v_and_b32 v83, 0xffff0000, v47
    ds_read_b64_tr_b16 a[196:197], v20 offset:4864
    v_fma_f32 v82, v82, v86, v87
    v_fma_f32 v83, v83, v86, v87
    v_mfma_f32_32x32x16_bf16 a[112:127], a[160:163], v[36:39], a[112:127]
    v_fma_f32 v82, v82, v78, v70
    ds_read_b64_tr_b16 a[198:199], v20 offset:6016
    v_fma_f32 v83, v83, v79, v71
    v_cvt_pk_bf16_f32 v47, v82, v83
    s_waitcnt lgkmcnt(15)
    v_mfma_f32_32x32x16_bf16 v[96:111], a[164:167], v[40:43], v[96:111]
    ds_read_b128 v[32:35], v14 offset:0
    ds_read_b128 v[36:39], v14 offset:4096
    ds_read_b128 v[48:51], v22 offset:1152
    ds_read_b128 v[52:55], v22 offset:1168
    buffer_load_dwordx4 v10, s[16:19], 0 offen offset:3072 lds
    v_mfma_f32_32x32x16_bf16 v[112:127], a[164:167], v[44:47], v[112:127]
    ds_read_b128 v[56:59], v22 offset:3456
    ds_read_b128 v[60:63], v22 offset:3472
    s_add_u32 m0, s45, 77952
    ds_read_b64_tr_b16 a[128:129], v20 offset:9216
    ds_read_b64_tr_b16 a[130:131], v20 offset:10368
    s_waitcnt lgkmcnt(15)
    v_mfma_f32_32x32x16_bf16 v[128:143], a[168:171], v[40:43], v[128:143]
    buffer_load_dwordx4 v11, s[16:19], 0 offen offset:0 lds
    ds_read_b64_tr_b16 a[132:133], v20 offset:9248
    ds_read_b64_tr_b16 a[134:135], v20 offset:10400
    s_waitcnt lgkmcnt(9)
    v_lshlrev_b32 v80, 16, v32
    v_and_b32 v81, 0xffff0000, v32
    v_mfma_f32_32x32x16_bf16 v[144:159], a[168:171], v[44:47], v[144:159]
    v_fma_f32 v80, v80, v84, v85
    ds_read_b64_tr_b16 a[136:137], v20 offset:9280
    v_fma_f32 v81, v81, v84, v85
    s_waitcnt lgkmcnt(6)
    v_fma_f32 v80, v80, v56, v48
    v_fma_f32 v81, v81, v57, v49
    v_mfma_f32_32x32x16_bf16 v[160:175], a[172:175], v[40:43], v[160:175]
    s_add_u32 s12, s12, 128
    v_cvt_pk_bf16_f32 v32, v80, v81
    v_lshlrev_b32 v82, 16, v33
    ds_read_b64_tr_b16 a[138:139], v20 offset:10432
    v_and_b32 v83, 0xffff0000, v33
    v_mfma_f32_32x32x16_bf16 v[176:191], a[172:175], v[44:47], v[176:191]
    v_fma_f32 v82, v82, v84, v85
    v_fma_f32 v83, v83, v84, v85
    ds_read_b64_tr_b16 a[140:141], v20 offset:9312
    v_fma_f32 v82, v82, v58, v50
    v_fma_f32 v83, v83, v59, v51
    v_mfma_f32_32x32x16_bf16 v[192:207], a[176:179], v[40:43], v[192:207]
    v_cvt_pk_bf16_f32 v33, v82, v83
    s_addc_u32 s13, s13, 0
    v_lshlrev_b32 v80, 16, v34
    v_and_b32 v81, 0xffff0000, v34
    ds_read_b64_tr_b16 a[142:143], v20 offset:10464
    v_mfma_f32_32x32x16_bf16 v[208:223], a[176:179], v[44:47], v[208:223]
    v_fma_f32 v80, v80, v84, v85
    v_fma_f32 v81, v81, v84, v85
    s_waitcnt lgkmcnt(8)
    v_fma_f32 v80, v80, v60, v52
    ds_read_b64_tr_b16 a[144:145], v20 offset:9344
    v_fma_f32 v81, v81, v61, v53
    v_mfma_f32_32x32x16_bf16 v[224:239], a[180:183], v[40:43], v[224:239]
    v_cvt_pk_bf16_f32 v34, v80, v81
    v_lshlrev_b32 v82, 16, v35
    s_sub_u32 s14, s14, 128
    v_and_b32 v83, 0xffff0000, v35
    v_fma_f32 v82, v82, v84, v85
    v_mfma_f32_32x32x16_bf16 v[240:255], a[180:183], v[44:47], v[240:255]
    ds_read_b64_tr_b16 a[146:147], v20 offset:10496
    v_fma_f32 v83, v83, v84, v85
    v_fma_f32 v82, v82, v62, v54
    v_fma_f32 v83, v83, v63, v55
    ds_read_b64_tr_b16 a[148:149], v20 offset:9376
    v_mfma_f32_32x32x16_bf16 a[0:15], a[184:187], v[40:43], a[0:15]
    v_cvt_pk_bf16_f32 v35, v82, v83
    v_lshlrev_b32 v80, 16, v36
    v_and_b32 v81, 0xffff0000, v36
    ds_read_b64_tr_b16 a[150:151], v20 offset:10528
    v_fma_f32 v80, v80, v86, v87
    v_mfma_f32_32x32x16_bf16 a[16:31], a[184:187], v[44:47], a[16:31]
    v_fma_f32 v81, v81, v86, v87
    s_add_u32 s16, s16, 589824
    v_fma_f32 v80, v80, v56, v48
    v_fma_f32 v81, v81, v57, v49
    v_cvt_pk_bf16_f32 v36, v80, v81
    v_mfma_f32_32x32x16_bf16 a[32:47], a[188:191], v[40:43], a[32:47]
    ds_read_b64_tr_b16 a[152:153], v20 offset:9408
    v_lshlrev_b32 v82, 16, v37
    v_and_b32 v83, 0xffff0000, v37
    v_fma_f32 v82, v82, v86, v87
    ds_read_b64_tr_b16 a[154:155], v20 offset:10560
    v_mfma_f32_32x32x16_bf16 a[48:63], a[188:191], v[44:47], a[48:63]
    v_fma_f32 v83, v83, v86, v87
    v_fma_f32 v82, v82, v58, v50
    s_addc_u32 s17, s17, 0
    v_fma_f32 v83, v83, v59, v51
    v_cvt_pk_bf16_f32 v37, v82, v83
    v_mfma_f32_32x32x16_bf16 a[64:79], a[192:195], v[40:43], a[64:79]
    v_lshlrev_b32 v80, 16, v38
    ds_read_b64_tr_b16 a[156:157], v20 offset:9440
    v_and_b32 v81, 0xffff0000, v38
    v_fma_f32 v80, v80, v86, v87
    v_fma_f32 v81, v81, v86, v87
    v_mfma_f32_32x32x16_bf16 a[80:95], a[192:195], v[44:47], a[80:95]
    ds_read_b64_tr_b16 a[158:159], v20 offset:10592
    v_fma_f32 v80, v80, v60, v52
    v_fma_f32 v81, v81, v61, v53
    s_sub_u32 s18, s18, 589824
    v_cvt_pk_bf16_f32 v38, v80, v81
    v_mfma_f32_32x32x16_bf16 a[96:111], a[196:199], v[40:43], a[96:111]
    v_lshlrev_b32 v82, 16, v39
    v_and_b32 v83, 0xffff0000, v39
    ds_read_b64_tr_b16 a[160:161], v20 offset:9472
    v_fma_f32 v82, v82, v86, v87
    v_fma_f32 v83, v83, v86, v87
    v_mfma_f32_32x32x16_bf16 a[112:127], a[196:199], v[44:47], a[112:127]
    v_fma_f32 v82, v82, v62, v54
    ds_read_b64_tr_b16 a[162:163], v20 offset:10624
    v_fma_f32 v83, v83, v63, v55
    v_cvt_pk_bf16_f32 v39, v82, v83
    s_waitcnt lgkmcnt(15)
    v_mfma_f32_32x32x16_bf16 v[96:111], a[128:131], v[32:35], v[96:111]
    ds_read_b128 v[40:43], v15 offset:0
    ds_read_b128 v[44:47], v15 offset:4096
    ds_read_b128 v[64:67], v22 offset:1216
    ds_read_b128 v[68:71], v22 offset:1232
    ds_read_b128 v[72:75], v22 offset:3520
    v_mfma_f32_32x32x16_bf16 v[112:127], a[128:131], v[36:39], v[112:127]
    ds_read_b128 v[76:79], v22 offset:3536
    ds_read_b64_tr_b16 a[164:165], v20 offset:13824
    ds_read_b64_tr_b16 a[166:167], v20 offset:14976
    ds_read_b64_tr_b16 a[168:169], v20 offset:13856
    s_waitcnt lgkmcnt(15)
    v_mfma_f32_32x32x16_bf16 v[128:143], a[132:135], v[32:35], v[128:143]
    ds_read_b64_tr_b16 a[170:171], v20 offset:15008
    ds_read_b64_tr_b16 a[172:173], v20 offset:13888
    ds_read_b64_tr_b16 a[174:175], v20 offset:15040
    ds_read_b64_tr_b16 a[176:177], v20 offset:13920
    s_waitcnt lgkmcnt(12)
    v_lshlrev_b32 v80, 16, v40
    v_mfma_f32_32x32x16_bf16 v[144:159], a[132:135], v[36:39], v[144:159]
    v_and_b32 v81, 0xffff0000, v40
    v_fma_f32 v80, v80, v84, v85
    v_fma_f32 v81, v81, v84, v85
    s_waitcnt lgkmcnt(8)
    v_fma_f32 v80, v80, v72, v64
    v_mfma_f32_32x32x16_bf16 v[160:175], a[136:139], v[32:35], v[160:175]
    ds_read_b64_tr_b16 a[178:179], v20 offset:15072
    v_fma_f32 v81, v81, v73, v65
    v_cvt_pk_bf16_f32 v40, v80, v81
    v_lshlrev_b32 v82, 16, v41
    v_and_b32 v83, 0xffff0000, v41
    v_mfma_f32_32x32x16_bf16 v[176:191], a[136:139], v[36:39], v[176:191]
    v_fma_f32 v82, v82, v84, v85
    ds_read_b64_tr_b16 a[180:181], v20 offset:13952
    v_fma_f32 v83, v83, v84, v85
    v_fma_f32 v82, v82, v74, v66
    v_mfma_f32_32x32x16_bf16 v[192:207], a[140:143], v[32:35], v[192:207]
    v_fma_f32 v83, v83, v75, v67
    v_cvt_pk_bf16_f32 v41, v82, v83
    ds_read_b64_tr_b16 a[182:183], v20 offset:15104
    v_lshlrev_b32 v80, 16, v42
    v_and_b32 v81, 0xffff0000, v42
    v_mfma_f32_32x32x16_bf16 v[208:223], a[140:143], v[36:39], v[208:223]
    v_fma_f32 v80, v80, v84, v85
    v_fma_f32 v81, v81, v84, v85
    s_waitcnt lgkmcnt(10)
    v_fma_f32 v80, v80, v76, v68
    ds_read_b64_tr_b16 a[184:185], v20 offset:13984
    v_mfma_f32_32x32x16_bf16 v[224:239], a[144:147], v[32:35], v[224:239]
    v_fma_f32 v81, v81, v77, v69
    v_cvt_pk_bf16_f32 v42, v80, v81
    v_lshlrev_b32 v82, 16, v43
    v_and_b32 v83, 0xffff0000, v43
    v_mfma_f32_32x32x16_bf16 v[240:255], a[144:147], v[36:39], v[240:255]
    v_fma_f32 v82, v82, v84, v85
    ds_read_b64_tr_b16 a[186:187], v20 offset:15136
    v_fma_f32 v83, v83, v84, v85
    v_fma_f32 v82, v82, v78, v70
    v_fma_f32 v83, v83, v79, v71
    v_mfma_f32_32x32x16_bf16 a[0:15], a[148:151], v[32:35], a[0:15]
    v_cvt_pk_bf16_f32 v43, v82, v83
    ds_read_b64_tr_b16 a[188:189], v20 offset:14016
    v_lshlrev_b32 v80, 16, v44
    v_and_b32 v81, 0xffff0000, v44
    v_mfma_f32_32x32x16_bf16 a[16:31], a[148:151], v[36:39], a[16:31]
    v_fma_f32 v80, v80, v86, v87
    v_fma_f32 v81, v81, v86, v87
    v_fma_f32 v80, v80, v72, v64
    ds_read_b64_tr_b16 a[190:191], v20 offset:15168
    v_fma_f32 v81, v81, v73, v65
    v_mfma_f32_32x32x16_bf16 a[32:47], a[152:155], v[32:35], a[32:47]
    v_cvt_pk_bf16_f32 v44, v80, v81
    v_lshlrev_b32 v82, 16, v45
    v_and_b32 v83, 0xffff0000, v45
    v_fma_f32 v82, v82, v86, v87
    v_mfma_f32_32x32x16_bf16 a[48:63], a[152:155], v[36:39], a[48:63]
    ds_read_b64_tr_b16 a[192:193], v20 offset:14048
    v_fma_f32 v83, v83, v86, v87
    v_fma_f32 v82, v82, v74, v66
    v_fma_f32 v83, v83, v75, v67
    v_cvt_pk_bf16_f32 v45, v82, v83
    v_mfma_f32_32x32x16_bf16 a[64:79], a[156:159], v[32:35], a[64:79]
    ds_read_b64_tr_b16 a[194:195], v20 offset:15200
    v_lshlrev_b32 v80, 16, v46
    v_and_b32 v81, 0xffff0000, v46
    v_fma_f32 v80, v80, v86, v87
    v_mfma_f32_32x32x16_bf16 a[80:95], a[156:159], v[36:39], a[80:95]
    v_fma_f32 v81, v81, v86, v87
    v_fma_f32 v80, v80, v76, v68
    ds_read_b64_tr_b16 a[196:197], v20 offset:14080
    v_fma_f32 v81, v81, v77, v69
    v_cvt_pk_bf16_f32 v46, v80, v81
    v_mfma_f32_32x32x16_bf16 a[96:111], a[160:163], v[32:35], a[96:111]
    v_lshlrev_b32 v82, 16, v47
    v_and_b32 v83, 0xffff0000, v47
    v_fma_f32 v82, v82, v86, v87
    ds_read_b64_tr_b16 a[198:199], v20 offset:15232
    v_mfma_f32_32x32x16_bf16 a[112:127], a[160:163], v[36:39], a[112:127]
    v_fma_f32 v83, v83, v86, v87
    v_fma_f32 v82, v82, v78, v70
    v_fma_f32 v83, v83, v79, v71
    v_cvt_pk_bf16_f32 v47, v82, v83
    s_waitcnt lgkmcnt(0)
    v_mfma_f32_32x32x16_bf16 v[96:111], a[164:167], v[40:43], v[96:111]
    v_mfma_f32_32x32x16_bf16 v[112:127], a[164:167], v[44:47], v[112:127]
    s_waitcnt vmcnt(0)
    s_barrier
    v_mfma_f32_32x32x16_bf16 v[128:143], a[168:171], v[40:43], v[128:143]
    ds_read_b128 v[32:35], v16 offset:0
    ds_read_b128 v[36:39], v16 offset:4096
    ds_read_b128 v[48:51], v22 offset:1280
    ds_read_b128 v[52:55], v22 offset:1296
    s_add_u32 m0, s44, 0
    ds_read_b128 v[56:59], v22 offset:3584
    v_mfma_f32_32x32x16_bf16 v[144:159], a[168:171], v[44:47], v[144:159]
    ds_read_b128 v[60:63], v22 offset:3600
    buffer_load_dwordx4 v1, s[12:15], s24 offen offset:0 lds
    ds_read_b64_tr_b16 a[128:129], v21 offset:0
    ds_read_b64_tr_b16 a[130:131], v21 offset:1152
    buffer_load_dwordx4 v2, s[12:15], s25 offen offset:1024 lds
    ds_read_b64_tr_b16 a[132:133], v21 offset:32
    v_mfma_f32_32x32x16_bf16 v[160:175], a[172:175], v[40:43], v[160:175]
    ds_read_b64_tr_b16 a[134:135], v21 offset:1184
    s_waitcnt lgkmcnt(9)
    v_lshlrev_b32 v80, 16, v32
    v_and_b32 v81, 0xffff0000, v32
    v_fma_f32 v80, v80, v84, v85
    buffer_load_dwordx4 v1, s[12:15], s26 offen offset:2048 lds
    v_mfma_f32_32x32x16_bf16 v[176:191], a[172:175], v[44:47], v[176:191]
    v_fma_f32 v81, v81, v84, v85
    s_waitcnt lgkmcnt(5)
    v_fma_f32 v80, v80, v56, v48
    v_fma_f32 v81, v81, v57, v49
    ds_read_b64_tr_b16 a[136:137], v21 offset:64
    v_cvt_pk_bf16_f32 v32, v80, v81
    v_lshlrev_b32 v82, 16, v33
    v_mfma_f32_32x32x16_bf16 v[192:207], a[176:179], v[40:43], v[192:207]
    ds_read_b64_tr_b16 a[138:139], v21 offset:1216
    v_and_b32 v83, 0xffff0000, v33
    v_fma_f32 v82, v82, v84, v85
    v_fma_f32 v83, v83, v84, v85
    buffer_load_dwordx4 v2, s[12:15], s27 offen offset:3072 lds
    v_fma_f32 v82, v82, v58, v50
    v_mfma_f32_32x32x16_bf16 v[208:223], a[176:179], v[44:47], v[208:223]
    v_fma_f32 v83, v83, v59, v51
    ds_read_b64_tr_b16 a[140:141], v21 offset:96
    v_cvt_pk_bf16_f32 v33, v82, v83
    v_lshlrev_b32 v80, 16, v34
    v_and_b32 v81, 0xffff0000, v34
    v_mfma_f32_32x32x16_bf16 v[224:239], a[180:183], v[40:43], v[224:239]
    ds_read_b64_tr_b16 a[142:143], v21 offset:1248
    v_fma_f32 v80, v80, v84, v85
    v_fma_f32 v81, v81, v84, v85
    s_add_u32 m0, s44, 4096
    s_waitcnt lgkmcnt(8)
    v_fma_f32 v80, v80, v60, v52
    v_fma_f32 v81, v81, v61, v53
    v_mfma_f32_32x32x16_bf16 v[240:255], a[180:183], v[44:47], v[240:255]
    v_cvt_pk_bf16_f32 v34, v80, v81
    ds_read_b64_tr_b16 a[144:145], v21 offset:128
    v_lshlrev_b32 v82, 16, v35
    v_and_b32 v83, 0xffff0000, v35
    ds_read_b64_tr_b16 a[146:147], v21 offset:1280
    v_mfma_f32_32x32x16_bf16 a[0:15], a[184:187], v[40:43], a[0:15]
    v_fma_f32 v82, v82, v84, v85
    v_fma_f32 v83, v83, v84, v85
    v_fma_f32 v82, v82, v62, v54
    buffer_load_dwordx4 v1, s[12:15], s28 offen offset:0 lds
    v_fma_f32 v83, v83, v63, v55
    v_cvt_pk_bf16_f32 v35, v82, v83
    v_mfma_f32_32x32x16_bf16 a[16:31], a[184:187], v[44:47], a[16:31]
    ds_read_b64_tr_b16 a[148:149], v21 offset:160
    v_lshlrev_b32 v80, 16, v36
    v_and_b32 v81, 0xffff0000, v36
    v_fma_f32 v80, v80, v86, v87
    ds_read_b64_tr_b16 a[150:151], v21 offset:1312
    v_fma_f32 v81, v81, v86, v87
    v_mfma_f32_32x32x16_bf16 a[32:47], a[188:191], v[40:43], a[32:47]
    v_fma_f32 v80, v80, v56, v48
    v_fma_f32 v81, v81, v57, v49
    buffer_load_dwordx4 v2, s[12:15], s29 offen offset:1024 lds
    v_cvt_pk_bf16_f32 v36, v80, v81
    v_lshlrev_b32 v82, 16, v37
    v_mfma_f32_32x32x16_bf16 a[48:63], a[188:191], v[44:47], a[48:63]
    ds_read_b64_tr_b16 a[152:153], v21 offset:192
    v_and_b32 v83, 0xffff0000, v37
    v_fma_f32 v82, v82, v86, v87
    v_fma_f32 v83, v83, v86, v87
    ds_read_b64_tr_b16 a[154:155], v21 offset:1344
    v_fma_f32 v82, v82, v58, v50
    v_mfma_f32_32x32x16_bf16 a[64:79], a[192:195], v[40:43], a[64:79]
    v_fma_f32 v83, v83, v59, v51
    buffer_load_dwordx4 v1, s[12:15], s30 offen offset:2048 lds
    v_cvt_pk_bf16_f32 v37, v82, v83
    v_lshlrev_b32 v80, 16, v38
    v_and_b32 v81, 0xffff0000, v38
    ds_read_b64_tr_b16 a[156:157], v21 offset:224
    v_mfma_f32_32x32x16_bf16 a[80:95], a[192:195], v[44:47], a[80:95]
    v_fma_f32 v80, v80, v86, v87
    v_fma_f32 v81, v81, v86, v87
    ds_read_b64_tr_b16 a[158:159], v21 offset:1376
    v_fma_f32 v80, v80, v60, v52
    v_fma_f32 v81, v81, v61, v53
    v_mfma_f32_32x32x16_bf16 a[96:111], a[196:199], v[40:43], a[96:111]
    v_cvt_pk_bf16_f32 v38, v80, v81
    buffer_load_dwordx4 v2, s[12:15], s31 offen offset:3072 lds
    v_lshlrev_b32 v82, 16, v39
    v_and_b32 v83, 0xffff0000, v39
    ds_read_b64_tr_b16 a[160:161], v21 offset:256
    v_fma_f32 v82, v82, v86, v87
    v_mfma_f32_32x32x16_bf16 a[112:127], a[196:199], v[44:47], a[112:127]
    v_fma_f32 v83, v83, v86, v87
    v_fma_f32 v82, v82, v62, v54
    ds_read_b64_tr_b16 a[162:163], v21 offset:1408
    v_fma_f32 v83, v83, v63, v55
    v_cvt_pk_bf16_f32 v39, v82, v83
    s_waitcnt lgkmcnt(15)
    v_mfma_f32_32x32x16_bf16 v[96:111], a[128:131], v[32:35], v[96:111]
    ds_read_b128 v[40:43], v17 offset:0
    ds_read_b128 v[44:47], v17 offset:4096
    ds_read_b128 v[64:67], v22 offset:1344
    ds_read_b128 v[68:71], v22 offset:1360
    s_add_u32 m0, s45, 0
    v_mfma_f32_32x32x16_bf16 v[112:127], a[128:131], v[36:39], v[112:127]
    ds_read_b128 v[72:75], v22 offset:3648
    ds_read_b128 v[76:79], v22 offset:3664
    buffer_load_dwordx4 v3, s[16:19], 0 offen offset:0 lds
    ds_read_b64_tr_b16 a[164:165], v21 offset:4608
    ds_read_b64_tr_b16 a[166:167], v21 offset:5760
    s_waitcnt lgkmcnt(15)
    v_mfma_f32_32x32x16_bf16 v[128:143], a[132:135], v[32:35], v[128:143]
    buffer_load_dwordx4 v4, s[16:19], 0 offen offset:1024 lds
    ds_read_b64_tr_b16 a[168:169], v21 offset:4640
    ds_read_b64_tr_b16 a[170:171], v21 offset:5792
    s_waitcnt lgkmcnt(9)
    v_lshlrev_b32 v80, 16, v40
    v_and_b32 v81, 0xffff0000, v40
    v_mfma_f32_32x32x16_bf16 v[144:159], a[132:135], v[36:39], v[144:159]
    v_fma_f32 v80, v80, v84, v85
    ds_read_b64_tr_b16 a[172:173], v21 offset:4672
    v_fma_f32 v81, v81, v84, v85
    s_waitcnt lgkmcnt(6)
    v_fma_f32 v80, v80, v72, v64
    v_fma_f32 v81, v81, v73, v65
    v_mfma_f32_32x32x16_bf16 v[160:175], a[136:139], v[32:35], v[160:175]
    buffer_load_dwordx4 v5, s[16:19], 0 offen offset:2048 lds
    v_cvt_pk_bf16_f32 v40, v80, v81
    v_lshlrev_b32 v82, 16, v41
    ds_read_b64_tr_b16 a[174:175], v21 offset:5824
    v_and_b32 v83, 0xffff0000, v41
    v_mfma_f32_32x32x16_bf16 v[176:191], a[136:139], v[36:39], v[176:191]
    v_fma_f32 v82, v82, v84, v85
    v_fma_f32 v83, v83, v84, v85
    ds_read_b64_tr_b16 a[176:177], v21 offset:4704
    v_fma_f32 v82, v82, v74, v66
    v_fma_f32 v83, v83, v75, v67
    v_mfma_f32_32x32x16_bf16 v[192:207], a[140:143], v[32:35], v[192:207]
    v_cvt_pk_bf16_f32 v41, v82, v83
    buffer_load_dwordx4 v6, s[16:19], 0 offen offset:3072 lds
    v_lshlrev_b32 v80, 16, v42
    v_and_b32 v81, 0xffff0000, v42
    ds_read_b64_tr_b16 a[178:179], v21 offset:5856
    v_mfma_f32_32x32x16_bf16 v[208:223], a[140:143], v[36:39], v[208:223]
    v_fma_f32 v80, v80, v84, v85
    v_fma_f32 v81, v81, v84, v85
    s_waitcnt lgkmcnt(8)
    v_fma_f32 v80, v80, v76, v68
    ds_read_b64_tr_b16 a[180:181], v21 offset:4736
    v_fma_f32 v81, v81, v77, v69
    v_mfma_f32_32x32x16_bf16 v[224:239], a[144:147], v[32:35], v[224:239]
    v_cvt_pk_bf16_f32 v42, v80, v81
    v_lshlrev_b32 v82, 16, v43
    s_add_u32 m0, s45, 4096
    v_and_b32 v83, 0xffff0000, v43
    v_fma_f32 v82, v82, v84, v85
    v_mfma_f32_32x32x16_bf16 v[240:255], a[144:147], v[36:39], v[240:255]
    ds_read_b64_tr_b16 a[182:183], v21 offset:5888
    v_fma_f32 v83, v83, v84, v85
    v_fma_f32 v82, v82, v78, v70
    v_fma_f32 v83, v83, v79, v71
    ds_read_b64_tr_b16 a[184:185], v21 offset:4768
    v_mfma_f32_32x32x16_bf16 a[0:15], a[148:151], v[32:35], a[0:15]
    v_cvt_pk_bf16_f32 v43, v82, v83
    v_lshlrev_b32 v80, 16, v44
    v_and_b32 v81, 0xffff0000, v44
    ds_read_b64_tr_b16 a[186:187], v21 offset:5920
    v_fma_f32 v80, v80, v86, v87
    v_mfma_f32_32x32x16_bf16 a[16:31], a[148:151], v[36:39], a[16:31]
    v_fma_f32 v81, v81, v86, v87
    buffer_load_dwordx4 v7, s[16:19], 0 offen offset:0 lds
    v_fma_f32 v80, v80, v72, v64
    v_fma_f32 v81, v81, v73, v65
    v_cvt_pk_bf16_f32 v44, v80, v81
    v_mfma_f32_32x32x16_bf16 a[32:47], a[152:155], v[32:35], a[32:47]
    ds_read_b64_tr_b16 a[188:189], v21 offset:4800
    v_lshlrev_b32 v82, 16, v45
    v_and_b32 v83, 0xffff0000, v45
    v_fma_f32 v82, v82, v86, v87
    ds_read_b64_tr_b16 a[190:191], v21 offset:5952
    v_mfma_f32_32x32x16_bf16 a[48:63], a[152:155], v[36:39], a[48:63]
    v_fma_f32 v83, v83, v86, v87
    v_fma_f32 v82, v82, v74, v66
    buffer_load_dwordx4 v8, s[16:19], 0 offen offset:1024 lds
    v_fma_f32 v83, v83, v75, v67
    v_cvt_pk_bf16_f32 v45, v82, v83
    v_mfma_f32_32x32x16_bf16 a[64:79], a[156:159], v[32:35], a[64:79]
    v_lshlrev_b32 v80, 16, v46
    ds_read_b64_tr_b16 a[192:193], v21 offset:4832
    v_and_b32 v81, 0xffff0000, v46
    v_fma_f32 v80, v80, v86, v87
    v_fma_f32 v81, v81, v86, v87
    v_mfma_f32_32x32x16_bf16 a[80:95], a[156:159], v[36:39], a[80:95]
    ds_read_b64_tr_b16 a[194:195], v21 offset:5984
    v_fma_f32 v80, v80, v76, v68
    v_fma_f32 v81, v81, v77, v69
    buffer_load_dwordx4 v9, s[16:19], 0 offen offset:2048 lds
    v_cvt_pk_bf16_f32 v46, v80, v81
    v_mfma_f32_32x32x16_bf16 a[96:111], a[160:163], v[32:35], a[96:111]
    v_lshlrev_b32 v82, 16, v47
    v_and_b32 v83, 0xffff0000, v47
    ds_read_b64_tr_b16 a[196:197], v21 offset:4864
    v_fma_f32 v82, v82, v86, v87
    v_fma_f32 v83, v83, v86, v87
    v_mfma_f32_32x32x16_bf16 a[112:127], a[160:163], v[36:39], a[112:127]
    v_fma_f32 v82, v82, v78, v70
    ds_read_b64_tr_b16 a[198:199], v21 offset:6016
    v_fma_f32 v83, v83, v79, v71
    v_cvt_pk_bf16_f32 v47, v82, v83
    s_waitcnt lgkmcnt(15)
    v_mfma_f32_32x32x16_bf16 v[96:111], a[164:167], v[40:43], v[96:111]
    ds_read_b128 v[32:35], v18 offset:0
    ds_read_b128 v[36:39], v18 offset:4096
    ds_read_b128 v[48:51], v22 offset:1408
    ds_read_b128 v[52:55], v22 offset:1424
    buffer_load_dwordx4 v10, s[16:19], 0 offen offset:3072 lds
    v_mfma_f32_32x32x16_bf16 v[112:127], a[164:167], v[44:47], v[112:127]
    ds_read_b128 v[56:59], v22 offset:3712
    ds_read_b128 v[60:63], v22 offset:3728
    s_add_u32 m0, s45, 8192
    ds_read_b64_tr_b16 a[128:129], v21 offset:9216
    ds_read_b64_tr_b16 a[130:131], v21 offset:10368
    s_waitcnt lgkmcnt(15)
    v_mfma_f32_32x32x16_bf16 v[128:143], a[168:171], v[40:43], v[128:143]
    buffer_load_dwordx4 v11, s[16:19], 0 offen offset:0 lds
    ds_read_b64_tr_b16 a[132:133], v21 offset:9248
    ds_read_b64_tr_b16 a[134:135], v21 offset:10400
    s_waitcnt lgkmcnt(9)
    v_lshlrev_b32 v80, 16, v32
    v_and_b32 v81, 0xffff0000, v32
    v_mfma_f32_32x32x16_bf16 v[144:159], a[168:171], v[44:47], v[144:159]
    v_fma_f32 v80, v80, v84, v85
    ds_read_b64_tr_b16 a[136:137], v21 offset:9280
    v_fma_f32 v81, v81, v84, v85
    s_waitcnt lgkmcnt(6)
    v_fma_f32 v80, v80, v56, v48
    v_fma_f32 v81, v81, v57, v49
    v_mfma_f32_32x32x16_bf16 v[160:175], a[172:175], v[40:43], v[160:175]
    s_add_u32 s12, s12, 128
    v_cvt_pk_bf16_f32 v32, v80, v81
    v_lshlrev_b32 v82, 16, v33
    ds_read_b64_tr_b16 a[138:139], v21 offset:10432
    v_and_b32 v83, 0xffff0000, v33
    v_mfma_f32_32x32x16_bf16 v[176:191], a[172:175], v[44:47], v[176:191]
    v_fma_f32 v82, v82, v84, v85
    v_fma_f32 v83, v83, v84, v85
    ds_read_b64_tr_b16 a[140:141], v21 offset:9312
    v_fma_f32 v82, v82, v58, v50
    v_fma_f32 v83, v83, v59, v51
    v_mfma_f32_32x32x16_bf16 v[192:207], a[176:179], v[40:43], v[192:207]
    v_cvt_pk_bf16_f32 v33, v82, v83
    s_addc_u32 s13, s13, 0
    v_lshlrev_b32 v80, 16, v34
    v_and_b32 v81, 0xffff0000, v34
    ds_read_b64_tr_b16 a[142:143], v21 offset:10464
    v_mfma_f32_32x32x16_bf16 v[208:223], a[176:179], v[44:47], v[208:223]
    v_fma_f32 v80, v80, v84, v85
    v_fma_f32 v81, v81, v84, v85
    s_waitcnt lgkmcnt(8)
    v_fma_f32 v80, v80, v60, v52
    ds_read_b64_tr_b16 a[144:145], v21 offset:9344
    v_fma_f32 v81, v81, v61, v53
    v_mfma_f32_32x32x16_bf16 v[224:239], a[180:183], v[40:43], v[224:239]
    v_cvt_pk_bf16_f32 v34, v80, v81
    v_lshlrev_b32 v82, 16, v35
    s_sub_u32 s14, s14, 128
    v_and_b32 v83, 0xffff0000, v35
    v_fma_f32 v82, v82, v84, v85
    v_mfma_f32_32x32x16_bf16 v[240:255], a[180:183], v[44:47], v[240:255]
    ds_read_b64_tr_b16 a[146:147], v21 offset:10496
    v_fma_f32 v83, v83, v84, v85
    v_fma_f32 v82, v82, v62, v54
    v_fma_f32 v83, v83, v63, v55
    ds_read_b64_tr_b16 a[148:149], v21 offset:9376
    v_mfma_f32_32x32x16_bf16 a[0:15], a[184:187], v[40:43], a[0:15]
    v_cvt_pk_bf16_f32 v35, v82, v83
    v_lshlrev_b32 v80, 16, v36
    v_and_b32 v81, 0xffff0000, v36
    ds_read_b64_tr_b16 a[150:151], v21 offset:10528
    v_fma_f32 v80, v80, v86, v87
    v_mfma_f32_32x32x16_bf16 a[16:31], a[184:187], v[44:47], a[16:31]
    v_fma_f32 v81, v81, v86, v87
    s_add_u32 s16, s16, 589824
    v_fma_f32 v80, v80, v56, v48
    v_fma_f32 v81, v81, v57, v49
    v_cvt_pk_bf16_f32 v36, v80, v81
    v_mfma_f32_32x32x16_bf16 a[32:47], a[188:191], v[40:43], a[32:47]
    ds_read_b64_tr_b16 a[152:153], v21 offset:9408
    v_lshlrev_b32 v82, 16, v37
    v_and_b32 v83, 0xffff0000, v37
    v_fma_f32 v82, v82, v86, v87
    ds_read_b64_tr_b16 a[154:155], v21 offset:10560
    v_mfma_f32_32x32x16_bf16 a[48:63], a[188:191], v[44:47], a[48:63]
    v_fma_f32 v83, v83, v86, v87
    v_fma_f32 v82, v82, v58, v50
    s_addc_u32 s17, s17, 0
    v_fma_f32 v83, v83, v59, v51
    v_cvt_pk_bf16_f32 v37, v82, v83
    v_mfma_f32_32x32x16_bf16 a[64:79], a[192:195], v[40:43], a[64:79]
    v_lshlrev_b32 v80, 16, v38
    ds_read_b64_tr_b16 a[156:157], v21 offset:9440
    v_and_b32 v81, 0xffff0000, v38
    v_fma_f32 v80, v80, v86, v87
    v_fma_f32 v81, v81, v86, v87
    v_mfma_f32_32x32x16_bf16 a[80:95], a[192:195], v[44:47], a[80:95]
    ds_read_b64_tr_b16 a[158:159], v21 offset:10592
    v_fma_f32 v80, v80, v60, v52
    v_fma_f32 v81, v81, v61, v53
    s_sub_u32 s18, s18, 589824
    v_cvt_pk_bf16_f32 v38, v80, v81
    v_mfma_f32_32x32x16_bf16 a[96:111], a[196:199], v[40:43], a[96:111]
    v_lshlrev_b32 v82, 16, v39
    v_and_b32 v83, 0xffff0000, v39
    ds_read_b64_tr_b16 a[160:161], v21 offset:9472
    v_fma_f32 v82, v82, v86, v87
    v_fma_f32 v83, v83, v86, v87
    v_mfma_f32_32x32x16_bf16 a[112:127], a[196:199], v[44:47], a[112:127]
    v_fma_f32 v82, v82, v62, v54
    ds_read_b64_tr_b16 a[162:163], v21 offset:10624
    v_fma_f32 v83, v83, v63, v55
    v_cvt_pk_bf16_f32 v39, v82, v83
    s_waitcnt lgkmcnt(15)
    v_mfma_f32_32x32x16_bf16 v[96:111], a[128:131], v[32:35], v[96:111]
    ds_read_b128 v[40:43], v19 offset:0
    ds_read_b128 v[44:47], v19 offset:4096
    ds_read_b128 v[64:67], v22 offset:1472
    ds_read_b128 v[68:71], v22 offset:1488
    ds_read_b128 v[72:75], v22 offset:3776
    v_mfma_f32_32x32x16_bf16 v[112:127], a[128:131], v[36:39], v[112:127]
    ds_read_b128 v[76:79], v22 offset:3792
    ds_read_b64_tr_b16 a[164:165], v21 offset:13824
    ds_read_b64_tr_b16 a[166:167], v21 offset:14976
    ds_read_b64_tr_b16 a[168:169], v21 offset:13856
    s_waitcnt lgkmcnt(15)
    v_mfma_f32_32x32x16_bf16 v[128:143], a[132:135], v[32:35], v[128:143]
    ds_read_b64_tr_b16 a[170:171], v21 offset:15008
    ds_read_b64_tr_b16 a[172:173], v21 offset:13888
    ds_read_b64_tr_b16 a[174:175], v21 offset:15040
    ds_read_b64_tr_b16 a[176:177], v21 offset:13920
    s_waitcnt lgkmcnt(12)
    v_lshlrev_b32 v80, 16, v40
    v_mfma_f32_32x32x16_bf16 v[144:159], a[132:135], v[36:39], v[144:159]
    v_and_b32 v81, 0xffff0000, v40
    v_fma_f32 v80, v80, v84, v85
    v_fma_f32 v81, v81, v84, v85
    s_waitcnt lgkmcnt(8)
    v_fma_f32 v80, v80, v72, v64
    v_mfma_f32_32x32x16_bf16 v[160:175], a[136:139], v[32:35], v[160:175]
    ds_read_b64_tr_b16 a[178:179], v21 offset:15072
    v_fma_f32 v81, v81, v73, v65
    v_cvt_pk_bf16_f32 v40, v80, v81
    v_lshlrev_b32 v82, 16, v41
    v_and_b32 v83, 0xffff0000, v41
    v_mfma_f32_32x32x16_bf16 v[176:191], a[136:139], v[36:39], v[176:191]
    v_fma_f32 v82, v82, v84, v85
    ds_read_b64_tr_b16 a[180:181], v21 offset:13952
    v_fma_f32 v83, v83, v84, v85
    v_fma_f32 v82, v82, v74, v66
    v_mfma_f32_32x32x16_bf16 v[192:207], a[140:143], v[32:35], v[192:207]
    v_fma_f32 v83, v83, v75, v67
    v_cvt_pk_bf16_f32 v41, v82, v83
    ds_read_b64_tr_b16 a[182:183], v21 offset:15104
    v_lshlrev_b32 v80, 16, v42
    v_and_b32 v81, 0xffff0000, v42
    v_mfma_f32_32x32x16_bf16 v[208:223], a[140:143], v[36:39], v[208:223]
    v_fma_f32 v80, v80, v84, v85
    v_fma_f32 v81, v81, v84, v85
    s_waitcnt lgkmcnt(10)
    v_fma_f32 v80, v80, v76, v68
    ds_read_b64_tr_b16 a[184:185], v21 offset:13984
    v_mfma_f32_32x32x16_bf16 v[224:239], a[144:147], v[32:35], v[224:239]
    v_fma_f32 v81, v81, v77, v69
    v_cvt_pk_bf16_f32 v42, v80, v81
    v_lshlrev_b32 v82, 16, v43
    v_and_b32 v83, 0xffff0000, v43
    v_mfma_f32_32x32x16_bf16 v[240:255], a[144:147], v[36:39], v[240:255]
    v_fma_f32 v82, v82, v84, v85
    ds_read_b64_tr_b16 a[186:187], v21 offset:15136
    v_fma_f32 v83, v83, v84, v85
    v_fma_f32 v82, v82, v78, v70
    v_fma_f32 v83, v83, v79, v71
    v_mfma_f32_32x32x16_bf16 a[0:15], a[148:151], v[32:35], a[0:15]
    v_cvt_pk_bf16_f32 v43, v82, v83
    ds_read_b64_tr_b16 a[188:189], v21 offset:14016
    v_lshlrev_b32 v80, 16, v44
    v_and_b32 v81, 0xffff0000, v44
    v_mfma_f32_32x32x16_bf16 a[16:31], a[148:151], v[36:39], a[16:31]
    v_fma_f32 v80, v80, v86, v87
    v_fma_f32 v81, v81, v86, v87
    v_fma_f32 v80, v80, v72, v64
    ds_read_b64_tr_b16 a[190:191], v21 offset:15168
    v_fma_f32 v81, v81, v73, v65
    v_mfma_f32_32x32x16_bf16 a[32:47], a[152:155], v[32:35], a[32:47]
    v_cvt_pk_bf16_f32 v44, v80, v81
    v_lshlrev_b32 v82, 16, v45
    v_and_b32 v83, 0xffff0000, v45
    v_fma_f32 v82, v82, v86, v87
    v_mfma_f32_32x32x16_bf16 a[48:63], a[152:155], v[36:39], a[48:63]
    ds_read_b64_tr_b16 a[192:193], v21 offset:14048
    v_fma_f32 v83, v83, v86, v87
    v_fma_f32 v82, v82, v74, v66
    v_fma_f32 v83, v83, v75, v67
    v_cvt_pk_bf16_f32 v45, v82, v83
    v_mfma_f32_32x32x16_bf16 a[64:79], a[156:159], v[32:35], a[64:79]
    ds_read_b64_tr_b16 a[194:195], v21 offset:15200
    v_lshlrev_b32 v80, 16, v46
    v_and_b32 v81, 0xffff0000, v46
    v_fma_f32 v80, v80, v86, v87
    v_mfma_f32_32x32x16_bf16 a[80:95], a[156:159], v[36:39], a[80:95]
    v_fma_f32 v81, v81, v86, v87
    v_fma_f32 v80, v80, v76, v68
    ds_read_b64_tr_b16 a[196:197], v21 offset:14080
    v_fma_f32 v81, v81, v77, v69
    v_cvt_pk_bf16_f32 v46, v80, v81
    v_mfma_f32_32x32x16_bf16 a[96:111], a[160:163], v[32:35], a[96:111]
    v_lshlrev_b32 v82, 16, v47
    v_and_b32 v83, 0xffff0000, v47
    v_fma_f32 v82, v82, v86, v87
    ds_read_b64_tr_b16 a[198:199], v21 offset:15232
    v_mfma_f32_32x32x16_bf16 a[112:127], a[160:163], v[36:39], a[112:127]
    v_fma_f32 v83, v83, v86, v87
    v_fma_f32 v82, v82, v78, v70
    v_fma_f32 v83, v83, v79, v71
    v_cvt_pk_bf16_f32 v47, v82, v83
    s_waitcnt lgkmcnt(0)
    v_mfma_f32_32x32x16_bf16 v[96:111], a[164:167], v[40:43], v[96:111]
    v_mfma_f32_32x32x16_bf16 v[112:127], a[164:167], v[44:47], v[112:127]
    s_waitcnt vmcnt(0)
    s_barrier
    v_mfma_f32_32x32x16_bf16 v[128:143], a[168:171], v[40:43], v[128:143]
    ds_read_b128 v[32:35], v12 offset:0
    ds_read_b128 v[36:39], v12 offset:4096
    ds_read_b128 v[48:51], v22 offset:1536
    ds_read_b128 v[52:55], v22 offset:1552
    s_add_u32 m0, s44, 69760
    ds_read_b128 v[56:59], v22 offset:3840
    v_mfma_f32_32x32x16_bf16 v[144:159], a[168:171], v[44:47], v[144:159]
    ds_read_b128 v[60:63], v22 offset:3856
    buffer_load_dwordx4 v1, s[12:15], s24 offen offset:0 lds
    ds_read_b64_tr_b16 a[128:129], v20 offset:0
    ds_read_b64_tr_b16 a[130:131], v20 offset:1152
    buffer_load_dwordx4 v2, s[12:15], s25 offen offset:1024 lds
    ds_read_b64_tr_b16 a[132:133], v20 offset:32
    v_mfma_f32_32x32x16_bf16 v[160:175], a[172:175], v[40:43], v[160:175]
    ds_read_b64_tr_b16 a[134:135], v20 offset:1184
    s_waitcnt lgkmcnt(9)
    v_lshlrev_b32 v80, 16, v32
    v_and_b32 v81, 0xffff0000, v32
    v_fma_f32 v80, v80, v84, v85
    buffer_load_dwordx4 v1, s[12:15], s26 offen offset:2048 lds
    v_mfma_f32_32x32x16_bf16 v[176:191], a[172:175], v[44:47], v[176:191]
    v_fma_f32 v81, v81, v84, v85
    s_waitcnt lgkmcnt(5)
    v_fma_f32 v80, v80, v56, v48
    v_fma_f32 v81, v81, v57, v49
    ds_read_b64_tr_b16 a[136:137], v20 offset:64
    v_cvt_pk_bf16_f32 v32, v80, v81
    v_lshlrev_b32 v82, 16, v33
    v_mfma_f32_32x32x16_bf16 v[192:207], a[176:179], v[40:43], v[192:207]
    ds_read_b64_tr_b16 a[138:139], v20 offset:1216
    v_and_b32 v83, 0xffff0000, v33
    v_fma_f32 v82, v82, v84, v85
    v_fma_f32 v83, v83, v84, v85
    buffer_load_dwordx4 v2, s[12:15], s27 offen offset:3072 lds
    v_fma_f32 v82, v82, v58, v50
    v_mfma_f32_32x32x16_bf16 v[208:223], a[176:179], v[44:47], v[208:223]
    v_fma_f32 v83, v83, v59, v51
    ds_read_b64_tr_b16 a[140:141], v20 offset:96
    v_cvt_pk_bf16_f32 v33, v82, v83
    v_lshlrev_b32 v80, 16, v34
    v_and_b32 v81, 0xffff0000, v34
    v_mfma_f32_32x32x16_bf16 v[224:239], a[180:183], v[40:43], v[224:239]
    ds_read_b64_tr_b16 a[142:143], v20 offset:1248
    v_fma_f32 v80, v80, v84, v85
    v_fma_f32 v81, v81, v84, v85
    s_add_u32 m0, s44, 73856
    s_waitcnt lgkmcnt(8)
    v_fma_f32 v80, v80, v60, v52
    v_fma_f32 v81, v81, v61, v53
    v_mfma_f32_32x32x16_bf16 v[240:255], a[180:183], v[44:47], v[240:255]
    v_cvt_pk_bf16_f32 v34, v80, v81
    ds_read_b64_tr_b16 a[144:145], v20 offset:128
    v_lshlrev_b32 v82, 16, v35
    v_and_b32 v83, 0xffff0000, v35
    ds_read_b64_tr_b16 a[146:147], v20 offset:1280
    v_mfma_f32_32x32x16_bf16 a[0:15], a[184:187], v[40:43], a[0:15]
    v_fma_f32 v82, v82, v84, v85
    v_fma_f32 v83, v83, v84, v85
    v_fma_f32 v82, v82, v62, v54
    buffer_load_dwordx4 v1, s[12:15], s28 offen offset:0 lds
    v_fma_f32 v83, v83, v63, v55
    v_cvt_pk_bf16_f32 v35, v82, v83
    v_mfma_f32_32x32x16_bf16 a[16:31], a[184:187], v[44:47], a[16:31]
    ds_read_b64_tr_b16 a[148:149], v20 offset:160
    v_lshlrev_b32 v80, 16, v36
    v_and_b32 v81, 0xffff0000, v36
    v_fma_f32 v80, v80, v86, v87
    ds_read_b64_tr_b16 a[150:151], v20 offset:1312
    v_fma_f32 v81, v81, v86, v87
    v_mfma_f32_32x32x16_bf16 a[32:47], a[188:191], v[40:43], a[32:47]
    v_fma_f32 v80, v80, v56, v48
    v_fma_f32 v81, v81, v57, v49
    buffer_load_dwordx4 v2, s[12:15], s29 offen offset:1024 lds
    v_cvt_pk_bf16_f32 v36, v80, v81
    v_lshlrev_b32 v82, 16, v37
    v_mfma_f32_32x32x16_bf16 a[48:63], a[188:191], v[44:47], a[48:63]
    ds_read_b64_tr_b16 a[152:153], v20 offset:192
    v_and_b32 v83, 0xffff0000, v37
    v_fma_f32 v82, v82, v86, v87
    v_fma_f32 v83, v83, v86, v87
    ds_read_b64_tr_b16 a[154:155], v20 offset:1344
    v_fma_f32 v82, v82, v58, v50
    v_mfma_f32_32x32x16_bf16 a[64:79], a[192:195], v[40:43], a[64:79]
    v_fma_f32 v83, v83, v59, v51
    buffer_load_dwordx4 v1, s[12:15], s30 offen offset:2048 lds
    v_cvt_pk_bf16_f32 v37, v82, v83
    v_lshlrev_b32 v80, 16, v38
    v_and_b32 v81, 0xffff0000, v38
    ds_read_b64_tr_b16 a[156:157], v20 offset:224
    v_mfma_f32_32x32x16_bf16 a[80:95], a[192:195], v[44:47], a[80:95]
    v_fma_f32 v80, v80, v86, v87
    v_fma_f32 v81, v81, v86, v87
    ds_read_b64_tr_b16 a[158:159], v20 offset:1376
    v_fma_f32 v80, v80, v60, v52
    v_fma_f32 v81, v81, v61, v53
    v_mfma_f32_32x32x16_bf16 a[96:111], a[196:199], v[40:43], a[96:111]
    v_cvt_pk_bf16_f32 v38, v80, v81
    buffer_load_dwordx4 v2, s[12:15], s31 offen offset:3072 lds
    v_lshlrev_b32 v82, 16, v39
    v_and_b32 v83, 0xffff0000, v39
    ds_read_b64_tr_b16 a[160:161], v20 offset:256
    v_fma_f32 v82, v82, v86, v87
    v_mfma_f32_32x32x16_bf16 a[112:127], a[196:199], v[44:47], a[112:127]
    v_fma_f32 v83, v83, v86, v87
    v_fma_f32 v82, v82, v62, v54
    ds_read_b64_tr_b16 a[162:163], v20 offset:1408
    v_fma_f32 v83, v83, v63, v55
    v_cvt_pk_bf16_f32 v39, v82, v83
    s_waitcnt lgkmcnt(15)
    v_mfma_f32_32x32x16_bf16 v[96:111], a[128:131], v[32:35], v[96:111]
    ds_read_b128 v[40:43], v13 offset:0
    ds_read_b128 v[44:47], v13 offset:4096
    ds_read_b128 v[64:67], v22 offset:1600
    ds_read_b128 v[68:71], v22 offset:1616
    s_add_u32 m0, s45, 69760
    v_mfma_f32_32x32x16_bf16 v[112:127], a[128:131], v[36:39], v[112:127]
    ds_read_b128 v[72:75], v22 offset:3904
    ds_read_b128 v[76:79], v22 offset:3920
    buffer_load_dwordx4 v3, s[16:19], 0 offen offset:0 lds
    ds_read_b64_tr_b16 a[164:165], v20 offset:4608
    ds_read_b64_tr_b16 a[166:167], v20 offset:5760
    s_waitcnt lgkmcnt(15)
    v_mfma_f32_32x32x16_bf16 v[128:143], a[132:135], v[32:35], v[128:143]
    buffer_load_dwordx4 v4, s[16:19], 0 offen offset:1024 lds
    ds_read_b64_tr_b16 a[168:169], v20 offset:4640
    ds_read_b64_tr_b16 a[170:171], v20 offset:5792
    s_waitcnt lgkmcnt(9)
    v_lshlrev_b32 v80, 16, v40
    v_and_b32 v81, 0xffff0000, v40
    v_mfma_f32_32x32x16_bf16 v[144:159], a[132:135], v[36:39], v[144:159]
    v_fma_f32 v80, v80, v84, v85
    ds_read_b64_tr_b16 a[172:173], v20 offset:4672
    v_fma_f32 v81, v81, v84, v85
    s_waitcnt lgkmcnt(6)
    v_fma_f32 v80, v80, v72, v64
    v_fma_f32 v81, v81, v73, v65
    v_mfma_f32_32x32x16_bf16 v[160:175], a[136:139], v[32:35], v[160:175]
    buffer_load_dwordx4 v5, s[16:19], 0 offen offset:2048 lds
    v_cvt_pk_bf16_f32 v40, v80, v81
    v_lshlrev_b32 v82, 16, v41
    ds_read_b64_tr_b16 a[174:175], v20 offset:5824
    v_and_b32 v83, 0xffff0000, v41
    v_mfma_f32_32x32x16_bf16 v[176:191], a[136:139], v[36:39], v[176:191]
    v_fma_f32 v82, v82, v84, v85
    v_fma_f32 v83, v83, v84, v85
    ds_read_b64_tr_b16 a[176:177], v20 offset:4704
    v_fma_f32 v82, v82, v74, v66
    v_fma_f32 v83, v83, v75, v67
    v_mfma_f32_32x32x16_bf16 v[192:207], a[140:143], v[32:35], v[192:207]
    v_cvt_pk_bf16_f32 v41, v82, v83
    buffer_load_dwordx4 v6, s[16:19], 0 offen offset:3072 lds
    v_lshlrev_b32 v80, 16, v42
    v_and_b32 v81, 0xffff0000, v42
    ds_read_b64_tr_b16 a[178:179], v20 offset:5856
    v_mfma_f32_32x32x16_bf16 v[208:223], a[140:143], v[36:39], v[208:223]
    v_fma_f32 v80, v80, v84, v85
    v_fma_f32 v81, v81, v84, v85
    s_waitcnt lgkmcnt(8)
    v_fma_f32 v80, v80, v76, v68
    ds_read_b64_tr_b16 a[180:181], v20 offset:4736
    v_fma_f32 v81, v81, v77, v69
    v_mfma_f32_32x32x16_bf16 v[224:239], a[144:147], v[32:35], v[224:239]
    v_cvt_pk_bf16_f32 v42, v80, v81
    v_lshlrev_b32 v82, 16, v43
    s_add_u32 m0, s45, 73856
    v_and_b32 v83, 0xffff0000, v43
    v_fma_f32 v82, v82, v84, v85
    v_mfma_f32_32x32x16_bf16 v[240:255], a[144:147], v[36:39], v[240:255]
    ds_read_b64_tr_b16 a[182:183], v20 offset:5888
    v_fma_f32 v83, v83, v84, v85
    v_fma_f32 v82, v82, v78, v70
    v_fma_f32 v83, v83, v79, v71
    ds_read_b64_tr_b16 a[184:185], v20 offset:4768
    v_mfma_f32_32x32x16_bf16 a[0:15], a[148:151], v[32:35], a[0:15]
    v_cvt_pk_bf16_f32 v43, v82, v83
    v_lshlrev_b32 v80, 16, v44
    v_and_b32 v81, 0xffff0000, v44
    ds_read_b64_tr_b16 a[186:187], v20 offset:5920
    v_fma_f32 v80, v80, v86, v87
    v_mfma_f32_32x32x16_bf16 a[16:31], a[148:151], v[36:39], a[16:31]
    v_fma_f32 v81, v81, v86, v87
    buffer_load_dwordx4 v7, s[16:19], 0 offen offset:0 lds
    v_fma_f32 v80, v80, v72, v64
    v_fma_f32 v81, v81, v73, v65
    v_cvt_pk_bf16_f32 v44, v80, v81
    v_mfma_f32_32x32x16_bf16 a[32:47], a[152:155], v[32:35], a[32:47]
    ds_read_b64_tr_b16 a[188:189], v20 offset:4800
    v_lshlrev_b32 v82, 16, v45
    v_and_b32 v83, 0xffff0000, v45
    v_fma_f32 v82, v82, v86, v87
    ds_read_b64_tr_b16 a[190:191], v20 offset:5952
    v_mfma_f32_32x32x16_bf16 a[48:63], a[152:155], v[36:39], a[48:63]
    v_fma_f32 v83, v83, v86, v87
    v_fma_f32 v82, v82, v74, v66
    buffer_load_dwordx4 v8, s[16:19], 0 offen offset:1024 lds
    v_fma_f32 v83, v83, v75, v67
    v_cvt_pk_bf16_f32 v45, v82, v83
    v_mfma_f32_32x32x16_bf16 a[64:79], a[156:159], v[32:35], a[64:79]
    v_lshlrev_b32 v80, 16, v46
    ds_read_b64_tr_b16 a[192:193], v20 offset:4832
    v_and_b32 v81, 0xffff0000, v46
    v_fma_f32 v80, v80, v86, v87
    v_fma_f32 v81, v81, v86, v87
    v_mfma_f32_32x32x16_bf16 a[80:95], a[156:159], v[36:39], a[80:95]
    ds_read_b64_tr_b16 a[194:195], v20 offset:5984
    v_fma_f32 v80, v80, v76, v68
    v_fma_f32 v81, v81, v77, v69
    buffer_load_dwordx4 v9, s[16:19], 0 offen offset:2048 lds
    v_cvt_pk_bf16_f32 v46, v80, v81
    v_mfma_f32_32x32x16_bf16 a[96:111], a[160:163], v[32:35], a[96:111]
    v_lshlrev_b32 v82, 16, v47
    v_and_b32 v83, 0xffff0000, v47
    ds_read_b64_tr_b16 a[196:197], v20 offset:4864
    v_fma_f32 v82, v82, v86, v87
    v_fma_f32 v83, v83, v86, v87
    v_mfma_f32_32x32x16_bf16 a[112:127], a[160:163], v[36:39], a[112:127]
    v_fma_f32 v82, v82, v78, v70
    ds_read_b64_tr_b16 a[198:199], v20 offset:6016
    v_fma_f32 v83, v83, v79, v71
    v_cvt_pk_bf16_f32 v47, v82, v83
    s_waitcnt lgkmcnt(15)
    v_mfma_f32_32x32x16_bf16 v[96:111], a[164:167], v[40:43], v[96:111]
    ds_read_b128 v[32:35], v14 offset:0
    ds_read_b128 v[36:39], v14 offset:4096
    ds_read_b128 v[48:51], v22 offset:1664
    ds_read_b128 v[52:55], v22 offset:1680
    buffer_load_dwordx4 v10, s[16:19], 0 offen offset:3072 lds
    v_mfma_f32_32x32x16_bf16 v[112:127], a[164:167], v[44:47], v[112:127]
    ds_read_b128 v[56:59], v22 offset:3968
    ds_read_b128 v[60:63], v22 offset:3984
    s_add_u32 m0, s45, 77952
    ds_read_b64_tr_b16 a[128:129], v20 offset:9216
    ds_read_b64_tr_b16 a[130:131], v20 offset:10368
    s_waitcnt lgkmcnt(15)
    v_mfma_f32_32x32x16_bf16 v[128:143], a[168:171], v[40:43], v[128:143]
    buffer_load_dwordx4 v11, s[16:19], 0 offen offset:0 lds
    ds_read_b64_tr_b16 a[132:133], v20 offset:9248
    ds_read_b64_tr_b16 a[134:135], v20 offset:10400
    s_waitcnt lgkmcnt(9)
    v_lshlrev_b32 v80, 16, v32
    v_and_b32 v81, 0xffff0000, v32
    v_mfma_f32_32x32x16_bf16 v[144:159], a[168:171], v[44:47], v[144:159]
    v_fma_f32 v80, v80, v84, v85
    ds_read_b64_tr_b16 a[136:137], v20 offset:9280
    v_fma_f32 v81, v81, v84, v85
    s_waitcnt lgkmcnt(6)
    v_fma_f32 v80, v80, v56, v48
    v_fma_f32 v81, v81, v57, v49
    v_mfma_f32_32x32x16_bf16 v[160:175], a[172:175], v[40:43], v[160:175]
    s_add_u32 s12, s12, 128
    v_cvt_pk_bf16_f32 v32, v80, v81
    v_lshlrev_b32 v82, 16, v33
    ds_read_b64_tr_b16 a[138:139], v20 offset:10432
    v_and_b32 v83, 0xffff0000, v33
    v_mfma_f32_32x32x16_bf16 v[176:191], a[172:175], v[44:47], v[176:191]
    v_fma_f32 v82, v82, v84, v85
    v_fma_f32 v83, v83, v84, v85
    ds_read_b64_tr_b16 a[140:141], v20 offset:9312
    v_fma_f32 v82, v82, v58, v50
    v_fma_f32 v83, v83, v59, v51
    v_mfma_f32_32x32x16_bf16 v[192:207], a[176:179], v[40:43], v[192:207]
    v_cvt_pk_bf16_f32 v33, v82, v83
    s_addc_u32 s13, s13, 0
    v_lshlrev_b32 v80, 16, v34
    v_and_b32 v81, 0xffff0000, v34
    ds_read_b64_tr_b16 a[142:143], v20 offset:10464
    v_mfma_f32_32x32x16_bf16 v[208:223], a[176:179], v[44:47], v[208:223]
    v_fma_f32 v80, v80, v84, v85
    v_fma_f32 v81, v81, v84, v85
    s_waitcnt lgkmcnt(8)
    v_fma_f32 v80, v80, v60, v52
    ds_read_b64_tr_b16 a[144:145], v20 offset:9344
    v_fma_f32 v81, v81, v61, v53
    v_mfma_f32_32x32x16_bf16 v[224:239], a[180:183], v[40:43], v[224:239]
    v_cvt_pk_bf16_f32 v34, v80, v81
    v_lshlrev_b32 v82, 16, v35
    s_sub_u32 s14, s14, 128
    v_and_b32 v83, 0xffff0000, v35
    v_fma_f32 v82, v82, v84, v85
    v_mfma_f32_32x32x16_bf16 v[240:255], a[180:183], v[44:47], v[240:255]
    ds_read_b64_tr_b16 a[146:147], v20 offset:10496
    v_fma_f32 v83, v83, v84, v85
    v_fma_f32 v82, v82, v62, v54
    v_fma_f32 v83, v83, v63, v55
    ds_read_b64_tr_b16 a[148:149], v20 offset:9376
    v_mfma_f32_32x32x16_bf16 a[0:15], a[184:187], v[40:43], a[0:15]
    v_cvt_pk_bf16_f32 v35, v82, v83
    v_lshlrev_b32 v80, 16, v36
    v_and_b32 v81, 0xffff0000, v36
    ds_read_b64_tr_b16 a[150:151], v20 offset:10528
    v_fma_f32 v80, v80, v86, v87
    v_mfma_f32_32x32x16_bf16 a[16:31], a[184:187], v[44:47], a[16:31]
    v_fma_f32 v81, v81, v86, v87
    s_add_u32 s16, s16, 589824
    v_fma_f32 v80, v80, v56, v48
    v_fma_f32 v81, v81, v57, v49
    v_cvt_pk_bf16_f32 v36, v80, v81
    v_mfma_f32_32x32x16_bf16 a[32:47], a[188:191], v[40:43], a[32:47]
    ds_read_b64_tr_b16 a[152:153], v20 offset:9408
    v_lshlrev_b32 v82, 16, v37
    v_and_b32 v83, 0xffff0000, v37
    v_fma_f32 v82, v82, v86, v87
    ds_read_b64_tr_b16 a[154:155], v20 offset:10560
    v_mfma_f32_32x32x16_bf16 a[48:63], a[188:191], v[44:47], a[48:63]
    v_fma_f32 v83, v83, v86, v87
    v_fma_f32 v82, v82, v58, v50
    s_addc_u32 s17, s17, 0
    v_fma_f32 v83, v83, v59, v51
    v_cvt_pk_bf16_f32 v37, v82, v83
    v_mfma_f32_32x32x16_bf16 a[64:79], a[192:195], v[40:43], a[64:79]
    v_lshlrev_b32 v80, 16, v38
    ds_read_b64_tr_b16 a[156:157], v20 offset:9440
    v_and_b32 v81, 0xffff0000, v38
    v_fma_f32 v80, v80, v86, v87
    v_fma_f32 v81, v81, v86, v87
    v_mfma_f32_32x32x16_bf16 a[80:95], a[192:195], v[44:47], a[80:95]
    ds_read_b64_tr_b16 a[158:159], v20 offset:10592
    v_fma_f32 v80, v80, v60, v52
    v_fma_f32 v81, v81, v61, v53
    s_sub_u32 s18, s18, 589824
    v_cvt_pk_bf16_f32 v38, v80, v81
    v_mfma_f32_32x32x16_bf16 a[96:111], a[196:199], v[40:43], a[96:111]
    v_lshlrev_b32 v82, 16, v39
    v_and_b32 v83, 0xffff0000, v39
    ds_read_b64_tr_b16 a[160:161], v20 offset:9472
    v_fma_f32 v82, v82, v86, v87
    v_fma_f32 v83, v83, v86, v87
    v_mfma_f32_32x32x16_bf16 a[112:127], a[196:199], v[44:47], a[112:127]
    v_fma_f32 v82, v82, v62, v54
    ds_read_b64_tr_b16 a[162:163], v20 offset:10624
    v_fma_f32 v83, v83, v63, v55
    v_cvt_pk_bf16_f32 v39, v82, v83
    s_waitcnt lgkmcnt(15)
    v_mfma_f32_32x32x16_bf16 v[96:111], a[128:131], v[32:35], v[96:111]
    ds_read_b128 v[40:43], v15 offset:0
    ds_read_b128 v[44:47], v15 offset:4096
    ds_read_b128 v[64:67], v22 offset:1728
    ds_read_b128 v[68:71], v22 offset:1744
    ds_read_b128 v[72:75], v22 offset:4032
    v_mfma_f32_32x32x16_bf16 v[112:127], a[128:131], v[36:39], v[112:127]
    ds_read_b128 v[76:79], v22 offset:4048
    ds_read_b64_tr_b16 a[164:165], v20 offset:13824
    ds_read_b64_tr_b16 a[166:167], v20 offset:14976
    ds_read_b64_tr_b16 a[168:169], v20 offset:13856
    s_waitcnt lgkmcnt(15)
    v_mfma_f32_32x32x16_bf16 v[128:143], a[132:135], v[32:35], v[128:143]
    ds_read_b64_tr_b16 a[170:171], v20 offset:15008
    ds_read_b64_tr_b16 a[172:173], v20 offset:13888
    ds_read_b64_tr_b16 a[174:175], v20 offset:15040
    ds_read_b64_tr_b16 a[176:177], v20 offset:13920
    s_waitcnt lgkmcnt(12)
    v_lshlrev_b32 v80, 16, v40
    v_mfma_f32_32x32x16_bf16 v[144:159], a[132:135], v[36:39], v[144:159]
    v_and_b32 v81, 0xffff0000, v40
    v_fma_f32 v80, v80, v84, v85
    v_fma_f32 v81, v81, v84, v85
    s_waitcnt lgkmcnt(8)
    v_fma_f32 v80, v80, v72, v64
    v_mfma_f32_32x32x16_bf16 v[160:175], a[136:139], v[32:35], v[160:175]
    ds_read_b64_tr_b16 a[178:179], v20 offset:15072
    v_fma_f32 v81, v81, v73, v65
    v_cvt_pk_bf16_f32 v40, v80, v81
    v_lshlrev_b32 v82, 16, v41
    v_and_b32 v83, 0xffff0000, v41
    v_mfma_f32_32x32x16_bf16 v[176:191], a[136:139], v[36:39], v[176:191]
    v_fma_f32 v82, v82, v84, v85
    ds_read_b64_tr_b16 a[180:181], v20 offset:13952
    v_fma_f32 v83, v83, v84, v85
    v_fma_f32 v82, v82, v74, v66
    v_mfma_f32_32x32x16_bf16 v[192:207], a[140:143], v[32:35], v[192:207]
    v_fma_f32 v83, v83, v75, v67
    v_cvt_pk_bf16_f32 v41, v82, v83
    ds_read_b64_tr_b16 a[182:183], v20 offset:15104
    v_lshlrev_b32 v80, 16, v42
    v_and_b32 v81, 0xffff0000, v42
    v_mfma_f32_32x32x16_bf16 v[208:223], a[140:143], v[36:39], v[208:223]
    v_fma_f32 v80, v80, v84, v85
    v_fma_f32 v81, v81, v84, v85
    s_waitcnt lgkmcnt(10)
    v_fma_f32 v80, v80, v76, v68
    ds_read_b64_tr_b16 a[184:185], v20 offset:13984
    v_mfma_f32_32x32x16_bf16 v[224:239], a[144:147], v[32:35], v[224:239]
    v_fma_f32 v81, v81, v77, v69
    v_cvt_pk_bf16_f32 v42, v80, v81
    v_lshlrev_b32 v82, 16, v43
    v_and_b32 v83, 0xffff0000, v43
    v_mfma_f32_32x32x16_bf16 v[240:255], a[144:147], v[36:39], v[240:255]
    v_fma_f32 v82, v82, v84, v85
    ds_read_b64_tr_b16 a[186:187], v20 offset:15136
    v_fma_f32 v83, v83, v84, v85
    v_fma_f32 v82, v82, v78, v70
    v_fma_f32 v83, v83, v79, v71
    v_mfma_f32_32x32x16_bf16 a[0:15], a[148:151], v[32:35], a[0:15]
    v_cvt_pk_bf16_f32 v43, v82, v83
    ds_read_b64_tr_b16 a[188:189], v20 offset:14016
    v_lshlrev_b32 v80, 16, v44
    v_and_b32 v81, 0xffff0000, v44
    v_mfma_f32_32x32x16_bf16 a[16:31], a[148:151], v[36:39], a[16:31]
    v_fma_f32 v80, v80, v86, v87
    v_fma_f32 v81, v81, v86, v87
    v_fma_f32 v80, v80, v72, v64
    ds_read_b64_tr_b16 a[190:191], v20 offset:15168
    v_fma_f32 v81, v81, v73, v65
    v_mfma_f32_32x32x16_bf16 a[32:47], a[152:155], v[32:35], a[32:47]
    v_cvt_pk_bf16_f32 v44, v80, v81
    v_lshlrev_b32 v82, 16, v45
    v_and_b32 v83, 0xffff0000, v45
    v_fma_f32 v82, v82, v86, v87
    v_mfma_f32_32x32x16_bf16 a[48:63], a[152:155], v[36:39], a[48:63]
    ds_read_b64_tr_b16 a[192:193], v20 offset:14048
    v_fma_f32 v83, v83, v86, v87
    v_fma_f32 v82, v82, v74, v66
    v_fma_f32 v83, v83, v75, v67
    v_cvt_pk_bf16_f32 v45, v82, v83
    v_mfma_f32_32x32x16_bf16 a[64:79], a[156:159], v[32:35], a[64:79]
    ds_read_b64_tr_b16 a[194:195], v20 offset:15200
    v_lshlrev_b32 v80, 16, v46
    v_and_b32 v81, 0xffff0000, v46
    v_fma_f32 v80, v80, v86, v87
    v_mfma_f32_32x32x16_bf16 a[80:95], a[156:159], v[36:39], a[80:95]
    v_fma_f32 v81, v81, v86, v87
    v_fma_f32 v80, v80, v76, v68
    ds_read_b64_tr_b16 a[196:197], v20 offset:14080
    v_fma_f32 v81, v81, v77, v69
    v_cvt_pk_bf16_f32 v46, v80, v81
    v_mfma_f32_32x32x16_bf16 a[96:111], a[160:163], v[32:35], a[96:111]
    v_lshlrev_b32 v82, 16, v47
    v_and_b32 v83, 0xffff0000, v47
    v_fma_f32 v82, v82, v86, v87
    ds_read_b64_tr_b16 a[198:199], v20 offset:15232
    v_mfma_f32_32x32x16_bf16 a[112:127], a[160:163], v[36:39], a[112:127]
    v_fma_f32 v83, v83, v86, v87
    v_fma_f32 v82, v82, v78, v70
    v_fma_f32 v83, v83, v79, v71
    v_cvt_pk_bf16_f32 v47, v82, v83
    s_waitcnt lgkmcnt(0)
    v_mfma_f32_32x32x16_bf16 v[96:111], a[164:167], v[40:43], v[96:111]
    v_mfma_f32_32x32x16_bf16 v[112:127], a[164:167], v[44:47], v[112:127]
    s_waitcnt vmcnt(0)
    s_barrier
    v_mfma_f32_32x32x16_bf16 v[128:143], a[168:171], v[40:43], v[128:143]
    ds_read_b128 v[32:35], v16 offset:0
    ds_read_b128 v[36:39], v16 offset:4096
    ds_read_b128 v[48:51], v22 offset:1792
    ds_read_b128 v[52:55], v22 offset:1808
    s_add_u32 m0, s44, 0
    ds_read_b128 v[56:59], v22 offset:4096
    v_mfma_f32_32x32x16_bf16 v[144:159], a[168:171], v[44:47], v[144:159]
    ds_read_b128 v[60:63], v22 offset:4112
    buffer_load_dwordx4 v1, s[12:15], s24 offen offset:0 lds
    ds_read_b64_tr_b16 a[128:129], v21 offset:0
    ds_read_b64_tr_b16 a[130:131], v21 offset:1152
    buffer_load_dwordx4 v2, s[12:15], s25 offen offset:1024 lds
    ds_read_b64_tr_b16 a[132:133], v21 offset:32
    v_mfma_f32_32x32x16_bf16 v[160:175], a[172:175], v[40:43], v[160:175]
    ds_read_b64_tr_b16 a[134:135], v21 offset:1184
    s_waitcnt lgkmcnt(9)
    v_lshlrev_b32 v80, 16, v32
    v_and_b32 v81, 0xffff0000, v32
    v_fma_f32 v80, v80, v84, v85
    buffer_load_dwordx4 v1, s[12:15], s26 offen offset:2048 lds
    v_mfma_f32_32x32x16_bf16 v[176:191], a[172:175], v[44:47], v[176:191]
    v_fma_f32 v81, v81, v84, v85
    s_waitcnt lgkmcnt(5)
    v_fma_f32 v80, v80, v56, v48
    v_fma_f32 v81, v81, v57, v49
    ds_read_b64_tr_b16 a[136:137], v21 offset:64
    v_cvt_pk_bf16_f32 v32, v80, v81
    v_lshlrev_b32 v82, 16, v33
    v_mfma_f32_32x32x16_bf16 v[192:207], a[176:179], v[40:43], v[192:207]
    ds_read_b64_tr_b16 a[138:139], v21 offset:1216
    v_and_b32 v83, 0xffff0000, v33
    v_fma_f32 v82, v82, v84, v85
    v_fma_f32 v83, v83, v84, v85
    buffer_load_dwordx4 v2, s[12:15], s27 offen offset:3072 lds
    v_fma_f32 v82, v82, v58, v50
    v_mfma_f32_32x32x16_bf16 v[208:223], a[176:179], v[44:47], v[208:223]
    v_fma_f32 v83, v83, v59, v51
    ds_read_b64_tr_b16 a[140:141], v21 offset:96
    v_cvt_pk_bf16_f32 v33, v82, v83
    v_lshlrev_b32 v80, 16, v34
    v_and_b32 v81, 0xffff0000, v34
    v_mfma_f32_32x32x16_bf16 v[224:239], a[180:183], v[40:43], v[224:239]
    ds_read_b64_tr_b16 a[142:143], v21 offset:1248
    v_fma_f32 v80, v80, v84, v85
    v_fma_f32 v81, v81, v84, v85
    s_add_u32 m0, s44, 4096
    s_waitcnt lgkmcnt(8)
    v_fma_f32 v80, v80, v60, v52
    v_fma_f32 v81, v81, v61, v53
    v_mfma_f32_32x32x16_bf16 v[240:255], a[180:183], v[44:47], v[240:255]
    v_cvt_pk_bf16_f32 v34, v80, v81
    ds_read_b64_tr_b16 a[144:145], v21 offset:128
    v_lshlrev_b32 v82, 16, v35
    v_and_b32 v83, 0xffff0000, v35
    ds_read_b64_tr_b16 a[146:147], v21 offset:1280
    v_mfma_f32_32x32x16_bf16 a[0:15], a[184:187], v[40:43], a[0:15]
    v_fma_f32 v82, v82, v84, v85
    v_fma_f32 v83, v83, v84, v85
    v_fma_f32 v82, v82, v62, v54
    buffer_load_dwordx4 v1, s[12:15], s28 offen offset:0 lds
    v_fma_f32 v83, v83, v63, v55
    v_cvt_pk_bf16_f32 v35, v82, v83
    v_mfma_f32_32x32x16_bf16 a[16:31], a[184:187], v[44:47], a[16:31]
    ds_read_b64_tr_b16 a[148:149], v21 offset:160
    v_lshlrev_b32 v80, 16, v36
    v_and_b32 v81, 0xffff0000, v36
    v_fma_f32 v80, v80, v86, v87
    ds_read_b64_tr_b16 a[150:151], v21 offset:1312
    v_fma_f32 v81, v81, v86, v87
    v_mfma_f32_32x32x16_bf16 a[32:47], a[188:191], v[40:43], a[32:47]
    v_fma_f32 v80, v80, v56, v48
    v_fma_f32 v81, v81, v57, v49
    buffer_load_dwordx4 v2, s[12:15], s29 offen offset:1024 lds
    v_cvt_pk_bf16_f32 v36, v80, v81
    v_lshlrev_b32 v82, 16, v37
    v_mfma_f32_32x32x16_bf16 a[48:63], a[188:191], v[44:47], a[48:63]
    ds_read_b64_tr_b16 a[152:153], v21 offset:192
    v_and_b32 v83, 0xffff0000, v37
    v_fma_f32 v82, v82, v86, v87
    v_fma_f32 v83, v83, v86, v87
    ds_read_b64_tr_b16 a[154:155], v21 offset:1344
    v_fma_f32 v82, v82, v58, v50
    v_mfma_f32_32x32x16_bf16 a[64:79], a[192:195], v[40:43], a[64:79]
    v_fma_f32 v83, v83, v59, v51
    buffer_load_dwordx4 v1, s[12:15], s30 offen offset:2048 lds
    v_cvt_pk_bf16_f32 v37, v82, v83
    v_lshlrev_b32 v80, 16, v38
    v_and_b32 v81, 0xffff0000, v38
    ds_read_b64_tr_b16 a[156:157], v21 offset:224
    v_mfma_f32_32x32x16_bf16 a[80:95], a[192:195], v[44:47], a[80:95]
    v_fma_f32 v80, v80, v86, v87
    v_fma_f32 v81, v81, v86, v87
    ds_read_b64_tr_b16 a[158:159], v21 offset:1376
    v_fma_f32 v80, v80, v60, v52
    v_fma_f32 v81, v81, v61, v53
    v_mfma_f32_32x32x16_bf16 a[96:111], a[196:199], v[40:43], a[96:111]
    v_cvt_pk_bf16_f32 v38, v80, v81
    buffer_load_dwordx4 v2, s[12:15], s31 offen offset:3072 lds
    v_lshlrev_b32 v82, 16, v39
    v_and_b32 v83, 0xffff0000, v39
    ds_read_b64_tr_b16 a[160:161], v21 offset:256
    v_fma_f32 v82, v82, v86, v87
    v_mfma_f32_32x32x16_bf16 a[112:127], a[196:199], v[44:47], a[112:127]
    v_fma_f32 v83, v83, v86, v87
    v_fma_f32 v82, v82, v62, v54
    ds_read_b64_tr_b16 a[162:163], v21 offset:1408
    v_fma_f32 v83, v83, v63, v55
    v_cvt_pk_bf16_f32 v39, v82, v83
    s_waitcnt lgkmcnt(15)
    v_mfma_f32_32x32x16_bf16 v[96:111], a[128:131], v[32:35], v[96:111]
    ds_read_b128 v[40:43], v17 offset:0
    ds_read_b128 v[44:47], v17 offset:4096
    ds_read_b128 v[64:67], v22 offset:1856
    ds_read_b128 v[68:71], v22 offset:1872
    s_add_u32 m0, s45, 0
    v_mfma_f32_32x32x16_bf16 v[112:127], a[128:131], v[36:39], v[112:127]
    ds_read_b128 v[72:75], v22 offset:4160
    ds_read_b128 v[76:79], v22 offset:4176
    buffer_load_dwordx4 v3, s[16:19], 0 offen offset:0 lds
    ds_read_b64_tr_b16 a[164:165], v21 offset:4608
    ds_read_b64_tr_b16 a[166:167], v21 offset:5760
    s_waitcnt lgkmcnt(15)
    v_mfma_f32_32x32x16_bf16 v[128:143], a[132:135], v[32:35], v[128:143]
    buffer_load_dwordx4 v4, s[16:19], 0 offen offset:1024 lds
    ds_read_b64_tr_b16 a[168:169], v21 offset:4640
    ds_read_b64_tr_b16 a[170:171], v21 offset:5792
    s_waitcnt lgkmcnt(9)
    v_lshlrev_b32 v80, 16, v40
    v_and_b32 v81, 0xffff0000, v40
    v_mfma_f32_32x32x16_bf16 v[144:159], a[132:135], v[36:39], v[144:159]
    v_fma_f32 v80, v80, v84, v85
    ds_read_b64_tr_b16 a[172:173], v21 offset:4672
    v_fma_f32 v81, v81, v84, v85
    s_waitcnt lgkmcnt(6)
    v_fma_f32 v80, v80, v72, v64
    v_fma_f32 v81, v81, v73, v65
    v_mfma_f32_32x32x16_bf16 v[160:175], a[136:139], v[32:35], v[160:175]
    buffer_load_dwordx4 v5, s[16:19], 0 offen offset:2048 lds
    v_cvt_pk_bf16_f32 v40, v80, v81
    v_lshlrev_b32 v82, 16, v41
    ds_read_b64_tr_b16 a[174:175], v21 offset:5824
    v_and_b32 v83, 0xffff0000, v41
    v_mfma_f32_32x32x16_bf16 v[176:191], a[136:139], v[36:39], v[176:191]
    v_fma_f32 v82, v82, v84, v85
    v_fma_f32 v83, v83, v84, v85
    ds_read_b64_tr_b16 a[176:177], v21 offset:4704
    v_fma_f32 v82, v82, v74, v66
    v_fma_f32 v83, v83, v75, v67
    v_mfma_f32_32x32x16_bf16 v[192:207], a[140:143], v[32:35], v[192:207]
    v_cvt_pk_bf16_f32 v41, v82, v83
    buffer_load_dwordx4 v6, s[16:19], 0 offen offset:3072 lds
    v_lshlrev_b32 v80, 16, v42
    v_and_b32 v81, 0xffff0000, v42
    ds_read_b64_tr_b16 a[178:179], v21 offset:5856
    v_mfma_f32_32x32x16_bf16 v[208:223], a[140:143], v[36:39], v[208:223]
    v_fma_f32 v80, v80, v84, v85
    v_fma_f32 v81, v81, v84, v85
    s_waitcnt lgkmcnt(8)
    v_fma_f32 v80, v80, v76, v68
    ds_read_b64_tr_b16 a[180:181], v21 offset:4736
    v_fma_f32 v81, v81, v77, v69
    v_mfma_f32_32x32x16_bf16 v[224:239], a[144:147], v[32:35], v[224:239]
    v_cvt_pk_bf16_f32 v42, v80, v81
    v_lshlrev_b32 v82, 16, v43
    s_add_u32 m0, s45, 4096
    v_and_b32 v83, 0xffff0000, v43
    v_fma_f32 v82, v82, v84, v85
    v_mfma_f32_32x32x16_bf16 v[240:255], a[144:147], v[36:39], v[240:255]
    ds_read_b64_tr_b16 a[182:183], v21 offset:5888
    v_fma_f32 v83, v83, v84, v85
    v_fma_f32 v82, v82, v78, v70
    v_fma_f32 v83, v83, v79, v71
    ds_read_b64_tr_b16 a[184:185], v21 offset:4768
    v_mfma_f32_32x32x16_bf16 a[0:15], a[148:151], v[32:35], a[0:15]
    v_cvt_pk_bf16_f32 v43, v82, v83
    v_lshlrev_b32 v80, 16, v44
    v_and_b32 v81, 0xffff0000, v44
    ds_read_b64_tr_b16 a[186:187], v21 offset:5920
    v_fma_f32 v80, v80, v86, v87
    v_mfma_f32_32x32x16_bf16 a[16:31], a[148:151], v[36:39], a[16:31]
    v_fma_f32 v81, v81, v86, v87
    buffer_load_dwordx4 v7, s[16:19], 0 offen offset:0 lds
    v_fma_f32 v80, v80, v72, v64
    v_fma_f32 v81, v81, v73, v65
    v_cvt_pk_bf16_f32 v44, v80, v81
    v_mfma_f32_32x32x16_bf16 a[32:47], a[152:155], v[32:35], a[32:47]
    ds_read_b64_tr_b16 a[188:189], v21 offset:4800
    v_lshlrev_b32 v82, 16, v45
    v_and_b32 v83, 0xffff0000, v45
    v_fma_f32 v82, v82, v86, v87
    ds_read_b64_tr_b16 a[190:191], v21 offset:5952
    v_mfma_f32_32x32x16_bf16 a[48:63], a[152:155], v[36:39], a[48:63]
    v_fma_f32 v83, v83, v86, v87
    v_fma_f32 v82, v82, v74, v66
    buffer_load_dwordx4 v8, s[16:19], 0 offen offset:1024 lds
    v_fma_f32 v83, v83, v75, v67
    v_cvt_pk_bf16_f32 v45, v82, v83
    v_mfma_f32_32x32x16_bf16 a[64:79], a[156:159], v[32:35], a[64:79]
    v_lshlrev_b32 v80, 16, v46
    ds_read_b64_tr_b16 a[192:193], v21 offset:4832
    v_and_b32 v81, 0xffff0000, v46
    v_fma_f32 v80, v80, v86, v87
    v_fma_f32 v81, v81, v86, v87
    v_mfma_f32_32x32x16_bf16 a[80:95], a[156:159], v[36:39], a[80:95]
    ds_read_b64_tr_b16 a[194:195], v21 offset:5984
    v_fma_f32 v80, v80, v76, v68
    v_fma_f32 v81, v81, v77, v69
    buffer_load_dwordx4 v9, s[16:19], 0 offen offset:2048 lds
    v_cvt_pk_bf16_f32 v46, v80, v81
    v_mfma_f32_32x32x16_bf16 a[96:111], a[160:163], v[32:35], a[96:111]
    v_lshlrev_b32 v82, 16, v47
    v_and_b32 v83, 0xffff0000, v47
    ds_read_b64_tr_b16 a[196:197], v21 offset:4864
    v_fma_f32 v82, v82, v86, v87
    v_fma_f32 v83, v83, v86, v87
    v_mfma_f32_32x32x16_bf16 a[112:127], a[160:163], v[36:39], a[112:127]
    v_fma_f32 v82, v82, v78, v70
    ds_read_b64_tr_b16 a[198:199], v21 offset:6016
    v_fma_f32 v83, v83, v79, v71
    v_cvt_pk_bf16_f32 v47, v82, v83
    s_waitcnt lgkmcnt(15)
    v_mfma_f32_32x32x16_bf16 v[96:111], a[164:167], v[40:43], v[96:111]
    ds_read_b128 v[32:35], v18 offset:0
    ds_read_b128 v[36:39], v18 offset:4096
    ds_read_b128 v[48:51], v22 offset:1920
    ds_read_b128 v[52:55], v22 offset:1936
    buffer_load_dwordx4 v10, s[16:19], 0 offen offset:3072 lds
    v_mfma_f32_32x32x16_bf16 v[112:127], a[164:167], v[44:47], v[112:127]
    ds_read_b128 v[56:59], v22 offset:4224
    ds_read_b128 v[60:63], v22 offset:4240
    s_add_u32 m0, s45, 8192
    ds_read_b64_tr_b16 a[128:129], v21 offset:9216
    ds_read_b64_tr_b16 a[130:131], v21 offset:10368
    s_waitcnt lgkmcnt(15)
    v_mfma_f32_32x32x16_bf16 v[128:143], a[168:171], v[40:43], v[128:143]
    buffer_load_dwordx4 v11, s[16:19], 0 offen offset:0 lds
    ds_read_b64_tr_b16 a[132:133], v21 offset:9248
    ds_read_b64_tr_b16 a[134:135], v21 offset:10400
    s_waitcnt lgkmcnt(9)
    v_lshlrev_b32 v80, 16, v32
    v_and_b32 v81, 0xffff0000, v32
    v_mfma_f32_32x32x16_bf16 v[144:159], a[168:171], v[44:47], v[144:159]
    v_fma_f32 v80, v80, v84, v85
    ds_read_b64_tr_b16 a[136:137], v21 offset:9280
    v_fma_f32 v81, v81, v84, v85
    s_waitcnt lgkmcnt(6)
    v_fma_f32 v80, v80, v56, v48
    v_fma_f32 v81, v81, v57, v49
    v_mfma_f32_32x32x16_bf16 v[160:175], a[172:175], v[40:43], v[160:175]
    s_add_u32 s12, s12, 128
    v_cvt_pk_bf16_f32 v32, v80, v81
    v_lshlrev_b32 v82, 16, v33
    ds_read_b64_tr_b16 a[138:139], v21 offset:10432
    v_and_b32 v83, 0xffff0000, v33
    v_mfma_f32_32x32x16_bf16 v[176:191], a[172:175], v[44:47], v[176:191]
    v_fma_f32 v82, v82, v84, v85
    v_fma_f32 v83, v83, v84, v85
    ds_read_b64_tr_b16 a[140:141], v21 offset:9312
    v_fma_f32 v82, v82, v58, v50
    v_fma_f32 v83, v83, v59, v51
    v_mfma_f32_32x32x16_bf16 v[192:207], a[176:179], v[40:43], v[192:207]
    v_cvt_pk_bf16_f32 v33, v82, v83
    s_addc_u32 s13, s13, 0
    v_lshlrev_b32 v80, 16, v34
    v_and_b32 v81, 0xffff0000, v34
    ds_read_b64_tr_b16 a[142:143], v21 offset:10464
    v_mfma_f32_32x32x16_bf16 v[208:223], a[176:179], v[44:47], v[208:223]
    v_fma_f32 v80, v80, v84, v85
    v_fma_f32 v81, v81, v84, v85
    s_waitcnt lgkmcnt(8)
    v_fma_f32 v80, v80, v60, v52
    ds_read_b64_tr_b16 a[144:145], v21 offset:9344
    v_fma_f32 v81, v81, v61, v53
    v_mfma_f32_32x32x16_bf16 v[224:239], a[180:183], v[40:43], v[224:239]
    v_cvt_pk_bf16_f32 v34, v80, v81
    v_lshlrev_b32 v82, 16, v35
    s_sub_u32 s14, s14, 128
    v_and_b32 v83, 0xffff0000, v35
    v_fma_f32 v82, v82, v84, v85
    v_mfma_f32_32x32x16_bf16 v[240:255], a[180:183], v[44:47], v[240:255]
    ds_read_b64_tr_b16 a[146:147], v21 offset:10496
    v_fma_f32 v83, v83, v84, v85
    v_fma_f32 v82, v82, v62, v54
    v_fma_f32 v83, v83, v63, v55
    ds_read_b64_tr_b16 a[148:149], v21 offset:9376
    v_mfma_f32_32x32x16_bf16 a[0:15], a[184:187], v[40:43], a[0:15]
    v_cvt_pk_bf16_f32 v35, v82, v83
    v_lshlrev_b32 v80, 16, v36
    v_and_b32 v81, 0xffff0000, v36
    ds_read_b64_tr_b16 a[150:151], v21 offset:10528
    v_fma_f32 v80, v80, v86, v87
    v_mfma_f32_32x32x16_bf16 a[16:31], a[184:187], v[44:47], a[16:31]
    v_fma_f32 v81, v81, v86, v87
    s_add_u32 s16, s16, 589824
    v_fma_f32 v80, v80, v56, v48
    v_fma_f32 v81, v81, v57, v49
    v_cvt_pk_bf16_f32 v36, v80, v81
    v_mfma_f32_32x32x16_bf16 a[32:47], a[188:191], v[40:43], a[32:47]
    ds_read_b64_tr_b16 a[152:153], v21 offset:9408
    v_lshlrev_b32 v82, 16, v37
    v_and_b32 v83, 0xffff0000, v37
    v_fma_f32 v82, v82, v86, v87
    ds_read_b64_tr_b16 a[154:155], v21 offset:10560
    v_mfma_f32_32x32x16_bf16 a[48:63], a[188:191], v[44:47], a[48:63]
    v_fma_f32 v83, v83, v86, v87
    v_fma_f32 v82, v82, v58, v50
    s_addc_u32 s17, s17, 0
    v_fma_f32 v83, v83, v59, v51
    v_cvt_pk_bf16_f32 v37, v82, v83
    v_mfma_f32_32x32x16_bf16 a[64:79], a[192:195], v[40:43], a[64:79]
    v_lshlrev_b32 v80, 16, v38
    ds_read_b64_tr_b16 a[156:157], v21 offset:9440
    v_and_b32 v81, 0xffff0000, v38
    v_fma_f32 v80, v80, v86, v87
    v_fma_f32 v81, v81, v86, v87
    v_mfma_f32_32x32x16_bf16 a[80:95], a[192:195], v[44:47], a[80:95]
    ds_read_b64_tr_b16 a[158:159], v21 offset:10592
    v_fma_f32 v80, v80, v60, v52
    v_fma_f32 v81, v81, v61, v53
    s_sub_u32 s18, s18, 589824
    v_cvt_pk_bf16_f32 v38, v80, v81
    v_mfma_f32_32x32x16_bf16 a[96:111], a[196:199], v[40:43], a[96:111]
    v_lshlrev_b32 v82, 16, v39
    v_and_b32 v83, 0xffff0000, v39
    ds_read_b64_tr_b16 a[160:161], v21 offset:9472
    v_fma_f32 v82, v82, v86, v87
    v_fma_f32 v83, v83, v86, v87
    v_mfma_f32_32x32x16_bf16 a[112:127], a[196:199], v[44:47], a[112:127]
    v_fma_f32 v82, v82, v62, v54
    ds_read_b64_tr_b16 a[162:163], v21 offset:10624
    v_fma_f32 v83, v83, v63, v55
    v_cvt_pk_bf16_f32 v39, v82, v83
    s_waitcnt lgkmcnt(15)
    v_mfma_f32_32x32x16_bf16 v[96:111], a[128:131], v[32:35], v[96:111]
    ds_read_b128 v[40:43], v19 offset:0
    ds_read_b128 v[44:47], v19 offset:4096
    ds_read_b128 v[64:67], v22 offset:1984
    ds_read_b128 v[68:71], v22 offset:2000
    ds_read_b128 v[72:75], v22 offset:4288
    v_mfma_f32_32x32x16_bf16 v[112:127], a[128:131], v[36:39], v[112:127]
    ds_read_b128 v[76:79], v22 offset:4304
    ds_read_b64_tr_b16 a[164:165], v21 offset:13824
    ds_read_b64_tr_b16 a[166:167], v21 offset:14976
    ds_read_b64_tr_b16 a[168:169], v21 offset:13856
    s_waitcnt lgkmcnt(15)
    v_mfma_f32_32x32x16_bf16 v[128:143], a[132:135], v[32:35], v[128:143]
    ds_read_b64_tr_b16 a[170:171], v21 offset:15008
    ds_read_b64_tr_b16 a[172:173], v21 offset:13888
    ds_read_b64_tr_b16 a[174:175], v21 offset:15040
    ds_read_b64_tr_b16 a[176:177], v21 offset:13920
    s_waitcnt lgkmcnt(12)
    v_lshlrev_b32 v80, 16, v40
    v_mfma_f32_32x32x16_bf16 v[144:159], a[132:135], v[36:39], v[144:159]
    v_and_b32 v81, 0xffff0000, v40
    v_fma_f32 v80, v80, v84, v85
    v_fma_f32 v81, v81, v84, v85
    s_waitcnt lgkmcnt(8)
    v_fma_f32 v80, v80, v72, v64
    v_mfma_f32_32x32x16_bf16 v[160:175], a[136:139], v[32:35], v[160:175]
    ds_read_b64_tr_b16 a[178:179], v21 offset:15072
    v_fma_f32 v81, v81, v73, v65
    v_cvt_pk_bf16_f32 v40, v80, v81
    v_lshlrev_b32 v82, 16, v41
    v_and_b32 v83, 0xffff0000, v41
    v_mfma_f32_32x32x16_bf16 v[176:191], a[136:139], v[36:39], v[176:191]
    v_fma_f32 v82, v82, v84, v85
    ds_read_b64_tr_b16 a[180:181], v21 offset:13952
    v_fma_f32 v83, v83, v84, v85
    v_fma_f32 v82, v82, v74, v66
    v_mfma_f32_32x32x16_bf16 v[192:207], a[140:143], v[32:35], v[192:207]
    v_fma_f32 v83, v83, v75, v67
    v_cvt_pk_bf16_f32 v41, v82, v83
    ds_read_b64_tr_b16 a[182:183], v21 offset:15104
    v_lshlrev_b32 v80, 16, v42
    v_and_b32 v81, 0xffff0000, v42
    v_mfma_f32_32x32x16_bf16 v[208:223], a[140:143], v[36:39], v[208:223]
    v_fma_f32 v80, v80, v84, v85
    v_fma_f32 v81, v81, v84, v85
    s_waitcnt lgkmcnt(10)
    v_fma_f32 v80, v80, v76, v68
    ds_read_b64_tr_b16 a[184:185], v21 offset:13984
    v_mfma_f32_32x32x16_bf16 v[224:239], a[144:147], v[32:35], v[224:239]
    v_fma_f32 v81, v81, v77, v69
    v_cvt_pk_bf16_f32 v42, v80, v81
    v_lshlrev_b32 v82, 16, v43
    v_and_b32 v83, 0xffff0000, v43
    v_mfma_f32_32x32x16_bf16 v[240:255], a[144:147], v[36:39], v[240:255]
    v_fma_f32 v82, v82, v84, v85
    ds_read_b64_tr_b16 a[186:187], v21 offset:15136
    v_fma_f32 v83, v83, v84, v85
    v_fma_f32 v82, v82, v78, v70
    v_fma_f32 v83, v83, v79, v71
    v_mfma_f32_32x32x16_bf16 a[0:15], a[148:151], v[32:35], a[0:15]
    v_cvt_pk_bf16_f32 v43, v82, v83
    ds_read_b64_tr_b16 a[188:189], v21 offset:14016
    v_lshlrev_b32 v80, 16, v44
    v_and_b32 v81, 0xffff0000, v44
    v_mfma_f32_32x32x16_bf16 a[16:31], a[148:151], v[36:39], a[16:31]
    v_fma_f32 v80, v80, v86, v87
    v_fma_f32 v81, v81, v86, v87
    v_fma_f32 v80, v80, v72, v64
    ds_read_b64_tr_b16 a[190:191], v21 offset:15168
    v_fma_f32 v81, v81, v73, v65
    v_mfma_f32_32x32x16_bf16 a[32:47], a[152:155], v[32:35], a[32:47]
    v_cvt_pk_bf16_f32 v44, v80, v81
    v_lshlrev_b32 v82, 16, v45
    v_and_b32 v83, 0xffff0000, v45
    v_fma_f32 v82, v82, v86, v87
    v_mfma_f32_32x32x16_bf16 a[48:63], a[152:155], v[36:39], a[48:63]
    ds_read_b64_tr_b16 a[192:193], v21 offset:14048
    v_fma_f32 v83, v83, v86, v87
    v_fma_f32 v82, v82, v74, v66
    v_fma_f32 v83, v83, v75, v67
    v_cvt_pk_bf16_f32 v45, v82, v83
    v_mfma_f32_32x32x16_bf16 a[64:79], a[156:159], v[32:35], a[64:79]
    ds_read_b64_tr_b16 a[194:195], v21 offset:15200
    v_lshlrev_b32 v80, 16, v46
    v_and_b32 v81, 0xffff0000, v46
    v_fma_f32 v80, v80, v86, v87
    v_mfma_f32_32x32x16_bf16 a[80:95], a[156:159], v[36:39], a[80:95]
    v_fma_f32 v81, v81, v86, v87
    v_fma_f32 v80, v80, v76, v68
    ds_read_b64_tr_b16 a[196:197], v21 offset:14080
    v_fma_f32 v81, v81, v77, v69
    v_cvt_pk_bf16_f32 v46, v80, v81
    v_mfma_f32_32x32x16_bf16 a[96:111], a[160:163], v[32:35], a[96:111]
    v_lshlrev_b32 v82, 16, v47
    v_and_b32 v83, 0xffff0000, v47
    v_fma_f32 v82, v82, v86, v87
    ds_read_b64_tr_b16 a[198:199], v21 offset:15232
    v_mfma_f32_32x32x16_bf16 a[112:127], a[160:163], v[36:39], a[112:127]
    v_fma_f32 v83, v83, v86, v87
    v_fma_f32 v82, v82, v78, v70
    v_fma_f32 v83, v83, v79, v71
    v_cvt_pk_bf16_f32 v47, v82, v83
    s_waitcnt lgkmcnt(0)
    v_mfma_f32_32x32x16_bf16 v[96:111], a[164:167], v[40:43], v[96:111]
    v_mfma_f32_32x32x16_bf16 v[112:127], a[164:167], v[44:47], v[112:127]
    s_waitcnt vmcnt(0)
    s_barrier
    v_mfma_f32_32x32x16_bf16 v[128:143], a[168:171], v[40:43], v[128:143]
    ds_read_b128 v[32:35], v12 offset:0
    ds_read_b128 v[36:39], v12 offset:4096
    ds_read_b128 v[48:51], v22 offset:2048
    ds_read_b128 v[52:55], v22 offset:2064
    ds_read_b128 v[56:59], v22 offset:4352
    v_mfma_f32_32x32x16_bf16 v[144:159], a[168:171], v[44:47], v[144:159]
    ds_read_b128 v[60:63], v22 offset:4368
    ds_read_b64_tr_b16 a[128:129], v20 offset:0
    ds_read_b64_tr_b16 a[130:131], v20 offset:1152
    ds_read_b64_tr_b16 a[132:133], v20 offset:32
    ds_read_b64_tr_b16 a[134:135], v20 offset:1184
    v_mfma_f32_32x32x16_bf16 v[160:175], a[172:175], v[40:43], v[160:175]
    ds_read_b64_tr_b16 a[136:137], v20 offset:64
    ds_read_b64_tr_b16 a[138:139], v20 offset:1216
    ds_read_b64_tr_b16 a[140:141], v20 offset:96
    s_waitcnt lgkmcnt(12)
    v_lshlrev_b32 v80, 16, v32
    v_and_b32 v81, 0xffff0000, v32
    v_mfma_f32_32x32x16_bf16 v[176:191], a[172:175], v[44:47], v[176:191]
    v_fma_f32 v80, v80, v84, v85
    v_fma_f32 v81, v81, v84, v85
    s_waitcnt lgkmcnt(8)
    v_fma_f32 v80, v80, v56, v48
    ds_read_b64_tr_b16 a[142:143], v20 offset:1248
    v_fma_f32 v81, v81, v57, v49
    v_mfma_f32_32x32x16_bf16 v[192:207], a[176:179], v[40:43], v[192:207]
    v_cvt_pk_bf16_f32 v32, v80, v81
    v_lshlrev_b32 v82, 16, v33
    v_and_b32 v83, 0xffff0000, v33
    v_fma_f32 v82, v82, v84, v85
    ds_read_b64_tr_b16 a[144:145], v20 offset:128
    v_mfma_f32_32x32x16_bf16 v[208:223], a[176:179], v[44:47], v[208:223]
    v_fma_f32 v83, v83, v84, v85
    v_fma_f32 v82, v82, v58, v50
    v_fma_f32 v83, v83, v59, v51
    v_cvt_pk_bf16_f32 v33, v82, v83
    ds_read_b64_tr_b16 a[146:147], v20 offset:1280
    v_mfma_f32_32x32x16_bf16 v[224:239], a[180:183], v[40:43], v[224:239]
    v_lshlrev_b32 v80, 16, v34
    v_and_b32 v81, 0xffff0000, v34
    v_fma_f32 v80, v80, v84, v85
    v_fma_f32 v81, v81, v84, v85
    s_waitcnt lgkmcnt(10)
    v_fma_f32 v80, v80, v60, v52
    v_mfma_f32_32x32x16_bf16 v[240:255], a[180:183], v[44:47], v[240:255]
    ds_read_b64_tr_b16 a[148:149], v20 offset:160
    v_fma_f32 v81, v81, v61, v53
    v_cvt_pk_bf16_f32 v34, v80, v81
    v_lshlrev_b32 v82, 16, v35
    v_and_b32 v83, 0xffff0000, v35
    v_mfma_f32_32x32x16_bf16 a[0:15], a[184:187], v[40:43], a[0:15]
    v_fma_f32 v82, v82, v84, v85
    ds_read_b64_tr_b16 a[150:151], v20 offset:1312
    v_fma_f32 v83, v83, v84, v85
    v_fma_f32 v82, v82, v62, v54
    v_fma_f32 v83, v83, v63, v55
    v_mfma_f32_32x32x16_bf16 a[16:31], a[184:187], v[44:47], a[16:31]
    v_cvt_pk_bf16_f32 v35, v82, v83
    ds_read_b64_tr_b16 a[152:153], v20 offset:192
    v_lshlrev_b32 v80, 16, v36
    v_and_b32 v81, 0xffff0000, v36
    v_fma_f32 v80, v80, v86, v87
    v_mfma_f32_32x32x16_bf16 a[32:47], a[188:191], v[40:43], a[32:47]
    v_fma_f32 v81, v81, v86, v87
    v_fma_f32 v80, v80, v56, v48
    ds_read_b64_tr_b16 a[154:155], v20 offset:1344
    v_fma_f32 v81, v81, v57, v49
    v_cvt_pk_bf16_f32 v36, v80, v81
    v_mfma_f32_32x32x16_bf16 a[48:63], a[188:191], v[44:47], a[48:63]
    v_lshlrev_b32 v82, 16, v37
    v_and_b32 v83, 0xffff0000, v37
    v_fma_f32 v82, v82, v86, v87
    ds_read_b64_tr_b16 a[156:157], v20 offset:224
    v_fma_f32 v83, v83, v86, v87
    v_mfma_f32_32x32x16_bf16 a[64:79], a[192:195], v[40:43], a[64:79]
    v_fma_f32 v82, v82, v58, v50
    v_fma_f32 v83, v83, v59, v51
    v_cvt_pk_bf16_f32 v37, v82, v83
    ds_read_b64_tr_b16 a[158:159], v20 offset:1376
    v_lshlrev_b32 v80, 16, v38
    v_mfma_f32_32x32x16_bf16 a[80:95], a[192:195], v[44:47], a[80:95]
    v_and_b32 v81, 0xffff0000, v38
    v_fma_f32 v80, v80, v86, v87
    v_fma_f32 v81, v81, v86, v87
    v_fma_f32 v80, v80, v60, v52
    ds_read_b64_tr_b16 a[160:161], v20 offset:256
    v_mfma_f32_32x32x16_bf16 a[96:111], a[196:199], v[40:43], a[96:111]
    v_fma_f32 v81, v81, v61, v53
    v_cvt_pk_bf16_f32 v38, v80, v81
    v_lshlrev_b32 v82, 16, v39
    v_and_b32 v83, 0xffff0000, v39
    v_fma_f32 v82, v82, v86, v87
    v_mfma_f32_32x32x16_bf16 a[112:127], a[196:199], v[44:47], a[112:127]
    ds_read_b64_tr_b16 a[162:163], v20 offset:1408
    v_fma_f32 v83, v83, v86, v87
    v_fma_f32 v82, v82, v62, v54
    v_fma_f32 v83, v83, v63, v55
    v_cvt_pk_bf16_f32 v39, v82, v83
    s_waitcnt lgkmcnt(15)
    v_mfma_f32_32x32x16_bf16 v[96:111], a[128:131], v[32:35], v[96:111]
    ds_read_b128 v[40:43], v13 offset:0
    ds_read_b128 v[44:47], v13 offset:4096
    ds_read_b128 v[64:67], v22 offset:2112
    ds_read_b128 v[68:71], v22 offset:2128
    ds_read_b128 v[72:75], v22 offset:4416
    v_mfma_f32_32x32x16_bf16 v[112:127], a[128:131], v[36:39], v[112:127]
    ds_read_b128 v[76:79], v22 offset:4432
    ds_read_b64_tr_b16 a[164:165], v20 offset:4608
    ds_read_b64_tr_b16 a[166:167], v20 offset:5760
    ds_read_b64_tr_b16 a[168:169], v20 offset:4640
    s_waitcnt lgkmcnt(15)
    v_mfma_f32_32x32x16_bf16 v[128:143], a[132:135], v[32:35], v[128:143]
    ds_read_b64_tr_b16 a[170:171], v20 offset:5792
    ds_read_b64_tr_b16 a[172:173], v20 offset:4672
    ds_read_b64_tr_b16 a[174:175], v20 offset:5824
    ds_read_b64_tr_b16 a[176:177], v20 offset:4704
    s_waitcnt lgkmcnt(12)
    v_lshlrev_b32 v80, 16, v40
    v_mfma_f32_32x32x16_bf16 v[144:159], a[132:135], v[36:39], v[144:159]
    v_and_b32 v81, 0xffff0000, v40
    v_fma_f32 v80, v80, v84, v85
    v_fma_f32 v81, v81, v84, v85
    s_waitcnt lgkmcnt(8)
    v_fma_f32 v80, v80, v72, v64
    v_mfma_f32_32x32x16_bf16 v[160:175], a[136:139], v[32:35], v[160:175]
    ds_read_b64_tr_b16 a[178:179], v20 offset:5856
    v_fma_f32 v81, v81, v73, v65
    v_cvt_pk_bf16_f32 v40, v80, v81
    v_lshlrev_b32 v82, 16, v41
    v_and_b32 v83, 0xffff0000, v41
    v_mfma_f32_32x32x16_bf16 v[176:191], a[136:139], v[36:39], v[176:191]
    v_fma_f32 v82, v82, v84, v85
    ds_read_b64_tr_b16 a[180:181], v20 offset:4736
    v_fma_f32 v83, v83, v84, v85
    v_fma_f32 v82, v82, v74, v66
    v_mfma_f32_32x32x16_bf16 v[192:207], a[140:143], v[32:35], v[192:207]
    v_fma_f32 v83, v83, v75, v67
    v_cvt_pk_bf16_f32 v41, v82, v83
    ds_read_b64_tr_b16 a[182:183], v20 offset:5888
    v_lshlrev_b32 v80, 16, v42
    v_and_b32 v81, 0xffff0000, v42
    v_mfma_f32_32x32x16_bf16 v[208:223], a[140:143], v[36:39], v[208:223]
    v_fma_f32 v80, v80, v84, v85
    v_fma_f32 v81, v81, v84, v85
    s_waitcnt lgkmcnt(10)
    v_fma_f32 v80, v80, v76, v68
    ds_read_b64_tr_b16 a[184:185], v20 offset:4768
    v_mfma_f32_32x32x16_bf16 v[224:239], a[144:147], v[32:35], v[224:239]
    v_fma_f32 v81, v81, v77, v69
    v_cvt_pk_bf16_f32 v42, v80, v81
    v_lshlrev_b32 v82, 16, v43
    v_and_b32 v83, 0xffff0000, v43
    v_mfma_f32_32x32x16_bf16 v[240:255], a[144:147], v[36:39], v[240:255]
    v_fma_f32 v82, v82, v84, v85
    ds_read_b64_tr_b16 a[186:187], v20 offset:5920
    v_fma_f32 v83, v83, v84, v85
    v_fma_f32 v82, v82, v78, v70
    v_fma_f32 v83, v83, v79, v71
    v_mfma_f32_32x32x16_bf16 a[0:15], a[148:151], v[32:35], a[0:15]
    v_cvt_pk_bf16_f32 v43, v82, v83
    ds_read_b64_tr_b16 a[188:189], v20 offset:4800
    v_lshlrev_b32 v80, 16, v44
    v_and_b32 v81, 0xffff0000, v44
    v_mfma_f32_32x32x16_bf16 a[16:31], a[148:151], v[36:39], a[16:31]
    v_fma_f32 v80, v80, v86, v87
    v_fma_f32 v81, v81, v86, v87
    v_fma_f32 v80, v80, v72, v64
    ds_read_b64_tr_b16 a[190:191], v20 offset:5952
    v_fma_f32 v81, v81, v73, v65
    v_mfma_f32_32x32x16_bf16 a[32:47], a[152:155], v[32:35], a[32:47]
    v_cvt_pk_bf16_f32 v44, v80, v81
    v_lshlrev_b32 v82, 16, v45
    v_and_b32 v83, 0xffff0000, v45
    v_fma_f32 v82, v82, v86, v87
    v_mfma_f32_32x32x16_bf16 a[48:63], a[152:155], v[36:39], a[48:63]
    ds_read_b64_tr_b16 a[192:193], v20 offset:4832
    v_fma_f32 v83, v83, v86, v87
    v_fma_f32 v82, v82, v74, v66
    v_fma_f32 v83, v83, v75, v67
    v_cvt_pk_bf16_f32 v45, v82, v83
    v_mfma_f32_32x32x16_bf16 a[64:79], a[156:159], v[32:35], a[64:79]
    ds_read_b64_tr_b16 a[194:195], v20 offset:5984
    v_lshlrev_b32 v80, 16, v46
    v_and_b32 v81, 0xffff0000, v46
    v_fma_f32 v80, v80, v86, v87
    v_mfma_f32_32x32x16_bf16 a[80:95], a[156:159], v[36:39], a[80:95]
    v_fma_f32 v81, v81, v86, v87
    v_fma_f32 v80, v80, v76, v68
    ds_read_b64_tr_b16 a[196:197], v20 offset:4864
    v_fma_f32 v81, v81, v77, v69
    v_cvt_pk_bf16_f32 v46, v80, v81
    v_mfma_f32_32x32x16_bf16 a[96:111], a[160:163], v[32:35], a[96:111]
    v_lshlrev_b32 v82, 16, v47
    v_and_b32 v83, 0xffff0000, v47
    v_fma_f32 v82, v82, v86, v87
    ds_read_b64_tr_b16 a[198:199], v20 offset:6016
    v_mfma_f32_32x32x16_bf16 a[112:127], a[160:163], v[36:39], a[112:127]
    v_fma_f32 v83, v83, v86, v87
    v_fma_f32 v82, v82, v78, v70
    v_fma_f32 v83, v83, v79, v71
    v_cvt_pk_bf16_f32 v47, v82, v83
    s_waitcnt lgkmcnt(15)
    v_mfma_f32_32x32x16_bf16 v[96:111], a[164:167], v[40:43], v[96:111]
    ds_read_b128 v[32:35], v14 offset:0
    ds_read_b128 v[36:39], v14 offset:4096
    ds_read_b128 v[48:51], v22 offset:2176
    ds_read_b128 v[52:55], v22 offset:2192
    ds_read_b128 v[56:59], v22 offset:4480
    v_mfma_f32_32x32x16_bf16 v[112:127], a[164:167], v[44:47], v[112:127]
    ds_read_b128 v[60:63], v22 offset:4496
    ds_read_b64_tr_b16 a[128:129], v20 offset:9216
    ds_read_b64_tr_b16 a[130:131], v20 offset:10368
    ds_read_b64_tr_b16 a[132:133], v20 offset:9248
    s_waitcnt lgkmcnt(15)
    v_mfma_f32_32x32x16_bf16 v[128:143], a[168:171], v[40:43], v[128:143]
    ds_read_b64_tr_b16 a[134:135], v20 offset:10400
    ds_read_b64_tr_b16 a[136:137], v20 offset:9280
    ds_read_b64_tr_b16 a[138:139], v20 offset:10432
    ds_read_b64_tr_b16 a[140:141], v20 offset:9312
    s_waitcnt lgkmcnt(12)
    v_lshlrev_b32 v80, 16, v32
    v_mfma_f32_32x32x16_bf16 v[144:159], a[168:171], v[44:47], v[144:159]
    v_and_b32 v81, 0xffff0000, v32
    v_fma_f32 v80, v80, v84, v85
    v_fma_f32 v81, v81, v84, v85
    s_waitcnt lgkmcnt(8)
    v_fma_f32 v80, v80, v56, v48
    v_mfma_f32_32x32x16_bf16 v[160:175], a[172:175], v[40:43], v[160:175]
    ds_read_b64_tr_b16 a[142:143], v20 offset:10464
    v_fma_f32 v81, v81, v57, v49
    v_cvt_pk_bf16_f32 v32, v80, v81
    v_lshlrev_b32 v82, 16, v33
    v_and_b32 v83, 0xffff0000, v33
    v_mfma_f32_32x32x16_bf16 v[176:191], a[172:175], v[44:47], v[176:191]
    v_fma_f32 v82, v82, v84, v85
    ds_read_b64_tr_b16 a[144:145], v20 offset:9344
    v_fma_f32 v83, v83, v84, v85
    v_fma_f32 v82, v82, v58, v50
    v_mfma_f32_32x32x16_bf16 v[192:207], a[176:179], v[40:43], v[192:207]
    v_fma_f32 v83, v83, v59, v51
    v_cvt_pk_bf16_f32 v33, v82, v83
    ds_read_b64_tr_b16 a[146:147], v20 offset:10496
    v_lshlrev_b32 v80, 16, v34
    v_and_b32 v81, 0xffff0000, v34
    v_mfma_f32_32x32x16_bf16 v[208:223], a[176:179], v[44:47], v[208:223]
    v_fma_f32 v80, v80, v84, v85
    v_fma_f32 v81, v81, v84, v85
    s_waitcnt lgkmcnt(10)
    v_fma_f32 v80, v80, v60, v52
    ds_read_b64_tr_b16 a[148:149], v20 offset:9376
    v_mfma_f32_32x32x16_bf16 v[224:239], a[180:183], v[40:43], v[224:239]
    v_fma_f32 v81, v81, v61, v53
    v_cvt_pk_bf16_f32 v34, v80, v81
    v_lshlrev_b32 v82, 16, v35
    v_and_b32 v83, 0xffff0000, v35
    v_mfma_f32_32x32x16_bf16 v[240:255], a[180:183], v[44:47], v[240:255]
    v_fma_f32 v82, v82, v84, v85
    ds_read_b64_tr_b16 a[150:151], v20 offset:10528
    v_fma_f32 v83, v83, v84, v85
    v_fma_f32 v82, v82, v62, v54
    v_fma_f32 v83, v83, v63, v55
    v_mfma_f32_32x32x16_bf16 a[0:15], a[184:187], v[40:43], a[0:15]
    v_cvt_pk_bf16_f32 v35, v82, v83
    ds_read_b64_tr_b16 a[152:153], v20 offset:9408
    v_lshlrev_b32 v80, 16, v36
    v_and_b32 v81, 0xffff0000, v36
    v_mfma_f32_32x32x16_bf16 a[16:31], a[184:187], v[44:47], a[16:31]
    v_fma_f32 v80, v80, v86, v87
    v_fma_f32 v81, v81, v86, v87
    v_fma_f32 v80, v80, v56, v48
    ds_read_b64_tr_b16 a[154:155], v20 offset:10560
    v_fma_f32 v81, v81, v57, v49
    v_mfma_f32_32x32x16_bf16 a[32:47], a[188:191], v[40:43], a[32:47]
    v_cvt_pk_bf16_f32 v36, v80, v81
    v_lshlrev_b32 v82, 16, v37
    v_and_b32 v83, 0xffff0000, v37
    v_fma_f32 v82, v82, v86, v87
    v_mfma_f32_32x32x16_bf16 a[48:63], a[188:191], v[44:47], a[48:63]
    ds_read_b64_tr_b16 a[156:157], v20 offset:9440
    v_fma_f32 v83, v83, v86, v87
    v_fma_f32 v82, v82, v58, v50
    v_fma_f32 v83, v83, v59, v51
    v_cvt_pk_bf16_f32 v37, v82, v83
    v_mfma_f32_32x32x16_bf16 a[64:79], a[192:195], v[40:43], a[64:79]
    ds_read_b64_tr_b16 a[158:159], v20 offset:10592
    v_lshlrev_b32 v80, 16, v38
    v_and_b32 v81, 0xffff0000, v38
    v_fma_f32 v80, v80, v86, v87
    v_mfma_f32_32x32x16_bf16 a[80:95], a[192:195], v[44:47], a[80:95]
    v_fma_f32 v81, v81, v86, v87
    v_fma_f32 v80, v80, v60, v52
    ds_read_b64_tr_b16 a[160:161], v20 offset:9472
    v_fma_f32 v81, v81, v61, v53
    v_cvt_pk_bf16_f32 v38, v80, v81
    v_mfma_f32_32x32x16_bf16 a[96:111], a[196:199], v[40:43], a[96:111]
    v_lshlrev_b32 v82, 16, v39
    v_and_b32 v83, 0xffff0000, v39
    v_fma_f32 v82, v82, v86, v87
    ds_read_b64_tr_b16 a[162:163], v20 offset:10624
    v_mfma_f32_32x32x16_bf16 a[112:127], a[196:199], v[44:47], a[112:127]
    v_fma_f32 v83, v83, v86, v87
    v_fma_f32 v82, v82, v62, v54
    v_fma_f32 v83, v83, v63, v55
    v_cvt_pk_bf16_f32 v39, v82, v83
    s_waitcnt lgkmcnt(15)
    v_mfma_f32_32x32x16_bf16 v[96:111], a[128:131], v[32:35], v[96:111]
    ds_read_b128 v[40:43], v15 offset:0
    ds_read_b128 v[44:47], v15 offset:4096
    ds_read_b128 v[64:67], v22 offset:2240
    ds_read_b128 v[68:71], v22 offset:2256
    ds_read_b128 v[72:75], v22 offset:4544
    v_mfma_f32_32x32x16_bf16 v[112:127], a[128:131], v[36:39], v[112:127]
    ds_read_b128 v[76:79], v22 offset:4560
    ds_read_b64_tr_b16 a[164:165], v20 offset:13824
    ds_read_b64_tr_b16 a[166:167], v20 offset:14976
    ds_read_b64_tr_b16 a[168:169], v20 offset:13856
    s_waitcnt lgkmcnt(15)
    v_mfma_f32_32x32x16_bf16 v[128:143], a[132:135], v[32:35], v[128:143]
    ds_read_b64_tr_b16 a[170:171], v20 offset:15008
    ds_read_b64_tr_b16 a[172:173], v20 offset:13888
    ds_read_b64_tr_b16 a[174:175], v20 offset:15040
    ds_read_b64_tr_b16 a[176:177], v20 offset:13920
    s_waitcnt lgkmcnt(12)
    v_lshlrev_b32 v80, 16, v40
    v_mfma_f32_32x32x16_bf16 v[144:159], a[132:135], v[36:39], v[144:159]
    v_and_b32 v81, 0xffff0000, v40
    v_fma_f32 v80, v80, v84, v85
    v_fma_f32 v81, v81, v84, v85
    s_waitcnt lgkmcnt(8)
    v_fma_f32 v80, v80, v72, v64
    v_mfma_f32_32x32x16_bf16 v[160:175], a[136:139], v[32:35], v[160:175]
    ds_read_b64_tr_b16 a[178:179], v20 offset:15072
    v_fma_f32 v81, v81, v73, v65
    v_cvt_pk_bf16_f32 v40, v80, v81
    v_lshlrev_b32 v82, 16, v41
    v_and_b32 v83, 0xffff0000, v41
    v_mfma_f32_32x32x16_bf16 v[176:191], a[136:139], v[36:39], v[176:191]
    v_fma_f32 v82, v82, v84, v85
    ds_read_b64_tr_b16 a[180:181], v20 offset:13952
    v_fma_f32 v83, v83, v84, v85
    v_fma_f32 v82, v82, v74, v66
    v_mfma_f32_32x32x16_bf16 v[192:207], a[140:143], v[32:35], v[192:207]
    v_fma_f32 v83, v83, v75, v67
    v_cvt_pk_bf16_f32 v41, v82, v83
    ds_read_b64_tr_b16 a[182:183], v20 offset:15104
    v_lshlrev_b32 v80, 16, v42
    v_and_b32 v81, 0xffff0000, v42
    v_mfma_f32_32x32x16_bf16 v[208:223], a[140:143], v[36:39], v[208:223]
    v_fma_f32 v80, v80, v84, v85
    v_fma_f32 v81, v81, v84, v85
    s_waitcnt lgkmcnt(10)
    v_fma_f32 v80, v80, v76, v68
    ds_read_b64_tr_b16 a[184:185], v20 offset:13984
    v_mfma_f32_32x32x16_bf16 v[224:239], a[144:147], v[32:35], v[224:239]
    v_fma_f32 v81, v81, v77, v69
    v_cvt_pk_bf16_f32 v42, v80, v81
    v_lshlrev_b32 v82, 16, v43
    v_and_b32 v83, 0xffff0000, v43
    v_mfma_f32_32x32x16_bf16 v[240:255], a[144:147], v[36:39], v[240:255]
    v_fma_f32 v82, v82, v84, v85
    ds_read_b64_tr_b16 a[186:187], v20 offset:15136
    v_fma_f32 v83, v83, v84, v85
    v_fma_f32 v82, v82, v78, v70
    v_fma_f32 v83, v83, v79, v71
    v_mfma_f32_32x32x16_bf16 a[0:15], a[148:151], v[32:35], a[0:15]
    v_cvt_pk_bf16_f32 v43, v82, v83
    ds_read_b64_tr_b16 a[188:189], v20 offset:14016
    v_lshlrev_b32 v80, 16, v44
    v_and_b32 v81, 0xffff0000, v44
    v_mfma_f32_32x32x16_bf16 a[16:31], a[148:151], v[36:39], a[16:31]
    v_fma_f32 v80, v80, v86, v87
    v_fma_f32 v81, v81, v86, v87
    v_fma_f32 v80, v80, v72, v64
    ds_read_b64_tr_b16 a[190:191], v20 offset:15168
    v_fma_f32 v81, v81, v73, v65
    v_mfma_f32_32x32x16_bf16 a[32:47], a[152:155], v[32:35], a[32:47]
    v_cvt_pk_bf16_f32 v44, v80, v81
    v_lshlrev_b32 v82, 16, v45
    v_and_b32 v83, 0xffff0000, v45
    v_fma_f32 v82, v82, v86, v87
    v_mfma_f32_32x32x16_bf16 a[48:63], a[152:155], v[36:39], a[48:63]
    ds_read_b64_tr_b16 a[192:193], v20 offset:14048
    v_fma_f32 v83, v83, v86, v87
    v_fma_f32 v82, v82, v74, v66
    v_fma_f32 v83, v83, v75, v67
    v_cvt_pk_bf16_f32 v45, v82, v83
    v_mfma_f32_32x32x16_bf16 a[64:79], a[156:159], v[32:35], a[64:79]
    ds_read_b64_tr_b16 a[194:195], v20 offset:15200
    v_lshlrev_b32 v80, 16, v46
    v_and_b32 v81, 0xffff0000, v46
    v_fma_f32 v80, v80, v86, v87
    v_mfma_f32_32x32x16_bf16 a[80:95], a[156:159], v[36:39], a[80:95]
    v_fma_f32 v81, v81, v86, v87
    v_fma_f32 v80, v80, v76, v68
    ds_read_b64_tr_b16 a[196:197], v20 offset:14080
    v_fma_f32 v81, v81, v77, v69
    v_cvt_pk_bf16_f32 v46, v80, v81
    v_mfma_f32_32x32x16_bf16 a[96:111], a[160:163], v[32:35], a[96:111]
    v_lshlrev_b32 v82, 16, v47
    v_and_b32 v83, 0xffff0000, v47
    v_fma_f32 v82, v82, v86, v87
    ds_read_b64_tr_b16 a[198:199], v20 offset:15232
    v_mfma_f32_32x32x16_bf16 a[112:127], a[160:163], v[36:39], a[112:127]
    v_fma_f32 v83, v83, v86, v87
    v_fma_f32 v82, v82, v78, v70
    v_fma_f32 v83, v83, v79, v71
    v_cvt_pk_bf16_f32 v47, v82, v83
    s_waitcnt lgkmcnt(15)
    v_mfma_f32_32x32x16_bf16 v[96:111], a[164:167], v[40:43], v[96:111]
    v_mfma_f32_32x32x16_bf16 v[112:127], a[164:167], v[44:47], v[112:127]
    s_waitcnt lgkmcnt(14)
    v_mfma_f32_32x32x16_bf16 v[128:143], a[168:171], v[40:43], v[128:143]
    v_mfma_f32_32x32x16_bf16 v[144:159], a[168:171], v[44:47], v[144:159]
    s_waitcnt lgkmcnt(12)
    v_mfma_f32_32x32x16_bf16 v[160:175], a[172:175], v[40:43], v[160:175]
    v_mfma_f32_32x32x16_bf16 v[176:191], a[172:175], v[44:47], v[176:191]
    s_waitcnt lgkmcnt(10)
    v_mfma_f32_32x32x16_bf16 v[192:207], a[176:179], v[40:43], v[192:207]
    v_mfma_f32_32x32x16_bf16 v[208:223], a[176:179], v[44:47], v[208:223]
    s_waitcnt lgkmcnt(8)
    v_mfma_f32_32x32x16_bf16 v[224:239], a[180:183], v[40:43], v[224:239]
    v_mfma_f32_32x32x16_bf16 v[240:255], a[180:183], v[44:47], v[240:255]
    s_waitcnt lgkmcnt(6)
    v_mfma_f32_32x32x16_bf16 a[0:15], a[184:187], v[40:43], a[0:15]
    v_mfma_f32_32x32x16_bf16 a[16:31], a[184:187], v[44:47], a[16:31]
    s_waitcnt lgkmcnt(4)
    v_mfma_f32_32x32x16_bf16 a[32:47], a[188:191], v[40:43], a[32:47]
    v_mfma_f32_32x32x16_bf16 a[48:63], a[188:191], v[44:47], a[48:63]
    s_waitcnt lgkmcnt(2)
    v_mfma_f32_32x32x16_bf16 a[64:79], a[192:195], v[40:43], a[64:79]
    v_mfma_f32_32x32x16_bf16 a[80:95], a[192:195], v[44:47], a[80:95]
    s_waitcnt lgkmcnt(0)
    v_mfma_f32_32x32x16_bf16 a[96:111], a[196:199], v[40:43], a[96:111]
    v_mfma_f32_32x32x16_bf16 a[112:127], a[196:199], v[44:47], a[112:127]
    v_and_b32 v1, 63, v0
    v_and_b32 v2, 31, v1
    v_lshrrev_b32 v3, 5, v1
    s_lshl_b32 s40, s38, 8
    s_lshl_b32 s41, s36, 6
    s_add_u32 s40, s40, s41
    v_add_u32 v2, s40, v2
    s_movk_i32 s41, 9216
    v_mul_lo_u32 v2, v2, s41
    v_lshl_add_u32 v2, v3, 4, v2
    s_mul_i32 s40, s37, 288
    v_add_u32 v2, s40, v2
    v_add_u32 v3, 294912, v2
    s_barrier
    s_mul_i32 s43, s36, 19456
    v_and_b32 v4, 31, v1
    v_mul_u32_u24 v4, 304, v4
    v_lshrrev_b32 v5, 5, v1
    v_lshl_add_u32 v4, v5, 4, v4
    v_add_u32 v4, s43, v4
    s_lshl_b32 s44, s38, 8
    s_lshl_b32 s45, s36, 6
    s_add_u32 s44, s44, s45
    s_mul_i32 s44, s44, 9216
    s_mul_i32 s45, s37, 288
    s_add_u32 s44, s44, s45
    s_mov_b32 s42, 58255
    v_add_u32 v8, 0, v1
    v_mul_lo_u32 v9, v8, s42
    v_lshrrev_b32 v9, 20, v9
    v_mul_u32_u24 v10, 18, v9
    v_sub_u32 v10, v8, v10
    v_mul_u32_u24 v11, 304, v9
    v_lshl_add_u32 v11, v10, 4, v11
    v_add_u32 v32, s43, v11
    v_mul_lo_u32 v9, v9, s41
    v_lshl_add_u32 v41, v10, 4, v9
    v_add_u32 v8, 64, v1
    v_mul_lo_u32 v9, v8, s42
    v_lshrrev_b32 v9, 20, v9
    v_mul_u32_u24 v10, 18, v9
    v_sub_u32 v10, v8, v10
    v_mul_u32_u24 v11, 304, v9
    v_lshl_add_u32 v11, v10, 4, v11
    v_add_u32 v33, s43, v11
    v_mul_lo_u32 v9, v9, s41
    v_lshl_add_u32 v42, v10, 4, v9
    v_add_u32 v8, 128, v1
    v_mul_lo_u32 v9, v8, s42
    v_lshrrev_b32 v9, 20, v9
    v_mul_u32_u24 v10, 18, v9
    v_sub_u32 v10, v8, v10
    v_mul_u32_u24 v11, 304, v9
    v_lshl_add_u32 v11, v10, 4, v11
    v_add_u32 v34, s43, v11
    v_mul_lo_u32 v9, v9, s41
    v_lshl_add_u32 v43, v10, 4, v9
    v_add_u32 v8, 192, v1
    v_mul_lo_u32 v9, v8, s42
    v_lshrrev_b32 v9, 20, v9
    v_mul_u32_u24 v10, 18, v9
    v_sub_u32 v10, v8, v10
    v_mul_u32_u24 v11, 304, v9
    v_lshl_add_u32 v11, v10, 4, v11
    v_add_u32 v35, s43, v11
    v_mul_lo_u32 v9, v9, s41
    v_lshl_add_u32 v44, v10, 4, v9
    v_add_u32 v8, 256, v1
    v_mul_lo_u32 v9, v8, s42
    v_lshrrev_b32 v9, 20, v9
    v_mul_u32_u24 v10, 18, v9
    v_sub_u32 v10, v8, v10
    v_mul_u32_u24 v11, 304, v9
    v_lshl_add_u32 v11, v10, 4, v11
    v_add_u32 v36, s43, v11
    v_mul_lo_u32 v9, v9, s41
    v_lshl_add_u32 v45, v10, 4, v9
    v_add_u32 v8, 320, v1
    v_mul_lo_u32 v9, v8, s42
    v_lshrrev_b32 v9, 20, v9
    v_mul_u32_u24 v10, 18, v9
    v_sub_u32 v10, v8, v10
    v_mul_u32_u24 v11, 304, v9
    v_lshl_add_u32 v11, v10, 4, v11
    v_add_u32 v37, s43, v11
    v_mul_lo_u32 v9, v9, s41
    v_lshl_add_u32 v46, v10, 4, v9
    v_add_u32 v8, 384, v1
    v_mul_lo_u32 v9, v8, s42
    v_lshrrev_b32 v9, 20, v9
    v_mul_u32_u24 v10, 18, v9
    v_sub_u32 v10, v8, v10
    v_mul_u32_u24 v11, 304, v9
    v_lshl_add_u32 v11, v10, 4, v11
    v_add_u32 v38, s43, v11
    v_mul_lo_u32 v9, v9, s41
    v_lshl_add_u32 v47, v10, 4, v9
    v_add_u32 v8, 448, v1
    v_mul_lo_u32 v9, v8, s42
    v_lshrrev_b32 v9, 20, v9
    v_mul_u32_u24 v10, 18, v9
    v_sub_u32 v10, v8, v10
    v_mul_u32_u24 v11, 304, v9
    v_lshl_add_u32 v11, v10, 4, v11
    v_add_u32 v39, s43, v11
    v_mul_lo_u32 v9, v9, s41
    v_lshl_add_u32 v48, v10, 4, v9
    v_add_u32 v8, 512, v1
    v_mul_lo_u32 v9, v8, s42
    v_lshrrev_b32 v9, 20, v9
    v_mul_u32_u24 v10, 18, v9
    v_sub_u32 v10, v8, v10
    v_mul_u32_u24 v11, 304, v9
    v_lshl_add_u32 v11, v10, 4, v11
    v_add_u32 v40, s43, v11
    v_mul_lo_u32 v9, v9, s41
    v_lshl_add_u32 v49, v10, 4, v9
    s_add_u32 s45, s44, 294912
    v_max_f32 v20, 0, v96
    v_max_f32 v21, 0, v97
    v_mul_f32 v20, v20, v104
    v_mul_f32 v21, v21, v105
    v_cvt_pk_bf16_f32 v8, v20, v21
    v_max_f32 v20, 0, v98
    v_max_f32 v21, 0, v99
    v_mul_f32 v20, v20, v106
    v_mul_f32 v21, v21, v107
    v_cvt_pk_bf16_f32 v9, v20, v21
    v_max_f32 v20, 0, v100
    v_max_f32 v21, 0, v101
    v_mul_f32 v20, v20, v108
    v_mul_f32 v21, v21, v109
    v_cvt_pk_bf16_f32 v10, v20, v21
    v_max_f32 v20, 0, v102
    v_max_f32 v21, 0, v103
    v_mul_f32 v20, v20, v110
    v_mul_f32 v21, v21, v111
    v_cvt_pk_bf16_f32 v11, v20, v21
    v_permlane32_swap_b32 v8, v10
    s_nop 0
    v_permlane32_swap_b32 v9, v11
    ds_write_b128 v4, v[8:11] offset:0
    v_max_f32 v20, 0, v128
    v_max_f32 v21, 0, v129
    v_mul_f32 v20, v20, v136
    v_mul_f32 v21, v21, v137
    v_cvt_pk_bf16_f32 v12, v20, v21
    v_max_f32 v20, 0, v130
    v_max_f32 v21, 0, v131
    v_mul_f32 v20, v20, v138
    v_mul_f32 v21, v21, v139
    v_cvt_pk_bf16_f32 v13, v20, v21
    v_max_f32 v20, 0, v132
    v_max_f32 v21, 0, v133
    v_mul_f32 v20, v20, v140
    v_mul_f32 v21, v21, v141
    v_cvt_pk_bf16_f32 v14, v20, v21
    v_max_f32 v20, 0, v134
    v_max_f32 v21, 0, v135
    v_mul_f32 v20, v20, v142
    v_mul_f32 v21, v21, v143
    v_cvt_pk_bf16_f32 v15, v20, v21
    v_permlane32_swap_b32 v12, v14
    s_nop 0
    v_permlane32_swap_b32 v13, v15
    ds_write_b128 v4, v[12:15] offset:32
    v_max_f32 v20, 0, v160
    v_max_f32 v21, 0, v161
    v_mul_f32 v20, v20, v168
    v_mul_f32 v21, v21, v169
    v_cvt_pk_bf16_f32 v8, v20, v21
    v_max_f32 v20, 0, v162
    v_max_f32 v21, 0, v163
    v_mul_f32 v20, v20, v170
    v_mul_f32 v21, v21, v171
    v_cvt_pk_bf16_f32 v9, v20, v21
    v_max_f32 v20, 0, v164
    v_max_f32 v21, 0, v165
    v_mul_f32 v20, v20, v172
    v_mul_f32 v21, v21, v173
    v_cvt_pk_bf16_f32 v10, v20, v21
    v_max_f32 v20, 0, v166
    v_max_f32 v21, 0, v167
    v_mul_f32 v20, v20, v174
    v_mul_f32 v21, v21, v175
    v_cvt_pk_bf16_f32 v11, v20, v21
    v_permlane32_swap_b32 v8, v10
    s_nop 0
    v_permlane32_swap_b32 v9, v11
    ds_write_b128 v4, v[8:11] offset:64
    v_max_f32 v20, 0, v192
    v_max_f32 v21, 0, v193
    v_mul_f32 v20, v20, v200
    v_mul_f32 v21, v21, v201
    v_cvt_pk_bf16_f32 v12, v20, v21
    v_max_f32 v20, 0, v194
    v_max_f32 v21, 0, v195
    v_mul_f32 v20, v20, v202
    v_mul_f32 v21, v21, v203
    v_cvt_pk_bf16_f32 v13, v20, v21
    v_max_f32 v20, 0, v196
    v_max_f32 v21, 0, v197
    v_mul_f32 v20, v20, v204
    v_mul_f32 v21, v21, v205
    v_cvt_pk_bf16_f32 v14, v20, v21
    v_max_f32 v20, 0, v198
    v_max_f32 v21, 0, v199
    v_mul_f32 v20, v20, v206
    v_mul_f32 v21, v21, v207
    v_cvt_pk_bf16_f32 v15, v20, v21
    v_permlane32_swap_b32 v12, v14
    s_nop 0
    v_permlane32_swap_b32 v13, v15
    ds_write_b128 v4, v[12:15] offset:96
    v_max_f32 v20, 0, v224
    v_max_f32 v21, 0, v225
    v_mul_f32 v20, v20, v232
    v_mul_f32 v21, v21, v233
    v_cvt_pk_bf16_f32 v8, v20, v21
    v_max_f32 v20, 0, v226
    v_max_f32 v21, 0, v227
    v_mul_f32 v20, v20, v234
    v_mul_f32 v21, v21, v235
    v_cvt_pk_bf16_f32 v9, v20, v21
    v_max_f32 v20, 0, v228
    v_max_f32 v21, 0, v229
    v_mul_f32 v20, v20, v236
    v_mul_f32 v21, v21, v237
    v_cvt_pk_bf16_f32 v10, v20, v21
    v_max_f32 v20, 0, v230
    v_max_f32 v21, 0, v231
    v_mul_f32 v20, v20, v238
    v_mul_f32 v21, v21, v239
    v_cvt_pk_bf16_f32 v11, v20, v21
    v_permlane32_swap_b32 v8, v10
    s_nop 0
    v_permlane32_swap_b32 v9, v11
    ds_write_b128 v4, v[8:11] offset:128
    v_accvgpr_read_b32 v16, a0
    v_accvgpr_read_b32 v17, a1
    v_accvgpr_read_b32 v18, a8
    v_accvgpr_read_b32 v19, a9
    v_max_f32 v20, 0, v16
    v_max_f32 v21, 0, v17
    v_mul_f32 v20, v20, v18
    v_mul_f32 v21, v21, v19
    v_cvt_pk_bf16_f32 v12, v20, v21
    v_accvgpr_read_b32 v16, a2
    v_accvgpr_read_b32 v17, a3
    v_accvgpr_read_b32 v18, a10
    v_accvgpr_read_b32 v19, a11
    v_max_f32 v20, 0, v16
    v_max_f32 v21, 0, v17
    v_mul_f32 v20, v20, v18
    v_mul_f32 v21, v21, v19
    v_cvt_pk_bf16_f32 v13, v20, v21
    v_accvgpr_read_b32 v16, a4
    v_accvgpr_read_b32 v17, a5
    v_accvgpr_read_b32 v18, a12
    v_accvgpr_read_b32 v19, a13
    v_max_f32 v20, 0, v16
    v_max_f32 v21, 0, v17
    v_mul_f32 v20, v20, v18
    v_mul_f32 v21, v21, v19
    v_cvt_pk_bf16_f32 v14, v20, v21
    v_accvgpr_read_b32 v16, a6
    v_accvgpr_read_b32 v17, a7
    v_accvgpr_read_b32 v18, a14
    v_accvgpr_read_b32 v19, a15
    v_max_f32 v20, 0, v16
    v_max_f32 v21, 0, v17
    v_mul_f32 v20, v20, v18
    v_mul_f32 v21, v21, v19
    v_cvt_pk_bf16_f32 v15, v20, v21
    v_permlane32_swap_b32 v12, v14
    s_nop 0
    v_permlane32_swap_b32 v13, v15
    ds_write_b128 v4, v[12:15] offset:160
    v_accvgpr_read_b32 v16, a32
    v_accvgpr_read_b32 v17, a33
    v_accvgpr_read_b32 v18, a40
    v_accvgpr_read_b32 v19, a41
    v_max_f32 v20, 0, v16
    v_max_f32 v21, 0, v17
    v_mul_f32 v20, v20, v18
    v_mul_f32 v21, v21, v19
    v_cvt_pk_bf16_f32 v8, v20, v21
    v_accvgpr_read_b32 v16, a34
    v_accvgpr_read_b32 v17, a35
    v_accvgpr_read_b32 v18, a42
    v_accvgpr_read_b32 v19, a43
    v_max_f32 v20, 0, v16
    v_max_f32 v21, 0, v17
    v_mul_f32 v20, v20, v18
    v_mul_f32 v21, v21, v19
    v_cvt_pk_bf16_f32 v9, v20, v21
    v_accvgpr_read_b32 v16, a36
    v_accvgpr_read_b32 v17, a37
    v_accvgpr_read_b32 v18, a44
    v_accvgpr_read_b32 v19, a45
    v_max_f32 v20, 0, v16
    v_max_f32 v21, 0, v17
    v_mul_f32 v20, v20, v18
    v_mul_f32 v21, v21, v19
    v_cvt_pk_bf16_f32 v10, v20, v21
    v_accvgpr_read_b32 v16, a38
    v_accvgpr_read_b32 v17, a39
    v_accvgpr_read_b32 v18, a46
    v_accvgpr_read_b32 v19, a47
    v_max_f32 v20, 0, v16
    v_max_f32 v21, 0, v17
    v_mul_f32 v20, v20, v18
    v_mul_f32 v21, v21, v19
    v_cvt_pk_bf16_f32 v11, v20, v21
    v_permlane32_swap_b32 v8, v10
    s_nop 0
    v_permlane32_swap_b32 v9, v11
    ds_write_b128 v4, v[8:11] offset:192
    v_accvgpr_read_b32 v16, a64
    v_accvgpr_read_b32 v17, a65
    v_accvgpr_read_b32 v18, a72
    v_accvgpr_read_b32 v19, a73
    v_max_f32 v20, 0, v16
    v_max_f32 v21, 0, v17
    v_mul_f32 v20, v20, v18
    v_mul_f32 v21, v21, v19
    v_cvt_pk_bf16_f32 v12, v20, v21
    v_accvgpr_read_b32 v16, a66
    v_accvgpr_read_b32 v17, a67
    v_accvgpr_read_b32 v18, a74
    v_accvgpr_read_b32 v19, a75
    v_max_f32 v20, 0, v16
    v_max_f32 v21, 0, v17
    v_mul_f32 v20, v20, v18
    v_mul_f32 v21, v21, v19
    v_cvt_pk_bf16_f32 v13, v20, v21
    v_accvgpr_read_b32 v16, a68
    v_accvgpr_read_b32 v17, a69
    v_accvgpr_read_b32 v18, a76
    v_accvgpr_read_b32 v19, a77
    v_max_f32 v20, 0, v16
    v_max_f32 v21, 0, v17
    v_mul_f32 v20, v20, v18
    v_mul_f32 v21, v21, v19
    v_cvt_pk_bf16_f32 v14, v20, v21
    v_accvgpr_read_b32 v16, a70
    v_accvgpr_read_b32 v17, a71
    v_accvgpr_read_b32 v18, a78
    v_accvgpr_read_b32 v19, a79
    v_max_f32 v20, 0, v16
    v_max_f32 v21, 0, v17
    v_mul_f32 v20, v20, v18
    v_mul_f32 v21, v21, v19
    v_cvt_pk_bf16_f32 v15, v20, v21
    v_permlane32_swap_b32 v12, v14
    s_nop 0
    v_permlane32_swap_b32 v13, v15
    ds_write_b128 v4, v[12:15] offset:224
    v_accvgpr_read_b32 v16, a96
    v_accvgpr_read_b32 v17, a97
    v_accvgpr_read_b32 v18, a104
    v_accvgpr_read_b32 v19, a105
    v_max_f32 v20, 0, v16
    v_max_f32 v21, 0, v17
    v_mul_f32 v20, v20, v18
    v_mul_f32 v21, v21, v19
    v_cvt_pk_bf16_f32 v8, v20, v21
    v_accvgpr_read_b32 v16, a98
    v_accvgpr_read_b32 v17, a99
    v_accvgpr_read_b32 v18, a106
    v_accvgpr_read_b32 v19, a107
    v_max_f32 v20, 0, v16
    v_max_f32 v21, 0, v17
    v_mul_f32 v20, v20, v18
    v_mul_f32 v21, v21, v19
    v_cvt_pk_bf16_f32 v9, v20, v21
    v_accvgpr_read_b32 v16, a100
    v_accvgpr_read_b32 v17, a101
    v_accvgpr_read_b32 v18, a108
    v_accvgpr_read_b32 v19, a109
    v_max_f32 v20, 0, v16
    v_max_f32 v21, 0, v17
    v_mul_f32 v20, v20, v18
    v_mul_f32 v21, v21, v19
    v_cvt_pk_bf16_f32 v10, v20, v21
    v_accvgpr_read_b32 v16, a102
    v_accvgpr_read_b32 v17, a103
    v_accvgpr_read_b32 v18, a110
    v_accvgpr_read_b32 v19, a111
    v_max_f32 v20, 0, v16
    v_max_f32 v21, 0, v17
    v_mul_f32 v20, v20, v18
    v_mul_f32 v21, v21, v19
    v_cvt_pk_bf16_f32 v11, v20, v21
    v_permlane32_swap_b32 v8, v10
    s_nop 0
    v_permlane32_swap_b32 v9, v11
    ds_write_b128 v4, v[8:11] offset:256
    s_waitcnt lgkmcnt(0)
    ds_read_b128 v[52:55], v32 offset:0
    ds_read_b128 v[56:59], v33 offset:0
    ds_read_b128 v[60:63], v34 offset:0
    ds_read_b128 v[64:67], v35 offset:0
    ds_read_b128 v[68:71], v36 offset:0
    ds_read_b128 v[72:75], v37 offset:0
    ds_read_b128 v[76:79], v38 offset:0
    ds_read_b128 v[80:83], v39 offset:0
    ds_read_b128 v[84:87], v40 offset:0
    s_waitcnt lgkmcnt(8)
    buffer_store_dwordx4 v[52:55], v41, s[20:23], s44 offen
    s_waitcnt lgkmcnt(7)
    buffer_store_dwordx4 v[56:59], v42, s[20:23], s44 offen
    s_waitcnt lgkmcnt(6)
    buffer_store_dwordx4 v[60:63], v43, s[20:23], s44 offen
    s_waitcnt lgkmcnt(5)
    buffer_store_dwordx4 v[64:67], v44, s[20:23], s44 offen
    s_waitcnt lgkmcnt(4)
    buffer_store_dwordx4 v[68:71], v45, s[20:23], s44 offen
    s_waitcnt lgkmcnt(3)
    buffer_store_dwordx4 v[72:75], v46, s[20:23], s44 offen
    s_waitcnt lgkmcnt(2)
    buffer_store_dwordx4 v[76:79], v47, s[20:23], s44 offen
    s_waitcnt lgkmcnt(1)
    buffer_store_dwordx4 v[80:83], v48, s[20:23], s44 offen
    s_waitcnt lgkmcnt(0)
    buffer_store_dwordx4 v[84:87], v49, s[20:23], s44 offen
    v_max_f32 v20, 0, v112
    v_max_f32 v21, 0, v113
    v_mul_f32 v20, v20, v120
    v_mul_f32 v21, v21, v121
    v_cvt_pk_bf16_f32 v12, v20, v21
    v_max_f32 v20, 0, v114
    v_max_f32 v21, 0, v115
    v_mul_f32 v20, v20, v122
    v_mul_f32 v21, v21, v123
    v_cvt_pk_bf16_f32 v13, v20, v21
    v_max_f32 v20, 0, v116
    v_max_f32 v21, 0, v117
    v_mul_f32 v20, v20, v124
    v_mul_f32 v21, v21, v125
    v_cvt_pk_bf16_f32 v14, v20, v21
    v_max_f32 v20, 0, v118
    v_max_f32 v21, 0, v119
    v_mul_f32 v20, v20, v126
    v_mul_f32 v21, v21, v127
    v_cvt_pk_bf16_f32 v15, v20, v21
    v_permlane32_swap_b32 v12, v14
    s_nop 0
    v_permlane32_swap_b32 v13, v15
    ds_write_b128 v4, v[12:15] offset:9728
    v_max_f32 v20, 0, v144
    v_max_f32 v21, 0, v145
    v_mul_f32 v20, v20, v152
    v_mul_f32 v21, v21, v153
    v_cvt_pk_bf16_f32 v8, v20, v21
    v_max_f32 v20, 0, v146
    v_max_f32 v21, 0, v147
    v_mul_f32 v20, v20, v154
    v_mul_f32 v21, v21, v155
    v_cvt_pk_bf16_f32 v9, v20, v21
    v_max_f32 v20, 0, v148
    v_max_f32 v21, 0, v149
    v_mul_f32 v20, v20, v156
    v_mul_f32 v21, v21, v157
    v_cvt_pk_bf16_f32 v10, v20, v21
    v_max_f32 v20, 0, v150
    v_max_f32 v21, 0, v151
    v_mul_f32 v20, v20, v158
    v_mul_f32 v21, v21, v159
    v_cvt_pk_bf16_f32 v11, v20, v21
    v_permlane32_swap_b32 v8, v10
    s_nop 0
    v_permlane32_swap_b32 v9, v11
    ds_write_b128 v4, v[8:11] offset:9760
    v_max_f32 v20, 0, v176
    v_max_f32 v21, 0, v177
    v_mul_f32 v20, v20, v184
    v_mul_f32 v21, v21, v185
    v_cvt_pk_bf16_f32 v12, v20, v21
    v_max_f32 v20, 0, v178
    v_max_f32 v21, 0, v179
    v_mul_f32 v20, v20, v186
    v_mul_f32 v21, v21, v187
    v_cvt_pk_bf16_f32 v13, v20, v21
    v_max_f32 v20, 0, v180
    v_max_f32 v21, 0, v181
    v_mul_f32 v20, v20, v188
    v_mul_f32 v21, v21, v189
    v_cvt_pk_bf16_f32 v14, v20, v21
    v_max_f32 v20, 0, v182
    v_max_f32 v21, 0, v183
    v_mul_f32 v20, v20, v190
    v_mul_f32 v21, v21, v191
    v_cvt_pk_bf16_f32 v15, v20, v21
    v_permlane32_swap_b32 v12, v14
    s_nop 0
    v_permlane32_swap_b32 v13, v15
    ds_write_b128 v4, v[12:15] offset:9792
    v_max_f32 v20, 0, v208
    v_max_f32 v21, 0, v209
    v_mul_f32 v20, v20, v216
    v_mul_f32 v21, v21, v217
    v_cvt_pk_bf16_f32 v8, v20, v21
    v_max_f32 v20, 0, v210
    v_max_f32 v21, 0, v211
    v_mul_f32 v20, v20, v218
    v_mul_f32 v21, v21, v219
    v_cvt_pk_bf16_f32 v9, v20, v21
    v_max_f32 v20, 0, v212
    v_max_f32 v21, 0, v213
    v_mul_f32 v20, v20, v220
    v_mul_f32 v21, v21, v221
    v_cvt_pk_bf16_f32 v10, v20, v21
    v_max_f32 v20, 0, v214
    v_max_f32 v21, 0, v215
    v_mul_f32 v20, v20, v222
    v_mul_f32 v21, v21, v223
    v_cvt_pk_bf16_f32 v11, v20, v21
    v_permlane32_swap_b32 v8, v10
    s_nop 0
    v_permlane32_swap_b32 v9, v11
    ds_write_b128 v4, v[8:11] offset:9824
    v_max_f32 v20, 0, v240
    v_max_f32 v21, 0, v241
    v_mul_f32 v20, v20, v248
    v_mul_f32 v21, v21, v249
    v_cvt_pk_bf16_f32 v12, v20, v21
    v_max_f32 v20, 0, v242
    v_max_f32 v21, 0, v243
    v_mul_f32 v20, v20, v250
    v_mul_f32 v21, v21, v251
    v_cvt_pk_bf16_f32 v13, v20, v21
    v_max_f32 v20, 0, v244
    v_max_f32 v21, 0, v245
    v_mul_f32 v20, v20, v252
    v_mul_f32 v21, v21, v253
    v_cvt_pk_bf16_f32 v14, v20, v21
    v_max_f32 v20, 0, v246
    v_max_f32 v21, 0, v247
    v_mul_f32 v20, v20, v254
    v_mul_f32 v21, v21, v255
    v_cvt_pk_bf16_f32 v15, v20, v21
    v_permlane32_swap_b32 v12, v14
    s_nop 0
    v_permlane32_swap_b32 v13, v15
    ds_write_b128 v4, v[12:15] offset:9856
    v_accvgpr_read_b32 v16, a16
    v_accvgpr_read_b32 v17, a17
    v_accvgpr_read_b32 v18, a24
    v_accvgpr_read_b32 v19, a25
    v_max_f32 v20, 0, v16
    v_max_f32 v21, 0, v17
    v_mul_f32 v20, v20, v18
    v_mul_f32 v21, v21, v19
    v_cvt_pk_bf16_f32 v8, v20, v21
    v_accvgpr_read_b32 v16, a18
    v_accvgpr_read_b32 v17, a19
    v_accvgpr_read_b32 v18, a26
    v_accvgpr_read_b32 v19, a27
    v_max_f32 v20, 0, v16
    v_max_f32 v21, 0, v17
    v_mul_f32 v20, v20, v18
    v_mul_f32 v21, v21, v19
    v_cvt_pk_bf16_f32 v9, v20, v21
    v_accvgpr_read_b32 v16, a20
    v_accvgpr_read_b32 v17, a21
    v_accvgpr_read_b32 v18, a28
    v_accvgpr_read_b32 v19, a29
    v_max_f32 v20, 0, v16
    v_max_f32 v21, 0, v17
    v_mul_f32 v20, v20, v18
    v_mul_f32 v21, v21, v19
    v_cvt_pk_bf16_f32 v10, v20, v21
    v_accvgpr_read_b32 v16, a22
    v_accvgpr_read_b32 v17, a23
    v_accvgpr_read_b32 v18, a30
    v_accvgpr_read_b32 v19, a31
    v_max_f32 v20, 0, v16
    v_max_f32 v21, 0, v17
    v_mul_f32 v20, v20, v18
    v_mul_f32 v21, v21, v19
    v_cvt_pk_bf16_f32 v11, v20, v21
    v_permlane32_swap_b32 v8, v10
    s_nop 0
    v_permlane32_swap_b32 v9, v11
    ds_write_b128 v4, v[8:11] offset:9888
    v_accvgpr_read_b32 v16, a48
    v_accvgpr_read_b32 v17, a49
    v_accvgpr_read_b32 v18, a56
    v_accvgpr_read_b32 v19, a57
    v_max_f32 v20, 0, v16
    v_max_f32 v21, 0, v17
    v_mul_f32 v20, v20, v18
    v_mul_f32 v21, v21, v19
    v_cvt_pk_bf16_f32 v12, v20, v21
    v_accvgpr_read_b32 v16, a50
    v_accvgpr_read_b32 v17, a51
    v_accvgpr_read_b32 v18, a58
    v_accvgpr_read_b32 v19, a59
    v_max_f32 v20, 0, v16
    v_max_f32 v21, 0, v17
    v_mul_f32 v20, v20, v18
    v_mul_f32 v21, v21, v19
    v_cvt_pk_bf16_f32 v13, v20, v21
    v_accvgpr_read_b32 v16, a52
    v_accvgpr_read_b32 v17, a53
    v_accvgpr_read_b32 v18, a60
    v_accvgpr_read_b32 v19, a61
    v_max_f32 v20, 0, v16
    v_max_f32 v21, 0, v17
    v_mul_f32 v20, v20, v18
    v_mul_f32 v21, v21, v19
    v_cvt_pk_bf16_f32 v14, v20, v21
    v_accvgpr_read_b32 v16, a54
    v_accvgpr_read_b32 v17, a55
    v_accvgpr_read_b32 v18, a62
    v_accvgpr_read_b32 v19, a63
    v_max_f32 v20, 0, v16
    v_max_f32 v21, 0, v17
    v_mul_f32 v20, v20, v18
    v_mul_f32 v21, v21, v19
    v_cvt_pk_bf16_f32 v15, v20, v21
    v_permlane32_swap_b32 v12, v14
    s_nop 0
    v_permlane32_swap_b32 v13, v15
    ds_write_b128 v4, v[12:15] offset:9920
    v_accvgpr_read_b32 v16, a80
    v_accvgpr_read_b32 v17, a81
    v_accvgpr_read_b32 v18, a88
    v_accvgpr_read_b32 v19, a89
    v_max_f32 v20, 0, v16
    v_max_f32 v21, 0, v17
    v_mul_f32 v20, v20, v18
    v_mul_f32 v21, v21, v19
    v_cvt_pk_bf16_f32 v8, v20, v21
    v_accvgpr_read_b32 v16, a82
    v_accvgpr_read_b32 v17, a83
    v_accvgpr_read_b32 v18, a90
    v_accvgpr_read_b32 v19, a91
    v_max_f32 v20, 0, v16
    v_max_f32 v21, 0, v17
    v_mul_f32 v20, v20, v18
    v_mul_f32 v21, v21, v19
    v_cvt_pk_bf16_f32 v9, v20, v21
    v_accvgpr_read_b32 v16, a84
    v_accvgpr_read_b32 v17, a85
    v_accvgpr_read_b32 v18, a92
    v_accvgpr_read_b32 v19, a93
    v_max_f32 v20, 0, v16
    v_max_f32 v21, 0, v17
    v_mul_f32 v20, v20, v18
    v_mul_f32 v21, v21, v19
    v_cvt_pk_bf16_f32 v10, v20, v21
    v_accvgpr_read_b32 v16, a86
    v_accvgpr_read_b32 v17, a87
    v_accvgpr_read_b32 v18, a94
    v_accvgpr_read_b32 v19, a95
    v_max_f32 v20, 0, v16
    v_max_f32 v21, 0, v17
    v_mul_f32 v20, v20, v18
    v_mul_f32 v21, v21, v19
    v_cvt_pk_bf16_f32 v11, v20, v21
    v_permlane32_swap_b32 v8, v10
    s_nop 0
    v_permlane32_swap_b32 v9, v11
    ds_write_b128 v4, v[8:11] offset:9952
    v_accvgpr_read_b32 v16, a112
    v_accvgpr_read_b32 v17, a113
    v_accvgpr_read_b32 v18, a120
    v_accvgpr_read_b32 v19, a121
    v_max_f32 v20, 0, v16
    v_max_f32 v21, 0, v17
    v_mul_f32 v20, v20, v18
    v_mul_f32 v21, v21, v19
    v_cvt_pk_bf16_f32 v12, v20, v21
    v_accvgpr_read_b32 v16, a114
    v_accvgpr_read_b32 v17, a115
    v_accvgpr_read_b32 v18, a122
    v_accvgpr_read_b32 v19, a123
    v_max_f32 v20, 0, v16
    v_max_f32 v21, 0, v17
    v_mul_f32 v20, v20, v18
    v_mul_f32 v21, v21, v19
    v_cvt_pk_bf16_f32 v13, v20, v21
    v_accvgpr_read_b32 v16, a116
    v_accvgpr_read_b32 v17, a117
    v_accvgpr_read_b32 v18, a124
    v_accvgpr_read_b32 v19, a125
    v_max_f32 v20, 0, v16
    v_max_f32 v21, 0, v17
    v_mul_f32 v20, v20, v18
    v_mul_f32 v21, v21, v19
    v_cvt_pk_bf16_f32 v14, v20, v21
    v_accvgpr_read_b32 v16, a118
    v_accvgpr_read_b32 v17, a119
    v_accvgpr_read_b32 v18, a126
    v_accvgpr_read_b32 v19, a127
    v_max_f32 v20, 0, v16
    v_max_f32 v21, 0, v17
    v_mul_f32 v20, v20, v18
    v_mul_f32 v21, v21, v19
    v_cvt_pk_bf16_f32 v15, v20, v21
    v_permlane32_swap_b32 v12, v14
    s_nop 0
    v_permlane32_swap_b32 v13, v15
    ds_write_b128 v4, v[12:15] offset:9984
    s_waitcnt lgkmcnt(0)
    ds_read_b128 v[52:55], v32 offset:9728
    ds_read_b128 v[56:59], v33 offset:9728
    ds_read_b128 v[60:63], v34 offset:9728
    ds_read_b128 v[64:67], v35 offset:9728
    ds_read_b128 v[68:71], v36 offset:9728
    ds_read_b128 v[72:75], v37 offset:9728
    ds_read_b128 v[76:79], v38 offset:9728
    ds_read_b128 v[80:83], v39 offset:9728
    ds_read_b128 v[84:87], v40 offset:9728
    s_waitcnt lgkmcnt(8)
    buffer_store_dwordx4 v[52:55], v41, s[20:23], s45 offen
    s_waitcnt lgkmcnt(7)
    buffer_store_dwordx4 v[56:59], v42, s[20:23], s45 offen
    s_waitcnt lgkmcnt(6)
    buffer_store_dwordx4 v[60:63], v43, s[20:23], s45 offen
    s_waitcnt lgkmcnt(5)
    buffer_store_dwordx4 v[64:67], v44, s[20:23], s45 offen
    s_waitcnt lgkmcnt(4)
    buffer_store_dwordx4 v[68:71], v45, s[20:23], s45 offen
    s_waitcnt lgkmcnt(3)
    buffer_store_dwordx4 v[72:75], v46, s[20:23], s45 offen
    s_waitcnt lgkmcnt(2)
    buffer_store_dwordx4 v[76:79], v47, s[20:23], s45 offen
    s_waitcnt lgkmcnt(1)
    buffer_store_dwordx4 v[80:83], v48, s[20:23], s45 offen
    s_waitcnt lgkmcnt(0)
    buffer_store_dwordx4 v[84:87], v49, s[20:23], s45 offen
glu_kernel_end:
    s_endpgm
.globl down_kernel
.p2align 8
.type down_kernel,@function
down_kernel:

    s_cmp_ge_u32 s2, 256
    s_cbranch_scc1 down_kernel_end
    s_and_b32 s38, s2, 7
    s_lshr_b32 s40, s2, 3
    s_cmp_lt_u32 s38, 4
    s_cbranch_scc1 down_kernel_ta
    s_sub_u32 s38, s38, 4
    s_cmp_lt_u32 s40, 26
    s_cbranch_scc1 down_kernel_tb
    s_cmp_lg_u32 s40, 26
    s_cbranch_scc1 down_kernel_end
    s_cmp_ge_u32 s38, 2
    s_cbranch_scc1 down_kernel_end
    s_add_u32 s40, s38, 128
    s_branch down_kernel_tc
down_kernel_tb:
    s_mul_i32 s38, s38, 26
    s_add_u32 s40, s40, s38
    s_add_u32 s40, s40, 130
    s_branch down_kernel_tc
down_kernel_ta:
    s_lshl_b32 s38, s38, 5
    s_add_u32 s40, s40, s38
down_kernel_tc:
    s_load_dwordx2 s[6:7], s[0:1], 64
    s_load_dwordx2 s[10:11], s[0:1], 104
    s_load_dwordx2 s[4:5], s[0:1], 88
    v_lshrrev_b32 v236, 6, v0
    v_and_b32 v237, 63, v0
    v_readfirstlane_b32 s36, v236
    s_mul_i32 s38, s40, 13108
    s_lshr_b32 s38, s38, 16
    s_mul_i32 s37, s38, 5
    s_sub_u32 s37, s40, s37
    s_sub_u32 s41, s40, 130
    s_lshr_b32 s42, s41, 2
    s_and_b32 s41, s41, 3
    s_add_u32 s41, s41, 5
    s_cmp_ge_u32 s40, 130
    s_cselect_b32 s38, s42, s38
    s_cselect_b32 s37, s41, s37
    v_lshrrev_b32 v238, 4, v237
    v_and_b32 v239, 15, v237
    s_mul_i32 s41, s36, 20
    s_movk_i32 s40, 9216
    v_add_u32 v240, 0, v238
    v_add_u32 v240, s41, v240
    v_and_b32 v241, 15, v240
    v_xor_b32 v241, v241, v239
    v_mul_lo_u32 v240, v240, s40
    v_lshl_add_u32 v240, v241, 4, v240
    v_add_u32 v1, 4096, v240
    v_add_u32 v240, 4, v238
    v_add_u32 v240, s41, v240
    v_and_b32 v241, 15, v240
    v_xor_b32 v241, v241, v239
    v_mul_lo_u32 v240, v240, s40
    v_lshl_add_u32 v240, v241, 4, v240
    v_add_u32 v2, 3072, v240
    v_add_u32 v240, 8, v238
    v_add_u32 v240, s41, v240
    v_and_b32 v241, 15, v240
    v_xor_b32 v241, v241, v239
    v_mul_lo_u32 v240, v240, s40
    v_lshl_add_u32 v240, v241, 4, v240
    v_add_u32 v3, 2048, v240
    v_add_u32 v240, 12, v238
    v_add_u32 v240, s41, v240
    v_and_b32 v241, 15, v240
    v_xor_b32 v241, v241, v239
    v_mul_lo_u32 v240, v240, s40
    v_lshl_add_u32 v240, v241, 4, v240
    v_add_u32 v4, 1024, v240
    v_add_u32 v240, 16, v238
    v_add_u32 v240, s41, v240
    v_and_b32 v241, 15, v240
    v_xor_b32 v241, v241, v239
    v_mul_lo_u32 v240, v240, s40
    v_lshl_add_u32 v240, v241, 4, v240
    v_add_u32 v5, 4096, v240
    v_lshrrev_b32 v240, 3, v237
    s_lshl_b32 s41, s36, 5
    v_add_u32 v240, s41, v240
    v_mul_u32_u24 v240, 1152, v240
    s_lshl_b32 s41, s37, 7
    v_add_u32 v240, s41, v240
    v_and_b32 v241, 7, v237
    v_and_b32 v242, 1, v238
    v_lshlrev_b32 v242, 1, v242
    v_xor_b32 v241, v241, v242
    v_lshl_add_u32 v6, v241, 4, v240
    v_xor_b32 v241, 4, v241
    v_lshl_add_u32 v7, v241, 4, v240
    s_mov_b32 s24, 0
    s_mov_b32 s25, 8192
    s_mov_b32 s26, 16384
    s_mov_b32 s27, 24576
    s_waitcnt lgkmcnt(0)
    s_mul_i32 s40, s38, 737280
    s_add_u32 s41, s40, 0x3aff000
    s_add_u32 s12, s10, s41
    s_addc_u32 s13, s11, 0
    s_sub_u32 s14, 18874368, s40
    s_min_u32 s14, s14, 737280
    s_add_u32 s14, s14, 4096
    s_mov_b32 s15, 0x00020000
    s_mov_b32 s16, s6
    s_mov_b32 s17, s7
    s_mov_b32 s18, 0x510000
    s_mov_b32 s19, 0x00020000
    s_mul_i32 s44, s36, 5120
    s_lshl_b32 s45, s36, 12
    s_add_u32 s45, s45, 20480
    s_add_u32 m0, s44, 0
    s_nop 0
    buffer_load_dwordx4 v1, s[12:15], 0 offen offset:0 lds
    buffer_load_dwordx4 v2, s[12:15], 0 offen offset:1024 lds
    buffer_load_dwordx4 v3, s[12:15], 0 offen offset:2048 lds
    buffer_load_dwordx4 v4, s[12:15], 0 offen offset:3072 lds
    s_add_u32 m0, s44, 4096
    s_nop 0
    buffer_load_dwordx4 v5, s[12:15], 0 offen offset:0 lds
    s_add_u32 m0, s45, 0
    s_nop 0
    buffer_load_dwordx4 v6, s[16:19], s24 offen offset:0 lds
    buffer_load_dwordx4 v7, s[16:19], s25 offen offset:1024 lds
    buffer_load_dwordx4 v6, s[16:19], s26 offen offset:2048 lds
    buffer_load_dwordx4 v7, s[16:19], s27 offen offset:3072 lds
    s_add_u32 s12, s12, 256
    s_addc_u32 s13, s13, 0
    s_sub_u32 s14, s14, 256
    s_add_u32 s16, s16, 147456
    s_addc_u32 s17, s17, 0
    s_sub_u32 s18, s18, 147456
    s_add_u32 m0, s44, 36864
    s_nop 0
    buffer_load_dwordx4 v1, s[12:15], 0 offen offset:0 lds
    buffer_load_dwordx4 v2, s[12:15], 0 offen offset:1024 lds
    buffer_load_dwordx4 v3, s[12:15], 0 offen offset:2048 lds
    buffer_load_dwordx4 v4, s[12:15], 0 offen offset:3072 lds
    s_add_u32 m0, s44, 40960
    s_nop 0
    buffer_load_dwordx4 v5, s[12:15], 0 offen offset:0 lds
    s_add_u32 m0, s45, 36864
    s_nop 0
    buffer_load_dwordx4 v6, s[16:19], s24 offen offset:0 lds
    buffer_load_dwordx4 v7, s[16:19], s25 offen offset:1024 lds
    buffer_load_dwordx4 v6, s[16:19], s26 offen offset:2048 lds
    buffer_load_dwordx4 v7, s[16:19], s27 offen offset:3072 lds
    s_add_u32 s12, s12, 256
    s_addc_u32 s13, s13, 0
    s_sub_u32 s14, s14, 256
    s_add_u32 s16, s16, 147456
    s_addc_u32 s17, s17, 0
    s_sub_u32 s18, s18, 147456
    s_lshl_b32 s40, s36, 2
    v_add_u32 v240, s40, v238
    v_xor_b32 v240, v240, v239
    v_lshlrev_b32 v240, 4, v240
    v_lshl_add_u32 v240, v239, 8, v240
    v_lshrrev_b32 v241, 2, v239
    v_lshl_add_u32 v242, v238, 3, v241
    s_lshl_b32 s40, s36, 5
    v_add_u32 v242, s40, v242
    v_lshlrev_b32 v242, 7, v242
    v_and_b32 v243, 3, v237
    v_lshl_add_u32 v242, v243, 3, v242
    v_and_b32 v241, 2, v241
    v_and_b32 v243, 1, v238
    v_lshl_add_u32 v241, v243, 2, v241
    v_add_u32 v8, 0, v240
    v_add_u32 v9, 36864, v240
    v_add_u32 v10, 73728, v240
    v_add_u32 v11, 110592, v240
    v_xor_b32 v243, 0, v241
    v_lshl_add_u32 v243, v243, 4, v242
    v_add_u32 v12, 20480, v243
    v_add_u32 v16, 57344, v243
    v_add_u32 v20, 94208, v243
    v_add_u32 v24, 131072, v243
    v_xor_b32 v243, 2, v241
    v_lshl_add_u32 v243, v243, 4, v242
    v_add_u32 v13, 20480, v243
    v_add_u32 v17, 57344, v243
    v_add_u32 v21, 94208, v243
    v_add_u32 v25, 131072, v243
    v_xor_b32 v243, 4, v241
    v_lshl_add_u32 v243, v243, 4, v242
    v_add_u32 v14, 20480, v243
    v_add_u32 v18, 57344, v243
    v_add_u32 v22, 94208, v243
    v_add_u32 v26, 131072, v243
    v_xor_b32 v243, 6, v241
    v_lshl_add_u32 v243, v243, 4, v242
    v_add_u32 v15, 20480, v243
    v_add_u32 v19, 57344, v243
    v_add_u32 v23, 94208, v243
    v_add_u32 v27, 131072, v243
    s_mul_i32 s40, s38, 80
    v_add_u32 v240, s40, v239
    v_mul_u32_u24 v28, 1152, v240
    v_lshl_add_u32 v28, v238, 3, v28
    s_lshl_b32 s40, s37, 7
    s_lshl_b32 s41, s36, 5
    s_add_u32 s40, s40, s41
    v_add_u32 v28, s40, v28
    s_lshl_b32 s40, s40, 1
    s_add_u32 s40, s40, 11520
    v_lshlrev_b32 v29, 4, v238
    v_add_u32 v29, s40, v29
    s_mov_b32 s56, s10
    s_mov_b32 s57, s11
    s_mov_b32 s58, 0x3600
    s_mov_b32 s59, 0x00020000
    s_add_u32 s20, s10, 0x3500000
    s_addc_u32 s21, s11, 0
    s_mov_b32 s22, 0x240000
    s_mov_b32 s23, 0x00020000
    s_mov_b32 s28, s4
    s_mov_b32 s29, s5
    s_mov_b32 s30, 0x240000
    s_mov_b32 s31, 0x00020000
    s_mov_b32 s32, 0
    s_mov_b32 s33, 18432
    s_mov_b32 s34, 36864
    s_mov_b32 s35, 55296
    s_mov_b32 s49, 73728
    buffer_load_dwordx2 v[200:201], v28, s[20:23], s32 offen
    buffer_load_dwordx2 v[202:203], v28, s[20:23], s33 offen
    buffer_load_dwordx2 v[204:205], v28, s[20:23], s34 offen
    buffer_load_dwordx2 v[206:207], v28, s[20:23], s35 offen
    buffer_load_dwordx2 v[208:209], v28, s[20:23], s49 offen
    buffer_load_dwordx4 v[212:215], v29, s[56:59], 0 offen
    s_waitcnt vmcnt(15)
    s_barrier
    ds_read_b128 v[112:115], v8 offset:0
    ds_read_b64_tr_b16 v[132:133], v12 offset:0
    ds_read_b64_tr_b16 v[134:135], v12 offset:512
    ds_read_b128 v[116:119], v8 offset:4096
    ds_read_b128 v[120:123], v8 offset:8192
    ds_read_b128 v[124:127], v8 offset:12288
    ds_read_b128 v[128:131], v8 offset:16384
    ds_read_b64_tr_b16 v[136:137], v13 offset:0
    ds_read_b64_tr_b16 v[138:139], v13 offset:512
    ds_read_b64_tr_b16 v[140:141], v14 offset:0
    ds_read_b64_tr_b16 v[142:143], v14 offset:512
    ds_read_b64_tr_b16 v[144:145], v15 offset:0
    ds_read_b64_tr_b16 v[146:147], v15 offset:512
    s_waitcnt lgkmcnt(0)
    v_mfma_f32_16x16x32_bf16 v[32:35], v[132:135], v[112:115], 0
    v_mfma_f32_16x16x32_bf16 v[36:39], v[132:135], v[116:119], 0
    s_waitcnt vmcnt(6)
    s_barrier
    v_mfma_f32_16x16x32_bf16 v[40:43], v[132:135], v[120:123], 0
    ds_read_b128 v[148:151], v9 offset:0
    s_add_u32 m0, s44, 73728
    s_nop 0
    buffer_load_dwordx4 v1, s[12:15], 0 offen offset:0 lds
    v_mfma_f32_16x16x32_bf16 v[44:47], v[132:135], v[124:127], 0
    buffer_load_dwordx4 v2, s[12:15], 0 offen offset:1024 lds
    ds_read_b64_tr_b16 v[168:169], v16 offset:0
    buffer_load_dwordx4 v3, s[12:15], 0 offen offset:2048 lds
    v_mfma_f32_16x16x32_bf16 v[48:51], v[132:135], v[128:131], 0
    buffer_load_dwordx4 v4, s[12:15], 0 offen offset:3072 lds
    s_add_u32 m0, s44, 77824
    ds_read_b64_tr_b16 v[170:171], v16 offset:512
    v_mfma_f32_16x16x32_bf16 v[52:55], v[136:139], v[112:115], 0
    buffer_load_dwordx4 v5, s[12:15], 0 offen offset:0 lds
    s_add_u32 m0, s45, 73728
    v_mfma_f32_16x16x32_bf16 v[56:59], v[136:139], v[116:119], 0
    buffer_load_dwordx4 v6, s[16:19], s24 offen offset:0 lds
    ds_read_b128 v[152:155], v9 offset:4096
    buffer_load_dwordx4 v7, s[16:19], s25 offen offset:1024 lds
    v_mfma_f32_16x16x32_bf16 v[60:63], v[136:139], v[120:123], 0
    buffer_load_dwordx4 v6, s[16:19], s26 offen offset:2048 lds
    buffer_load_dwordx4 v7, s[16:19], s27 offen offset:3072 lds
    ds_read_b128 v[156:159], v9 offset:8192
    v_mfma_f32_16x16x32_bf16 v[64:67], v[136:139], v[124:127], 0
    s_add_u32 s12, s12, 256
    s_addc_u32 s13, s13, 0
    ds_read_b128 v[160:163], v9 offset:12288
    v_mfma_f32_16x16x32_bf16 v[68:71], v[136:139], v[128:131], 0
    s_sub_u32 s14, s14, 256
    s_add_u32 s16, s16, 147456
    v_mfma_f32_16x16x32_bf16 v[72:75], v[140:143], v[112:115], 0
    s_addc_u32 s17, s17, 0
    ds_read_b128 v[164:167], v9 offset:16384
    s_sub_u32 s18, s18, 147456
    v_mfma_f32_16x16x32_bf16 v[76:79], v[140:143], v[116:119], 0
    s_add_u32 m0, s44, 110592
    s_nop 0
    buffer_load_dwordx4 v1, s[12:15], 0 offen offset:0 lds
    ds_read_b64_tr_b16 v[172:173], v17 offset:0
    v_mfma_f32_16x16x32_bf16 v[80:83], v[140:143], v[120:123], 0
    buffer_load_dwordx4 v2, s[12:15], 0 offen offset:1024 lds
    buffer_load_dwordx4 v3, s[12:15], 0 offen offset:2048 lds
    v_mfma_f32_16x16x32_bf16 v[84:87], v[140:143], v[124:127], 0
    buffer_load_dwordx4 v4, s[12:15], 0 offen offset:3072 lds
    ds_read_b64_tr_b16 v[174:175], v17 offset:512
    s_add_u32 m0, s44, 114688
    v_mfma_f32_16x16x32_bf16 v[88:91], v[140:143], v[128:131], 0
    buffer_load_dwordx4 v5, s[12:15], 0 offen offset:0 lds
    ds_read_b64_tr_b16 v[176:177], v18 offset:0
    s_add_u32 m0, s45, 110592
    v_mfma_f32_16x16x32_bf16 v[92:95], v[144:147], v[112:115], 0
    buffer_load_dwordx4 v6, s[16:19], s24 offen offset:0 lds
    buffer_load_dwordx4 v7, s[16:19], s25 offen offset:1024 lds
    ds_read_b64_tr_b16 v[178:179], v18 offset:512
    v_mfma_f32_16x16x32_bf16 v[96:99], v[144:147], v[116:119], 0
    buffer_load_dwordx4 v6, s[16:19], s26 offen offset:2048 lds
    buffer_load_dwordx4 v7, s[16:19], s27 offen offset:3072 lds
    v_mfma_f32_16x16x32_bf16 v[100:103], v[144:147], v[120:123], 0
    s_add_u32 s12, s12, 256
    ds_read_b64_tr_b16 v[180:181], v19 offset:0
    s_addc_u32 s13, s13, 0
    v_mfma_f32_16x16x32_bf16 v[104:107], v[144:147], v[124:127], 0
    s_sub_u32 s14, s14, 256
    s_add_u32 s16, s16, 147456
    ds_read_b64_tr_b16 v[182:183], v19 offset:512
    v_mfma_f32_16x16x32_bf16 v[108:111], v[144:147], v[128:131], 0
    s_addc_u32 s17, s17, 0
    s_sub_u32 s18, s18, 147456
    s_waitcnt lgkmcnt(0)
    v_mfma_f32_16x16x32_bf16 v[32:35], v[168:171], v[148:151], v[32:35]
    v_mfma_f32_16x16x32_bf16 v[36:39], v[168:171], v[152:155], v[36:39]
    s_waitcnt vmcnt(9)
    s_barrier
    v_mfma_f32_16x16x32_bf16 v[40:43], v[168:171], v[156:159], v[40:43]
    ds_read_b128 v[112:115], v10 offset:0
    s_add_u32 m0, s44, 0
    s_nop 0
    buffer_load_dwordx4 v1, s[12:15], 0 offen offset:0 lds
    v_mfma_f32_16x16x32_bf16 v[44:47], v[168:171], v[160:163], v[44:47]
    buffer_load_dwordx4 v2, s[12:15], 0 offen offset:1024 lds
    ds_read_b64_tr_b16 v[132:133], v20 offset:0
    buffer_load_dwordx4 v3, s[12:15], 0 offen offset:2048 lds
    v_mfma_f32_16x16x32_bf16 v[48:51], v[168:171], v[164:167], v[48:51]
    buffer_load_dwordx4 v4, s[12:15], 0 offen offset:3072 lds
    s_add_u32 m0, s44, 4096
    ds_read_b64_tr_b16 v[134:135], v20 offset:512
    v_mfma_f32_16x16x32_bf16 v[52:55], v[172:175], v[148:151], v[52:55]
    buffer_load_dwordx4 v5, s[12:15], 0 offen offset:0 lds
    s_add_u32 m0, s45, 0
    v_mfma_f32_16x16x32_bf16 v[56:59], v[172:175], v[152:155], v[56:59]
    buffer_load_dwordx4 v6, s[16:19], s24 offen offset:0 lds
    ds_read_b128 v[116:119], v10 offset:4096
    buffer_load_dwordx4 v7, s[16:19], s25 offen offset:1024 lds
    v_mfma_f32_16x16x32_bf16 v[60:63], v[172:175], v[156:159], v[60:63]
    buffer_load_dwordx4 v6, s[16:19], s26 offen offset:2048 lds
    buffer_load_dwordx4 v7, s[16:19], s27 offen offset:3072 lds
    ds_read_b128 v[120:123], v10 offset:8192
    v_mfma_f32_16x16x32_bf16 v[64:67], v[172:175], v[160:163], v[64:67]
    s_add_u32 s12, s12, 256
    s_addc_u32 s13, s13, 0
    ds_read_b128 v[124:127], v10 offset:12288
    v_mfma_f32_16x16x32_bf16 v[68:71], v[172:175], v[164:167], v[68:71]
    s_sub_u32 s14, s14, 256
    s_add_u32 s16, s16, 147456
    v_mfma_f32_16x16x32_bf16 v[72:75], v[176:179], v[148:151], v[72:75]
    s_addc_u32 s17, s17, 0
    ds_read_b128 v[128:131], v10 offset:16384
    s_sub_u32 s18, s18, 147456
    v_mfma_f32_16x16x32_bf16 v[76:79], v[176:179], v[152:155], v[76:79]
    s_add_u32 m0, s44, 36864
    s_nop 0
    buffer_load_dwordx4 v1, s[12:15], 0 offen offset:0 lds
    ds_read_b64_tr_b16 v[136:137], v21 offset:0
    v_mfma_f32_16x16x32_bf16 v[80:83], v[176:179], v[156:159], v[80:83]
    buffer_load_dwordx4 v2, s[12:15], 0 offen offset:1024 lds
    buffer_load_dwordx4 v3, s[12:15], 0 offen offset:2048 lds
    v_mfma_f32_16x16x32_bf16 v[84:87], v[176:179], v[160:163], v[84:87]
    buffer_load_dwordx4 v4, s[12:15], 0 offen offset:3072 lds
    ds_read_b64_tr_b16 v[138:139], v21 offset:512
    s_add_u32 m0, s44, 40960
    v_mfma_f32_16x16x32_bf16 v[88:91], v[176:179], v[164:167], v[88:91]
    buffer_load_dwordx4 v5, s[12:15], 0 offen offset:0 lds
    ds_read_b64_tr_b16 v[140:141], v22 offset:0
    s_add_u32 m0, s45, 36864
    v_mfma_f32_16x16x32_bf16 v[92:95], v[180:183], v[148:151], v[92:95]
    buffer_load_dwordx4 v6, s[16:19], s24 offen offset:0 lds
    buffer_load_dwordx4 v7, s[16:19], s25 offen offset:1024 lds
    ds_read_b64_tr_b16 v[142:143], v22 offset:512
    v_mfma_f32_16x16x32_bf16 v[96:99], v[180:183], v[152:155], v[96:99]
    buffer_load_dwordx4 v6, s[16:19], s26 offen offset:2048 lds
    buffer_load_dwordx4 v7, s[16:19], s27 offen offset:3072 lds
    v_mfma_f32_16x16x32_bf16 v[100:103], v[180:183], v[156:159], v[100:103]
    s_add_u32 s12, s12, 256
    ds_read_b64_tr_b16 v[144:145], v23 offset:0
    s_addc_u32 s13, s13, 0
    v_mfma_f32_16x16x32_bf16 v[104:107], v[180:183], v[160:163], v[104:107]
    s_sub_u32 s14, s14, 256
    s_add_u32 s16, s16, 147456
    ds_read_b64_tr_b16 v[146:147], v23 offset:512
    v_mfma_f32_16x16x32_bf16 v[108:111], v[180:183], v[164:167], v[108:111]
    s_addc_u32 s17, s17, 0
    s_sub_u32 s18, s18, 147456
    s_waitcnt lgkmcnt(0)
    v_mfma_f32_16x16x32_bf16 v[32:35], v[132:135], v[112:115], v[32:35]
    v_mfma_f32_16x16x32_bf16 v[36:39], v[132:135], v[116:119], v[36:39]
    s_waitcnt vmcnt(18)
    s_barrier
    v_mfma_f32_16x16x32_bf16 v[40:43], v[132:135], v[120:123], v[40:43]
    ds_read_b128 v[148:151], v11 offset:0
    s_add_u32 m0, s44, 73728
    v_mfma_f32_16x16x32_bf16 v[44:47], v[132:135], v[124:127], v[44:47]
    buffer_load_dwordx4 v1, s[12:15], 0 offen offset:0 lds
    ds_read_b64_tr_b16 v[168:169], v24 offset:0
    v_mfma_f32_16x16x32_bf16 v[48:51], v[132:135], v[128:131], v[48:51]
    buffer_load_dwordx4 v2, s[12:15], 0 offen offset:1024 lds
    ds_read_b64_tr_b16 v[170:171], v24 offset:512
    v_mfma_f32_16x16x32_bf16 v[52:55], v[136:139], v[112:115], v[52:55]
    buffer_load_dwordx4 v3, s[12:15], 0 offen offset:2048 lds
    v_mfma_f32_16x16x32_bf16 v[56:59], v[136:139], v[116:119], v[56:59]
    buffer_load_dwordx4 v4, s[12:15], 0 offen offset:3072 lds
    ds_read_b128 v[152:155], v11 offset:4096
    v_mfma_f32_16x16x32_bf16 v[60:63], v[136:139], v[120:123], v[60:63]
    s_add_u32 m0, s44, 77824
    ds_read_b128 v[156:159], v11 offset:8192
    v_mfma_f32_16x16x32_bf16 v[64:67], v[136:139], v[124:127], v[64:67]
    buffer_load_dwordx4 v5, s[12:15], 0 offen offset:0 lds
    ds_read_b128 v[160:163], v11 offset:12288
    v_mfma_f32_16x16x32_bf16 v[68:71], v[136:139], v[128:131], v[68:71]
    s_add_u32 m0, s45, 73728
    v_mfma_f32_16x16x32_bf16 v[72:75], v[140:143], v[112:115], v[72:75]
    buffer_load_dwordx4 v6, s[16:19], s24 offen offset:0 lds
    ds_read_b128 v[164:167], v11 offset:16384
    v_mfma_f32_16x16x32_bf16 v[76:79], v[140:143], v[116:119], v[76:79]
    buffer_load_dwordx4 v7, s[16:19], s25 offen offset:1024 lds
    ds_read_b64_tr_b16 v[172:173], v25 offset:0
    v_mfma_f32_16x16x32_bf16 v[80:83], v[140:143], v[120:123], v[80:83]
    buffer_load_dwordx4 v6, s[16:19], s26 offen offset:2048 lds
    v_mfma_f32_16x16x32_bf16 v[84:87], v[140:143], v[124:127], v[84:87]
    buffer_load_dwordx4 v7, s[16:19], s27 offen offset:3072 lds
    ds_read_b64_tr_b16 v[174:175], v25 offset:512
    v_mfma_f32_16x16x32_bf16 v[88:91], v[140:143], v[128:131], v[88:91]
    s_add_u32 s12, s12, 256
    ds_read_b64_tr_b16 v[176:177], v26 offset:0
    v_mfma_f32_16x16x32_bf16 v[92:95], v[144:147], v[112:115], v[92:95]
    s_addc_u32 s13, s13, 0
    ds_read_b64_tr_b16 v[178:179], v26 offset:512
    v_mfma_f32_16x16x32_bf16 v[96:99], v[144:147], v[116:119], v[96:99]
    s_sub_u32 s14, s14, 256
    v_mfma_f32_16x16x32_bf16 v[100:103], v[144:147], v[120:123], v[100:103]
    s_add_u32 s16, s16, 147456
    ds_read_b64_tr_b16 v[180:181], v27 offset:0
    v_mfma_f32_16x16x32_bf16 v[104:107], v[144:147], v[124:127], v[104:107]
    s_addc_u32 s17, s17, 0
    ds_read_b64_tr_b16 v[182:183], v27 offset:512
    v_mfma_f32_16x16x32_bf16 v[108:111], v[144:147], v[128:131], v[108:111]
    s_sub_u32 s18, s18, 147456
    s_waitcnt lgkmcnt(0)
    v_mfma_f32_16x16x32_bf16 v[32:35], v[168:171], v[148:151], v[32:35]
    v_mfma_f32_16x16x32_bf16 v[36:39], v[168:171], v[152:155], v[36:39]
    s_waitcnt vmcnt(18)
    s_barrier
    v_mfma_f32_16x16x32_bf16 v[40:43], v[168:171], v[156:159], v[40:43]
    ds_read_b128 v[112:115], v8 offset:0
    s_add_u32 m0, s44, 110592
    v_mfma_f32_16x16x32_bf16 v[44:47], v[168:171], v[160:163], v[44:47]
    buffer_load_dwordx4 v1, s[12:15], 0 offen offset:0 lds
    ds_read_b64_tr_b16 v[132:133], v12 offset:0
    v_mfma_f32_16x16x32_bf16 v[48:51], v[168:171], v[164:167], v[48:51]
    buffer_load_dwordx4 v2, s[12:15], 0 offen offset:1024 lds
    ds_read_b64_tr_b16 v[134:135], v12 offset:512
    v_mfma_f32_16x16x32_bf16 v[52:55], v[172:175], v[148:151], v[52:55]
    buffer_load_dwordx4 v3, s[12:15], 0 offen offset:2048 lds
    v_mfma_f32_16x16x32_bf16 v[56:59], v[172:175], v[152:155], v[56:59]
    buffer_load_dwordx4 v4, s[12:15], 0 offen offset:3072 lds
    ds_read_b128 v[116:119], v8 offset:4096
    v_mfma_f32_16x16x32_bf16 v[60:63], v[172:175], v[156:159], v[60:63]
    s_add_u32 m0, s44, 114688
    ds_read_b128 v[120:123], v8 offset:8192
    v_mfma_f32_16x16x32_bf16 v[64:67], v[172:175], v[160:163], v[64:67]
    buffer_load_dwordx4 v5, s[12:15], 0 offen offset:0 lds
    ds_read_b128 v[124:127], v8 offset:12288
    v_mfma_f32_16x16x32_bf16 v[68:71], v[172:175], v[164:167], v[68:71]
    s_add_u32 m0, s45, 110592
    v_mfma_f32_16x16x32_bf16 v[72:75], v[176:179], v[148:151], v[72:75]
    buffer_load_dwordx4 v6, s[16:19], s24 offen offset:0 lds
    ds_read_b128 v[128:131], v8 offset:16384
    v_mfma_f32_16x16x32_bf16 v[76:79], v[176:179], v[152:155], v[76:79]
    buffer_load_dwordx4 v7, s[16:19], s25 offen offset:1024 lds
    ds_read_b64_tr_b16 v[136:137], v13 offset:0
    v_mfma_f32_16x16x32_bf16 v[80:83], v[176:179], v[156:159], v[80:83]
    buffer_load_dwordx4 v6, s[16:19], s26 offen offset:2048 lds
    v_mfma_f32_16x16x32_bf16 v[84:87], v[176:179], v[160:163], v[84:87]
    buffer_load_dwordx4 v7, s[16:19], s27 offen offset:3072 lds
    ds_read_b64_tr_b16 v[138:139], v13 offset:512
    v_mfma_f32_16x16x32_bf16 v[88:91], v[176:179], v[164:167], v[88:91]
    s_add_u32 s12, s12, 256
    ds_read_b64_tr_b16 v[140:141], v14 offset:0
    v_mfma_f32_16x16x32_bf16 v[92:95], v[180:183], v[148:151], v[92:95]
    s_addc_u32 s13, s13, 0
    ds_read_b64_tr_b16 v[142:143], v14 offset:512
    v_mfma_f32_16x16x32_bf16 v[96:99], v[180:183], v[152:155], v[96:99]
    s_sub_u32 s14, s14, 256
    v_mfma_f32_16x16x32_bf16 v[100:103], v[180:183], v[156:159], v[100:103]
    s_add_u32 s16, s16, 147456
    ds_read_b64_tr_b16 v[144:145], v15 offset:0
    v_mfma_f32_16x16x32_bf16 v[104:107], v[180:183], v[160:163], v[104:107]
    s_addc_u32 s17, s17, 0
    ds_read_b64_tr_b16 v[146:147], v15 offset:512
    v_mfma_f32_16x16x32_bf16 v[108:111], v[180:183], v[164:167], v[108:111]
    s_sub_u32 s18, s18, 147456
    s_mov_b32 s48, 0
down_kernel_loop:
    s_waitcnt lgkmcnt(0)
    v_mfma_f32_16x16x32_bf16 v[32:35], v[132:135], v[112:115], v[32:35]
    v_mfma_f32_16x16x32_bf16 v[36:39], v[132:135], v[116:119], v[36:39]
    s_waitcnt vmcnt(18)
    s_barrier
    v_mfma_f32_16x16x32_bf16 v[40:43], v[132:135], v[120:123], v[40:43]
    ds_read_b128 v[148:151], v9 offset:0
    s_add_u32 m0, s44, 0
    v_mfma_f32_16x16x32_bf16 v[44:47], v[132:135], v[124:127], v[44:47]
    buffer_load_dwordx4 v1, s[12:15], 0 offen offset:0 lds
    ds_read_b64_tr_b16 v[168:169], v16 offset:0
    v_mfma_f32_16x16x32_bf16 v[48:51], v[132:135], v[128:131], v[48:51]
    buffer_load_dwordx4 v2, s[12:15], 0 offen offset:1024 lds
    ds_read_b64_tr_b16 v[170:171], v16 offset:512
    v_mfma_f32_16x16x32_bf16 v[52:55], v[136:139], v[112:115], v[52:55]
    buffer_load_dwordx4 v3, s[12:15], 0 offen offset:2048 lds
    v_mfma_f32_16x16x32_bf16 v[56:59], v[136:139], v[116:119], v[56:59]
    buffer_load_dwordx4 v4, s[12:15], 0 offen offset:3072 lds
    ds_read_b128 v[152:155], v9 offset:4096
    v_mfma_f32_16x16x32_bf16 v[60:63], v[136:139], v[120:123], v[60:63]
    s_add_u32 m0, s44, 4096
    ds_read_b128 v[156:159], v9 offset:8192
    v_mfma_f32_16x16x32_bf16 v[64:67], v[136:139], v[124:127], v[64:67]
    buffer_load_dwordx4 v5, s[12:15], 0 offen offset:0 lds
    ds_read_b128 v[160:163], v9 offset:12288
    v_mfma_f32_16x16x32_bf16 v[68:71], v[136:139], v[128:131], v[68:71]
    s_add_u32 m0, s45, 0
    v_mfma_f32_16x16x32_bf16 v[72:75], v[140:143], v[112:115], v[72:75]
    buffer_load_dwordx4 v6, s[16:19], s24 offen offset:0 lds
    ds_read_b128 v[164:167], v9 offset:16384
    v_mfma_f32_16x16x32_bf16 v[76:79], v[140:143], v[116:119], v[76:79]
    buffer_load_dwordx4 v7, s[16:19], s25 offen offset:1024 lds
    ds_read_b64_tr_b16 v[172:173], v17 offset:0
    v_mfma_f32_16x16x32_bf16 v[80:83], v[140:143], v[120:123], v[80:83]
    buffer_load_dwordx4 v6, s[16:19], s26 offen offset:2048 lds
    v_mfma_f32_16x16x32_bf16 v[84:87], v[140:143], v[124:127], v[84:87]
    buffer_load_dwordx4 v7, s[16:19], s27 offen offset:3072 lds
    ds_read_b64_tr_b16 v[174:175], v17 offset:512
    v_mfma_f32_16x16x32_bf16 v[88:91], v[140:143], v[128:131], v[88:91]
    s_add_u32 s12, s12, 256
    ds_read_b64_tr_b16 v[176:177], v18 offset:0
    v_mfma_f32_16x16x32_bf16 v[92:95], v[144:147], v[112:115], v[92:95]
    s_addc_u32 s13, s13, 0
    ds_read_b64_tr_b16 v[178:179], v18 offset:512
    v_mfma_f32_16x16x32_bf16 v[96:99], v[144:147], v[116:119], v[96:99]
    s_sub_u32 s14, s14, 256
    v_mfma_f32_16x16x32_bf16 v[100:103], v[144:147], v[120:123], v[100:103]
    s_add_u32 s16, s16, 147456
    ds_read_b64_tr_b16 v[180:181], v19 offset:0
    v_mfma_f32_16x16x32_bf16 v[104:107], v[144:147], v[124:127], v[104:107]
    s_addc_u32 s17, s17, 0
    ds_read_b64_tr_b16 v[182:183], v19 offset:512
    v_mfma_f32_16x16x32_bf16 v[108:111], v[144:147], v[128:131], v[108:111]
    s_sub_u32 s18, s18, 147456
    s_waitcnt lgkmcnt(0)
    v_mfma_f32_16x16x32_bf16 v[32:35], v[168:171], v[148:151], v[32:35]
    v_mfma_f32_16x16x32_bf16 v[36:39], v[168:171], v[152:155], v[36:39]
    s_waitcnt vmcnt(18)
    s_barrier
    v_mfma_f32_16x16x32_bf16 v[40:43], v[168:171], v[156:159], v[40:43]
    ds_read_b128 v[112:115], v10 offset:0
    s_add_u32 m0, s44, 36864
    v_mfma_f32_16x16x32_bf16 v[44:47], v[168:171], v[160:163], v[44:47]
    buffer_load_dwordx4 v1, s[12:15], 0 offen offset:0 lds
    ds_read_b64_tr_b16 v[132:133], v20 offset:0
    v_mfma_f32_16x16x32_bf16 v[48:51], v[168:171], v[164:167], v[48:51]
    buffer_load_dwordx4 v2, s[12:15], 0 offen offset:1024 lds
    ds_read_b64_tr_b16 v[134:135], v20 offset:512
    v_mfma_f32_16x16x32_bf16 v[52:55], v[172:175], v[148:151], v[52:55]
    buffer_load_dwordx4 v3, s[12:15], 0 offen offset:2048 lds
    v_mfma_f32_16x16x32_bf16 v[56:59], v[172:175], v[152:155], v[56:59]
    buffer_load_dwordx4 v4, s[12:15], 0 offen offset:3072 lds
    ds_read_b128 v[116:119], v10 offset:4096
    v_mfma_f32_16x16x32_bf16 v[60:63], v[172:175], v[156:159], v[60:63]
    s_add_u32 m0, s44, 40960
    ds_read_b128 v[120:123], v10 offset:8192
    v_mfma_f32_16x16x32_bf16 v[64:67], v[172:175], v[160:163], v[64:67]
    buffer_load_dwordx4 v5, s[12:15], 0 offen offset:0 lds
    ds_read_b128 v[124:127], v10 offset:12288
    v_mfma_f32_16x16x32_bf16 v[68:71], v[172:175], v[164:167], v[68:71]
    s_add_u32 m0, s45, 36864
    v_mfma_f32_16x16x32_bf16 v[72:75], v[176:179], v[148:151], v[72:75]
    buffer_load_dwordx4 v6, s[16:19], s24 offen offset:0 lds
    ds_read_b128 v[128:131], v10 offset:16384
    v_mfma_f32_16x16x32_bf16 v[76:79], v[176:179], v[152:155], v[76:79]
    buffer_load_dwordx4 v7, s[16:19], s25 offen offset:1024 lds
    ds_read_b64_tr_b16 v[136:137], v21 offset:0
    v_mfma_f32_16x16x32_bf16 v[80:83], v[176:179], v[156:159], v[80:83]
    buffer_load_dwordx4 v6, s[16:19], s26 offen offset:2048 lds
    v_mfma_f32_16x16x32_bf16 v[84:87], v[176:179], v[160:163], v[84:87]
    buffer_load_dwordx4 v7, s[16:19], s27 offen offset:3072 lds
    ds_read_b64_tr_b16 v[138:139], v21 offset:512
    v_mfma_f32_16x16x32_bf16 v[88:91], v[176:179], v[164:167], v[88:91]
    s_add_u32 s12, s12, 256
    ds_read_b64_tr_b16 v[140:141], v22 offset:0
    v_mfma_f32_16x16x32_bf16 v[92:95], v[180:183], v[148:151], v[92:95]
    s_addc_u32 s13, s13, 0
    ds_read_b64_tr_b16 v[142:143], v22 offset:512
    v_mfma_f32_16x16x32_bf16 v[96:99], v[180:183], v[152:155], v[96:99]
    s_sub_u32 s14, s14, 256
    v_mfma_f32_16x16x32_bf16 v[100:103], v[180:183], v[156:159], v[100:103]
    s_add_u32 s16, s16, 147456
    ds_read_b64_tr_b16 v[144:145], v23 offset:0
    v_mfma_f32_16x16x32_bf16 v[104:107], v[180:183], v[160:163], v[104:107]
    s_addc_u32 s17, s17, 0
    ds_read_b64_tr_b16 v[146:147], v23 offset:512
    v_mfma_f32_16x16x32_bf16 v[108:111], v[180:183], v[164:167], v[108:111]
    s_sub_u32 s18, s18, 147456
    s_waitcnt lgkmcnt(0)
    v_mfma_f32_16x16x32_bf16 v[32:35], v[132:135], v[112:115], v[32:35]
    v_mfma_f32_16x16x32_bf16 v[36:39], v[132:135], v[116:119], v[36:39]
    s_waitcnt vmcnt(18)
    s_barrier
    v_mfma_f32_16x16x32_bf16 v[40:43], v[132:135], v[120:123], v[40:43]
    ds_read_b128 v[148:151], v11 offset:0
    s_add_u32 m0, s44, 73728
    v_mfma_f32_16x16x32_bf16 v[44:47], v[132:135], v[124:127], v[44:47]
    buffer_load_dwordx4 v1, s[12:15], 0 offen offset:0 lds
    ds_read_b64_tr_b16 v[168:169], v24 offset:0
    v_mfma_f32_16x16x32_bf16 v[48:51], v[132:135], v[128:131], v[48:51]
    buffer_load_dwordx4 v2, s[12:15], 0 offen offset:1024 lds
    ds_read_b64_tr_b16 v[170:171], v24 offset:512
    v_mfma_f32_16x16x32_bf16 v[52:55], v[136:139], v[112:115], v[52:55]
    buffer_load_dwordx4 v3, s[12:15], 0 offen offset:2048 lds
    v_mfma_f32_16x16x32_bf16 v[56:59], v[136:139], v[116:119], v[56:59]
    buffer_load_dwordx4 v4, s[12:15], 0 offen offset:3072 lds
    ds_read_b128 v[152:155], v11 offset:4096
    v_mfma_f32_16x16x32_bf16 v[60:63], v[136:139], v[120:123], v[60:63]
    s_add_u32 m0, s44, 77824
    ds_read_b128 v[156:159], v11 offset:8192
    v_mfma_f32_16x16x32_bf16 v[64:67], v[136:139], v[124:127], v[64:67]
    buffer_load_dwordx4 v5, s[12:15], 0 offen offset:0 lds
    ds_read_b128 v[160:163], v11 offset:12288
    v_mfma_f32_16x16x32_bf16 v[68:71], v[136:139], v[128:131], v[68:71]
    s_add_u32 m0, s45, 73728
    v_mfma_f32_16x16x32_bf16 v[72:75], v[140:143], v[112:115], v[72:75]
    buffer_load_dwordx4 v6, s[16:19], s24 offen offset:0 lds
    ds_read_b128 v[164:167], v11 offset:16384
    v_mfma_f32_16x16x32_bf16 v[76:79], v[140:143], v[116:119], v[76:79]
    buffer_load_dwordx4 v7, s[16:19], s25 offen offset:1024 lds
    ds_read_b64_tr_b16 v[172:173], v25 offset:0
    v_mfma_f32_16x16x32_bf16 v[80:83], v[140:143], v[120:123], v[80:83]
    buffer_load_dwordx4 v6, s[16:19], s26 offen offset:2048 lds
    v_mfma_f32_16x16x32_bf16 v[84:87], v[140:143], v[124:127], v[84:87]
    buffer_load_dwordx4 v7, s[16:19], s27 offen offset:3072 lds
    ds_read_b64_tr_b16 v[174:175], v25 offset:512
    v_mfma_f32_16x16x32_bf16 v[88:91], v[140:143], v[128:131], v[88:91]
    s_add_u32 s12, s12, 256
    ds_read_b64_tr_b16 v[176:177], v26 offset:0
    v_mfma_f32_16x16x32_bf16 v[92:95], v[144:147], v[112:115], v[92:95]
    s_addc_u32 s13, s13, 0
    ds_read_b64_tr_b16 v[178:179], v26 offset:512
    v_mfma_f32_16x16x32_bf16 v[96:99], v[144:147], v[116:119], v[96:99]
    s_sub_u32 s14, s14, 256
    v_mfma_f32_16x16x32_bf16 v[100:103], v[144:147], v[120:123], v[100:103]
    s_add_u32 s16, s16, 147456
    ds_read_b64_tr_b16 v[180:181], v27 offset:0
    v_mfma_f32_16x16x32_bf16 v[104:107], v[144:147], v[124:127], v[104:107]
    s_addc_u32 s17, s17, 0
    ds_read_b64_tr_b16 v[182:183], v27 offset:512
    v_mfma_f32_16x16x32_bf16 v[108:111], v[144:147], v[128:131], v[108:111]
    s_sub_u32 s18, s18, 147456
    s_waitcnt lgkmcnt(0)
    v_mfma_f32_16x16x32_bf16 v[32:35], v[168:171], v[148:151], v[32:35]
    v_mfma_f32_16x16x32_bf16 v[36:39], v[168:171], v[152:155], v[36:39]
    s_waitcnt vmcnt(18)
    s_barrier
    v_mfma_f32_16x16x32_bf16 v[40:43], v[168:171], v[156:159], v[40:43]
    ds_read_b128 v[112:115], v8 offset:0
    s_add_u32 m0, s44, 110592
    v_mfma_f32_16x16x32_bf16 v[44:47], v[168:171], v[160:163], v[44:47]
    buffer_load_dwordx4 v1, s[12:15], 0 offen offset:0 lds
    ds_read_b64_tr_b16 v[132:133], v12 offset:0
    v_mfma_f32_16x16x32_bf16 v[48:51], v[168:171], v[164:167], v[48:51]
    buffer_load_dwordx4 v2, s[12:15], 0 offen offset:1024 lds
    ds_read_b64_tr_b16 v[134:135], v12 offset:512
    v_mfma_f32_16x16x32_bf16 v[52:55], v[172:175], v[148:151], v[52:55]
    buffer_load_dwordx4 v3, s[12:15], 0 offen offset:2048 lds
    v_mfma_f32_16x16x32_bf16 v[56:59], v[172:175], v[152:155], v[56:59]
    buffer_load_dwordx4 v4, s[12:15], 0 offen offset:3072 lds
    ds_read_b128 v[116:119], v8 offset:4096
    v_mfma_f32_16x16x32_bf16 v[60:63], v[172:175], v[156:159], v[60:63]
    s_add_u32 m0, s44, 114688
    ds_read_b128 v[120:123], v8 offset:8192
    v_mfma_f32_16x16x32_bf16 v[64:67], v[172:175], v[160:163], v[64:67]
    buffer_load_dwordx4 v5, s[12:15], 0 offen offset:0 lds
    ds_read_b128 v[124:127], v8 offset:12288
    v_mfma_f32_16x16x32_bf16 v[68:71], v[172:175], v[164:167], v[68:71]
    s_add_u32 m0, s45, 110592
    v_mfma_f32_16x16x32_bf16 v[72:75], v[176:179], v[148:151], v[72:75]
    buffer_load_dwordx4 v6, s[16:19], s24 offen offset:0 lds
    ds_read_b128 v[128:131], v8 offset:16384
    v_mfma_f32_16x16x32_bf16 v[76:79], v[176:179], v[152:155], v[76:79]
    buffer_load_dwordx4 v7, s[16:19], s25 offen offset:1024 lds
    ds_read_b64_tr_b16 v[136:137], v13 offset:0
    v_mfma_f32_16x16x32_bf16 v[80:83], v[176:179], v[156:159], v[80:83]
    buffer_load_dwordx4 v6, s[16:19], s26 offen offset:2048 lds
    v_mfma_f32_16x16x32_bf16 v[84:87], v[176:179], v[160:163], v[84:87]
    buffer_load_dwordx4 v7, s[16:19], s27 offen offset:3072 lds
    ds_read_b64_tr_b16 v[138:139], v13 offset:512
    v_mfma_f32_16x16x32_bf16 v[88:91], v[176:179], v[164:167], v[88:91]
    s_add_u32 s12, s12, 256
    ds_read_b64_tr_b16 v[140:141], v14 offset:0
    v_mfma_f32_16x16x32_bf16 v[92:95], v[180:183], v[148:151], v[92:95]
    s_addc_u32 s13, s13, 0
    ds_read_b64_tr_b16 v[142:143], v14 offset:512
    v_mfma_f32_16x16x32_bf16 v[96:99], v[180:183], v[152:155], v[96:99]
    s_sub_u32 s14, s14, 256
    v_mfma_f32_16x16x32_bf16 v[100:103], v[180:183], v[156:159], v[100:103]
    s_add_u32 s16, s16, 147456
    ds_read_b64_tr_b16 v[144:145], v15 offset:0
    v_mfma_f32_16x16x32_bf16 v[104:107], v[180:183], v[160:163], v[104:107]
    s_addc_u32 s17, s17, 0
    ds_read_b64_tr_b16 v[146:147], v15 offset:512
    v_mfma_f32_16x16x32_bf16 v[108:111], v[180:183], v[164:167], v[108:111]
    s_sub_u32 s18, s18, 147456
    s_add_u32 s48, s48, 1
    s_cmp_lt_u32 s48, 7
    s_cbranch_scc1 down_kernel_loop
    s_waitcnt lgkmcnt(0)
    v_mfma_f32_16x16x32_bf16 v[32:35], v[132:135], v[112:115], v[32:35]
    v_mfma_f32_16x16x32_bf16 v[36:39], v[132:135], v[116:119], v[36:39]
    s_waitcnt vmcnt(18)
    s_barrier
    v_mfma_f32_16x16x32_bf16 v[40:43], v[132:135], v[120:123], v[40:43]
    ds_read_b128 v[148:151], v9 offset:0
    v_mfma_f32_16x16x32_bf16 v[44:47], v[132:135], v[124:127], v[44:47]
    ds_read_b64_tr_b16 v[168:169], v16 offset:0
    v_mfma_f32_16x16x32_bf16 v[48:51], v[132:135], v[128:131], v[48:51]
    ds_read_b64_tr_b16 v[170:171], v16 offset:512
    v_mfma_f32_16x16x32_bf16 v[52:55], v[136:139], v[112:115], v[52:55]
    v_mfma_f32_16x16x32_bf16 v[56:59], v[136:139], v[116:119], v[56:59]
    ds_read_b128 v[152:155], v9 offset:4096
    v_mfma_f32_16x16x32_bf16 v[60:63], v[136:139], v[120:123], v[60:63]
    ds_read_b128 v[156:159], v9 offset:8192
    v_mfma_f32_16x16x32_bf16 v[64:67], v[136:139], v[124:127], v[64:67]
    ds_read_b128 v[160:163], v9 offset:12288
    v_mfma_f32_16x16x32_bf16 v[68:71], v[136:139], v[128:131], v[68:71]
    v_mfma_f32_16x16x32_bf16 v[72:75], v[140:143], v[112:115], v[72:75]
    ds_read_b128 v[164:167], v9 offset:16384
    v_mfma_f32_16x16x32_bf16 v[76:79], v[140:143], v[116:119], v[76:79]
    ds_read_b64_tr_b16 v[172:173], v17 offset:0
    v_mfma_f32_16x16x32_bf16 v[80:83], v[140:143], v[120:123], v[80:83]
    v_mfma_f32_16x16x32_bf16 v[84:87], v[140:143], v[124:127], v[84:87]
    ds_read_b64_tr_b16 v[174:175], v17 offset:512
    v_mfma_f32_16x16x32_bf16 v[88:91], v[140:143], v[128:131], v[88:91]
    ds_read_b64_tr_b16 v[176:177], v18 offset:0
    v_mfma_f32_16x16x32_bf16 v[92:95], v[144:147], v[112:115], v[92:95]
    ds_read_b64_tr_b16 v[178:179], v18 offset:512
    v_mfma_f32_16x16x32_bf16 v[96:99], v[144:147], v[116:119], v[96:99]
    v_mfma_f32_16x16x32_bf16 v[100:103], v[144:147], v[120:123], v[100:103]
    ds_read_b64_tr_b16 v[180:181], v19 offset:0
    v_mfma_f32_16x16x32_bf16 v[104:107], v[144:147], v[124:127], v[104:107]
    ds_read_b64_tr_b16 v[182:183], v19 offset:512
    v_mfma_f32_16x16x32_bf16 v[108:111], v[144:147], v[128:131], v[108:111]
    s_waitcnt lgkmcnt(0)
    v_mfma_f32_16x16x32_bf16 v[32:35], v[168:171], v[148:151], v[32:35]
    v_mfma_f32_16x16x32_bf16 v[36:39], v[168:171], v[152:155], v[36:39]
    s_waitcnt vmcnt(9)
    s_barrier
    v_mfma_f32_16x16x32_bf16 v[40:43], v[168:171], v[156:159], v[40:43]
    ds_read_b128 v[112:115], v10 offset:0
    v_mfma_f32_16x16x32_bf16 v[44:47], v[168:171], v[160:163], v[44:47]
    ds_read_b64_tr_b16 v[132:133], v20 offset:0
    v_mfma_f32_16x16x32_bf16 v[48:51], v[168:171], v[164:167], v[48:51]
    ds_read_b64_tr_b16 v[134:135], v20 offset:512
    v_mfma_f32_16x16x32_bf16 v[52:55], v[172:175], v[148:151], v[52:55]
    v_mfma_f32_16x16x32_bf16 v[56:59], v[172:175], v[152:155], v[56:59]
    ds_read_b128 v[116:119], v10 offset:4096
    v_mfma_f32_16x16x32_bf16 v[60:63], v[172:175], v[156:159], v[60:63]
    ds_read_b128 v[120:123], v10 offset:8192
    v_mfma_f32_16x16x32_bf16 v[64:67], v[172:175], v[160:163], v[64:67]
    ds_read_b128 v[124:127], v10 offset:12288
    v_mfma_f32_16x16x32_bf16 v[68:71], v[172:175], v[164:167], v[68:71]
    v_mfma_f32_16x16x32_bf16 v[72:75], v[176:179], v[148:151], v[72:75]
    ds_read_b128 v[128:131], v10 offset:16384
    v_mfma_f32_16x16x32_bf16 v[76:79], v[176:179], v[152:155], v[76:79]
    ds_read_b64_tr_b16 v[136:137], v21 offset:0
    v_mfma_f32_16x16x32_bf16 v[80:83], v[176:179], v[156:159], v[80:83]
    v_mfma_f32_16x16x32_bf16 v[84:87], v[176:179], v[160:163], v[84:87]
    ds_read_b64_tr_b16 v[138:139], v21 offset:512
    v_mfma_f32_16x16x32_bf16 v[88:91], v[176:179], v[164:167], v[88:91]
    ds_read_b64_tr_b16 v[140:141], v22 offset:0
    v_mfma_f32_16x16x32_bf16 v[92:95], v[180:183], v[148:151], v[92:95]
    ds_read_b64_tr_b16 v[142:143], v22 offset:512
    v_mfma_f32_16x16x32_bf16 v[96:99], v[180:183], v[152:155], v[96:99]
    v_mfma_f32_16x16x32_bf16 v[100:103], v[180:183], v[156:159], v[100:103]
    ds_read_b64_tr_b16 v[144:145], v23 offset:0
    v_mfma_f32_16x16x32_bf16 v[104:107], v[180:183], v[160:163], v[104:107]
    ds_read_b64_tr_b16 v[146:147], v23 offset:512
    v_mfma_f32_16x16x32_bf16 v[108:111], v[180:183], v[164:167], v[108:111]
    s_waitcnt lgkmcnt(0)
    v_mfma_f32_16x16x32_bf16 v[32:35], v[132:135], v[112:115], v[32:35]
    v_mfma_f32_16x16x32_bf16 v[36:39], v[132:135], v[116:119], v[36:39]
    s_waitcnt vmcnt(0)
    s_barrier
    v_mfma_f32_16x16x32_bf16 v[40:43], v[132:135], v[120:123], v[40:43]
    ds_read_b128 v[148:151], v11 offset:0
    v_mfma_f32_16x16x32_bf16 v[44:47], v[132:135], v[124:127], v[44:47]
    ds_read_b64_tr_b16 v[168:169], v24 offset:0
    v_mfma_f32_16x16x32_bf16 v[48:51], v[132:135], v[128:131], v[48:51]
    ds_read_b64_tr_b16 v[170:171], v24 offset:512
    v_mfma_f32_16x16x32_bf16 v[52:55], v[136:139], v[112:115], v[52:55]
    v_mfma_f32_16x16x32_bf16 v[56:59], v[136:139], v[116:119], v[56:59]
    ds_read_b128 v[152:155], v11 offset:4096
    v_mfma_f32_16x16x32_bf16 v[60:63], v[136:139], v[120:123], v[60:63]
    ds_read_b128 v[156:159], v11 offset:8192
    v_mfma_f32_16x16x32_bf16 v[64:67], v[136:139], v[124:127], v[64:67]
    ds_read_b128 v[160:163], v11 offset:12288
    v_mfma_f32_16x16x32_bf16 v[68:71], v[136:139], v[128:131], v[68:71]
    v_mfma_f32_16x16x32_bf16 v[72:75], v[140:143], v[112:115], v[72:75]
    ds_read_b128 v[164:167], v11 offset:16384
    v_mfma_f32_16x16x32_bf16 v[76:79], v[140:143], v[116:119], v[76:79]
    ds_read_b64_tr_b16 v[172:173], v25 offset:0
    v_mfma_f32_16x16x32_bf16 v[80:83], v[140:143], v[120:123], v[80:83]
    v_mfma_f32_16x16x32_bf16 v[84:87], v[140:143], v[124:127], v[84:87]
    ds_read_b64_tr_b16 v[174:175], v25 offset:512
    v_mfma_f32_16x16x32_bf16 v[88:91], v[140:143], v[128:131], v[88:91]
    ds_read_b64_tr_b16 v[176:177], v26 offset:0
    v_mfma_f32_16x16x32_bf16 v[92:95], v[144:147], v[112:115], v[92:95]
    ds_read_b64_tr_b16 v[178:179], v26 offset:512
    v_mfma_f32_16x16x32_bf16 v[96:99], v[144:147], v[116:119], v[96:99]
    v_mfma_f32_16x16x32_bf16 v[100:103], v[144:147], v[120:123], v[100:103]
    ds_read_b64_tr_b16 v[180:181], v27 offset:0
    v_mfma_f32_16x16x32_bf16 v[104:107], v[144:147], v[124:127], v[104:107]
    ds_read_b64_tr_b16 v[182:183], v27 offset:512
    v_mfma_f32_16x16x32_bf16 v[108:111], v[144:147], v[128:131], v[108:111]
    s_waitcnt lgkmcnt(10)
    v_mfma_f32_16x16x32_bf16 v[32:35], v[168:171], v[148:151], v[32:35]
    s_waitcnt lgkmcnt(9)
    v_mfma_f32_16x16x32_bf16 v[36:39], v[168:171], v[152:155], v[36:39]
    s_waitcnt lgkmcnt(8)
    v_mfma_f32_16x16x32_bf16 v[40:43], v[168:171], v[156:159], v[40:43]
    s_waitcnt lgkmcnt(7)
    v_mfma_f32_16x16x32_bf16 v[44:47], v[168:171], v[160:163], v[44:47]
    s_waitcnt lgkmcnt(6)
    v_mfma_f32_16x16x32_bf16 v[48:51], v[168:171], v[164:167], v[48:51]
    s_waitcnt lgkmcnt(4)
    v_mfma_f32_16x16x32_bf16 v[52:55], v[172:175], v[148:151], v[52:55]
    v_mfma_f32_16x16x32_bf16 v[56:59], v[172:175], v[152:155], v[56:59]
    v_mfma_f32_16x16x32_bf16 v[60:63], v[172:175], v[156:159], v[60:63]
    v_mfma_f32_16x16x32_bf16 v[64:67], v[172:175], v[160:163], v[64:67]
    v_mfma_f32_16x16x32_bf16 v[68:71], v[172:175], v[164:167], v[68:71]
    s_waitcnt lgkmcnt(2)
    v_mfma_f32_16x16x32_bf16 v[72:75], v[176:179], v[148:151], v[72:75]
    v_mfma_f32_16x16x32_bf16 v[76:79], v[176:179], v[152:155], v[76:79]
    v_mfma_f32_16x16x32_bf16 v[80:83], v[176:179], v[156:159], v[80:83]
    v_mfma_f32_16x16x32_bf16 v[84:87], v[176:179], v[160:163], v[84:87]
    v_mfma_f32_16x16x32_bf16 v[88:91], v[176:179], v[164:167], v[88:91]
    s_waitcnt lgkmcnt(0)
    v_mfma_f32_16x16x32_bf16 v[92:95], v[180:183], v[148:151], v[92:95]
    v_mfma_f32_16x16x32_bf16 v[96:99], v[180:183], v[152:155], v[96:99]
    v_mfma_f32_16x16x32_bf16 v[100:103], v[180:183], v[156:159], v[100:103]
    v_mfma_f32_16x16x32_bf16 v[104:107], v[180:183], v[160:163], v[104:107]
    v_mfma_f32_16x16x32_bf16 v[108:111], v[180:183], v[164:167], v[108:111]
    s_barrier
    v_lshlrev_b32 v240, 4, v237
    s_mul_i32 s40, s36, 20480
    v_add_u32 v241, s40, v240
    s_mul_i32 s40, s36, 5120
    v_add_u32 v242, s40, v240
    ds_write_b128 v241, v[32:35] offset:0
    ds_write_b128 v241, v[36:39] offset:1024
    ds_write_b128 v241, v[40:43] offset:2048
    ds_write_b128 v241, v[44:47] offset:3072
    ds_write_b128 v241, v[48:51] offset:4096
    ds_write_b128 v241, v[52:55] offset:5120
    ds_write_b128 v241, v[56:59] offset:6144
    ds_write_b128 v241, v[60:63] offset:7168
    ds_write_b128 v241, v[64:67] offset:8192
    ds_write_b128 v241, v[68:71] offset:9216
    ds_write_b128 v241, v[72:75] offset:10240
    ds_write_b128 v241, v[76:79] offset:11264
    ds_write_b128 v241, v[80:83] offset:12288
    ds_write_b128 v241, v[84:87] offset:13312
    ds_write_b128 v241, v[88:91] offset:14336
    ds_write_b128 v241, v[92:95] offset:15360
    ds_write_b128 v241, v[96:99] offset:16384
    ds_write_b128 v241, v[100:103] offset:17408
    ds_write_b128 v241, v[104:107] offset:18432
    ds_write_b128 v241, v[108:111] offset:19456
    s_waitcnt lgkmcnt(0)
    s_barrier
    v_add_u32 v241, 40960, v242
    ds_read_b128 v[112:115], v242 offset:0
    ds_read_b128 v[116:119], v242 offset:1024
    ds_read_b128 v[120:123], v242 offset:2048
    ds_read_b128 v[124:127], v242 offset:3072
    ds_read_b128 v[128:131], v242 offset:4096
    ds_read_b128 v[132:135], v242 offset:20480
    ds_read_b128 v[136:139], v242 offset:21504
    ds_read_b128 v[140:143], v242 offset:22528
    ds_read_b128 v[144:147], v242 offset:23552
    ds_read_b128 v[148:151], v242 offset:24576
    ds_read_b128 v[152:155], v241 offset:0
    ds_read_b128 v[156:159], v241 offset:1024
    ds_read_b128 v[160:163], v241 offset:2048
    ds_read_b128 v[164:167], v241 offset:3072
    ds_read_b128 v[168:171], v241 offset:4096
    ds_read_b128 v[172:175], v241 offset:20480
    ds_read_b128 v[176:179], v241 offset:21504
    ds_read_b128 v[180:183], v241 offset:22528
    ds_read_b128 v[184:187], v241 offset:23552
    ds_read_b128 v[188:191], v241 offset:24576
    s_waitcnt lgkmcnt(14)
    v_add_f32 v32, v112, v132
    s_waitcnt lgkmcnt(4)
    v_add_f32 v152, v152, v172
    v_add_f32 v32, v32, v152
    v_add_f32 v33, v113, v133
    v_add_f32 v153, v153, v173
    v_add_f32 v33, v33, v153
    v_add_f32 v34, v114, v134
    v_add_f32 v154, v154, v174
    v_add_f32 v34, v34, v154
    v_add_f32 v35, v115, v135
    v_add_f32 v155, v155, v175
    v_add_f32 v35, v35, v155
    v_add_f32 v36, v116, v136
    s_waitcnt lgkmcnt(3)
    v_add_f32 v156, v156, v176
    v_add_f32 v36, v36, v156
    v_add_f32 v37, v117, v137
    v_add_f32 v157, v157, v177
    v_add_f32 v37, v37, v157
    v_add_f32 v38, v118, v138
    v_add_f32 v158, v158, v178
    v_add_f32 v38, v38, v158
    v_add_f32 v39, v119, v139
    v_add_f32 v159, v159, v179
    v_add_f32 v39, v39, v159
    v_add_f32 v40, v120, v140
    s_waitcnt lgkmcnt(2)
    v_add_f32 v160, v160, v180
    v_add_f32 v40, v40, v160
    v_add_f32 v41, v121, v141
    v_add_f32 v161, v161, v181
    v_add_f32 v41, v41, v161
    v_add_f32 v42, v122, v142
    v_add_f32 v162, v162, v182
    v_add_f32 v42, v42, v162
    v_add_f32 v43, v123, v143
    v_add_f32 v163, v163, v183
    v_add_f32 v43, v43, v163
    v_add_f32 v44, v124, v144
    s_waitcnt lgkmcnt(0)
    v_add_f32 v164, v164, v184
    v_add_f32 v44, v44, v164
    v_add_f32 v45, v125, v145
    v_add_f32 v165, v165, v185
    v_add_f32 v45, v45, v165
    v_add_f32 v46, v126, v146
    v_add_f32 v166, v166, v186
    v_add_f32 v46, v46, v166
    v_add_f32 v47, v127, v147
    v_add_f32 v167, v167, v187
    v_add_f32 v47, v47, v167
    v_add_f32 v48, v128, v148
    v_add_f32 v168, v168, v188
    v_add_f32 v48, v48, v168
    v_add_f32 v49, v129, v149
    v_add_f32 v169, v169, v189
    v_add_f32 v49, v49, v169
    v_add_f32 v50, v130, v150
    v_add_f32 v170, v170, v190
    v_add_f32 v50, v50, v170
    v_add_f32 v51, v131, v151
    v_add_f32 v171, v171, v191
    v_add_f32 v51, v51, v171
    v_cvt_pk_bf16_f32 v243, v32, v33
    v_lshlrev_b32 v32, 16, v243
    v_and_b32 v33, 0xffff0000, v243
    v_mul_f32 v32, v32, v212
    v_mul_f32 v33, v33, v213
    v_cvt_pk_bf16_f32 v243, v32, v33
    v_lshlrev_b32 v32, 16, v243
    v_and_b32 v33, 0xffff0000, v243
    v_lshlrev_b32 v243, 16, v200
    v_and_b32 v244, 0xffff0000, v200
    v_add_f32 v32, v32, v243
    v_add_f32 v33, v33, v244
    v_cvt_pk_bf16_f32 v200, v32, v33
    v_cvt_pk_bf16_f32 v243, v34, v35
    v_lshlrev_b32 v34, 16, v243
    v_and_b32 v35, 0xffff0000, v243
    v_mul_f32 v34, v34, v214
    v_mul_f32 v35, v35, v215
    v_cvt_pk_bf16_f32 v243, v34, v35
    v_lshlrev_b32 v34, 16, v243
    v_and_b32 v35, 0xffff0000, v243
    v_lshlrev_b32 v243, 16, v201
    v_and_b32 v244, 0xffff0000, v201
    v_add_f32 v34, v34, v243
    v_add_f32 v35, v35, v244
    v_cvt_pk_bf16_f32 v201, v34, v35
    buffer_store_dwordx2 v[200:201], v28, s[28:31], s32 offen
    v_cvt_pk_bf16_f32 v243, v36, v37
    v_lshlrev_b32 v36, 16, v243
    v_and_b32 v37, 0xffff0000, v243
    v_mul_f32 v36, v36, v212
    v_mul_f32 v37, v37, v213
    v_cvt_pk_bf16_f32 v243, v36, v37
    v_lshlrev_b32 v36, 16, v243
    v_and_b32 v37, 0xffff0000, v243
    v_lshlrev_b32 v243, 16, v202
    v_and_b32 v244, 0xffff0000, v202
    v_add_f32 v36, v36, v243
    v_add_f32 v37, v37, v244
    v_cvt_pk_bf16_f32 v202, v36, v37
    v_cvt_pk_bf16_f32 v243, v38, v39
    v_lshlrev_b32 v38, 16, v243
    v_and_b32 v39, 0xffff0000, v243
    v_mul_f32 v38, v38, v214
    v_mul_f32 v39, v39, v215
    v_cvt_pk_bf16_f32 v243, v38, v39
    v_lshlrev_b32 v38, 16, v243
    v_and_b32 v39, 0xffff0000, v243
    v_lshlrev_b32 v243, 16, v203
    v_and_b32 v244, 0xffff0000, v203
    v_add_f32 v38, v38, v243
    v_add_f32 v39, v39, v244
    v_cvt_pk_bf16_f32 v203, v38, v39
    buffer_store_dwordx2 v[202:203], v28, s[28:31], s33 offen
    v_cvt_pk_bf16_f32 v243, v40, v41
    v_lshlrev_b32 v40, 16, v243
    v_and_b32 v41, 0xffff0000, v243
    v_mul_f32 v40, v40, v212
    v_mul_f32 v41, v41, v213
    v_cvt_pk_bf16_f32 v243, v40, v41
    v_lshlrev_b32 v40, 16, v243
    v_and_b32 v41, 0xffff0000, v243
    v_lshlrev_b32 v243, 16, v204
    v_and_b32 v244, 0xffff0000, v204
    v_add_f32 v40, v40, v243
    v_add_f32 v41, v41, v244
    v_cvt_pk_bf16_f32 v204, v40, v41
    v_cvt_pk_bf16_f32 v243, v42, v43
    v_lshlrev_b32 v42, 16, v243
    v_and_b32 v43, 0xffff0000, v243
    v_mul_f32 v42, v42, v214
    v_mul_f32 v43, v43, v215
    v_cvt_pk_bf16_f32 v243, v42, v43
    v_lshlrev_b32 v42, 16, v243
    v_and_b32 v43, 0xffff0000, v243
    v_lshlrev_b32 v243, 16, v205
    v_and_b32 v244, 0xffff0000, v205
    v_add_f32 v42, v42, v243
    v_add_f32 v43, v43, v244
    v_cvt_pk_bf16_f32 v205, v42, v43
    buffer_store_dwordx2 v[204:205], v28, s[28:31], s34 offen
    v_cvt_pk_bf16_f32 v243, v44, v45
    v_lshlrev_b32 v44, 16, v243
    v_and_b32 v45, 0xffff0000, v243
    v_mul_f32 v44, v44, v212
    v_mul_f32 v45, v45, v213
    v_cvt_pk_bf16_f32 v243, v44, v45
    v_lshlrev_b32 v44, 16, v243
    v_and_b32 v45, 0xffff0000, v243
    v_lshlrev_b32 v243, 16, v206
    v_and_b32 v244, 0xffff0000, v206
    v_add_f32 v44, v44, v243
    v_add_f32 v45, v45, v244
    v_cvt_pk_bf16_f32 v206, v44, v45
    v_cvt_pk_bf16_f32 v243, v46, v47
    v_lshlrev_b32 v46, 16, v243
    v_and_b32 v47, 0xffff0000, v243
    v_mul_f32 v46, v46, v214
    v_mul_f32 v47, v47, v215
    v_cvt_pk_bf16_f32 v243, v46, v47
    v_lshlrev_b32 v46, 16, v243
    v_and_b32 v47, 0xffff0000, v243
    v_lshlrev_b32 v243, 16, v207
    v_and_b32 v244, 0xffff0000, v207
    v_add_f32 v46, v46, v243
    v_add_f32 v47, v47, v244
    v_cvt_pk_bf16_f32 v207, v46, v47
    buffer_store_dwordx2 v[206:207], v28, s[28:31], s35 offen
    v_cvt_pk_bf16_f32 v243, v48, v49
    v_lshlrev_b32 v48, 16, v243
    v_and_b32 v49, 0xffff0000, v243
    v_mul_f32 v48, v48, v212
    v_mul_f32 v49, v49, v213
    v_cvt_pk_bf16_f32 v243, v48, v49
    v_lshlrev_b32 v48, 16, v243
    v_and_b32 v49, 0xffff0000, v243
    v_lshlrev_b32 v243, 16, v208
    v_and_b32 v244, 0xffff0000, v208
    v_add_f32 v48, v48, v243
    v_add_f32 v49, v49, v244
    v_cvt_pk_bf16_f32 v208, v48, v49
    v_cvt_pk_bf16_f32 v243, v50, v51
    v_lshlrev_b32 v50, 16, v243
    v_and_b32 v51, 0xffff0000, v243
    v_mul_f32 v50, v50, v214
    v_mul_f32 v51, v51, v215
    v_cvt_pk_bf16_f32 v243, v50, v51
    v_lshlrev_b32 v50, 16, v243
    v_and_b32 v51, 0xffff0000, v243
    v_lshlrev_b32 v243, 16, v209
    v_and_b32 v244, 0xffff0000, v209
    v_add_f32 v50, v50, v243
    v_add_f32 v51, v51, v244
    v_cvt_pk_bf16_f32 v209, v50, v51
    buffer_store_dwordx2 v[208:209], v28, s[28:31], s49 offen
down_kernel_end:
    s_endpgm
.section .rodata,"a"
.p2align 6
.amdhsa_kernel mod_kernel
  .amdhsa_next_free_vgpr 80
  .amdhsa_next_free_sgpr 48
  .amdhsa_accum_offset 80
  .amdhsa_group_segment_fixed_size 0
  .amdhsa_kernarg_size 112
  .amdhsa_user_sgpr_count 2
  .amdhsa_user_sgpr_kernarg_segment_ptr 1
  .amdhsa_system_sgpr_workgroup_id_x 1
  .amdhsa_float_denorm_mode_32 3
.end_amdhsa_kernel
.p2align 6
.amdhsa_kernel ln1_kernel
  .amdhsa_next_free_vgpr 192
  .amdhsa_next_free_sgpr 72
  .amdhsa_accum_offset 192
  .amdhsa_group_segment_fixed_size 0
  .amdhsa_kernarg_size 112
  .amdhsa_user_sgpr_count 2
  .amdhsa_user_sgpr_kernarg_segment_ptr 1
  .amdhsa_system_sgpr_workgroup_id_x 1
  .amdhsa_float_denorm_mode_32 3
.end_amdhsa_kernel
.p2align 6
.amdhsa_kernel attn_kernel
  .amdhsa_next_free_vgpr 512
  .amdhsa_next_free_sgpr 96
  .amdhsa_accum_offset 256
  .amdhsa_group_segment_fixed_size 0
  .amdhsa_kernarg_size 112
  .amdhsa_user_sgpr_count 2
  .amdhsa_user_sgpr_kernarg_segment_ptr 1
  .amdhsa_system_sgpr_workgroup_id_x 1
  .amdhsa_float_denorm_mode_32 3
.end_amdhsa_kernel
.p2align 6
.amdhsa_kernel oproj_kernel
  .amdhsa_next_free_vgpr 248
  .amdhsa_next_free_sgpr 72
  .amdhsa_accum_offset 248
  .amdhsa_group_segment_fixed_size 0
  .amdhsa_kernarg_size 112
  .amdhsa_user_sgpr_count 2
  .amdhsa_user_sgpr_kernarg_segment_ptr 1
  .amdhsa_system_sgpr_workgroup_id_x 1
  .amdhsa_float_denorm_mode_32 3
.end_amdhsa_kernel
.p2align 6
.amdhsa_kernel glu_kernel
  .amdhsa_next_free_vgpr 456
  .amdhsa_next_free_sgpr 80
  .amdhsa_accum_offset 256
  .amdhsa_group_segment_fixed_size 0
  .amdhsa_kernarg_size 112
  .amdhsa_user_sgpr_count 2
  .amdhsa_user_sgpr_kernarg_segment_ptr 1
  .amdhsa_system_sgpr_workgroup_id_x 1
  .amdhsa_float_denorm_mode_32 3
.end_amdhsa_kernel
.p2align 6
.amdhsa_kernel down_kernel
  .amdhsa_next_free_vgpr 248
  .amdhsa_next_free_sgpr 72
  .amdhsa_accum_offset 248
  .amdhsa_group_segment_fixed_size 0
  .amdhsa_kernarg_size 112
  .amdhsa_user_sgpr_count 2
  .amdhsa_user_sgpr_kernarg_segment_ptr 1
  .amdhsa_system_sgpr_workgroup_id_x 1
  .amdhsa_float_denorm_mode_32 3
.end_amdhsa_kernel
```
